```python
import torch

def _softmax(x, axis=-1):
    return torch.softmax(x, dim=axis)
def _gelu(x):
    return torch.nn.functional.gelu(x, approximate="tanh")
def _silu(x):
    return torch.nn.functional.silu(x)
def _sigmoid(x):
    return torch.sigmoid(x)
def _layernorm(x, axis=-1, eps=1e-5):
    m = x.mean(dim=axis, keepdim=True)
    v = x.var(dim=axis, keepdim=True, unbiased=False)
    return (x - m) / torch.sqrt(v + eps)
def _scatter_add(tgt, idx, src, axis=0):
    return tgt.clone().index_add_(axis, idx, src)
def _segment_sum(src, seg, n):
    out = torch.zeros((n,) + src.shape[1:], dtype=src.dtype)
    return out.index_add_(0, seg, src)
def _pad(x, pw):
    flat = tuple(v for pair in reversed(pw) for v in pair)
    return torch.nn.functional.pad(x, flat)

kernel_name = 'recurrent_scan__linear_kernel_hedgehog__dense_activation_mish__prompt'

def setup_inputs():

    _w = (lambda a: (lambda t: t.to(torch.bfloat16) if t.is_floating_point() else t)(torch.as_tensor(a)))
    def _A_setup():
        B, S, D, H = 1, 2048, 1024, 32
        Dh = D // H
        return {
            "x": _w((lambda *s: torch.randn(*s, dtype=torch.bfloat16) * 0.05)(B, S, D)),
            "wqkv": _w((lambda *s: torch.randn(*s, dtype=torch.bfloat16) * 0.2)(D, 3 * D)),
            "w_phi": _w((lambda *s: torch.randn(*s, dtype=torch.bfloat16) * 0.2)(H, Dh, Dh) * (Dh ** -0.5)),
            "wo": _w((lambda *s: torch.randn(*s, dtype=torch.bfloat16) * 0.2)(D, D)),
        }
    _A_in = _A_setup()

    def _B_setup():
        B, S, D, F = 1, 2048, 1024, 3584
        return {
            "x": _w((lambda *s: torch.randn(*s, dtype=torch.bfloat16) * 0.05)(B, S, D)),
            "w1": _w((lambda *s: torch.randn(*s, dtype=torch.bfloat16) * 0.4)(D, F) * (D ** -0.5)),
            "b1": _w((lambda *s: torch.randn(*s, dtype=torch.bfloat16) * 0.2)(F)),
            "w2": _w((lambda *s: torch.randn(*s, dtype=torch.bfloat16) * 0.1)(F, D) * (F ** -0.5)),
        }
    _B_in = _B_setup()

    return {
        "A_x": _A_in["x"],
        "A_wqkv": _A_in["wqkv"],
        "A_w_phi": _A_in["w_phi"],
        "A_wo": _A_in["wo"],
        "B_x": _B_in["x"],
        "B_w1": _B_in["w1"],
        "B_b1": _B_in["b1"],
        "B_w2": _B_in["w2"],
    }

def reference(A_x, A_wqkv, A_w_phi, A_wo, B_x, B_w1, B_b1, B_w2):
    def _A_ref(x, wqkv, w_phi, wo):
        B, S, D = x.shape
        H = 32; Dh = D // H
        qkv = (lambda x, *d: x.permute(*d))((x @ wqkv).reshape(B, S, 3, H, Dh), 2, 0, 3, 1, 4)
        q, k, v = qkv[0], qkv[1], qkv[2]
        pq = torch.einsum("bhsd,hdf->bhsf", q, w_phi)
        pk = torch.einsum("bhsd,hdf->bhsf", k, w_phi)
        phi_q = torch.concatenate([_softmax(pq, axis=-1), _softmax(-pq, axis=-1)], axis=-1)
        phi_k = torch.concatenate([_softmax(pk, axis=-1), _softmax(-pk, axis=-1)], axis=-1)
        kv = torch.einsum("bhsf,bhsd->bhfd", phi_k, v)
        z  = torch.einsum("bhsf->bhf", phi_k)
        num = torch.einsum("bhqf,bhfd->bhqd", phi_q, kv)
        den = torch.einsum("bhqf,bhf->bhq", phi_q, z)[..., None] + 1e-6
        o = num / den
        return (lambda x, *d: x.permute(*d))(o, 0, 2, 1, 3).reshape(B, S, D) @ wo

    def _B_ref(x, w1, b1, w2):
        h = torch.einsum("bsd,df->bsf", x, w1) + b1
        sp = torch.log1p(torch.exp(-torch.abs(h))) + torch.where(h > 0, h, torch.zeros_like(h))
        act = h * torch.tanh(sp)
        return torch.einsum("bsf,fd->bsd", act, w2)

    x = A_x
    xn = _layernorm(x, axis=-1)
    s = _A_ref(xn, A_wqkv, A_w_phi, A_wo)
    g = _silu(_B_ref(xn, B_w1, B_b1, B_w2))
    return x + s * g
```

```asm
; @launch grid=(256,1,1) block=(512,1,1) lds=163840
.amdgcn_target "amdgcn-amd-amdhsa--gfx950"
.text
.globl recurrent_scan__linear_kernel_hedgehog__dense_activation_mish__prompt_kernel
.p2align 8
.type recurrent_scan__linear_kernel_hedgehog__dense_activation_mish__prompt_kernel,@function
recurrent_scan__linear_kernel_hedgehog__dense_activation_mish__prompt_kernel:
    s_cmp_ge_u32 s2, 256
    s_cbranch_scc1 L_k1_exit
    s_load_dwordx4 s[4:7], s[0:1], 0
    s_load_dwordx4 s[12:15], s[0:1], 40
    s_load_dwordx4 s[16:19], s[0:1], 72
    s_load_dwordx2 s[8:9], s[0:1], 16
    s_load_dwordx2 s[92:93], s[0:1], 24
    s_load_dwordx2 s[88:89], s[0:1], 56
    v_and_b32 v1, 63, v0
    v_lshrrev_b32 v15, 6, v0
    s_nop 0
    v_readfirstlane_b32 s42, v15
    s_and_b32 s50, s2, 1
    s_lshl_b32 s47, s50, 3
    s_lshl_b32 s50, s50, 2
    s_bfe_u32 s86, s2, 0x20003
    s_add_u32 s40, s86, s50
    s_bfe_u32 s50, s2, 0x20001
    s_lshl_b32 s50, s50, 2
    s_lshr_b32 s41, s2, 6
    s_add_u32 s41, s41, s50
    s_and_b32 s43, s42, 3
    s_lshr_b32 s44, s42, 2
    s_lshl_b32 s48, s43, 10
    s_getpc_b64 s[52:53]
L_pc0:
    s_sub_u32 s52, s52, L_pc0-recurrent_scan__linear_kernel_hedgehog__dense_activation_mish__prompt_kernel
    s_subb_u32 s53, s53, 0
    s_and_b32 s50, s2, 0xf8
    s_add_u32 s50, s50, s42
    v_lshlrev_b32 v15, 15, v1
    s_lshl_b32 s50, s50, 7
    v_add_u32 v15, s50, v15
    v_cmp_gt_u32 vcc, L_code_end-recurrent_scan__linear_kernel_hedgehog__dense_activation_mish__prompt_kernel-128, v15
    s_nop 0
    s_and_b64 exec, vcc, 15
    global_load_dword v247, v15, s[52:53]
    s_mov_b64 exec, -1
    s_waitcnt lgkmcnt(0)
    s_mov_b32 s20, s4
    s_and_b32 s21, s5, 0xffff
    s_mov_b32 s22, 0x400000
    s_mov_b32 s23, 0x00020000
    s_bfe_u32 s50, s2, 0x10005
    s_lshl_b32 s50, s50, 1
    s_add_u32 s50, s50, s44
    s_cmp_eq_u32 s50, 1
    s_cbranch_scc1 L_k1_p1
    s_cmp_eq_u32 s50, 2
    s_cbranch_scc1 L_k1_p2
    s_cmp_eq_u32 s50, 3
    s_cbranch_scc1 L_k1_p3
    s_mov_b32 s24, s6
    s_and_b32 s25, s7, 0xffff
    s_mov_b32 s26, 0x600000
    s_mov_b32 s27, 0x00020000
    v_lshrrev_b32 v15, 3, v1
    s_lshl_b32 s50, s43, 3
    v_add_u32 v15, s50, v15
    s_mov_b32 s51, 6144
    v_mul_lo_u32 v2, v15, s51
    v_bfe_u32 v15, v1, 4, 1
    s_and_b32 s50, s43, 1
    s_lshl_b32 s50, s50, 1
    v_or_b32 v15, s50, v15
    v_lshlrev_b32 v15, 1, v15
    v_and_b32 v28, 7, v1
    v_xor_b32 v15, v15, v28
    v_lshl_add_u32 v2, v15, 4, v2
    s_lshl_b32 s50, s41, 7
    v_add_u32 v2, s50, v2
    v_add_u32 v3, 196608, v2
    v_add_u32 v4, 0x1000, v2
    v_add_u32 v5, 0x1000, v3
    s_mul_i32 s46, s47, 393216
    s_lshl_b32 s50, s2, 3
    s_add_u32 s50, s50, s42
    s_lshl_b32 s50, s50, 11
    v_lshlrev_b32 v15, 4, v1
    buffer_load_dwordx4 v[232:235], v15, s[20:23], s50 offen
    buffer_load_dwordx4 v[236:239], v15, s[20:23], s50 offen offset:1024
    s_add_u32 m0, s48, 98304
    s_nop 0
    buffer_load_dwordx4 v2, s[24:27], s46 offen  lds
    s_add_u32 m0, s48, 102400
    s_nop 0
    buffer_load_dwordx4 v3, s[24:27], s46 offen  lds
    s_add_u32 m0, s48, 104448
    s_nop 0
    buffer_load_dwordx4 v2, s[24:27], s46 offen offset:2048  lds
    s_add_u32 m0, s48, 108544
    s_nop 0
    buffer_load_dwordx4 v3, s[24:27], s46 offen offset:2048  lds
    s_add_u32 m0, s48, 114688
    s_nop 0
    buffer_load_dwordx4 v4, s[24:27], s46 offen  lds
    s_add_u32 m0, s48, 118784
    s_nop 0
    buffer_load_dwordx4 v5, s[24:27], s46 offen  lds
    s_add_u32 s47, s47, 1
    s_and_b32 s47, s47, 15
    s_mul_i32 s46, s47, 393216
    s_mov_b32 s28, s18
    s_and_b32 s29, s19, 0xffff
    s_mov_b32 s30, 0x10000000
    s_mov_b32 s31, 0x00020000
    v_lshlrev_b32 v15, 4, v1
    s_mov_b32 s36, s8
    s_and_b32 s37, s9, 0xffff
    s_mov_b32 s38, 0x10000
    s_mov_b32 s39, 0x00020000
    s_lshl_b32 s51, s41, 12
    s_add_u32 s51, s51, s48
    s_add_u32 m0, s48, 122880
    v_lshlrev_b32 v15, 4, v1
    buffer_load_dwordx4 v15, s[36:39], s51 offen lds
    s_mov_b32 s32, s16
    s_and_b32 s33, s17, 0xffff
    s_mov_b32 s34, 0x100
    s_mov_b32 s35, 0x00020000
    v_mov_b32 v16, 0x3f803f80
    v_mov_b32 v17, 0x3f803f80
    v_mov_b32 v18, 0x3f803f80
    v_mov_b32 v19, 0x3f803f80
    v_mov_b32 v20, 0
    v_mov_b32 v21, 0
    v_mov_b32 v22, 0
    v_mov_b32 v23, 0
    v_mov_b32 v24, 0
    v_mov_b32 v25, 0
    v_mov_b32 v26, 0
    v_mov_b32 v27, 0
    v_and_b32 v15, 15, v1
    s_lshl_b32 s50, s43, 6
    v_add_u32 v15, s50, v15
    v_lshlrev_b32 v6, 7, v15
    v_bfe_u32 v15, v1, 1, 3
    v_lshrrev_b32 v28, 4, v1
    v_xor_b32 v15, v15, v28
    v_lshl_add_u32 v6, v15, 4, v6
    s_mov_b32 s80, 0
    v_lshrrev_b32 v15, 4, v1
    v_lshlrev_b32 v15, 3, v15
    v_bfe_u32 v28, v1, 2, 2
    v_add_u32 v15, v15, v28
    v_lshlrev_b32 v15, 7, v15
    v_and_b32 v28, 3, v1
    v_lshl_add_u32 v15, v28, 3, v15
    v_add_u32 v15, 98304, v15
    v_bfe_u32 v28, v1, 3, 2
    v_xor_b32 v10, 0, v28
    v_lshl_add_u32 v10, v10, 5, v15
    v_xor_b32 v11, 1, v28
    v_lshl_add_u32 v11, v11, 5, v15
    v_mov_b32 v32, 0
    v_mov_b32 v33, 0
    v_mov_b32 v34, 0
    v_mov_b32 v35, 0
    v_mov_b32 v36, 0
    v_mov_b32 v37, 0
    v_mov_b32 v38, 0
    v_mov_b32 v39, 0
    v_mov_b32 v40, 0
    v_mov_b32 v41, 0
    v_mov_b32 v42, 0
    v_mov_b32 v43, 0
    v_mov_b32 v44, 0
    v_mov_b32 v45, 0
    v_mov_b32 v46, 0
    v_mov_b32 v47, 0
    v_mov_b32 v48, 0
    v_mov_b32 v49, 0
    v_mov_b32 v50, 0
    v_mov_b32 v51, 0
    v_mov_b32 v52, 0
    v_mov_b32 v53, 0
    v_mov_b32 v54, 0
    v_mov_b32 v55, 0
    v_mov_b32 v56, 0
    v_mov_b32 v57, 0
    v_mov_b32 v58, 0
    v_mov_b32 v59, 0
    v_mov_b32 v60, 0
    v_mov_b32 v61, 0
    v_mov_b32 v62, 0
    v_mov_b32 v63, 0
    v_mov_b32 v64, 0
    v_mov_b32 v65, 0
    v_mov_b32 v66, 0
    v_mov_b32 v67, 0
    v_mov_b32 v68, 0
    v_mov_b32 v69, 0
    v_mov_b32 v70, 0
    v_mov_b32 v71, 0
    v_mov_b32 v72, 0
    v_mov_b32 v73, 0
    v_mov_b32 v74, 0
    v_mov_b32 v75, 0
    v_mov_b32 v76, 0
    v_mov_b32 v77, 0
    v_mov_b32 v78, 0
    v_mov_b32 v79, 0
    v_mov_b32 v80, 0
    v_mov_b32 v81, 0
    v_mov_b32 v82, 0
    v_mov_b32 v83, 0
    v_mov_b32 v84, 0
    v_mov_b32 v85, 0
    v_mov_b32 v86, 0
    v_mov_b32 v87, 0
    v_mov_b32 v88, 0
    v_mov_b32 v89, 0
    v_mov_b32 v90, 0
    v_mov_b32 v91, 0
    v_mov_b32 v92, 0
    v_mov_b32 v93, 0
    v_mov_b32 v94, 0
    v_mov_b32 v95, 0
    v_mov_b32 v96, 0
    v_mov_b32 v97, 0
    v_mov_b32 v98, 0
    v_mov_b32 v99, 0
    v_mov_b32 v100, 0
    v_mov_b32 v101, 0
    v_mov_b32 v102, 0
    v_mov_b32 v103, 0
    v_mov_b32 v104, 0
    v_mov_b32 v105, 0
    v_mov_b32 v106, 0
    v_mov_b32 v107, 0
    v_mov_b32 v108, 0
    v_mov_b32 v109, 0
    v_mov_b32 v110, 0
    v_mov_b32 v111, 0
    v_mov_b32 v112, 0
    v_mov_b32 v113, 0
    v_mov_b32 v114, 0
    v_mov_b32 v115, 0
    v_mov_b32 v116, 0
    v_mov_b32 v117, 0
    v_mov_b32 v118, 0
    v_mov_b32 v119, 0
    v_mov_b32 v120, 0
    v_mov_b32 v121, 0
    v_mov_b32 v122, 0
    v_mov_b32 v123, 0
    v_mov_b32 v124, 0
    v_mov_b32 v125, 0
    v_mov_b32 v126, 0
    v_mov_b32 v127, 0
    s_waitcnt vmcnt(8)
    v_lshlrev_b32 v240, 16, v232
    v_and_b32 v241, 0xffff0000, v232
    v_lshlrev_b32 v242, 16, v233
    v_and_b32 v243, 0xffff0000, v233
    v_lshlrev_b32 v244, 16, v234
    v_and_b32 v245, 0xffff0000, v234
    v_lshlrev_b32 v246, 16, v235
    v_and_b32 v247, 0xffff0000, v235
    s_waitcnt vmcnt(7)
    v_lshlrev_b32 v248, 16, v236
    v_and_b32 v249, 0xffff0000, v236
    v_lshlrev_b32 v250, 16, v237
    v_and_b32 v251, 0xffff0000, v237
    v_lshlrev_b32 v252, 16, v238
    v_and_b32 v253, 0xffff0000, v238
    v_lshlrev_b32 v254, 16, v239
    v_and_b32 v255, 0xffff0000, v239
    v_pk_add_f32 v[232:233], v[240:241], v[242:243]
    v_pk_add_f32 v[234:235], v[244:245], v[246:247]
    v_pk_add_f32 v[236:237], v[248:249], v[250:251]
    v_pk_add_f32 v[238:239], v[252:253], v[254:255]
    v_pk_add_f32 v[232:233], v[232:233], v[234:235]
    v_pk_add_f32 v[236:237], v[236:237], v[238:239]
    v_pk_add_f32 v[232:233], v[232:233], v[236:237]
    v_add_f32 v232, v232, v233
    s_nop 1
    v_add_f32_dpp v232, v232, v232 row_ror:8 row_mask:0xf bank_mask:0xf
    s_nop 1
    v_add_f32_dpp v232, v232, v232 row_ror:4 row_mask:0xf bank_mask:0xf
    s_nop 1
    v_add_f32_dpp v232, v232, v232 row_ror:2 row_mask:0xf bank_mask:0xf
    s_nop 1
    v_add_f32_dpp v232, v232, v232 row_ror:1 row_mask:0xf bank_mask:0xf
    v_mov_b32 v233, v232
    s_nop 1
    v_permlane16_swap_b32 v232, v233
    v_add_f32 v232, v232, v233
    v_mov_b32 v233, v232
    s_nop 1
    v_permlane32_swap_b32 v232, v233
    v_add_f32 v232, v232, v233
    v_mul_f32 v28, 0xba800000, v232
    v_pk_add_f32 v[240:241], v[240:241], v[28:29] op_sel_hi:[1,0]
    v_pk_add_f32 v[242:243], v[242:243], v[28:29] op_sel_hi:[1,0]
    v_pk_add_f32 v[244:245], v[244:245], v[28:29] op_sel_hi:[1,0]
    v_pk_add_f32 v[246:247], v[246:247], v[28:29] op_sel_hi:[1,0]
    v_pk_add_f32 v[248:249], v[248:249], v[28:29] op_sel_hi:[1,0]
    v_pk_add_f32 v[250:251], v[250:251], v[28:29] op_sel_hi:[1,0]
    v_pk_add_f32 v[252:253], v[252:253], v[28:29] op_sel_hi:[1,0]
    v_pk_add_f32 v[254:255], v[254:255], v[28:29] op_sel_hi:[1,0]
    v_pk_mul_f32 v[232:233], v[240:241], v[240:241]
    v_pk_mul_f32 v[234:235], v[242:243], v[242:243]
    v_pk_fma_f32 v[232:233], v[244:245], v[244:245], v[232:233]
    v_pk_fma_f32 v[234:235], v[246:247], v[246:247], v[234:235]
    v_pk_fma_f32 v[232:233], v[248:249], v[248:249], v[232:233]
    v_pk_fma_f32 v[234:235], v[250:251], v[250:251], v[234:235]
    v_pk_fma_f32 v[232:233], v[252:253], v[252:253], v[232:233]
    v_pk_fma_f32 v[234:235], v[254:255], v[254:255], v[234:235]
    v_pk_add_f32 v[232:233], v[232:233], v[234:235]
    v_add_f32 v232, v232, v233
    s_nop 1
    v_add_f32_dpp v232, v232, v232 row_ror:8 row_mask:0xf bank_mask:0xf
    s_nop 1
    v_add_f32_dpp v232, v232, v232 row_ror:4 row_mask:0xf bank_mask:0xf
    s_nop 1
    v_add_f32_dpp v232, v232, v232 row_ror:2 row_mask:0xf bank_mask:0xf
    s_nop 1
    v_add_f32_dpp v232, v232, v232 row_ror:1 row_mask:0xf bank_mask:0xf
    v_mov_b32 v233, v232
    s_nop 1
    v_permlane16_swap_b32 v232, v233
    v_add_f32 v232, v232, v233
    v_mov_b32 v233, v232
    s_nop 1
    v_permlane32_swap_b32 v232, v233
    v_add_f32 v232, v232, v233
    v_mov_b32 v233, 0x3727c5ac
    v_fmac_f32 v233, 0x3a800000, v232
    v_rsq_f32 v239, v233
    v_cvt_pk_bf16_f32 v234, v28, v28
    v_mul_f32 v233, v233, v239
    v_and_b32 v234, 0xffff0000, v234
    v_sub_f32 v234, v28, v234
    v_cvt_pk_bf16_f32 v236, v28, v234
    v_cvt_pk_bf16_f32 v237, v28, v233
    v_and_b32 v235, 0xffff0000, v237
    v_sub_f32 v235, v233, v235
    v_cvt_pk_bf16_f32 v238, v235, 0
    s_add_u32 m0, s48, 131072
    s_nop 0
    buffer_load_dwordx4 v2, s[24:27], s46 offen  lds
    s_add_u32 m0, s48, 135168
    s_nop 0
    buffer_load_dwordx4 v3, s[24:27], s46 offen  lds
    s_add_u32 m0, s48, 137216
    s_nop 0
    buffer_load_dwordx4 v2, s[24:27], s46 offen offset:2048  lds
    s_add_u32 m0, s48, 141312
    s_nop 0
    buffer_load_dwordx4 v3, s[24:27], s46 offen offset:2048  lds
    s_add_u32 m0, s48, 147456
    s_nop 0
    buffer_load_dwordx4 v4, s[24:27], s46 offen  lds
    s_add_u32 m0, s48, 151552
    s_nop 0
    buffer_load_dwordx4 v5, s[24:27], s46 offen  lds
    s_add_u32 s47, s47, 1
    s_and_b32 s47, s47, 15
    s_mul_i32 s46, s47, 393216
    s_lshl_b32 s50, s2, 3
    s_add_u32 s50, s50, s42
    s_mul_i32 s51, s50, 3584
    s_add_u32 s88, s88, s51
    s_addc_u32 s89, s89, 0
    s_lshl_b32 s51, s50, 10
    s_add_u32 s92, s92, s51
    s_addc_u32 s93, s93, 0
    s_waitcnt vmcnt(7)
    s_barrier
    v_add_u32 v8, s80, v6
    v_xor_b32 v9, 64, v8
    s_add_u32 s80, s80, 32768
    s_cmp_ge_u32 s80, 98304
    s_cselect_b32 s80, 0, s80
    ds_read_b64_tr_b16 v[160:161], v10 offset:0
    ds_read_b64_tr_b16 v[162:163], v10 offset:512
    ds_read_b64_tr_b16 v[204:205], v10 offset:4096
    ds_read_b64_tr_b16 v[206:207], v10 offset:4608
    ds_read_b128 v[144:147], v8 offset:0
    ds_read_b128 v[148:151], v8 offset:2048
    ds_read_b128 v[152:155], v8 offset:4096
    ds_read_b128 v[156:159], v8 offset:6144
    ds_read_b128 v[188:191], v9 offset:0
    ds_read_b128 v[192:195], v9 offset:2048
    ds_read_b128 v[196:199], v9 offset:4096
    ds_read_b128 v[200:203], v9 offset:6144
    ds_read_b64_tr_b16 v[164:165], v11 offset:0
    ds_read_b64_tr_b16 v[166:167], v11 offset:512
    ds_read_b64_tr_b16 v[208:209], v11 offset:4096
    ds_read_b64_tr_b16 v[210:211], v11 offset:4608
    ds_read_b64_tr_b16 v[168:169], v10 offset:8192
    ds_read_b64_tr_b16 v[170:171], v10 offset:8704
    ds_read_b64_tr_b16 v[212:213], v10 offset:12288
    ds_read_b64_tr_b16 v[214:215], v10 offset:12800
    ds_read_b64_tr_b16 v[172:173], v11 offset:8192
    ds_read_b64_tr_b16 v[174:175], v11 offset:8704
    ds_read_b64_tr_b16 v[216:217], v11 offset:12288
    ds_read_b64_tr_b16 v[218:219], v11 offset:12800
    ds_read_b64_tr_b16 v[176:177], v10 offset:16384
    ds_read_b64_tr_b16 v[178:179], v10 offset:16896
    ds_read_b64_tr_b16 v[220:221], v10 offset:20480
    ds_read_b64_tr_b16 v[222:223], v10 offset:20992
    ds_read_b64_tr_b16 v[180:181], v11 offset:16384
    ds_read_b64_tr_b16 v[182:183], v11 offset:16896
    ds_read_b64_tr_b16 v[224:225], v11 offset:20480
    ds_read_b64_tr_b16 v[226:227], v11 offset:20992
    v_mov_b32 v248, -1
    v_mov_b32 v249, -1
    v_mov_b32 v250, -1
    v_mov_b32 v251, -1
    s_lshl_b32 s50, s2, 3
    s_add_u32 s50, s50, s42
    s_lshl_b32 s50, s50, 4
    s_add_u32 s50, s50, 18874368
    s_mov_b64 exec, 1
    buffer_store_dwordx4 v[236:239], off, s[28:31], s50 sc1
    s_mov_b64 exec, -1
    s_lshl_b32 s50, s41, 1
    s_add_u32 s50, s50, s44
    s_lshl_b32 s50, s50, 3
    s_add_u32 s50, s50, s40
    s_lshl_b32 s50, s50, 9
    s_lshl_b32 s51, s43, 7
    s_add_u32 s50, s50, s51
    s_add_u32 s50, s50, 18939904
    v_lshlrev_b32 v15, 4, v1
    s_mov_b64 exec, 0xff
    buffer_store_dwordx4 v[248:251], v15, s[28:31], s50 offen sc1
    s_mov_b64 exec, -1
    s_lshl_b32 s54, s41, 3
    s_add_u32 s54, s54, s42
    s_lshl_b32 s54, s54, 9
    s_add_u32 s54, s54, 21364736
    s_lshl_b32 s51, s42, 11
    s_lshl_b32 s52, s41, 17
    s_add_u32 s51, s51, s52
    s_add_u32 s51, s51, 19267584
    s_lshl_b32 s52, s40, 14
    s_add_u32 s52, s52, s51
    s_lshl_b32 s55, s40, 6
    s_add_u32 s55, s55, s54
    v_lshlrev_b32 v15, 4, v1
    v_and_b32 v29, 48, v1
    buffer_store_dwordx4 v[248:251], v15, s[28:31], s52 offen offset:0 sc1
    buffer_store_dwordx4 v[248:251], v15, s[28:31], s52 offen offset:1024 sc1
    s_mov_b32 exec_lo, 0x00010001
    s_mov_b32 exec_hi, 0x00010001
    buffer_store_dwordx4 v[248:251], v29, s[28:31], s55 offen sc1
    s_mov_b64 exec, -1
    v_lshlrev_b32 v15, 4, v1
    s_lshl_b32 s50, s2, 3
    s_add_u32 s50, s50, s42
    s_lshl_b32 s50, s50, 11
    s_add_u32 s50, s50, 33554432
    buffer_store_dwordx4 v[248:251], v15, s[28:31], s50 offen offset:0 sc1
    buffer_store_dwordx4 v[248:251], v15, s[28:31], s50 offen offset:1024 sc1
    s_cmp_lg_u32 s43, 0
    s_cbranch_scc1 L_skip_1001
    s_lshr_b32 s50, s41, 2
    s_lshl_b32 s50, s50, 5
    s_and_b32 s51, s41, 3
    s_add_u32 s50, s50, s51
    s_lshl_b32 s51, s40, 9
    s_add_u32 s50, s50, s51
    s_lshl_b32 s50, s50, 2
    s_add_u32 s50, s50, 21431296
    v_mov_b32 v15, 0
    s_mov_b64 exec, 1
    buffer_store_dword v15, off, s[28:31], s50 sc1
    s_add_u32 s50, s50, 16384
    buffer_store_dword v15, off, s[28:31], s50 sc1
    s_mov_b64 exec, -1
L_skip_1001:
    s_waitcnt lgkmcnt(0)
    s_cmp_lg_u32 s86, 0
    s_cbranch_scc1 L_cs_1002
    s_cmp_lg_u32 s43, 0
    s_cbranch_scc1 L_cs_1003
    v_mfma_f32_16x16x32_bf16 v[20:23], v[16:19], v[160:163], v[20:23]
    v_mfma_f32_16x16x32_bf16 v[20:23], v[16:19], v[204:207], v[20:23]
    v_mfma_f32_16x16x32_bf16 v[24:27], v[16:19], v[176:179], v[24:27]
    v_mfma_f32_16x16x32_bf16 v[24:27], v[16:19], v[220:223], v[24:27]
    s_branch L_cs_1002
L_cs_1003:
    s_cmp_lg_u32 s43, 1
    s_cbranch_scc1 L_cs_1004
    v_mfma_f32_16x16x32_bf16 v[20:23], v[16:19], v[164:167], v[20:23]
    v_mfma_f32_16x16x32_bf16 v[20:23], v[16:19], v[208:211], v[20:23]
    v_mfma_f32_16x16x32_bf16 v[24:27], v[16:19], v[180:183], v[24:27]
    v_mfma_f32_16x16x32_bf16 v[24:27], v[16:19], v[224:227], v[24:27]
    s_branch L_cs_1002
L_cs_1004:
    s_cmp_lg_u32 s43, 2
    s_cbranch_scc1 L_cs_1005
    v_mfma_f32_16x16x32_bf16 v[20:23], v[16:19], v[168:171], v[20:23]
    v_mfma_f32_16x16x32_bf16 v[20:23], v[16:19], v[212:215], v[20:23]
    s_branch L_cs_1002
L_cs_1005:
    v_mfma_f32_16x16x32_bf16 v[20:23], v[16:19], v[172:175], v[20:23]
    v_mfma_f32_16x16x32_bf16 v[20:23], v[16:19], v[216:219], v[20:23]
L_cs_1002:
    s_call_b64 s[100:101], L_sub_c0_0
    v_add_u32 v8, s80, v6
    v_xor_b32 v9, 64, v8
    s_add_u32 s80, s80, 32768
    s_cmp_ge_u32 s80, 98304
    s_cselect_b32 s80, 0, s80
    ds_read_b64_tr_b16 v[160:161], v10 offset:32768
    s_add_u32 m0, s48, 98304
    ds_read_b64_tr_b16 v[162:163], v10 offset:33280
    buffer_load_dwordx4 v2, s[24:27], s46 offen  lds
    ds_read_b64_tr_b16 v[204:205], v10 offset:36864
    ds_read_b64_tr_b16 v[206:207], v10 offset:37376
    ds_read_b128 v[144:147], v8 offset:0
    s_add_u32 m0, s48, 102400
    ds_read_b128 v[148:151], v8 offset:2048
    buffer_load_dwordx4 v3, s[24:27], s46 offen  lds
    ds_read_b128 v[152:155], v8 offset:4096
    ds_read_b128 v[156:159], v8 offset:6144
    ds_read_b128 v[188:191], v9 offset:0
    s_add_u32 m0, s48, 104448
    ds_read_b128 v[192:195], v9 offset:2048
    buffer_load_dwordx4 v2, s[24:27], s46 offen offset:2048  lds
    ds_read_b128 v[196:199], v9 offset:4096
    ds_read_b128 v[200:203], v9 offset:6144
    ds_read_b64_tr_b16 v[164:165], v11 offset:32768
    s_add_u32 m0, s48, 108544
    ds_read_b64_tr_b16 v[166:167], v11 offset:33280
    buffer_load_dwordx4 v3, s[24:27], s46 offen offset:2048  lds
    ds_read_b64_tr_b16 v[208:209], v11 offset:36864
    ds_read_b64_tr_b16 v[210:211], v11 offset:37376
    ds_read_b64_tr_b16 v[168:169], v10 offset:40960
    s_add_u32 m0, s48, 114688
    ds_read_b64_tr_b16 v[170:171], v10 offset:41472
    buffer_load_dwordx4 v4, s[24:27], s46 offen  lds
    ds_read_b64_tr_b16 v[212:213], v10 offset:45056
    ds_read_b64_tr_b16 v[214:215], v10 offset:45568
    ds_read_b64_tr_b16 v[172:173], v11 offset:40960
    s_add_u32 m0, s48, 118784
    ds_read_b64_tr_b16 v[174:175], v11 offset:41472
    buffer_load_dwordx4 v5, s[24:27], s46 offen  lds
    ds_read_b64_tr_b16 v[216:217], v11 offset:45056
    ds_read_b64_tr_b16 v[218:219], v11 offset:45568
    ds_read_b64_tr_b16 v[176:177], v10 offset:49152
    ds_read_b64_tr_b16 v[178:179], v10 offset:49664
    ds_read_b64_tr_b16 v[220:221], v10 offset:53248
    ds_read_b64_tr_b16 v[222:223], v10 offset:53760
    ds_read_b64_tr_b16 v[180:181], v11 offset:49152
    ds_read_b64_tr_b16 v[182:183], v11 offset:49664
    ds_read_b64_tr_b16 v[224:225], v11 offset:53248
    ds_read_b64_tr_b16 v[226:227], v11 offset:53760
    s_add_u32 s47, s47, 1
    s_and_b32 s47, s47, 15
    s_mul_i32 s46, s47, 393216
    s_waitcnt lgkmcnt(0)
    s_cmp_lg_u32 s86, 0
    s_cbranch_scc1 L_cs_1006
    s_cmp_lg_u32 s43, 0
    s_cbranch_scc1 L_cs_1007
    v_mfma_f32_16x16x32_bf16 v[20:23], v[16:19], v[160:163], v[20:23]
    v_mfma_f32_16x16x32_bf16 v[20:23], v[16:19], v[204:207], v[20:23]
    v_mfma_f32_16x16x32_bf16 v[24:27], v[16:19], v[176:179], v[24:27]
    v_mfma_f32_16x16x32_bf16 v[24:27], v[16:19], v[220:223], v[24:27]
    s_branch L_cs_1006
L_cs_1007:
    s_cmp_lg_u32 s43, 1
    s_cbranch_scc1 L_cs_1008
    v_mfma_f32_16x16x32_bf16 v[20:23], v[16:19], v[164:167], v[20:23]
    v_mfma_f32_16x16x32_bf16 v[20:23], v[16:19], v[208:211], v[20:23]
    v_mfma_f32_16x16x32_bf16 v[24:27], v[16:19], v[180:183], v[24:27]
    v_mfma_f32_16x16x32_bf16 v[24:27], v[16:19], v[224:227], v[24:27]
    s_branch L_cs_1006
L_cs_1008:
    s_cmp_lg_u32 s43, 2
    s_cbranch_scc1 L_cs_1009
    v_mfma_f32_16x16x32_bf16 v[20:23], v[16:19], v[168:171], v[20:23]
    v_mfma_f32_16x16x32_bf16 v[20:23], v[16:19], v[212:215], v[20:23]
    s_branch L_cs_1006
L_cs_1009:
    v_mfma_f32_16x16x32_bf16 v[20:23], v[16:19], v[172:175], v[20:23]
    v_mfma_f32_16x16x32_bf16 v[20:23], v[16:19], v[216:219], v[20:23]
L_cs_1006:
    s_sub_u32 s86, s86, 1
    s_mov_b32 s49, 2
L_loop_1058:
    s_call_b64 s[100:101], L_sub_c0_1
    v_add_u32 v8, s80, v6
    v_xor_b32 v9, 64, v8
    s_add_u32 s80, s80, 32768
    s_cmp_ge_u32 s80, 98304
    s_cselect_b32 s80, 0, s80
    ds_read_b64_tr_b16 v[160:161], v10 offset:0
    s_add_u32 m0, s48, 131072
    ds_read_b64_tr_b16 v[162:163], v10 offset:512
    buffer_load_dwordx4 v2, s[24:27], s46 offen  lds
    ds_read_b64_tr_b16 v[204:205], v10 offset:4096
    ds_read_b64_tr_b16 v[206:207], v10 offset:4608
    ds_read_b128 v[144:147], v8 offset:0
    s_add_u32 m0, s48, 135168
    ds_read_b128 v[148:151], v8 offset:2048
    buffer_load_dwordx4 v3, s[24:27], s46 offen  lds
    ds_read_b128 v[152:155], v8 offset:4096
    ds_read_b128 v[156:159], v8 offset:6144
    ds_read_b128 v[188:191], v9 offset:0
    s_add_u32 m0, s48, 137216
    ds_read_b128 v[192:195], v9 offset:2048
    buffer_load_dwordx4 v2, s[24:27], s46 offen offset:2048  lds
    ds_read_b128 v[196:199], v9 offset:4096
    ds_read_b128 v[200:203], v9 offset:6144
    ds_read_b64_tr_b16 v[164:165], v11 offset:0
    s_add_u32 m0, s48, 141312
    ds_read_b64_tr_b16 v[166:167], v11 offset:512
    buffer_load_dwordx4 v3, s[24:27], s46 offen offset:2048  lds
    ds_read_b64_tr_b16 v[208:209], v11 offset:4096
    ds_read_b64_tr_b16 v[210:211], v11 offset:4608
    ds_read_b64_tr_b16 v[168:169], v10 offset:8192
    s_add_u32 m0, s48, 147456
    ds_read_b64_tr_b16 v[170:171], v10 offset:8704
    buffer_load_dwordx4 v4, s[24:27], s46 offen  lds
    ds_read_b64_tr_b16 v[212:213], v10 offset:12288
    ds_read_b64_tr_b16 v[214:215], v10 offset:12800
    ds_read_b64_tr_b16 v[172:173], v11 offset:8192
    s_add_u32 m0, s48, 151552
    ds_read_b64_tr_b16 v[174:175], v11 offset:8704
    buffer_load_dwordx4 v5, s[24:27], s46 offen  lds
    ds_read_b64_tr_b16 v[216:217], v11 offset:12288
    ds_read_b64_tr_b16 v[218:219], v11 offset:12800
    ds_read_b64_tr_b16 v[176:177], v10 offset:16384
    ds_read_b64_tr_b16 v[178:179], v10 offset:16896
    ds_read_b64_tr_b16 v[220:221], v10 offset:20480
    ds_read_b64_tr_b16 v[222:223], v10 offset:20992
    ds_read_b64_tr_b16 v[180:181], v11 offset:16384
    ds_read_b64_tr_b16 v[182:183], v11 offset:16896
    ds_read_b64_tr_b16 v[224:225], v11 offset:20480
    ds_read_b64_tr_b16 v[226:227], v11 offset:20992
    s_add_u32 s47, s47, 1
    s_and_b32 s47, s47, 15
    s_mul_i32 s46, s47, 393216
    s_waitcnt lgkmcnt(0)
    s_cmp_lg_u32 s86, 0
    s_cbranch_scc1 L_cs_1010
    s_cmp_lg_u32 s43, 0
    s_cbranch_scc1 L_cs_1011
    v_mfma_f32_16x16x32_bf16 v[20:23], v[16:19], v[160:163], v[20:23]
    v_mfma_f32_16x16x32_bf16 v[20:23], v[16:19], v[204:207], v[20:23]
    v_mfma_f32_16x16x32_bf16 v[24:27], v[16:19], v[176:179], v[24:27]
    v_mfma_f32_16x16x32_bf16 v[24:27], v[16:19], v[220:223], v[24:27]
    s_branch L_cs_1010
L_cs_1011:
    s_cmp_lg_u32 s43, 1
    s_cbranch_scc1 L_cs_1012
    v_mfma_f32_16x16x32_bf16 v[20:23], v[16:19], v[164:167], v[20:23]
    v_mfma_f32_16x16x32_bf16 v[20:23], v[16:19], v[208:211], v[20:23]
    v_mfma_f32_16x16x32_bf16 v[24:27], v[16:19], v[180:183], v[24:27]
    v_mfma_f32_16x16x32_bf16 v[24:27], v[16:19], v[224:227], v[24:27]
    s_branch L_cs_1010
L_cs_1012:
    s_cmp_lg_u32 s43, 2
    s_cbranch_scc1 L_cs_1013
    v_mfma_f32_16x16x32_bf16 v[20:23], v[16:19], v[168:171], v[20:23]
    v_mfma_f32_16x16x32_bf16 v[20:23], v[16:19], v[212:215], v[20:23]
    s_branch L_cs_1010
L_cs_1013:
    v_mfma_f32_16x16x32_bf16 v[20:23], v[16:19], v[172:175], v[20:23]
    v_mfma_f32_16x16x32_bf16 v[20:23], v[16:19], v[216:219], v[20:23]
L_cs_1010:
    s_call_b64 s[100:101], L_sub_c0_1
    v_add_u32 v8, s80, v6
    v_xor_b32 v9, 64, v8
    s_add_u32 s80, s80, 32768
    s_cmp_ge_u32 s80, 98304
    s_cselect_b32 s80, 0, s80
    ds_read_b64_tr_b16 v[160:161], v10 offset:32768
    s_add_u32 m0, s48, 98304
    ds_read_b64_tr_b16 v[162:163], v10 offset:33280
    buffer_load_dwordx4 v2, s[24:27], s46 offen  lds
    ds_read_b64_tr_b16 v[204:205], v10 offset:36864
    ds_read_b64_tr_b16 v[206:207], v10 offset:37376
    ds_read_b128 v[144:147], v8 offset:0
    s_add_u32 m0, s48, 102400
    ds_read_b128 v[148:151], v8 offset:2048
    buffer_load_dwordx4 v3, s[24:27], s46 offen  lds
    ds_read_b128 v[152:155], v8 offset:4096
    ds_read_b128 v[156:159], v8 offset:6144
    ds_read_b128 v[188:191], v9 offset:0
    s_add_u32 m0, s48, 104448
    ds_read_b128 v[192:195], v9 offset:2048
    buffer_load_dwordx4 v2, s[24:27], s46 offen offset:2048  lds
    ds_read_b128 v[196:199], v9 offset:4096
    ds_read_b128 v[200:203], v9 offset:6144
    ds_read_b64_tr_b16 v[164:165], v11 offset:32768
    s_add_u32 m0, s48, 108544
    ds_read_b64_tr_b16 v[166:167], v11 offset:33280
    buffer_load_dwordx4 v3, s[24:27], s46 offen offset:2048  lds
    ds_read_b64_tr_b16 v[208:209], v11 offset:36864
    ds_read_b64_tr_b16 v[210:211], v11 offset:37376
    ds_read_b64_tr_b16 v[168:169], v10 offset:40960
    s_add_u32 m0, s48, 114688
    ds_read_b64_tr_b16 v[170:171], v10 offset:41472
    buffer_load_dwordx4 v4, s[24:27], s46 offen  lds
    ds_read_b64_tr_b16 v[212:213], v10 offset:45056
    ds_read_b64_tr_b16 v[214:215], v10 offset:45568
    ds_read_b64_tr_b16 v[172:173], v11 offset:40960
    s_add_u32 m0, s48, 118784
    ds_read_b64_tr_b16 v[174:175], v11 offset:41472
    buffer_load_dwordx4 v5, s[24:27], s46 offen  lds
    ds_read_b64_tr_b16 v[216:217], v11 offset:45056
    ds_read_b64_tr_b16 v[218:219], v11 offset:45568
    ds_read_b64_tr_b16 v[176:177], v10 offset:49152
    ds_read_b64_tr_b16 v[178:179], v10 offset:49664
    ds_read_b64_tr_b16 v[220:221], v10 offset:53248
    ds_read_b64_tr_b16 v[222:223], v10 offset:53760
    ds_read_b64_tr_b16 v[180:181], v11 offset:49152
    ds_read_b64_tr_b16 v[182:183], v11 offset:49664
    ds_read_b64_tr_b16 v[224:225], v11 offset:53248
    ds_read_b64_tr_b16 v[226:227], v11 offset:53760
    s_add_u32 s47, s47, 1
    s_and_b32 s47, s47, 15
    s_mul_i32 s46, s47, 393216
    s_waitcnt lgkmcnt(0)
    s_cmp_lg_u32 s86, 0
    s_cbranch_scc1 L_cs_1014
    s_cmp_lg_u32 s43, 0
    s_cbranch_scc1 L_cs_1015
    v_mfma_f32_16x16x32_bf16 v[20:23], v[16:19], v[160:163], v[20:23]
    v_mfma_f32_16x16x32_bf16 v[20:23], v[16:19], v[204:207], v[20:23]
    v_mfma_f32_16x16x32_bf16 v[24:27], v[16:19], v[176:179], v[24:27]
    v_mfma_f32_16x16x32_bf16 v[24:27], v[16:19], v[220:223], v[24:27]
    s_branch L_cs_1014
L_cs_1015:
    s_cmp_lg_u32 s43, 1
    s_cbranch_scc1 L_cs_1016
    v_mfma_f32_16x16x32_bf16 v[20:23], v[16:19], v[164:167], v[20:23]
    v_mfma_f32_16x16x32_bf16 v[20:23], v[16:19], v[208:211], v[20:23]
    v_mfma_f32_16x16x32_bf16 v[24:27], v[16:19], v[180:183], v[24:27]
    v_mfma_f32_16x16x32_bf16 v[24:27], v[16:19], v[224:227], v[24:27]
    s_branch L_cs_1014
L_cs_1016:
    s_cmp_lg_u32 s43, 2
    s_cbranch_scc1 L_cs_1017
    v_mfma_f32_16x16x32_bf16 v[20:23], v[16:19], v[168:171], v[20:23]
    v_mfma_f32_16x16x32_bf16 v[20:23], v[16:19], v[212:215], v[20:23]
    s_branch L_cs_1014
L_cs_1017:
    v_mfma_f32_16x16x32_bf16 v[20:23], v[16:19], v[172:175], v[20:23]
    v_mfma_f32_16x16x32_bf16 v[20:23], v[16:19], v[216:219], v[20:23]
L_cs_1014:
    s_sub_u32 s86, s86, 1
    s_sub_u32 s49, s49, 1
    s_cmp_lg_u32 s49, 0
    s_cbranch_scc1 L_loop_1058
    s_call_b64 s[100:101], L_sub_c0_1
    v_add_u32 v8, s80, v6
    v_xor_b32 v9, 64, v8
    s_add_u32 s80, s80, 32768
    s_cmp_ge_u32 s80, 98304
    s_cselect_b32 s80, 0, s80
    ds_read_b64_tr_b16 v[160:161], v10 offset:0
    s_add_u32 m0, s48, 131072
    ds_read_b64_tr_b16 v[162:163], v10 offset:512
    buffer_load_dwordx4 v2, s[24:27], s46 offen  lds
    ds_read_b64_tr_b16 v[204:205], v10 offset:4096
    ds_read_b64_tr_b16 v[206:207], v10 offset:4608
    ds_read_b128 v[144:147], v8 offset:0
    s_add_u32 m0, s48, 135168
    ds_read_b128 v[148:151], v8 offset:2048
    buffer_load_dwordx4 v3, s[24:27], s46 offen  lds
    ds_read_b128 v[152:155], v8 offset:4096
    ds_read_b128 v[156:159], v8 offset:6144
    ds_read_b128 v[188:191], v9 offset:0
    s_add_u32 m0, s48, 137216
    ds_read_b128 v[192:195], v9 offset:2048
    buffer_load_dwordx4 v2, s[24:27], s46 offen offset:2048  lds
    ds_read_b128 v[196:199], v9 offset:4096
    ds_read_b128 v[200:203], v9 offset:6144
    ds_read_b64_tr_b16 v[164:165], v11 offset:0
    s_add_u32 m0, s48, 141312
    ds_read_b64_tr_b16 v[166:167], v11 offset:512
    buffer_load_dwordx4 v3, s[24:27], s46 offen offset:2048  lds
    ds_read_b64_tr_b16 v[208:209], v11 offset:4096
    ds_read_b64_tr_b16 v[210:211], v11 offset:4608
    ds_read_b64_tr_b16 v[168:169], v10 offset:8192
    s_add_u32 m0, s48, 147456
    ds_read_b64_tr_b16 v[170:171], v10 offset:8704
    buffer_load_dwordx4 v4, s[24:27], s46 offen  lds
    ds_read_b64_tr_b16 v[212:213], v10 offset:12288
    ds_read_b64_tr_b16 v[214:215], v10 offset:12800
    ds_read_b64_tr_b16 v[172:173], v11 offset:8192
    s_add_u32 m0, s48, 151552
    ds_read_b64_tr_b16 v[174:175], v11 offset:8704
    buffer_load_dwordx4 v5, s[24:27], s46 offen  lds
    ds_read_b64_tr_b16 v[216:217], v11 offset:12288
    ds_read_b64_tr_b16 v[218:219], v11 offset:12800
    ds_read_b64_tr_b16 v[176:177], v10 offset:16384
    ds_read_b64_tr_b16 v[178:179], v10 offset:16896
    ds_read_b64_tr_b16 v[220:221], v10 offset:20480
    ds_read_b64_tr_b16 v[222:223], v10 offset:20992
    ds_read_b64_tr_b16 v[180:181], v11 offset:16384
    ds_read_b64_tr_b16 v[182:183], v11 offset:16896
    ds_read_b64_tr_b16 v[224:225], v11 offset:20480
    ds_read_b64_tr_b16 v[226:227], v11 offset:20992
    s_add_u32 s47, s47, 1
    s_and_b32 s47, s47, 15
    s_mul_i32 s46, s47, 393216
    s_waitcnt lgkmcnt(0)
    s_load_dword s90, s[88:89], 0
    s_load_dword s90, s[88:89], 64
    s_load_dword s90, s[88:89], 128
    s_load_dword s90, s[88:89], 192
    s_load_dword s90, s[88:89], 256
    s_load_dword s90, s[88:89], 320
    s_load_dword s90, s[88:89], 384
    s_load_dword s90, s[88:89], 448
    s_cmp_lg_u32 s86, 0
    s_cbranch_scc1 L_cs_1026
    s_cmp_lg_u32 s43, 0
    s_cbranch_scc1 L_cs_1027
    v_mfma_f32_16x16x32_bf16 v[20:23], v[16:19], v[160:163], v[20:23]
    v_mfma_f32_16x16x32_bf16 v[20:23], v[16:19], v[204:207], v[20:23]
    v_mfma_f32_16x16x32_bf16 v[24:27], v[16:19], v[176:179], v[24:27]
    v_mfma_f32_16x16x32_bf16 v[24:27], v[16:19], v[220:223], v[24:27]
    s_branch L_cs_1026
L_cs_1027:
    s_cmp_lg_u32 s43, 1
    s_cbranch_scc1 L_cs_1028
    v_mfma_f32_16x16x32_bf16 v[20:23], v[16:19], v[164:167], v[20:23]
    v_mfma_f32_16x16x32_bf16 v[20:23], v[16:19], v[208:211], v[20:23]
    v_mfma_f32_16x16x32_bf16 v[24:27], v[16:19], v[180:183], v[24:27]
    v_mfma_f32_16x16x32_bf16 v[24:27], v[16:19], v[224:227], v[24:27]
    s_branch L_cs_1026
L_cs_1028:
    s_cmp_lg_u32 s43, 2
    s_cbranch_scc1 L_cs_1029
    v_mfma_f32_16x16x32_bf16 v[20:23], v[16:19], v[168:171], v[20:23]
    v_mfma_f32_16x16x32_bf16 v[20:23], v[16:19], v[212:215], v[20:23]
    s_branch L_cs_1026
L_cs_1029:
    v_mfma_f32_16x16x32_bf16 v[20:23], v[16:19], v[172:175], v[20:23]
    v_mfma_f32_16x16x32_bf16 v[20:23], v[16:19], v[216:219], v[20:23]
L_cs_1026:
    s_call_b64 s[100:101], L_sub_c0_1
    v_add_u32 v8, s80, v6
    v_xor_b32 v9, 64, v8
    s_add_u32 s80, s80, 32768
    s_cmp_ge_u32 s80, 98304
    s_cselect_b32 s80, 0, s80
    ds_read_b64_tr_b16 v[160:161], v10 offset:32768
    s_add_u32 m0, s48, 98304
    ds_read_b64_tr_b16 v[162:163], v10 offset:33280
    buffer_load_dwordx4 v2, s[24:27], s46 offen  lds
    ds_read_b64_tr_b16 v[204:205], v10 offset:36864
    ds_read_b64_tr_b16 v[206:207], v10 offset:37376
    ds_read_b128 v[144:147], v8 offset:0
    s_add_u32 m0, s48, 102400
    ds_read_b128 v[148:151], v8 offset:2048
    buffer_load_dwordx4 v3, s[24:27], s46 offen  lds
    ds_read_b128 v[152:155], v8 offset:4096
    ds_read_b128 v[156:159], v8 offset:6144
    ds_read_b128 v[188:191], v9 offset:0
    s_add_u32 m0, s48, 104448
    ds_read_b128 v[192:195], v9 offset:2048
    buffer_load_dwordx4 v2, s[24:27], s46 offen offset:2048  lds
    ds_read_b128 v[196:199], v9 offset:4096
    ds_read_b128 v[200:203], v9 offset:6144
    ds_read_b64_tr_b16 v[164:165], v11 offset:32768
    s_add_u32 m0, s48, 108544
    ds_read_b64_tr_b16 v[166:167], v11 offset:33280
    buffer_load_dwordx4 v3, s[24:27], s46 offen offset:2048  lds
    ds_read_b64_tr_b16 v[208:209], v11 offset:36864
    ds_read_b64_tr_b16 v[210:211], v11 offset:37376
    ds_read_b64_tr_b16 v[168:169], v10 offset:40960
    s_add_u32 m0, s48, 114688
    ds_read_b64_tr_b16 v[170:171], v10 offset:41472
    buffer_load_dwordx4 v4, s[24:27], s46 offen  lds
    ds_read_b64_tr_b16 v[212:213], v10 offset:45056
    ds_read_b64_tr_b16 v[214:215], v10 offset:45568
    ds_read_b64_tr_b16 v[172:173], v11 offset:40960
    s_add_u32 m0, s48, 118784
    ds_read_b64_tr_b16 v[174:175], v11 offset:41472
    buffer_load_dwordx4 v5, s[24:27], s46 offen  lds
    ds_read_b64_tr_b16 v[216:217], v11 offset:45056
    ds_read_b64_tr_b16 v[218:219], v11 offset:45568
    ds_read_b64_tr_b16 v[176:177], v10 offset:49152
    ds_read_b64_tr_b16 v[178:179], v10 offset:49664
    ds_read_b64_tr_b16 v[220:221], v10 offset:53248
    ds_read_b64_tr_b16 v[222:223], v10 offset:53760
    ds_read_b64_tr_b16 v[180:181], v11 offset:49152
    ds_read_b64_tr_b16 v[182:183], v11 offset:49664
    ds_read_b64_tr_b16 v[224:225], v11 offset:53248
    ds_read_b64_tr_b16 v[226:227], v11 offset:53760
    s_add_u32 s47, s47, 1
    s_and_b32 s47, s47, 15
    s_mul_i32 s46, s47, 393216
    s_add_u32 s88, s88, 512
    s_addc_u32 s89, s89, 0
    s_waitcnt lgkmcnt(0)
    s_load_dword s90, s[88:89], 0
    s_load_dword s90, s[88:89], 64
    s_load_dword s90, s[88:89], 128
    s_load_dword s90, s[88:89], 192
    s_load_dword s90, s[88:89], 256
    s_load_dword s90, s[88:89], 320
    s_load_dword s90, s[88:89], 384
    s_load_dword s90, s[88:89], 448
    s_cmp_lg_u32 s86, 0
    s_cbranch_scc1 L_cs_1030
    s_cmp_lg_u32 s43, 0
    s_cbranch_scc1 L_cs_1031
    v_mfma_f32_16x16x32_bf16 v[20:23], v[16:19], v[160:163], v[20:23]
    v_mfma_f32_16x16x32_bf16 v[20:23], v[16:19], v[204:207], v[20:23]
    v_mfma_f32_16x16x32_bf16 v[24:27], v[16:19], v[176:179], v[24:27]
    v_mfma_f32_16x16x32_bf16 v[24:27], v[16:19], v[220:223], v[24:27]
    s_branch L_cs_1030
L_cs_1031:
    s_cmp_lg_u32 s43, 1
    s_cbranch_scc1 L_cs_1032
    v_mfma_f32_16x16x32_bf16 v[20:23], v[16:19], v[164:167], v[20:23]
    v_mfma_f32_16x16x32_bf16 v[20:23], v[16:19], v[208:211], v[20:23]
    v_mfma_f32_16x16x32_bf16 v[24:27], v[16:19], v[180:183], v[24:27]
    v_mfma_f32_16x16x32_bf16 v[24:27], v[16:19], v[224:227], v[24:27]
    s_branch L_cs_1030
L_cs_1032:
    s_cmp_lg_u32 s43, 2
    s_cbranch_scc1 L_cs_1033
    v_mfma_f32_16x16x32_bf16 v[20:23], v[16:19], v[168:171], v[20:23]
    v_mfma_f32_16x16x32_bf16 v[20:23], v[16:19], v[212:215], v[20:23]
    s_branch L_cs_1030
L_cs_1033:
    v_mfma_f32_16x16x32_bf16 v[20:23], v[16:19], v[172:175], v[20:23]
    v_mfma_f32_16x16x32_bf16 v[20:23], v[16:19], v[216:219], v[20:23]
L_cs_1030:
    s_sub_u32 s86, s86, 1
    s_call_b64 s[100:101], L_sub_c0_1
    s_lshl_b32 s50, s41, 1
    s_add_u32 s50, s50, s44
    s_lshl_b32 s50, s50, 3
    s_add_u32 s50, s50, s40
    s_lshl_b32 s50, s50, 9
    s_lshl_b32 s51, s43, 2
    s_add_u32 s50, s50, s51
    s_add_u32 s50, s50, 18939904
    v_lshlrev_b32 v15, 5, v1
    s_mov_b64 exec, 0xffff
    buffer_store_dword v20, v15, s[28:31], s50 offen sc1
    buffer_store_dword v24, v15, s[28:31], s50 offen offset:16 sc1
    s_mov_b64 exec, -1
    v_add_u32 v8, s80, v6
    v_xor_b32 v9, 64, v8
    s_add_u32 s80, s80, 32768
    s_cmp_ge_u32 s80, 98304
    s_cselect_b32 s80, 0, s80
    ds_read_b64_tr_b16 v[160:161], v10 offset:0
    s_add_u32 m0, s48, 131072
    ds_read_b64_tr_b16 v[162:163], v10 offset:512
    buffer_load_dwordx4 v2, s[24:27], s46 offen  lds
    ds_read_b64_tr_b16 v[204:205], v10 offset:4096
    ds_read_b64_tr_b16 v[206:207], v10 offset:4608
    ds_read_b128 v[144:147], v8 offset:0
    s_add_u32 m0, s48, 135168
    ds_read_b128 v[148:151], v8 offset:2048
    buffer_load_dwordx4 v3, s[24:27], s46 offen  lds
    ds_read_b128 v[152:155], v8 offset:4096
    ds_read_b128 v[156:159], v8 offset:6144
    ds_read_b128 v[188:191], v9 offset:0
    s_add_u32 m0, s48, 137216
    ds_read_b128 v[192:195], v9 offset:2048
    buffer_load_dwordx4 v2, s[24:27], s46 offen offset:2048  lds
    ds_read_b128 v[196:199], v9 offset:4096
    ds_read_b128 v[200:203], v9 offset:6144
    ds_read_b64_tr_b16 v[164:165], v11 offset:0
    s_add_u32 m0, s48, 141312
    ds_read_b64_tr_b16 v[166:167], v11 offset:512
    buffer_load_dwordx4 v3, s[24:27], s46 offen offset:2048  lds
    ds_read_b64_tr_b16 v[208:209], v11 offset:4096
    ds_read_b64_tr_b16 v[210:211], v11 offset:4608
    ds_read_b64_tr_b16 v[168:169], v10 offset:8192
    s_add_u32 m0, s48, 147456
    ds_read_b64_tr_b16 v[170:171], v10 offset:8704
    buffer_load_dwordx4 v4, s[24:27], s46 offen  lds
    ds_read_b64_tr_b16 v[212:213], v10 offset:12288
    ds_read_b64_tr_b16 v[214:215], v10 offset:12800
    ds_read_b64_tr_b16 v[172:173], v11 offset:8192
    s_add_u32 m0, s48, 151552
    ds_read_b64_tr_b16 v[174:175], v11 offset:8704
    buffer_load_dwordx4 v5, s[24:27], s46 offen  lds
    ds_read_b64_tr_b16 v[216:217], v11 offset:12288
    ds_read_b64_tr_b16 v[218:219], v11 offset:12800
    ds_read_b64_tr_b16 v[176:177], v10 offset:16384
    ds_read_b64_tr_b16 v[178:179], v10 offset:16896
    ds_read_b64_tr_b16 v[220:221], v10 offset:20480
    ds_read_b64_tr_b16 v[222:223], v10 offset:20992
    ds_read_b64_tr_b16 v[180:181], v11 offset:16384
    ds_read_b64_tr_b16 v[182:183], v11 offset:16896
    ds_read_b64_tr_b16 v[224:225], v11 offset:20480
    ds_read_b64_tr_b16 v[226:227], v11 offset:20992
    s_add_u32 s47, s47, 1
    s_and_b32 s47, s47, 15
    s_mul_i32 s46, s47, 393216
    s_add_u32 s88, s88, 512
    s_addc_u32 s89, s89, 0
    s_waitcnt lgkmcnt(0)
    s_load_dword s90, s[88:89], 0
    s_load_dword s90, s[88:89], 64
    s_load_dword s90, s[88:89], 128
    s_load_dword s90, s[88:89], 192
    s_load_dword s90, s[88:89], 256
    s_load_dword s90, s[88:89], 320
    s_load_dword s90, s[88:89], 384
    s_load_dword s90, s[88:89], 448
    s_call_b64 s[100:101], L_sub_c0_1
    v_add_u32 v8, s80, v6
    v_xor_b32 v9, 64, v8
    s_add_u32 s80, s80, 32768
    s_cmp_ge_u32 s80, 98304
    s_cselect_b32 s80, 0, s80
    ds_read_b64_tr_b16 v[160:161], v10 offset:32768
    s_add_u32 m0, s48, 98304
    ds_read_b64_tr_b16 v[162:163], v10 offset:33280
    buffer_load_dwordx4 v2, s[24:27], s46 offen  lds
    ds_read_b64_tr_b16 v[204:205], v10 offset:36864
    ds_read_b64_tr_b16 v[206:207], v10 offset:37376
    ds_read_b128 v[144:147], v8 offset:0
    s_add_u32 m0, s48, 102400
    ds_read_b128 v[148:151], v8 offset:2048
    buffer_load_dwordx4 v3, s[24:27], s46 offen  lds
    ds_read_b128 v[152:155], v8 offset:4096
    ds_read_b128 v[156:159], v8 offset:6144
    ds_read_b128 v[188:191], v9 offset:0
    s_add_u32 m0, s48, 104448
    ds_read_b128 v[192:195], v9 offset:2048
    buffer_load_dwordx4 v2, s[24:27], s46 offen offset:2048  lds
    ds_read_b128 v[196:199], v9 offset:4096
    ds_read_b128 v[200:203], v9 offset:6144
    ds_read_b64_tr_b16 v[164:165], v11 offset:32768
    s_add_u32 m0, s48, 108544
    ds_read_b64_tr_b16 v[166:167], v11 offset:33280
    buffer_load_dwordx4 v3, s[24:27], s46 offen offset:2048  lds
    ds_read_b64_tr_b16 v[208:209], v11 offset:36864
    ds_read_b64_tr_b16 v[210:211], v11 offset:37376
    ds_read_b64_tr_b16 v[168:169], v10 offset:40960
    s_add_u32 m0, s48, 114688
    ds_read_b64_tr_b16 v[170:171], v10 offset:41472
    buffer_load_dwordx4 v4, s[24:27], s46 offen  lds
    ds_read_b64_tr_b16 v[212:213], v10 offset:45056
    ds_read_b64_tr_b16 v[214:215], v10 offset:45568
    ds_read_b64_tr_b16 v[172:173], v11 offset:40960
    s_add_u32 m0, s48, 118784
    ds_read_b64_tr_b16 v[174:175], v11 offset:41472
    buffer_load_dwordx4 v5, s[24:27], s46 offen  lds
    ds_read_b64_tr_b16 v[216:217], v11 offset:45056
    ds_read_b64_tr_b16 v[218:219], v11 offset:45568
    ds_read_b64_tr_b16 v[176:177], v10 offset:49152
    ds_read_b64_tr_b16 v[178:179], v10 offset:49664
    ds_read_b64_tr_b16 v[220:221], v10 offset:53248
    ds_read_b64_tr_b16 v[222:223], v10 offset:53760
    ds_read_b64_tr_b16 v[180:181], v11 offset:49152
    ds_read_b64_tr_b16 v[182:183], v11 offset:49664
    ds_read_b64_tr_b16 v[224:225], v11 offset:53248
    ds_read_b64_tr_b16 v[226:227], v11 offset:53760
    s_add_u32 s47, s47, 1
    s_and_b32 s47, s47, 15
    s_mul_i32 s46, s47, 393216
    s_add_u32 s88, s88, 512
    s_addc_u32 s89, s89, 0
    s_waitcnt lgkmcnt(0)
    s_load_dword s90, s[88:89], 0
    s_load_dword s90, s[88:89], 64
    s_load_dword s90, s[88:89], 128
    s_load_dword s90, s[88:89], 192
    s_load_dword s90, s[88:89], 256
    s_load_dword s90, s[88:89], 320
    s_load_dword s90, s[88:89], 384
    s_load_dword s90, s[88:89], 448
    s_call_b64 s[100:101], L_sub_c0_1
    v_add_u32 v8, s80, v6
    v_xor_b32 v9, 64, v8
    s_add_u32 s80, s80, 32768
    s_cmp_ge_u32 s80, 98304
    s_cselect_b32 s80, 0, s80
    ds_read_b64_tr_b16 v[160:161], v10 offset:0
    s_add_u32 m0, s48, 131072
    ds_read_b64_tr_b16 v[162:163], v10 offset:512
    buffer_load_dwordx4 v2, s[24:27], s46 offen  lds
    ds_read_b64_tr_b16 v[204:205], v10 offset:4096
    ds_read_b64_tr_b16 v[206:207], v10 offset:4608
    ds_read_b128 v[144:147], v8 offset:0
    s_add_u32 m0, s48, 135168
    ds_read_b128 v[148:151], v8 offset:2048
    buffer_load_dwordx4 v3, s[24:27], s46 offen  lds
    ds_read_b128 v[152:155], v8 offset:4096
    ds_read_b128 v[156:159], v8 offset:6144
    ds_read_b128 v[188:191], v9 offset:0
    s_add_u32 m0, s48, 137216
    ds_read_b128 v[192:195], v9 offset:2048
    buffer_load_dwordx4 v2, s[24:27], s46 offen offset:2048  lds
    ds_read_b128 v[196:199], v9 offset:4096
    ds_read_b128 v[200:203], v9 offset:6144
    ds_read_b64_tr_b16 v[164:165], v11 offset:0
    s_add_u32 m0, s48, 141312
    ds_read_b64_tr_b16 v[166:167], v11 offset:512
    buffer_load_dwordx4 v3, s[24:27], s46 offen offset:2048  lds
    ds_read_b64_tr_b16 v[208:209], v11 offset:4096
    ds_read_b64_tr_b16 v[210:211], v11 offset:4608
    ds_read_b64_tr_b16 v[168:169], v10 offset:8192
    s_add_u32 m0, s48, 147456
    ds_read_b64_tr_b16 v[170:171], v10 offset:8704
    buffer_load_dwordx4 v4, s[24:27], s46 offen  lds
    ds_read_b64_tr_b16 v[212:213], v10 offset:12288
    ds_read_b64_tr_b16 v[214:215], v10 offset:12800
    ds_read_b64_tr_b16 v[172:173], v11 offset:8192
    s_add_u32 m0, s48, 151552
    ds_read_b64_tr_b16 v[174:175], v11 offset:8704
    buffer_load_dwordx4 v5, s[24:27], s46 offen  lds
    ds_read_b64_tr_b16 v[216:217], v11 offset:12288
    ds_read_b64_tr_b16 v[218:219], v11 offset:12800
    ds_read_b64_tr_b16 v[176:177], v10 offset:16384
    ds_read_b64_tr_b16 v[178:179], v10 offset:16896
    ds_read_b64_tr_b16 v[220:221], v10 offset:20480
    ds_read_b64_tr_b16 v[222:223], v10 offset:20992
    ds_read_b64_tr_b16 v[180:181], v11 offset:16384
    ds_read_b64_tr_b16 v[182:183], v11 offset:16896
    ds_read_b64_tr_b16 v[224:225], v11 offset:20480
    ds_read_b64_tr_b16 v[226:227], v11 offset:20992
    s_add_u32 s47, s47, 1
    s_and_b32 s47, s47, 15
    s_mul_i32 s46, s47, 393216
    s_add_u32 s88, s88, 512
    s_addc_u32 s89, s89, 0
    s_waitcnt lgkmcnt(0)
    s_load_dword s90, s[88:89], 0
    s_load_dword s90, s[88:89], 64
    s_load_dword s90, s[88:89], 128
    s_load_dword s90, s[88:89], 192
    s_load_dword s90, s[88:89], 256
    s_load_dword s90, s[88:89], 320
    s_load_dword s90, s[88:89], 384
    s_load_dword s90, s[88:89], 448
    s_call_b64 s[100:101], L_sub_c0_1
    v_add_u32 v8, s80, v6
    v_xor_b32 v9, 64, v8
    s_add_u32 s80, s80, 32768
    s_cmp_ge_u32 s80, 98304
    s_cselect_b32 s80, 0, s80
    ds_read_b64_tr_b16 v[160:161], v10 offset:32768
    s_add_u32 m0, s48, 98304
    ds_read_b64_tr_b16 v[162:163], v10 offset:33280
    buffer_load_dwordx4 v2, s[24:27], s46 offen  lds
    ds_read_b64_tr_b16 v[204:205], v10 offset:36864
    ds_read_b64_tr_b16 v[206:207], v10 offset:37376
    ds_read_b128 v[144:147], v8 offset:0
    s_add_u32 m0, s48, 102400
    ds_read_b128 v[148:151], v8 offset:2048
    buffer_load_dwordx4 v3, s[24:27], s46 offen  lds
    ds_read_b128 v[152:155], v8 offset:4096
    ds_read_b128 v[156:159], v8 offset:6144
    ds_read_b128 v[188:191], v9 offset:0
    s_add_u32 m0, s48, 104448
    ds_read_b128 v[192:195], v9 offset:2048
    buffer_load_dwordx4 v2, s[24:27], s46 offen offset:2048  lds
    ds_read_b128 v[196:199], v9 offset:4096
    ds_read_b128 v[200:203], v9 offset:6144
    ds_read_b64_tr_b16 v[164:165], v11 offset:32768
    s_add_u32 m0, s48, 108544
    ds_read_b64_tr_b16 v[166:167], v11 offset:33280
    buffer_load_dwordx4 v3, s[24:27], s46 offen offset:2048  lds
    ds_read_b64_tr_b16 v[208:209], v11 offset:36864
    ds_read_b64_tr_b16 v[210:211], v11 offset:37376
    ds_read_b64_tr_b16 v[168:169], v10 offset:40960
    s_add_u32 m0, s48, 114688
    ds_read_b64_tr_b16 v[170:171], v10 offset:41472
    buffer_load_dwordx4 v4, s[24:27], s46 offen  lds
    ds_read_b64_tr_b16 v[212:213], v10 offset:45056
    ds_read_b64_tr_b16 v[214:215], v10 offset:45568
    ds_read_b64_tr_b16 v[172:173], v11 offset:40960
    s_add_u32 m0, s48, 118784
    ds_read_b64_tr_b16 v[174:175], v11 offset:41472
    buffer_load_dwordx4 v5, s[24:27], s46 offen  lds
    ds_read_b64_tr_b16 v[216:217], v11 offset:45056
    ds_read_b64_tr_b16 v[218:219], v11 offset:45568
    ds_read_b64_tr_b16 v[176:177], v10 offset:49152
    ds_read_b64_tr_b16 v[178:179], v10 offset:49664
    ds_read_b64_tr_b16 v[220:221], v10 offset:53248
    ds_read_b64_tr_b16 v[222:223], v10 offset:53760
    ds_read_b64_tr_b16 v[180:181], v11 offset:49152
    ds_read_b64_tr_b16 v[182:183], v11 offset:49664
    ds_read_b64_tr_b16 v[224:225], v11 offset:53248
    ds_read_b64_tr_b16 v[226:227], v11 offset:53760
    s_add_u32 s47, s47, 1
    s_and_b32 s47, s47, 15
    s_mul_i32 s46, s47, 393216
    s_add_u32 s88, s88, 512
    s_addc_u32 s89, s89, 0
    v_lshlrev_b32 v29, 2, v1
    s_cmp_lg_u32 s43, 0
    s_cbranch_scc1 L_skip_1034
    buffer_load_dword v28, v29, s[32:35], 0 offen sc1
L_skip_1034:
    s_waitcnt lgkmcnt(0)
    s_load_dword s90, s[88:89], 0
    s_load_dword s90, s[88:89], 64
    s_load_dword s90, s[88:89], 128
    s_load_dword s90, s[88:89], 192
    s_load_dword s90, s[88:89], 256
    s_load_dword s90, s[88:89], 320
    s_load_dword s90, s[88:89], 384
    s_load_dword s90, s[88:89], 448
    s_call_b64 s[100:101], L_sub_c0_1
    v_add_u32 v8, s80, v6
    v_xor_b32 v9, 64, v8
    s_add_u32 s80, s80, 32768
    s_cmp_ge_u32 s80, 98304
    s_cselect_b32 s80, 0, s80
    ds_read_b64_tr_b16 v[160:161], v10 offset:0
    s_add_u32 m0, s48, 131072
    ds_read_b64_tr_b16 v[162:163], v10 offset:512
    buffer_load_dwordx4 v2, s[24:27], s46 offen  lds
    ds_read_b64_tr_b16 v[204:205], v10 offset:4096
    ds_read_b64_tr_b16 v[206:207], v10 offset:4608
    ds_read_b128 v[144:147], v8 offset:0
    s_add_u32 m0, s48, 135168
    ds_read_b128 v[148:151], v8 offset:2048
    buffer_load_dwordx4 v3, s[24:27], s46 offen  lds
    ds_read_b128 v[152:155], v8 offset:4096
    ds_read_b128 v[156:159], v8 offset:6144
    ds_read_b128 v[188:191], v9 offset:0
    s_add_u32 m0, s48, 137216
    ds_read_b128 v[192:195], v9 offset:2048
    buffer_load_dwordx4 v2, s[24:27], s46 offen offset:2048  lds
    ds_read_b128 v[196:199], v9 offset:4096
    ds_read_b128 v[200:203], v9 offset:6144
    ds_read_b64_tr_b16 v[164:165], v11 offset:0
    s_add_u32 m0, s48, 141312
    ds_read_b64_tr_b16 v[166:167], v11 offset:512
    buffer_load_dwordx4 v3, s[24:27], s46 offen offset:2048  lds
    ds_read_b64_tr_b16 v[208:209], v11 offset:4096
    ds_read_b64_tr_b16 v[210:211], v11 offset:4608
    ds_read_b64_tr_b16 v[168:169], v10 offset:8192
    s_add_u32 m0, s48, 147456
    ds_read_b64_tr_b16 v[170:171], v10 offset:8704
    buffer_load_dwordx4 v4, s[24:27], s46 offen  lds
    ds_read_b64_tr_b16 v[212:213], v10 offset:12288
    ds_read_b64_tr_b16 v[214:215], v10 offset:12800
    ds_read_b64_tr_b16 v[172:173], v11 offset:8192
    s_add_u32 m0, s48, 151552
    ds_read_b64_tr_b16 v[174:175], v11 offset:8704
    buffer_load_dwordx4 v5, s[24:27], s46 offen  lds
    ds_read_b64_tr_b16 v[216:217], v11 offset:12288
    ds_read_b64_tr_b16 v[218:219], v11 offset:12800
    ds_read_b64_tr_b16 v[176:177], v10 offset:16384
    ds_read_b64_tr_b16 v[178:179], v10 offset:16896
    ds_read_b64_tr_b16 v[220:221], v10 offset:20480
    ds_read_b64_tr_b16 v[222:223], v10 offset:20992
    ds_read_b64_tr_b16 v[180:181], v11 offset:16384
    ds_read_b64_tr_b16 v[182:183], v11 offset:16896
    ds_read_b64_tr_b16 v[224:225], v11 offset:20480
    ds_read_b64_tr_b16 v[226:227], v11 offset:20992
    s_add_u32 s47, s47, 1
    s_and_b32 s47, s47, 15
    s_mul_i32 s46, s47, 393216
    s_add_u32 s88, s88, 512
    s_addc_u32 s89, s89, 0
    s_cmp_lg_u32 s43, 0
    s_cbranch_scc1 L_skip_1035
    v_mov_b32 v15, 0x01010101
    s_mov_b32 s63, 0x20000
L_poll_1036:
    v_and_b32 v28, v28, v15
    v_cmp_ne_u32 vcc, v28, v15
    s_nop 0
    s_cmp_eq_u64 vcc, 0
    s_cbranch_scc1 L_go_1037
    s_sleep 8
    buffer_load_dword v28, v29, s[32:35], 0 offen sc1
    s_waitcnt vmcnt(0)
    s_sub_u32 s63, s63, 1
    s_cmp_lg_u32 s63, 0
    s_cbranch_scc1 L_poll_1036
L_go_1037:
L_skip_1035:
    s_waitcnt lgkmcnt(0)
    s_load_dword s90, s[88:89], 0
    s_load_dword s90, s[88:89], 64
    s_load_dword s90, s[88:89], 128
    s_load_dword s90, s[88:89], 192
    s_load_dword s90, s[88:89], 256
    s_load_dword s90, s[88:89], 320
    s_load_dword s90, s[88:89], 384
    s_load_dword s90, s[88:89], 448
    s_call_b64 s[100:101], L_sub_c0_1
    v_add_u32 v8, s80, v6
    v_xor_b32 v9, 64, v8
    s_add_u32 s80, s80, 32768
    s_cmp_ge_u32 s80, 98304
    s_cselect_b32 s80, 0, s80
    ds_read_b64_tr_b16 v[160:161], v10 offset:32768
    s_add_u32 m0, s48, 98304
    ds_read_b64_tr_b16 v[162:163], v10 offset:33280
    buffer_load_dwordx4 v2, s[24:27], s46 offen  lds
    ds_read_b64_tr_b16 v[204:205], v10 offset:36864
    ds_read_b64_tr_b16 v[206:207], v10 offset:37376
    ds_read_b128 v[144:147], v8 offset:0
    s_add_u32 m0, s48, 102400
    ds_read_b128 v[148:151], v8 offset:2048
    buffer_load_dwordx4 v3, s[24:27], s46 offen  lds
    ds_read_b128 v[152:155], v8 offset:4096
    ds_read_b128 v[156:159], v8 offset:6144
    ds_read_b128 v[188:191], v9 offset:0
    s_add_u32 m0, s48, 104448
    ds_read_b128 v[192:195], v9 offset:2048
    buffer_load_dwordx4 v2, s[24:27], s46 offen offset:2048  lds
    ds_read_b128 v[196:199], v9 offset:4096
    ds_read_b128 v[200:203], v9 offset:6144
    ds_read_b64_tr_b16 v[164:165], v11 offset:32768
    s_add_u32 m0, s48, 108544
    ds_read_b64_tr_b16 v[166:167], v11 offset:33280
    buffer_load_dwordx4 v3, s[24:27], s46 offen offset:2048  lds
    ds_read_b64_tr_b16 v[208:209], v11 offset:36864
    ds_read_b64_tr_b16 v[210:211], v11 offset:37376
    ds_read_b64_tr_b16 v[168:169], v10 offset:40960
    s_add_u32 m0, s48, 114688
    ds_read_b64_tr_b16 v[170:171], v10 offset:41472
    buffer_load_dwordx4 v4, s[24:27], s46 offen  lds
    ds_read_b64_tr_b16 v[212:213], v10 offset:45056
    ds_read_b64_tr_b16 v[214:215], v10 offset:45568
    ds_read_b64_tr_b16 v[172:173], v11 offset:40960
    s_add_u32 m0, s48, 118784
    ds_read_b64_tr_b16 v[174:175], v11 offset:41472
    buffer_load_dwordx4 v5, s[24:27], s46 offen  lds
    ds_read_b64_tr_b16 v[216:217], v11 offset:45056
    ds_read_b64_tr_b16 v[218:219], v11 offset:45568
    ds_read_b64_tr_b16 v[176:177], v10 offset:49152
    ds_read_b64_tr_b16 v[178:179], v10 offset:49664
    ds_read_b64_tr_b16 v[220:221], v10 offset:53248
    ds_read_b64_tr_b16 v[222:223], v10 offset:53760
    ds_read_b64_tr_b16 v[180:181], v11 offset:49152
    ds_read_b64_tr_b16 v[182:183], v11 offset:49664
    ds_read_b64_tr_b16 v[224:225], v11 offset:53248
    ds_read_b64_tr_b16 v[226:227], v11 offset:53760
    s_add_u32 s47, s47, 1
    s_and_b32 s47, s47, 15
    s_mul_i32 s46, s47, 393216
    s_mov_b64 s[88:89], s[92:93]
    v_and_b32 v7, 15, v1
    v_lshrrev_b32 v0, 4, v1
    v_lshlrev_b32 v0, 10, v0
    v_lshl_add_u32 v0, v7, 5, v0
    v_lshlrev_b32 v7, 4, v7
    s_lshl_b32 s50, s40, 2
    s_add_u32 s50, s50, s43
    s_lshl_b32 s50, s50, 10
    s_add_u32 s94, s50, 18874368
    s_lshl_b32 s95, s41, 13
    s_add_u32 s95, s95, 18939904
    buffer_load_dwordx4 v[232:235], v7, s[28:31], s94 offen offset:0 sc1
    buffer_load_dwordx4 v[236:239], v7, s[28:31], s94 offen offset:256 sc1
    buffer_load_dwordx4 v[240:243], v7, s[28:31], s94 offen offset:512 sc1
    buffer_load_dwordx4 v[244:247], v7, s[28:31], s94 offen offset:768 sc1
    s_waitcnt lgkmcnt(0)
    s_load_dword s90, s[88:89], 0
    s_load_dword s90, s[88:89], 64
    s_load_dword s90, s[88:89], 128
    s_load_dword s90, s[88:89], 192
    s_load_dword s90, s[88:89], 256
    s_load_dword s90, s[88:89], 320
    s_load_dword s90, s[88:89], 384
    s_load_dword s90, s[88:89], 448
    s_call_b64 s[100:101], L_sub_c0_1
    v_add_u32 v8, s80, v6
    v_xor_b32 v9, 64, v8
    s_add_u32 s80, s80, 32768
    s_cmp_ge_u32 s80, 98304
    s_cselect_b32 s80, 0, s80
    ds_read_b64_tr_b16 v[160:161], v10 offset:0
    s_add_u32 m0, s48, 131072
    ds_read_b64_tr_b16 v[162:163], v10 offset:512
    buffer_load_dwordx4 v2, s[24:27], s46 offen  lds
    ds_read_b64_tr_b16 v[204:205], v10 offset:4096
    ds_read_b64_tr_b16 v[206:207], v10 offset:4608
    ds_read_b128 v[144:147], v8 offset:0
    s_add_u32 m0, s48, 135168
    ds_read_b128 v[148:151], v8 offset:2048
    buffer_load_dwordx4 v3, s[24:27], s46 offen  lds
    ds_read_b128 v[152:155], v8 offset:4096
    ds_read_b128 v[156:159], v8 offset:6144
    ds_read_b128 v[188:191], v9 offset:0
    s_add_u32 m0, s48, 137216
    ds_read_b128 v[192:195], v9 offset:2048
    buffer_load_dwordx4 v2, s[24:27], s46 offen offset:2048  lds
    ds_read_b128 v[196:199], v9 offset:4096
    ds_read_b128 v[200:203], v9 offset:6144
    ds_read_b64_tr_b16 v[164:165], v11 offset:0
    s_add_u32 m0, s48, 141312
    ds_read_b64_tr_b16 v[166:167], v11 offset:512
    buffer_load_dwordx4 v3, s[24:27], s46 offen offset:2048  lds
    ds_read_b64_tr_b16 v[208:209], v11 offset:4096
    ds_read_b64_tr_b16 v[210:211], v11 offset:4608
    ds_read_b64_tr_b16 v[168:169], v10 offset:8192
    s_add_u32 m0, s48, 147456
    ds_read_b64_tr_b16 v[170:171], v10 offset:8704
    buffer_load_dwordx4 v4, s[24:27], s46 offen  lds
    ds_read_b64_tr_b16 v[212:213], v10 offset:12288
    ds_read_b64_tr_b16 v[214:215], v10 offset:12800
    ds_read_b64_tr_b16 v[172:173], v11 offset:8192
    s_add_u32 m0, s48, 151552
    ds_read_b64_tr_b16 v[174:175], v11 offset:8704
    buffer_load_dwordx4 v5, s[24:27], s46 offen  lds
    ds_read_b64_tr_b16 v[216:217], v11 offset:12288
    ds_read_b64_tr_b16 v[218:219], v11 offset:12800
    ds_read_b64_tr_b16 v[176:177], v10 offset:16384
    ds_read_b64_tr_b16 v[178:179], v10 offset:16896
    ds_read_b64_tr_b16 v[220:221], v10 offset:20480
    ds_read_b64_tr_b16 v[222:223], v10 offset:20992
    ds_read_b64_tr_b16 v[180:181], v11 offset:16384
    ds_read_b64_tr_b16 v[182:183], v11 offset:16896
    ds_read_b64_tr_b16 v[224:225], v11 offset:20480
    ds_read_b64_tr_b16 v[226:227], v11 offset:20992
    s_add_u32 s47, s47, 1
    s_and_b32 s47, s47, 15
    s_mul_i32 s46, s47, 393216
    s_add_u32 s88, s88, 512
    s_addc_u32 s89, s89, 0
    buffer_load_dwordx4 v[20:23], v0, s[28:31], s95 offen offset:0 sc1
    buffer_load_dwordx4 v[24:27], v0, s[28:31], s95 offen offset:16 sc1
    buffer_load_dwordx4 v[248:251], v0, s[28:31], s95 offen offset:512 sc1
    buffer_load_dwordx4 v[252:255], v0, s[28:31], s95 offen offset:528 sc1
    s_waitcnt lgkmcnt(0)
    s_load_dword s90, s[88:89], 0
    s_load_dword s90, s[88:89], 64
    s_load_dword s90, s[88:89], 128
    s_load_dword s90, s[88:89], 192
    s_load_dword s90, s[88:89], 256
    s_load_dword s90, s[88:89], 320
    s_load_dword s90, s[88:89], 384
    s_load_dword s90, s[88:89], 448
    s_call_b64 s[100:101], L_sub_c0_1
    v_add_u32 v8, s80, v6
    v_xor_b32 v9, 64, v8
    s_add_u32 s80, s80, 32768
    s_cmp_ge_u32 s80, 98304
    s_cselect_b32 s80, 0, s80
    ds_read_b64_tr_b16 v[160:161], v10 offset:32768
    ds_read_b64_tr_b16 v[162:163], v10 offset:33280
    ds_read_b64_tr_b16 v[204:205], v10 offset:36864
    ds_read_b64_tr_b16 v[206:207], v10 offset:37376
    ds_read_b128 v[144:147], v8 offset:0
    ds_read_b128 v[148:151], v8 offset:2048
    ds_read_b128 v[152:155], v8 offset:4096
    ds_read_b128 v[156:159], v8 offset:6144
    ds_read_b128 v[188:191], v9 offset:0
    ds_read_b128 v[192:195], v9 offset:2048
    ds_read_b128 v[196:199], v9 offset:4096
    ds_read_b128 v[200:203], v9 offset:6144
    ds_read_b64_tr_b16 v[164:165], v11 offset:32768
    ds_read_b64_tr_b16 v[166:167], v11 offset:33280
    ds_read_b64_tr_b16 v[208:209], v11 offset:36864
    ds_read_b64_tr_b16 v[210:211], v11 offset:37376
    ds_read_b64_tr_b16 v[168:169], v10 offset:40960
    ds_read_b64_tr_b16 v[170:171], v10 offset:41472
    ds_read_b64_tr_b16 v[212:213], v10 offset:45056
    ds_read_b64_tr_b16 v[214:215], v10 offset:45568
    ds_read_b64_tr_b16 v[172:173], v11 offset:40960
    ds_read_b64_tr_b16 v[174:175], v11 offset:41472
    ds_read_b64_tr_b16 v[216:217], v11 offset:45056
    ds_read_b64_tr_b16 v[218:219], v11 offset:45568
    ds_read_b64_tr_b16 v[176:177], v10 offset:49152
    ds_read_b64_tr_b16 v[178:179], v10 offset:49664
    ds_read_b64_tr_b16 v[220:221], v10 offset:53248
    ds_read_b64_tr_b16 v[222:223], v10 offset:53760
    ds_read_b64_tr_b16 v[180:181], v11 offset:49152
    ds_read_b64_tr_b16 v[182:183], v11 offset:49664
    ds_read_b64_tr_b16 v[224:225], v11 offset:53248
    ds_read_b64_tr_b16 v[226:227], v11 offset:53760
    s_waitcnt lgkmcnt(0)
    s_call_b64 s[100:101], L_sub_c0_2
    s_mov_b32 s57, 0x3fb8aa3b
    s_mov_b32 s63, 0x20000
L_poll_1038:
    v_pk_add_f32 v[144:145], v[20:21], v[248:249]
    v_pk_add_f32 v[146:147], v[22:23], v[250:251]
    v_pk_add_f32 v[148:149], v[24:25], v[252:253]
    v_pk_add_f32 v[150:151], v[26:27], v[254:255]
    v_pk_add_f32 v[152:153], v[144:145], v[146:147]
    v_add_f32 v154, v235, v239
    v_add_f32 v155, v243, v247
    v_pk_add_f32 v[152:153], v[152:153], v[148:149]
    v_pk_add_f32 v[152:153], v[152:153], v[154:155]
    v_cmp_u_f32 vcc, v152, v153
    s_nop 0
    s_cmp_eq_u64 vcc, 0
    s_cbranch_scc1 L_go_1039
    s_sleep 4
    buffer_load_dwordx4 v[20:23], v0, s[28:31], s95 offen offset:0 sc1
    buffer_load_dwordx4 v[24:27], v0, s[28:31], s95 offen offset:16 sc1
    buffer_load_dwordx4 v[248:251], v0, s[28:31], s95 offen offset:512 sc1
    buffer_load_dwordx4 v[252:255], v0, s[28:31], s95 offen offset:528 sc1
    buffer_load_dwordx4 v[232:235], v7, s[28:31], s94 offen offset:0 sc1
    buffer_load_dwordx4 v[236:239], v7, s[28:31], s94 offen offset:256 sc1
    buffer_load_dwordx4 v[240:243], v7, s[28:31], s94 offen offset:512 sc1
    buffer_load_dwordx4 v[244:247], v7, s[28:31], s94 offen offset:768 sc1
    s_waitcnt vmcnt(0)
    s_sub_u32 s63, s63, 1
    s_cmp_lg_u32 s63, 0
    s_cbranch_scc1 L_poll_1038
L_go_1039:
    v_and_b32 v7, 15, v1
    v_lshlrev_b32 v7, 2, v7
    s_lshl_b32 s50, s42, 8
    s_add_u32 s50, s50, 110592
    v_add_u32 v7, s50, v7
    v_and_b32 v0, 48, v1
    v_add_u32 v0, s50, v0
    ds_write_b32 v7, v235 offset:0
    ds_write_b32 v7, v239 offset:64
    ds_write_b32 v7, v243 offset:128
    ds_write_b32 v7, v247 offset:192
    ds_read_b128 v[128:131], v0 offset:0
    ds_read_b128 v[132:135], v0 offset:64
    ds_read_b128 v[136:139], v0 offset:128
    ds_read_b128 v[140:143], v0 offset:192
    v_mul_f32 v216, s57, v235
    v_mov_b32 v235, 0
    v_mul_f32 v218, s57, v239
    v_mov_b32 v239, 0
    v_mul_f32 v220, s57, v243
    v_mov_b32 v243, 0
    v_mul_f32 v222, s57, v247
    v_mov_b32 v247, 0
    v_cvt_pk_bf16_f32 v160, v144, v144
    v_and_b32 v156, 0xffff0000, v160
    v_sub_f32 v144, v144, v156
    v_cvt_pk_bf16_f32 v161, v144, 0
    v_mov_b32 v162, 0
    v_mov_b32 v163, 0
    v_cvt_pk_bf16_f32 v164, v145, v145
    v_and_b32 v157, 0xffff0000, v164
    v_sub_f32 v145, v145, v157
    v_cvt_pk_bf16_f32 v165, v145, 0
    v_mov_b32 v166, 0
    v_mov_b32 v167, 0
    v_cvt_pk_bf16_f32 v168, v146, v146
    v_and_b32 v156, 0xffff0000, v168
    v_sub_f32 v146, v146, v156
    v_cvt_pk_bf16_f32 v169, v146, 0
    v_mov_b32 v170, 0
    v_mov_b32 v171, 0
    v_cvt_pk_bf16_f32 v172, v147, v147
    v_and_b32 v157, 0xffff0000, v172
    v_sub_f32 v147, v147, v157
    v_cvt_pk_bf16_f32 v173, v147, 0
    v_mov_b32 v174, 0
    v_mov_b32 v175, 0
    v_cvt_pk_bf16_f32 v176, v148, v148
    v_and_b32 v156, 0xffff0000, v176
    v_sub_f32 v148, v148, v156
    v_cvt_pk_bf16_f32 v177, v148, 0
    v_mov_b32 v178, 0
    v_mov_b32 v179, 0
    v_cvt_pk_bf16_f32 v180, v149, v149
    v_and_b32 v157, 0xffff0000, v180
    v_sub_f32 v149, v149, v157
    v_cvt_pk_bf16_f32 v181, v149, 0
    v_mov_b32 v182, 0
    v_mov_b32 v183, 0
    v_mfma_f32_16x16x32_bf16 v[32:35], v[160:163], v[232:235], v[32:35]
    v_mfma_f32_16x16x32_bf16 v[36:39], v[160:163], v[236:239], v[36:39]
    v_mfma_f32_16x16x32_bf16 v[40:43], v[160:163], v[240:243], v[40:43]
    v_mfma_f32_16x16x32_bf16 v[44:47], v[160:163], v[244:247], v[44:47]
    v_mfma_f32_16x16x32_bf16 v[48:51], v[164:167], v[232:235], v[48:51]
    v_mfma_f32_16x16x32_bf16 v[52:55], v[164:167], v[236:239], v[52:55]
    v_mfma_f32_16x16x32_bf16 v[56:59], v[164:167], v[240:243], v[56:59]
    v_mfma_f32_16x16x32_bf16 v[60:63], v[164:167], v[244:247], v[60:63]
    v_mfma_f32_16x16x32_bf16 v[64:67], v[168:171], v[232:235], v[64:67]
    v_mfma_f32_16x16x32_bf16 v[68:71], v[168:171], v[236:239], v[68:71]
    v_mfma_f32_16x16x32_bf16 v[72:75], v[168:171], v[240:243], v[72:75]
    v_mfma_f32_16x16x32_bf16 v[76:79], v[168:171], v[244:247], v[76:79]
    v_mfma_f32_16x16x32_bf16 v[80:83], v[172:175], v[232:235], v[80:83]
    v_mfma_f32_16x16x32_bf16 v[84:87], v[172:175], v[236:239], v[84:87]
    v_mfma_f32_16x16x32_bf16 v[88:91], v[172:175], v[240:243], v[88:91]
    v_mfma_f32_16x16x32_bf16 v[92:95], v[172:175], v[244:247], v[92:95]
    v_mfma_f32_16x16x32_bf16 v[96:99], v[232:235], v[176:179], v[96:99]
    v_mfma_f32_16x16x32_bf16 v[100:103], v[236:239], v[176:179], v[100:103]
    v_mfma_f32_16x16x32_bf16 v[104:107], v[240:243], v[176:179], v[104:107]
    v_mfma_f32_16x16x32_bf16 v[108:111], v[244:247], v[176:179], v[108:111]
    v_mfma_f32_16x16x32_bf16 v[112:115], v[232:235], v[180:183], v[112:115]
    v_mfma_f32_16x16x32_bf16 v[116:119], v[236:239], v[180:183], v[116:119]
    v_mfma_f32_16x16x32_bf16 v[120:123], v[240:243], v[180:183], v[120:123]
    v_mfma_f32_16x16x32_bf16 v[124:127], v[244:247], v[180:183], v[124:127]
    v_lshrrev_b32 v15, 2, v1
    v_lshlrev_b32 v15, 6, v15
    v_and_b32 v28, 3, v1
    v_lshl_add_u32 v15, v28, 3, v15
    s_lshl_b32 s50, s44, 11
    s_add_u32 s50, s50, 122880
    v_add_u32 v15, s50, v15
    ds_read_b64_tr_b16 v[224:225], v15 offset:0
    ds_read_b64_tr_b16 v[226:227], v15 offset:1024
    ds_read_b64_tr_b16 v[228:229], v15 offset:32
    ds_read_b64_tr_b16 v[230:231], v15 offset:1056
    s_mul_i32 s50, s44, 49152
    s_lshl_b32 s51, s43, 12
    s_add_u32 s51, s51, s50
    v_lshlrev_b32 v15, 4, v1
    v_add_u32 v28, s51, v15
    s_waitcnt lgkmcnt(7)
    v_pk_mul_f32 v[96:97], v[96:97], v[128:129]
    v_pk_mul_f32 v[98:99], v[98:99], v[130:131]
    s_waitcnt lgkmcnt(6)
    v_pk_mul_f32 v[100:101], v[100:101], v[132:133]
    v_pk_mul_f32 v[102:103], v[102:103], v[134:135]
    s_waitcnt lgkmcnt(5)
    v_pk_mul_f32 v[104:105], v[104:105], v[136:137]
    v_pk_mul_f32 v[106:107], v[106:107], v[138:139]
    s_waitcnt lgkmcnt(4)
    v_pk_mul_f32 v[108:109], v[108:109], v[140:141]
    v_pk_mul_f32 v[110:111], v[110:111], v[142:143]
    v_pk_mul_f32 v[112:113], v[112:113], v[128:129]
    v_pk_mul_f32 v[114:115], v[114:115], v[130:131]
    v_pk_mul_f32 v[116:117], v[116:117], v[132:133]
    v_pk_mul_f32 v[118:119], v[118:119], v[134:135]
    v_pk_mul_f32 v[120:121], v[120:121], v[136:137]
    v_pk_mul_f32 v[122:123], v[122:123], v[138:139]
    v_pk_mul_f32 v[124:125], v[124:125], v[140:141]
    v_pk_mul_f32 v[126:127], v[126:127], v[142:143]
    v_cvt_pk_bf16_f32 v240, v96, v97
    v_cvt_pk_bf16_f32 v241, v98, v99
    v_cvt_pk_bf16_f32 v242, v100, v101
    v_cvt_pk_bf16_f32 v243, v102, v103
    v_cvt_pk_bf16_f32 v244, v104, v105
    v_cvt_pk_bf16_f32 v245, v106, v107
    v_cvt_pk_bf16_f32 v246, v108, v109
    v_cvt_pk_bf16_f32 v247, v110, v111
    ds_write_b128 v28, v[240:243] offset:32768
    ds_write_b128 v28, v[244:247] offset:33792
    v_cvt_pk_bf16_f32 v248, v112, v113
    v_cvt_pk_bf16_f32 v249, v114, v115
    v_cvt_pk_bf16_f32 v250, v116, v117
    v_cvt_pk_bf16_f32 v251, v118, v119
    v_cvt_pk_bf16_f32 v252, v120, v121
    v_cvt_pk_bf16_f32 v253, v122, v123
    v_cvt_pk_bf16_f32 v254, v124, v125
    v_cvt_pk_bf16_f32 v255, v126, v127
    ds_write_b128 v28, v[248:251] offset:34816
    ds_write_b128 v28, v[252:255] offset:35840
    v_bfe_u32 v208, v1, 1, 2
    v_lshlrev_b32 v208, 2, v208
    v_and_b32 v209, 1, v1
    v_or_b32 v208, v208, v209
    v_bfe_u32 v209, v1, 3, 1
    v_lshl_or_b32 v208, v209, 1, v208
    v_lshrrev_b32 v209, 4, v1
    v_xor_b32 v208, v208, v209
    v_and_b32 v209, 15, v1
    v_lshlrev_b32 v209, 7, v209
    s_lshl_b32 s51, s43, 13
    s_add_u32 s51, s51, s50
    v_add_u32 v209, s51, v209
    v_xor_b32 v200, 0, v208
    v_lshl_add_u32 v200, v200, 3, v209
    v_xor_b32 v201, 4, v208
    v_lshl_add_u32 v201, v201, 3, v209
    v_xor_b32 v202, 8, v208
    v_lshl_add_u32 v202, v202, 3, v209
    v_xor_b32 v203, 12, v208
    v_lshl_add_u32 v203, v203, 3, v209
    v_lshrrev_b32 v209, 2, v1
    v_bfe_u32 v208, v209, 1, 2
    v_lshlrev_b32 v208, 2, v208
    v_and_b32 v205, 1, v209
    v_or_b32 v208, v208, v205
    v_bfe_u32 v205, v209, 3, 1
    v_lshl_or_b32 v208, v205, 1, v208
    v_and_b32 v205, 3, v1
    v_xor_b32 v208, v208, v205
    s_lshl_b32 s51, s43, 2
    v_xor_b32 v208, s51, v208
    v_lshlrev_b32 v209, 7, v209
    v_add_u32 v209, s50, v209
    v_lshl_add_u32 v204, v208, 3, v209
    v_add_u32 v205, s50, v15
    v_cvt_pk_bf16_f32 v144, v64, v65
    v_cvt_pk_bf16_f32 v145, v66, v67
    v_cvt_pk_bf16_f32 v146, v80, v81
    v_cvt_pk_bf16_f32 v147, v82, v83
    v_cvt_pk_bf16_f32 v148, v68, v69
    v_cvt_pk_bf16_f32 v149, v70, v71
    v_cvt_pk_bf16_f32 v150, v84, v85
    v_cvt_pk_bf16_f32 v151, v86, v87
    s_waitcnt lgkmcnt(6)
    v_mfma_f32_16x16x32_bf16 v[64:67], v[224:227], v[144:147], 0
    s_waitcnt lgkmcnt(4)
    v_mfma_f32_16x16x32_bf16 v[80:83], v[228:231], v[144:147], 0
    v_cvt_pk_bf16_f32 v152, v72, v73
    v_cvt_pk_bf16_f32 v153, v74, v75
    v_cvt_pk_bf16_f32 v154, v88, v89
    v_cvt_pk_bf16_f32 v155, v90, v91
    v_mfma_f32_16x16x32_bf16 v[68:71], v[224:227], v[148:151], 0
    v_mfma_f32_16x16x32_bf16 v[84:87], v[228:231], v[148:151], 0
    v_cvt_pk_bf16_f32 v156, v76, v77
    v_cvt_pk_bf16_f32 v157, v78, v79
    v_cvt_pk_bf16_f32 v158, v92, v93
    v_cvt_pk_bf16_f32 v159, v94, v95
    v_mfma_f32_16x16x32_bf16 v[72:75], v[224:227], v[152:155], 0
    v_mfma_f32_16x16x32_bf16 v[88:91], v[228:231], v[152:155], 0
    v_mfma_f32_16x16x32_bf16 v[76:79], v[224:227], v[156:159], 0
    v_mfma_f32_16x16x32_bf16 v[92:95], v[228:231], v[156:159], 0
    v_max3_f32 v192, v64, v65, v66
    v_min3_f32 v196, v64, v65, v66
    v_max3_f32 v192, v192, v67, v80
    v_min3_f32 v196, v196, v67, v80
    v_max3_f32 v192, v192, v81, v82
    v_min3_f32 v196, v196, v81, v82
    v_max_f32 v192, v192, v83
    v_min_f32 v196, v196, v83
    v_max3_f32 v193, v68, v69, v70
    v_min3_f32 v197, v68, v69, v70
    v_max3_f32 v193, v193, v71, v84
    v_min3_f32 v197, v197, v71, v84
    v_max3_f32 v193, v193, v85, v86
    v_min3_f32 v197, v197, v85, v86
    v_max_f32 v193, v193, v87
    v_min_f32 v197, v197, v87
    v_max3_f32 v194, v72, v73, v74
    v_min3_f32 v198, v72, v73, v74
    v_max3_f32 v194, v194, v75, v88
    v_min3_f32 v198, v198, v75, v88
    v_max3_f32 v194, v194, v89, v90
    v_min3_f32 v198, v198, v89, v90
    v_max_f32 v194, v194, v91
    v_min_f32 v198, v198, v91
    v_max3_f32 v195, v76, v77, v78
    v_min3_f32 v199, v76, v77, v78
    v_max3_f32 v195, v195, v79, v92
    v_min3_f32 v199, v199, v79, v92
    v_max3_f32 v195, v195, v93, v94
    v_min3_f32 v199, v199, v93, v94
    v_max_f32 v195, v195, v95
    v_min_f32 v199, v199, v95
    v_permlane32_swap_b32 v192, v193
    v_permlane32_swap_b32 v194, v195
    v_permlane32_swap_b32 v196, v197
    v_permlane32_swap_b32 v198, v199
    v_max_f32 v192, v192, v193
    v_max_f32 v194, v194, v195
    v_min_f32 v196, v196, v197
    v_min_f32 v198, v198, v199
    v_permlane16_swap_b32 v192, v194
    s_nop 0
    v_permlane16_swap_b32 v196, v198
    v_max_f32 v192, v192, v194
    v_min_f32 v196, v196, v198
    v_mov_b32 v194, v192
    v_mov_b32 v198, v196
    s_nop 0
    v_permlane16_swap_b32 v192, v194
    v_permlane16_swap_b32 v196, v198
    v_mov_b32 v193, v192
    v_mov_b32 v195, v194
    v_mov_b32 v197, v196
    v_mov_b32 v199, v198
    v_permlane32_swap_b32 v192, v193
    v_permlane32_swap_b32 v194, v195
    v_permlane32_swap_b32 v196, v197
    v_permlane32_swap_b32 v198, v199
    v_mul_f32 v144, v192, v216
    v_mul_f32 v146, v196, v216
    v_mul_f32 v148, v193, v218
    v_mul_f32 v150, v197, v218
    v_mul_f32 v152, v194, v220
    v_mul_f32 v154, v198, v220
    v_mul_f32 v156, v195, v222
    v_mul_f32 v158, v199, v222
    v_pk_fma_f32 v[160:161], v[64:65], v[216:217], v[144:145] op_sel_hi:[1,0,0] neg_lo:[0,0,1] neg_hi:[0,0,1]
    v_pk_fma_f32 v[162:163], v[66:67], v[216:217], v[144:145] op_sel_hi:[1,0,0] neg_lo:[0,0,1] neg_hi:[0,0,1]
    v_pk_fma_f32 v[164:165], v[80:81], v[216:217], v[144:145] op_sel_hi:[1,0,0] neg_lo:[0,0,1] neg_hi:[0,0,1]
    v_pk_fma_f32 v[166:167], v[82:83], v[216:217], v[144:145] op_sel_hi:[1,0,0] neg_lo:[0,0,1] neg_hi:[0,0,1]
    v_pk_fma_f32 v[64:65], v[64:65], v[216:217], v[146:147] op_sel_hi:[1,0,0] neg_lo:[1,0,0] neg_hi:[1,0,0]
    v_pk_fma_f32 v[66:67], v[66:67], v[216:217], v[146:147] op_sel_hi:[1,0,0] neg_lo:[1,0,0] neg_hi:[1,0,0]
    v_pk_fma_f32 v[80:81], v[80:81], v[216:217], v[146:147] op_sel_hi:[1,0,0] neg_lo:[1,0,0] neg_hi:[1,0,0]
    v_pk_fma_f32 v[82:83], v[82:83], v[216:217], v[146:147] op_sel_hi:[1,0,0] neg_lo:[1,0,0] neg_hi:[1,0,0]
    v_exp_f32 v160, v160
    v_exp_f32 v161, v161
    v_exp_f32 v162, v162
    v_exp_f32 v163, v163
    v_exp_f32 v164, v164
    v_exp_f32 v165, v165
    v_exp_f32 v166, v166
    v_exp_f32 v167, v167
    v_exp_f32 v64, v64
    v_exp_f32 v65, v65
    v_exp_f32 v66, v66
    v_exp_f32 v67, v67
    v_exp_f32 v80, v80
    v_exp_f32 v81, v81
    v_exp_f32 v82, v82
    v_exp_f32 v83, v83
    v_pk_add_f32 v[232:233], v[160:161], v[162:163]
    v_pk_add_f32 v[234:235], v[164:165], v[166:167]
    v_pk_add_f32 v[236:237], v[64:65], v[66:67]
    v_pk_add_f32 v[238:239], v[80:81], v[82:83]
    v_pk_add_f32 v[232:233], v[232:233], v[234:235]
    v_pk_add_f32 v[236:237], v[236:237], v[238:239]
    v_add_f32 v192, v232, v233
    v_add_f32 v196, v236, v237
    v_pk_fma_f32 v[168:169], v[68:69], v[218:219], v[148:149] op_sel_hi:[1,0,0] neg_lo:[0,0,1] neg_hi:[0,0,1]
    v_pk_fma_f32 v[170:171], v[70:71], v[218:219], v[148:149] op_sel_hi:[1,0,0] neg_lo:[0,0,1] neg_hi:[0,0,1]
    v_pk_fma_f32 v[172:173], v[84:85], v[218:219], v[148:149] op_sel_hi:[1,0,0] neg_lo:[0,0,1] neg_hi:[0,0,1]
    v_pk_fma_f32 v[174:175], v[86:87], v[218:219], v[148:149] op_sel_hi:[1,0,0] neg_lo:[0,0,1] neg_hi:[0,0,1]
    v_pk_fma_f32 v[68:69], v[68:69], v[218:219], v[150:151] op_sel_hi:[1,0,0] neg_lo:[1,0,0] neg_hi:[1,0,0]
    v_pk_fma_f32 v[70:71], v[70:71], v[218:219], v[150:151] op_sel_hi:[1,0,0] neg_lo:[1,0,0] neg_hi:[1,0,0]
    v_pk_fma_f32 v[84:85], v[84:85], v[218:219], v[150:151] op_sel_hi:[1,0,0] neg_lo:[1,0,0] neg_hi:[1,0,0]
    v_pk_fma_f32 v[86:87], v[86:87], v[218:219], v[150:151] op_sel_hi:[1,0,0] neg_lo:[1,0,0] neg_hi:[1,0,0]
    v_exp_f32 v168, v168
    v_exp_f32 v169, v169
    v_exp_f32 v170, v170
    v_exp_f32 v171, v171
    v_exp_f32 v172, v172
    v_exp_f32 v173, v173
    v_exp_f32 v174, v174
    v_exp_f32 v175, v175
    v_exp_f32 v68, v68
    v_exp_f32 v69, v69
    v_exp_f32 v70, v70
    v_exp_f32 v71, v71
    v_exp_f32 v84, v84
    v_exp_f32 v85, v85
    v_exp_f32 v86, v86
    v_exp_f32 v87, v87
    v_pk_add_f32 v[232:233], v[168:169], v[170:171]
    v_pk_add_f32 v[234:235], v[172:173], v[174:175]
    v_pk_add_f32 v[236:237], v[68:69], v[70:71]
    v_pk_add_f32 v[238:239], v[84:85], v[86:87]
    v_pk_add_f32 v[232:233], v[232:233], v[234:235]
    v_pk_add_f32 v[236:237], v[236:237], v[238:239]
    v_add_f32 v193, v232, v233
    v_add_f32 v197, v236, v237
    v_pk_fma_f32 v[176:177], v[72:73], v[220:221], v[152:153] op_sel_hi:[1,0,0] neg_lo:[0,0,1] neg_hi:[0,0,1]
    v_pk_fma_f32 v[178:179], v[74:75], v[220:221], v[152:153] op_sel_hi:[1,0,0] neg_lo:[0,0,1] neg_hi:[0,0,1]
    v_pk_fma_f32 v[180:181], v[88:89], v[220:221], v[152:153] op_sel_hi:[1,0,0] neg_lo:[0,0,1] neg_hi:[0,0,1]
    v_pk_fma_f32 v[182:183], v[90:91], v[220:221], v[152:153] op_sel_hi:[1,0,0] neg_lo:[0,0,1] neg_hi:[0,0,1]
    v_pk_fma_f32 v[72:73], v[72:73], v[220:221], v[154:155] op_sel_hi:[1,0,0] neg_lo:[1,0,0] neg_hi:[1,0,0]
    v_pk_fma_f32 v[74:75], v[74:75], v[220:221], v[154:155] op_sel_hi:[1,0,0] neg_lo:[1,0,0] neg_hi:[1,0,0]
    v_pk_fma_f32 v[88:89], v[88:89], v[220:221], v[154:155] op_sel_hi:[1,0,0] neg_lo:[1,0,0] neg_hi:[1,0,0]
    v_pk_fma_f32 v[90:91], v[90:91], v[220:221], v[154:155] op_sel_hi:[1,0,0] neg_lo:[1,0,0] neg_hi:[1,0,0]
    v_exp_f32 v176, v176
    v_exp_f32 v177, v177
    v_exp_f32 v178, v178
    v_exp_f32 v179, v179
    v_exp_f32 v180, v180
    v_exp_f32 v181, v181
    v_exp_f32 v182, v182
    v_exp_f32 v183, v183
    v_exp_f32 v72, v72
    v_exp_f32 v73, v73
    v_exp_f32 v74, v74
    v_exp_f32 v75, v75
    v_exp_f32 v88, v88
    v_exp_f32 v89, v89
    v_exp_f32 v90, v90
    v_exp_f32 v91, v91
    v_pk_add_f32 v[232:233], v[176:177], v[178:179]
    v_pk_add_f32 v[234:235], v[180:181], v[182:183]
    v_pk_add_f32 v[236:237], v[72:73], v[74:75]
    v_pk_add_f32 v[238:239], v[88:89], v[90:91]
    v_pk_add_f32 v[232:233], v[232:233], v[234:235]
    v_pk_add_f32 v[236:237], v[236:237], v[238:239]
    v_add_f32 v194, v232, v233
    v_add_f32 v198, v236, v237
    v_pk_fma_f32 v[184:185], v[76:77], v[222:223], v[156:157] op_sel_hi:[1,0,0] neg_lo:[0,0,1] neg_hi:[0,0,1]
    v_pk_fma_f32 v[186:187], v[78:79], v[222:223], v[156:157] op_sel_hi:[1,0,0] neg_lo:[0,0,1] neg_hi:[0,0,1]
    v_pk_fma_f32 v[188:189], v[92:93], v[222:223], v[156:157] op_sel_hi:[1,0,0] neg_lo:[0,0,1] neg_hi:[0,0,1]
    v_pk_fma_f32 v[190:191], v[94:95], v[222:223], v[156:157] op_sel_hi:[1,0,0] neg_lo:[0,0,1] neg_hi:[0,0,1]
    v_pk_fma_f32 v[76:77], v[76:77], v[222:223], v[158:159] op_sel_hi:[1,0,0] neg_lo:[1,0,0] neg_hi:[1,0,0]
    v_pk_fma_f32 v[78:79], v[78:79], v[222:223], v[158:159] op_sel_hi:[1,0,0] neg_lo:[1,0,0] neg_hi:[1,0,0]
    v_pk_fma_f32 v[92:93], v[92:93], v[222:223], v[158:159] op_sel_hi:[1,0,0] neg_lo:[1,0,0] neg_hi:[1,0,0]
    v_pk_fma_f32 v[94:95], v[94:95], v[222:223], v[158:159] op_sel_hi:[1,0,0] neg_lo:[1,0,0] neg_hi:[1,0,0]
    v_exp_f32 v184, v184
    v_exp_f32 v185, v185
    v_exp_f32 v186, v186
    v_exp_f32 v187, v187
    v_exp_f32 v188, v188
    v_exp_f32 v189, v189
    v_exp_f32 v190, v190
    v_exp_f32 v191, v191
    v_exp_f32 v76, v76
    v_exp_f32 v77, v77
    v_exp_f32 v78, v78
    v_exp_f32 v79, v79
    v_exp_f32 v92, v92
    v_exp_f32 v93, v93
    v_exp_f32 v94, v94
    v_exp_f32 v95, v95
    v_pk_add_f32 v[232:233], v[184:185], v[186:187]
    v_pk_add_f32 v[234:235], v[188:189], v[190:191]
    v_pk_add_f32 v[236:237], v[76:77], v[78:79]
    v_pk_add_f32 v[238:239], v[92:93], v[94:95]
    v_pk_add_f32 v[232:233], v[232:233], v[234:235]
    v_pk_add_f32 v[236:237], v[236:237], v[238:239]
    v_add_f32 v195, v232, v233
    v_add_f32 v199, v236, v237
    v_permlane32_swap_b32 v192, v193
    v_permlane32_swap_b32 v194, v195
    v_permlane32_swap_b32 v196, v197
    v_permlane32_swap_b32 v198, v199
    v_add_f32 v192, v192, v193
    v_add_f32 v194, v194, v195
    v_add_f32 v196, v196, v197
    v_add_f32 v198, v198, v199
    v_permlane16_swap_b32 v192, v194
    s_nop 0
    v_permlane16_swap_b32 v196, v198
    v_add_f32 v192, v192, v194
    v_add_f32 v196, v196, v198
    v_mov_b32 v194, v192
    v_mov_b32 v198, v196
    s_nop 0
    v_permlane16_swap_b32 v192, v194
    v_permlane16_swap_b32 v196, v198
    v_mov_b32 v193, v192
    v_mov_b32 v195, v194
    v_mov_b32 v197, v196
    v_mov_b32 v199, v198
    v_permlane32_swap_b32 v192, v193
    v_permlane32_swap_b32 v194, v195
    v_permlane32_swap_b32 v196, v197
    v_permlane32_swap_b32 v198, v199
    v_rcp_f32 v144, v192
    v_rcp_f32 v146, v196
    v_rcp_f32 v148, v193
    v_rcp_f32 v150, v197
    v_rcp_f32 v152, v194
    v_rcp_f32 v154, v198
    v_rcp_f32 v156, v195
    v_rcp_f32 v158, v199
    v_pk_mul_f32 v[160:161], v[160:161], v[144:145] op_sel_hi:[1,0]
    v_pk_mul_f32 v[162:163], v[162:163], v[144:145] op_sel_hi:[1,0]
    v_pk_mul_f32 v[164:165], v[164:165], v[144:145] op_sel_hi:[1,0]
    v_pk_mul_f32 v[166:167], v[166:167], v[144:145] op_sel_hi:[1,0]
    v_pk_mul_f32 v[64:65], v[64:65], v[146:147] op_sel_hi:[1,0]
    v_pk_mul_f32 v[66:67], v[66:67], v[146:147] op_sel_hi:[1,0]
    v_pk_mul_f32 v[80:81], v[80:81], v[146:147] op_sel_hi:[1,0]
    v_pk_mul_f32 v[82:83], v[82:83], v[146:147] op_sel_hi:[1,0]
    v_cvt_pk_bf16_f32 v96, v160, v161
    v_cvt_pk_bf16_f32 v97, v162, v163
    v_cvt_pk_bf16_f32 v98, v164, v165
    v_cvt_pk_bf16_f32 v99, v166, v167
    v_cvt_pk_bf16_f32 v100, v64, v65
    v_cvt_pk_bf16_f32 v101, v66, v67
    v_cvt_pk_bf16_f32 v102, v80, v81
    v_cvt_pk_bf16_f32 v103, v82, v83
    ds_write_b64 v200, v[96:97] offset:0
    ds_write_b64 v201, v[98:99] offset:0
    ds_write_b64 v202, v[100:101] offset:0
    ds_write_b64 v203, v[102:103] offset:0
    v_pk_mul_f32 v[168:169], v[168:169], v[148:149] op_sel_hi:[1,0]
    v_pk_mul_f32 v[170:171], v[170:171], v[148:149] op_sel_hi:[1,0]
    v_pk_mul_f32 v[172:173], v[172:173], v[148:149] op_sel_hi:[1,0]
    v_pk_mul_f32 v[174:175], v[174:175], v[148:149] op_sel_hi:[1,0]
    v_pk_mul_f32 v[68:69], v[68:69], v[150:151] op_sel_hi:[1,0]
    v_pk_mul_f32 v[70:71], v[70:71], v[150:151] op_sel_hi:[1,0]
    v_pk_mul_f32 v[84:85], v[84:85], v[150:151] op_sel_hi:[1,0]
    v_pk_mul_f32 v[86:87], v[86:87], v[150:151] op_sel_hi:[1,0]
    v_cvt_pk_bf16_f32 v104, v168, v169
    v_cvt_pk_bf16_f32 v105, v170, v171
    v_cvt_pk_bf16_f32 v106, v172, v173
    v_cvt_pk_bf16_f32 v107, v174, v175
    v_cvt_pk_bf16_f32 v108, v68, v69
    v_cvt_pk_bf16_f32 v109, v70, v71
    v_cvt_pk_bf16_f32 v110, v84, v85
    v_cvt_pk_bf16_f32 v111, v86, v87
    ds_write_b64 v200, v[104:105] offset:2048
    ds_write_b64 v201, v[106:107] offset:2048
    ds_write_b64 v202, v[108:109] offset:2048
    ds_write_b64 v203, v[110:111] offset:2048
    v_pk_mul_f32 v[176:177], v[176:177], v[152:153] op_sel_hi:[1,0]
    v_pk_mul_f32 v[178:179], v[178:179], v[152:153] op_sel_hi:[1,0]
    v_pk_mul_f32 v[180:181], v[180:181], v[152:153] op_sel_hi:[1,0]
    v_pk_mul_f32 v[182:183], v[182:183], v[152:153] op_sel_hi:[1,0]
    v_pk_mul_f32 v[72:73], v[72:73], v[154:155] op_sel_hi:[1,0]
    v_pk_mul_f32 v[74:75], v[74:75], v[154:155] op_sel_hi:[1,0]
    v_pk_mul_f32 v[88:89], v[88:89], v[154:155] op_sel_hi:[1,0]
    v_pk_mul_f32 v[90:91], v[90:91], v[154:155] op_sel_hi:[1,0]
    v_cvt_pk_bf16_f32 v112, v176, v177
    v_cvt_pk_bf16_f32 v113, v178, v179
    v_cvt_pk_bf16_f32 v114, v180, v181
    v_cvt_pk_bf16_f32 v115, v182, v183
    v_cvt_pk_bf16_f32 v116, v72, v73
    v_cvt_pk_bf16_f32 v117, v74, v75
    v_cvt_pk_bf16_f32 v118, v88, v89
    v_cvt_pk_bf16_f32 v119, v90, v91
    ds_write_b64 v200, v[112:113] offset:4096
    ds_write_b64 v201, v[114:115] offset:4096
    ds_write_b64 v202, v[116:117] offset:4096
    ds_write_b64 v203, v[118:119] offset:4096
    v_pk_mul_f32 v[184:185], v[184:185], v[156:157] op_sel_hi:[1,0]
    v_pk_mul_f32 v[186:187], v[186:187], v[156:157] op_sel_hi:[1,0]
    v_pk_mul_f32 v[188:189], v[188:189], v[156:157] op_sel_hi:[1,0]
    v_pk_mul_f32 v[190:191], v[190:191], v[156:157] op_sel_hi:[1,0]
    v_pk_mul_f32 v[76:77], v[76:77], v[158:159] op_sel_hi:[1,0]
    v_pk_mul_f32 v[78:79], v[78:79], v[158:159] op_sel_hi:[1,0]
    v_pk_mul_f32 v[92:93], v[92:93], v[158:159] op_sel_hi:[1,0]
    v_pk_mul_f32 v[94:95], v[94:95], v[158:159] op_sel_hi:[1,0]
    v_cvt_pk_bf16_f32 v120, v184, v185
    v_cvt_pk_bf16_f32 v121, v186, v187
    v_cvt_pk_bf16_f32 v122, v188, v189
    v_cvt_pk_bf16_f32 v123, v190, v191
    v_cvt_pk_bf16_f32 v124, v76, v77
    v_cvt_pk_bf16_f32 v125, v78, v79
    v_cvt_pk_bf16_f32 v126, v92, v93
    v_cvt_pk_bf16_f32 v127, v94, v95
    ds_write_b64 v200, v[120:121] offset:6144
    ds_write_b64 v201, v[122:123] offset:6144
    ds_write_b64 v202, v[124:125] offset:6144
    ds_write_b64 v203, v[126:127] offset:6144
    s_lshl_b32 s54, s41, 3
    s_add_u32 s54, s54, s42
    s_lshl_b32 s54, s54, 9
    s_add_u32 s54, s54, 21364736
    s_lshl_b32 s51, s42, 11
    s_lshl_b32 s52, s41, 17
    s_add_u32 s51, s51, s52
    s_add_u32 s51, s51, 19267584
    s_lshl_b32 s52, s40, 14
    s_add_u32 s52, s52, s51
    s_lshl_b32 s55, s40, 6
    s_add_u32 s55, s55, s54
    v_and_b32 v29, 48, v1
    s_waitcnt lgkmcnt(0)
    s_barrier
    ds_read_b64_tr_b16 v[160:161], v204 offset:0
    ds_read_b64_tr_b16 v[162:163], v204 offset:2048
    ds_read_b128 v[64:67], v205 offset:32768
    ds_read_b128 v[68:71], v205 offset:34816
    ds_read_b64_tr_b16 v[164:165], v204 offset:4096
    ds_read_b64_tr_b16 v[166:167], v204 offset:6144
    ds_read_b128 v[72:75], v205 offset:33792
    ds_read_b128 v[76:79], v205 offset:35840
    ds_read_b64_tr_b16 v[168:169], v204 offset:8192
    ds_read_b64_tr_b16 v[170:171], v204 offset:10240
    ds_read_b128 v[80:83], v205 offset:36864
    ds_read_b128 v[84:87], v205 offset:38912
    ds_read_b64_tr_b16 v[172:173], v204 offset:12288
    ds_read_b64_tr_b16 v[174:175], v204 offset:14336
    ds_read_b128 v[88:91], v205 offset:37888
    ds_read_b128 v[92:95], v205 offset:39936
    ds_read_b64_tr_b16 v[176:177], v204 offset:16384
    ds_read_b64_tr_b16 v[178:179], v204 offset:18432
    ds_read_b128 v[96:99], v205 offset:40960
    ds_read_b128 v[100:103], v205 offset:43008
    ds_read_b64_tr_b16 v[180:181], v204 offset:20480
    ds_read_b64_tr_b16 v[182:183], v204 offset:22528
    ds_read_b128 v[104:107], v205 offset:41984
    ds_read_b128 v[108:111], v205 offset:44032
    ds_read_b64_tr_b16 v[184:185], v204 offset:24576
    ds_read_b64_tr_b16 v[186:187], v204 offset:26624
    ds_read_b128 v[112:115], v205 offset:45056
    ds_read_b128 v[116:119], v205 offset:47104
    ds_read_b64_tr_b16 v[188:189], v204 offset:28672
    ds_read_b64_tr_b16 v[190:191], v204 offset:30720
    ds_read_b128 v[120:123], v205 offset:46080
    ds_read_b128 v[124:127], v205 offset:48128
    s_waitcnt lgkmcnt(15)
    v_mfma_f32_16x16x32_bf16 v[132:135], v[160:163], v[64:67], 0
    s_waitcnt lgkmcnt(15)
    v_mfma_f32_16x16x32_bf16 v[136:139], v[160:163], v[68:71], 0
    v_mfma_f32_16x16x32_bf16 v[140:143], v[160:163], v[16:19], 0
    s_waitcnt lgkmcnt(15)
    v_mfma_f32_16x16x32_bf16 v[132:135], v[164:167], v[72:75], v[132:135]
    s_waitcnt lgkmcnt(15)
    v_mfma_f32_16x16x32_bf16 v[136:139], v[164:167], v[76:79], v[136:139]
    v_mfma_f32_16x16x32_bf16 v[140:143], v[164:167], v[16:19], v[140:143]
    s_waitcnt lgkmcnt(15)
    v_mfma_f32_16x16x32_bf16 v[132:135], v[168:171], v[80:83], v[132:135]
    s_waitcnt lgkmcnt(15)
    v_mfma_f32_16x16x32_bf16 v[136:139], v[168:171], v[84:87], v[136:139]
    v_mfma_f32_16x16x32_bf16 v[140:143], v[168:171], v[16:19], v[140:143]
    s_waitcnt lgkmcnt(15)
    v_mfma_f32_16x16x32_bf16 v[132:135], v[172:175], v[88:91], v[132:135]
    s_waitcnt lgkmcnt(15)
    v_mfma_f32_16x16x32_bf16 v[136:139], v[172:175], v[92:95], v[136:139]
    v_mfma_f32_16x16x32_bf16 v[140:143], v[172:175], v[16:19], v[140:143]
    s_waitcnt lgkmcnt(13)
    v_mfma_f32_16x16x32_bf16 v[132:135], v[176:179], v[96:99], v[132:135]
    s_waitcnt lgkmcnt(12)
    v_mfma_f32_16x16x32_bf16 v[136:139], v[176:179], v[100:103], v[136:139]
    v_mfma_f32_16x16x32_bf16 v[140:143], v[176:179], v[16:19], v[140:143]
    s_waitcnt lgkmcnt(9)
    v_mfma_f32_16x16x32_bf16 v[132:135], v[180:183], v[104:107], v[132:135]
    s_waitcnt lgkmcnt(8)
    v_mfma_f32_16x16x32_bf16 v[136:139], v[180:183], v[108:111], v[136:139]
    v_mfma_f32_16x16x32_bf16 v[140:143], v[180:183], v[16:19], v[140:143]
    s_waitcnt lgkmcnt(5)
    v_mfma_f32_16x16x32_bf16 v[132:135], v[184:187], v[112:115], v[132:135]
    s_waitcnt lgkmcnt(4)
    v_mfma_f32_16x16x32_bf16 v[136:139], v[184:187], v[116:119], v[136:139]
    v_mfma_f32_16x16x32_bf16 v[140:143], v[184:187], v[16:19], v[140:143]
    s_waitcnt lgkmcnt(1)
    v_mfma_f32_16x16x32_bf16 v[132:135], v[188:191], v[120:123], v[132:135]
    s_waitcnt lgkmcnt(0)
    v_mfma_f32_16x16x32_bf16 v[136:139], v[188:191], v[124:127], v[136:139]
    v_mfma_f32_16x16x32_bf16 v[140:143], v[188:191], v[16:19], v[140:143]
    s_nop 4
    buffer_store_dwordx4 v[132:135], v15, s[28:31], s52 offen offset:0 sc1
    s_nop 0
    buffer_store_dwordx4 v[136:139], v15, s[28:31], s52 offen offset:1024 sc1
    s_mov_b32 exec_lo, 0x00010001
    s_mov_b32 exec_hi, 0x00010001
    buffer_store_dwordx4 v[140:143], v29, s[28:31], s55 offen sc1
    s_mov_b64 exec, -1
    v_and_b32 v28, 7, v1
    v_lshl_add_u32 v29, v28, 6, v29
    v_cvt_pk_bf16_f32 v144, v32, v33
    v_cvt_pk_bf16_f32 v145, v34, v35
    v_cvt_pk_bf16_f32 v146, v48, v49
    v_cvt_pk_bf16_f32 v147, v50, v51
    v_cvt_pk_bf16_f32 v148, v36, v37
    v_cvt_pk_bf16_f32 v149, v38, v39
    v_cvt_pk_bf16_f32 v150, v52, v53
    v_cvt_pk_bf16_f32 v151, v54, v55
    v_mfma_f32_16x16x32_bf16 v[32:35], v[224:227], v[144:147], 0
    v_mfma_f32_16x16x32_bf16 v[48:51], v[228:231], v[144:147], 0
    v_cvt_pk_bf16_f32 v152, v40, v41
    v_cvt_pk_bf16_f32 v153, v42, v43
    v_cvt_pk_bf16_f32 v154, v56, v57
    v_cvt_pk_bf16_f32 v155, v58, v59
    v_mfma_f32_16x16x32_bf16 v[36:39], v[224:227], v[148:151], 0
    v_mfma_f32_16x16x32_bf16 v[52:55], v[228:231], v[148:151], 0
    v_cvt_pk_bf16_f32 v156, v44, v45
    v_cvt_pk_bf16_f32 v157, v46, v47
    v_cvt_pk_bf16_f32 v158, v60, v61
    v_cvt_pk_bf16_f32 v159, v62, v63
    v_mfma_f32_16x16x32_bf16 v[40:43], v[224:227], v[152:155], 0
    v_mfma_f32_16x16x32_bf16 v[56:59], v[228:231], v[152:155], 0
    v_mfma_f32_16x16x32_bf16 v[44:47], v[224:227], v[156:159], 0
    v_mfma_f32_16x16x32_bf16 v[60:63], v[228:231], v[156:159], 0
    v_max3_f32 v192, v32, v33, v34
    v_min3_f32 v196, v32, v33, v34
    v_max3_f32 v192, v192, v35, v48
    v_min3_f32 v196, v196, v35, v48
    v_max3_f32 v192, v192, v49, v50
    v_min3_f32 v196, v196, v49, v50
    v_max_f32 v192, v192, v51
    v_min_f32 v196, v196, v51
    v_max3_f32 v193, v36, v37, v38
    v_min3_f32 v197, v36, v37, v38
    v_max3_f32 v193, v193, v39, v52
    v_min3_f32 v197, v197, v39, v52
    v_max3_f32 v193, v193, v53, v54
    v_min3_f32 v197, v197, v53, v54
    v_max_f32 v193, v193, v55
    v_min_f32 v197, v197, v55
    v_max3_f32 v194, v40, v41, v42
    v_min3_f32 v198, v40, v41, v42
    v_max3_f32 v194, v194, v43, v56
    v_min3_f32 v198, v198, v43, v56
    v_max3_f32 v194, v194, v57, v58
    v_min3_f32 v198, v198, v57, v58
    v_max_f32 v194, v194, v59
    v_min_f32 v198, v198, v59
    v_max3_f32 v195, v44, v45, v46
    v_min3_f32 v199, v44, v45, v46
    v_max3_f32 v195, v195, v47, v60
    v_min3_f32 v199, v199, v47, v60
    v_max3_f32 v195, v195, v61, v62
    v_min3_f32 v199, v199, v61, v62
    v_max_f32 v195, v195, v63
    v_min_f32 v199, v199, v63
    v_permlane32_swap_b32 v192, v193
    v_permlane32_swap_b32 v194, v195
    v_permlane32_swap_b32 v196, v197
    v_permlane32_swap_b32 v198, v199
    v_max_f32 v192, v192, v193
    v_max_f32 v194, v194, v195
    v_min_f32 v196, v196, v197
    v_min_f32 v198, v198, v199
    v_permlane16_swap_b32 v192, v194
    s_nop 0
    v_permlane16_swap_b32 v196, v198
    v_max_f32 v192, v192, v194
    v_min_f32 v196, v196, v198
    v_mov_b32 v194, v192
    v_mov_b32 v198, v196
    s_nop 0
    v_permlane16_swap_b32 v192, v194
    v_permlane16_swap_b32 v196, v198
    v_mov_b32 v193, v192
    v_mov_b32 v195, v194
    v_mov_b32 v197, v196
    v_mov_b32 v199, v198
    v_permlane32_swap_b32 v192, v193
    v_permlane32_swap_b32 v194, v195
    v_permlane32_swap_b32 v196, v197
    v_permlane32_swap_b32 v198, v199
    v_mul_f32 v144, v192, v216
    v_mul_f32 v146, v196, v216
    v_mul_f32 v148, v193, v218
    v_mul_f32 v150, v197, v218
    v_mul_f32 v152, v194, v220
    v_mul_f32 v154, v198, v220
    v_mul_f32 v156, v195, v222
    v_mul_f32 v158, v199, v222
    v_pk_fma_f32 v[160:161], v[32:33], v[216:217], v[144:145] op_sel_hi:[1,0,0] neg_lo:[0,0,1] neg_hi:[0,0,1]
    v_pk_fma_f32 v[162:163], v[34:35], v[216:217], v[144:145] op_sel_hi:[1,0,0] neg_lo:[0,0,1] neg_hi:[0,0,1]
    v_pk_fma_f32 v[164:165], v[48:49], v[216:217], v[144:145] op_sel_hi:[1,0,0] neg_lo:[0,0,1] neg_hi:[0,0,1]
    v_pk_fma_f32 v[166:167], v[50:51], v[216:217], v[144:145] op_sel_hi:[1,0,0] neg_lo:[0,0,1] neg_hi:[0,0,1]
    v_pk_fma_f32 v[32:33], v[32:33], v[216:217], v[146:147] op_sel_hi:[1,0,0] neg_lo:[1,0,0] neg_hi:[1,0,0]
    v_pk_fma_f32 v[34:35], v[34:35], v[216:217], v[146:147] op_sel_hi:[1,0,0] neg_lo:[1,0,0] neg_hi:[1,0,0]
    v_pk_fma_f32 v[48:49], v[48:49], v[216:217], v[146:147] op_sel_hi:[1,0,0] neg_lo:[1,0,0] neg_hi:[1,0,0]
    v_pk_fma_f32 v[50:51], v[50:51], v[216:217], v[146:147] op_sel_hi:[1,0,0] neg_lo:[1,0,0] neg_hi:[1,0,0]
    v_exp_f32 v160, v160
    v_exp_f32 v161, v161
    v_exp_f32 v162, v162
    v_exp_f32 v163, v163
    v_exp_f32 v164, v164
    v_exp_f32 v165, v165
    v_exp_f32 v166, v166
    v_exp_f32 v167, v167
    v_exp_f32 v32, v32
    v_exp_f32 v33, v33
    v_exp_f32 v34, v34
    v_exp_f32 v35, v35
    v_exp_f32 v48, v48
    v_exp_f32 v49, v49
    v_exp_f32 v50, v50
    v_exp_f32 v51, v51
    v_pk_add_f32 v[232:233], v[160:161], v[162:163]
    v_pk_add_f32 v[234:235], v[164:165], v[166:167]
    v_pk_add_f32 v[236:237], v[32:33], v[34:35]
    v_pk_add_f32 v[238:239], v[48:49], v[50:51]
    v_pk_add_f32 v[232:233], v[232:233], v[234:235]
    v_pk_add_f32 v[236:237], v[236:237], v[238:239]
    v_add_f32 v192, v232, v233
    v_add_f32 v196, v236, v237
    v_pk_fma_f32 v[168:169], v[36:37], v[218:219], v[148:149] op_sel_hi:[1,0,0] neg_lo:[0,0,1] neg_hi:[0,0,1]
    v_pk_fma_f32 v[170:171], v[38:39], v[218:219], v[148:149] op_sel_hi:[1,0,0] neg_lo:[0,0,1] neg_hi:[0,0,1]
    v_pk_fma_f32 v[172:173], v[52:53], v[218:219], v[148:149] op_sel_hi:[1,0,0] neg_lo:[0,0,1] neg_hi:[0,0,1]
    v_pk_fma_f32 v[174:175], v[54:55], v[218:219], v[148:149] op_sel_hi:[1,0,0] neg_lo:[0,0,1] neg_hi:[0,0,1]
    v_pk_fma_f32 v[36:37], v[36:37], v[218:219], v[150:151] op_sel_hi:[1,0,0] neg_lo:[1,0,0] neg_hi:[1,0,0]
    v_pk_fma_f32 v[38:39], v[38:39], v[218:219], v[150:151] op_sel_hi:[1,0,0] neg_lo:[1,0,0] neg_hi:[1,0,0]
    v_pk_fma_f32 v[52:53], v[52:53], v[218:219], v[150:151] op_sel_hi:[1,0,0] neg_lo:[1,0,0] neg_hi:[1,0,0]
    v_pk_fma_f32 v[54:55], v[54:55], v[218:219], v[150:151] op_sel_hi:[1,0,0] neg_lo:[1,0,0] neg_hi:[1,0,0]
    v_exp_f32 v168, v168
    v_exp_f32 v169, v169
    v_exp_f32 v170, v170
    v_exp_f32 v171, v171
    v_exp_f32 v172, v172
    v_exp_f32 v173, v173
    v_exp_f32 v174, v174
    v_exp_f32 v175, v175
    v_exp_f32 v36, v36
    v_exp_f32 v37, v37
    v_exp_f32 v38, v38
    v_exp_f32 v39, v39
    v_exp_f32 v52, v52
    v_exp_f32 v53, v53
    v_exp_f32 v54, v54
    v_exp_f32 v55, v55
    v_pk_add_f32 v[232:233], v[168:169], v[170:171]
    v_pk_add_f32 v[234:235], v[172:173], v[174:175]
    v_pk_add_f32 v[236:237], v[36:37], v[38:39]
    v_pk_add_f32 v[238:239], v[52:53], v[54:55]
    v_pk_add_f32 v[232:233], v[232:233], v[234:235]
    v_pk_add_f32 v[236:237], v[236:237], v[238:239]
    v_add_f32 v193, v232, v233
    v_add_f32 v197, v236, v237
    s_add_u32 s52, s51, 0
    buffer_load_dwordx4 v[64:67], v15, s[28:31], s52 offen offset:0 sc1
    buffer_load_dwordx4 v[68:71], v15, s[28:31], s52 offen offset:1024 sc1
    s_add_u32 s52, s51, 16384
    buffer_load_dwordx4 v[72:75], v15, s[28:31], s52 offen offset:0 sc1
    buffer_load_dwordx4 v[76:79], v15, s[28:31], s52 offen offset:1024 sc1
    s_add_u32 s52, s51, 32768
    buffer_load_dwordx4 v[80:83], v15, s[28:31], s52 offen offset:0 sc1
    buffer_load_dwordx4 v[84:87], v15, s[28:31], s52 offen offset:1024 sc1
    s_add_u32 s52, s51, 49152
    buffer_load_dwordx4 v[88:91], v15, s[28:31], s52 offen offset:0 sc1
    buffer_load_dwordx4 v[92:95], v15, s[28:31], s52 offen offset:1024 sc1
    s_add_u32 s52, s51, 65536
    buffer_load_dwordx4 v[96:99], v15, s[28:31], s52 offen offset:0 sc1
    buffer_load_dwordx4 v[100:103], v15, s[28:31], s52 offen offset:1024 sc1
    s_add_u32 s52, s51, 81920
    buffer_load_dwordx4 v[104:107], v15, s[28:31], s52 offen offset:0 sc1
    buffer_load_dwordx4 v[108:111], v15, s[28:31], s52 offen offset:1024 sc1
    s_add_u32 s52, s51, 98304
    buffer_load_dwordx4 v[112:115], v15, s[28:31], s52 offen offset:0 sc1
    buffer_load_dwordx4 v[116:119], v15, s[28:31], s52 offen offset:1024 sc1
    s_add_u32 s52, s51, 114688
    buffer_load_dwordx4 v[120:123], v15, s[28:31], s52 offen offset:0 sc1
    buffer_load_dwordx4 v[124:127], v15, s[28:31], s52 offen offset:1024 sc1
    buffer_load_dwordx4 v[128:131], v29, s[28:31], s54 offen sc1
    v_pk_fma_f32 v[176:177], v[40:41], v[220:221], v[152:153] op_sel_hi:[1,0,0] neg_lo:[0,0,1] neg_hi:[0,0,1]
    v_pk_fma_f32 v[178:179], v[42:43], v[220:221], v[152:153] op_sel_hi:[1,0,0] neg_lo:[0,0,1] neg_hi:[0,0,1]
    v_pk_fma_f32 v[180:181], v[56:57], v[220:221], v[152:153] op_sel_hi:[1,0,0] neg_lo:[0,0,1] neg_hi:[0,0,1]
    v_pk_fma_f32 v[182:183], v[58:59], v[220:221], v[152:153] op_sel_hi:[1,0,0] neg_lo:[0,0,1] neg_hi:[0,0,1]
    v_pk_fma_f32 v[40:41], v[40:41], v[220:221], v[154:155] op_sel_hi:[1,0,0] neg_lo:[1,0,0] neg_hi:[1,0,0]
    v_pk_fma_f32 v[42:43], v[42:43], v[220:221], v[154:155] op_sel_hi:[1,0,0] neg_lo:[1,0,0] neg_hi:[1,0,0]
    v_pk_fma_f32 v[56:57], v[56:57], v[220:221], v[154:155] op_sel_hi:[1,0,0] neg_lo:[1,0,0] neg_hi:[1,0,0]
    v_pk_fma_f32 v[58:59], v[58:59], v[220:221], v[154:155] op_sel_hi:[1,0,0] neg_lo:[1,0,0] neg_hi:[1,0,0]
    v_exp_f32 v176, v176
    v_exp_f32 v177, v177
    v_exp_f32 v178, v178
    v_exp_f32 v179, v179
    v_exp_f32 v180, v180
    v_exp_f32 v181, v181
    v_exp_f32 v182, v182
    v_exp_f32 v183, v183
    v_exp_f32 v40, v40
    v_exp_f32 v41, v41
    v_exp_f32 v42, v42
    v_exp_f32 v43, v43
    v_exp_f32 v56, v56
    v_exp_f32 v57, v57
    v_exp_f32 v58, v58
    v_exp_f32 v59, v59
    v_pk_add_f32 v[232:233], v[176:177], v[178:179]
    v_pk_add_f32 v[234:235], v[180:181], v[182:183]
    v_pk_add_f32 v[236:237], v[40:41], v[42:43]
    v_pk_add_f32 v[238:239], v[56:57], v[58:59]
    v_pk_add_f32 v[232:233], v[232:233], v[234:235]
    v_pk_add_f32 v[236:237], v[236:237], v[238:239]
    v_add_f32 v194, v232, v233
    v_add_f32 v198, v236, v237
    v_pk_fma_f32 v[184:185], v[44:45], v[222:223], v[156:157] op_sel_hi:[1,0,0] neg_lo:[0,0,1] neg_hi:[0,0,1]
    v_pk_fma_f32 v[186:187], v[46:47], v[222:223], v[156:157] op_sel_hi:[1,0,0] neg_lo:[0,0,1] neg_hi:[0,0,1]
    v_pk_fma_f32 v[188:189], v[60:61], v[222:223], v[156:157] op_sel_hi:[1,0,0] neg_lo:[0,0,1] neg_hi:[0,0,1]
    v_pk_fma_f32 v[190:191], v[62:63], v[222:223], v[156:157] op_sel_hi:[1,0,0] neg_lo:[0,0,1] neg_hi:[0,0,1]
    v_pk_fma_f32 v[44:45], v[44:45], v[222:223], v[158:159] op_sel_hi:[1,0,0] neg_lo:[1,0,0] neg_hi:[1,0,0]
    v_pk_fma_f32 v[46:47], v[46:47], v[222:223], v[158:159] op_sel_hi:[1,0,0] neg_lo:[1,0,0] neg_hi:[1,0,0]
    v_pk_fma_f32 v[60:61], v[60:61], v[222:223], v[158:159] op_sel_hi:[1,0,0] neg_lo:[1,0,0] neg_hi:[1,0,0]
    v_pk_fma_f32 v[62:63], v[62:63], v[222:223], v[158:159] op_sel_hi:[1,0,0] neg_lo:[1,0,0] neg_hi:[1,0,0]
    v_exp_f32 v184, v184
    v_exp_f32 v185, v185
    v_exp_f32 v186, v186
    v_exp_f32 v187, v187
    v_exp_f32 v188, v188
    v_exp_f32 v189, v189
    v_exp_f32 v190, v190
    v_exp_f32 v191, v191
    v_exp_f32 v44, v44
    v_exp_f32 v45, v45
    v_exp_f32 v46, v46
    v_exp_f32 v47, v47
    v_exp_f32 v60, v60
    v_exp_f32 v61, v61
    v_exp_f32 v62, v62
    v_exp_f32 v63, v63
    v_pk_add_f32 v[232:233], v[184:185], v[186:187]
    v_pk_add_f32 v[234:235], v[188:189], v[190:191]
    v_pk_add_f32 v[236:237], v[44:45], v[46:47]
    v_pk_add_f32 v[238:239], v[60:61], v[62:63]
    v_pk_add_f32 v[232:233], v[232:233], v[234:235]
    v_pk_add_f32 v[236:237], v[236:237], v[238:239]
    v_add_f32 v195, v232, v233
    v_add_f32 v199, v236, v237
    v_permlane32_swap_b32 v192, v193
    v_permlane32_swap_b32 v194, v195
    v_permlane32_swap_b32 v196, v197
    v_permlane32_swap_b32 v198, v199
    v_add_f32 v192, v192, v193
    v_add_f32 v194, v194, v195
    v_add_f32 v196, v196, v197
    v_add_f32 v198, v198, v199
    v_permlane16_swap_b32 v192, v194
    s_nop 0
    v_permlane16_swap_b32 v196, v198
    v_add_f32 v192, v192, v194
    v_add_f32 v196, v196, v198
    v_mov_b32 v194, v192
    v_mov_b32 v198, v196
    s_nop 0
    v_permlane16_swap_b32 v192, v194
    v_permlane16_swap_b32 v196, v198
    v_mov_b32 v193, v192
    v_mov_b32 v195, v194
    v_mov_b32 v197, v196
    v_mov_b32 v199, v198
    v_permlane32_swap_b32 v192, v193
    v_permlane32_swap_b32 v194, v195
    v_permlane32_swap_b32 v196, v197
    v_permlane32_swap_b32 v198, v199
    v_rcp_f32 v144, v192
    v_rcp_f32 v146, v196
    v_rcp_f32 v148, v193
    v_rcp_f32 v150, v197
    v_rcp_f32 v152, v194
    v_rcp_f32 v154, v198
    v_rcp_f32 v156, v195
    v_rcp_f32 v158, v199
    v_pk_mul_f32 v[160:161], v[160:161], v[144:145] op_sel_hi:[1,0]
    v_pk_mul_f32 v[162:163], v[162:163], v[144:145] op_sel_hi:[1,0]
    v_pk_mul_f32 v[164:165], v[164:165], v[144:145] op_sel_hi:[1,0]
    v_pk_mul_f32 v[166:167], v[166:167], v[144:145] op_sel_hi:[1,0]
    v_pk_mul_f32 v[32:33], v[32:33], v[146:147] op_sel_hi:[1,0]
    v_pk_mul_f32 v[34:35], v[34:35], v[146:147] op_sel_hi:[1,0]
    v_pk_mul_f32 v[48:49], v[48:49], v[146:147] op_sel_hi:[1,0]
    v_pk_mul_f32 v[50:51], v[50:51], v[146:147] op_sel_hi:[1,0]
    v_cvt_pk_bf16_f32 v224, v160, v161
    v_cvt_pk_bf16_f32 v225, v162, v163
    v_cvt_pk_bf16_f32 v226, v164, v165
    v_cvt_pk_bf16_f32 v227, v166, v167
    v_cvt_pk_bf16_f32 v228, v32, v33
    v_cvt_pk_bf16_f32 v229, v34, v35
    v_cvt_pk_bf16_f32 v230, v48, v49
    v_cvt_pk_bf16_f32 v231, v50, v51
    v_pk_mul_f32 v[168:169], v[168:169], v[148:149] op_sel_hi:[1,0]
    v_pk_mul_f32 v[170:171], v[170:171], v[148:149] op_sel_hi:[1,0]
    v_pk_mul_f32 v[172:173], v[172:173], v[148:149] op_sel_hi:[1,0]
    v_pk_mul_f32 v[174:175], v[174:175], v[148:149] op_sel_hi:[1,0]
    v_pk_mul_f32 v[36:37], v[36:37], v[150:151] op_sel_hi:[1,0]
    v_pk_mul_f32 v[38:39], v[38:39], v[150:151] op_sel_hi:[1,0]
    v_pk_mul_f32 v[52:53], v[52:53], v[150:151] op_sel_hi:[1,0]
    v_pk_mul_f32 v[54:55], v[54:55], v[150:151] op_sel_hi:[1,0]
    v_cvt_pk_bf16_f32 v232, v168, v169
    v_cvt_pk_bf16_f32 v233, v170, v171
    v_cvt_pk_bf16_f32 v234, v172, v173
    v_cvt_pk_bf16_f32 v235, v174, v175
    v_cvt_pk_bf16_f32 v236, v36, v37
    v_cvt_pk_bf16_f32 v237, v38, v39
    v_cvt_pk_bf16_f32 v238, v52, v53
    v_cvt_pk_bf16_f32 v239, v54, v55
    v_pk_mul_f32 v[176:177], v[176:177], v[152:153] op_sel_hi:[1,0]
    v_pk_mul_f32 v[178:179], v[178:179], v[152:153] op_sel_hi:[1,0]
    v_pk_mul_f32 v[180:181], v[180:181], v[152:153] op_sel_hi:[1,0]
    v_pk_mul_f32 v[182:183], v[182:183], v[152:153] op_sel_hi:[1,0]
    v_pk_mul_f32 v[40:41], v[40:41], v[154:155] op_sel_hi:[1,0]
    v_pk_mul_f32 v[42:43], v[42:43], v[154:155] op_sel_hi:[1,0]
    v_pk_mul_f32 v[56:57], v[56:57], v[154:155] op_sel_hi:[1,0]
    v_pk_mul_f32 v[58:59], v[58:59], v[154:155] op_sel_hi:[1,0]
    v_cvt_pk_bf16_f32 v240, v176, v177
    v_cvt_pk_bf16_f32 v241, v178, v179
    v_cvt_pk_bf16_f32 v242, v180, v181
    v_cvt_pk_bf16_f32 v243, v182, v183
    v_cvt_pk_bf16_f32 v244, v40, v41
    v_cvt_pk_bf16_f32 v245, v42, v43
    v_cvt_pk_bf16_f32 v246, v56, v57
    v_cvt_pk_bf16_f32 v247, v58, v59
    v_pk_mul_f32 v[184:185], v[184:185], v[156:157] op_sel_hi:[1,0]
    v_pk_mul_f32 v[186:187], v[186:187], v[156:157] op_sel_hi:[1,0]
    v_pk_mul_f32 v[188:189], v[188:189], v[156:157] op_sel_hi:[1,0]
    v_pk_mul_f32 v[190:191], v[190:191], v[156:157] op_sel_hi:[1,0]
    v_pk_mul_f32 v[44:45], v[44:45], v[158:159] op_sel_hi:[1,0]
    v_pk_mul_f32 v[46:47], v[46:47], v[158:159] op_sel_hi:[1,0]
    v_pk_mul_f32 v[60:61], v[60:61], v[158:159] op_sel_hi:[1,0]
    v_pk_mul_f32 v[62:63], v[62:63], v[158:159] op_sel_hi:[1,0]
    v_cvt_pk_bf16_f32 v248, v184, v185
    v_cvt_pk_bf16_f32 v249, v186, v187
    v_cvt_pk_bf16_f32 v250, v188, v189
    v_cvt_pk_bf16_f32 v251, v190, v191
    v_cvt_pk_bf16_f32 v252, v44, v45
    v_cvt_pk_bf16_f32 v253, v46, v47
    v_cvt_pk_bf16_f32 v254, v60, v61
    v_cvt_pk_bf16_f32 v255, v62, v63
    s_mov_b32 s63, 0x20000
L_poll_1048:
    s_waitcnt vmcnt(0)
    v_cmp_eq_u32 vcc, -1, v128
    s_nop 0
    s_cmp_lg_u64 vcc, 0
    s_cselect_b32 s56, 0x100, 0
    v_cmp_eq_u32 vcc, -1, v64
    v_cmp_eq_u32 s[58:59], -1, v68
    s_nop 0
    s_or_b64 vcc, vcc, s[58:59]
    s_cselect_b32 s57, 1, 0
    s_or_b32 s56, s56, s57
    v_cmp_eq_u32 vcc, -1, v72
    v_cmp_eq_u32 s[58:59], -1, v76
    s_nop 0
    s_or_b64 vcc, vcc, s[58:59]
    s_cselect_b32 s57, 2, 0
    s_or_b32 s56, s56, s57
    v_cmp_eq_u32 vcc, -1, v80
    v_cmp_eq_u32 s[58:59], -1, v84
    s_nop 0
    s_or_b64 vcc, vcc, s[58:59]
    s_cselect_b32 s57, 4, 0
    s_or_b32 s56, s56, s57
    v_cmp_eq_u32 vcc, -1, v88
    v_cmp_eq_u32 s[58:59], -1, v92
    s_nop 0
    s_or_b64 vcc, vcc, s[58:59]
    s_cselect_b32 s57, 8, 0
    s_or_b32 s56, s56, s57
    v_cmp_eq_u32 vcc, -1, v96
    v_cmp_eq_u32 s[58:59], -1, v100
    s_nop 0
    s_or_b64 vcc, vcc, s[58:59]
    s_cselect_b32 s57, 16, 0
    s_or_b32 s56, s56, s57
    v_cmp_eq_u32 vcc, -1, v104
    v_cmp_eq_u32 s[58:59], -1, v108
    s_nop 0
    s_or_b64 vcc, vcc, s[58:59]
    s_cselect_b32 s57, 32, 0
    s_or_b32 s56, s56, s57
    v_cmp_eq_u32 vcc, -1, v112
    v_cmp_eq_u32 s[58:59], -1, v116
    s_nop 0
    s_or_b64 vcc, vcc, s[58:59]
    s_cselect_b32 s57, 64, 0
    s_or_b32 s56, s56, s57
    v_cmp_eq_u32 vcc, -1, v120
    v_cmp_eq_u32 s[58:59], -1, v124
    s_nop 0
    s_or_b64 vcc, vcc, s[58:59]
    s_cselect_b32 s57, 128, 0
    s_or_b32 s56, s56, s57
    s_cmp_eq_u32 s56, 0
    s_cbranch_scc1 L_go_1049
    s_sleep 4
    s_bitcmp0_b32 s56, 0
    s_cbranch_scc1 L_sk_1050
    s_add_u32 s52, s51, 0
    buffer_load_dwordx4 v[64:67], v15, s[28:31], s52 offen offset:0 sc1
    buffer_load_dwordx4 v[68:71], v15, s[28:31], s52 offen offset:1024 sc1
L_sk_1050:
    s_bitcmp0_b32 s56, 1
    s_cbranch_scc1 L_sk_1051
    s_add_u32 s52, s51, 16384
    buffer_load_dwordx4 v[72:75], v15, s[28:31], s52 offen offset:0 sc1
    buffer_load_dwordx4 v[76:79], v15, s[28:31], s52 offen offset:1024 sc1
L_sk_1051:
    s_bitcmp0_b32 s56, 2
    s_cbranch_scc1 L_sk_1052
    s_add_u32 s52, s51, 32768
    buffer_load_dwordx4 v[80:83], v15, s[28:31], s52 offen offset:0 sc1
    buffer_load_dwordx4 v[84:87], v15, s[28:31], s52 offen offset:1024 sc1
L_sk_1052:
    s_bitcmp0_b32 s56, 3
    s_cbranch_scc1 L_sk_1053
    s_add_u32 s52, s51, 49152
    buffer_load_dwordx4 v[88:91], v15, s[28:31], s52 offen offset:0 sc1
    buffer_load_dwordx4 v[92:95], v15, s[28:31], s52 offen offset:1024 sc1
L_sk_1053:
    s_bitcmp0_b32 s56, 4
    s_cbranch_scc1 L_sk_1054
    s_add_u32 s52, s51, 65536
    buffer_load_dwordx4 v[96:99], v15, s[28:31], s52 offen offset:0 sc1
    buffer_load_dwordx4 v[100:103], v15, s[28:31], s52 offen offset:1024 sc1
L_sk_1054:
    s_bitcmp0_b32 s56, 5
    s_cbranch_scc1 L_sk_1055
    s_add_u32 s52, s51, 81920
    buffer_load_dwordx4 v[104:107], v15, s[28:31], s52 offen offset:0 sc1
    buffer_load_dwordx4 v[108:111], v15, s[28:31], s52 offen offset:1024 sc1
L_sk_1055:
    s_bitcmp0_b32 s56, 6
    s_cbranch_scc1 L_sk_1056
    s_add_u32 s52, s51, 98304
    buffer_load_dwordx4 v[112:115], v15, s[28:31], s52 offen offset:0 sc1
    buffer_load_dwordx4 v[116:119], v15, s[28:31], s52 offen offset:1024 sc1
L_sk_1056:
    s_bitcmp0_b32 s56, 7
    s_cbranch_scc1 L_sk_1057
    s_add_u32 s52, s51, 114688
    buffer_load_dwordx4 v[120:123], v15, s[28:31], s52 offen offset:0 sc1
    buffer_load_dwordx4 v[124:127], v15, s[28:31], s52 offen offset:1024 sc1
L_sk_1057:
    buffer_load_dwordx4 v[128:131], v29, s[28:31], s54 offen sc1
    s_sub_u32 s63, s63, 1
    s_cmp_lg_u32 s63, 0
    s_cbranch_scc1 L_poll_1048
L_go_1049:
    s_mul_i32 s50, s44, 6144
    s_add_u32 s50, s50, 98304
    v_add_u32 v28, s50, v15
    s_lshr_b32 s51, s43, 1
    s_mul_i32 s51, s51, 3072
    s_and_b32 s52, s43, 1
    s_lshl_b32 s52, s52, 3
    s_add_u32 s51, s51, s52
    v_add_u32 v29, s51, v28
    s_lshl_b32 s50, s40, 1
    s_lshr_b32 s51, s43, 1
    s_add_u32 s50, s50, s51
    s_lshl_b32 s50, s50, 5
    s_lshl_b32 s51, s41, 1
    s_add_u32 s50, s50, s51
    s_add_u32 s50, s50, s44
    s_lshl_b32 s50, s50, 13
    s_and_b32 s51, s43, 1
    s_lshl_b32 s51, s51, 12
    s_add_u32 s50, s50, s51
    s_add_u32 s50, s50, 14680064
    s_waitcnt vmcnt(0)
    v_pk_add_f32 v[64:65], v[64:65], v[72:73]
    v_pk_add_f32 v[66:67], v[66:67], v[74:75]
    v_pk_add_f32 v[68:69], v[68:69], v[76:77]
    v_pk_add_f32 v[70:71], v[70:71], v[78:79]
    v_pk_add_f32 v[80:81], v[80:81], v[88:89]
    v_pk_add_f32 v[82:83], v[82:83], v[90:91]
    v_pk_add_f32 v[84:85], v[84:85], v[92:93]
    v_pk_add_f32 v[86:87], v[86:87], v[94:95]
    v_pk_add_f32 v[96:97], v[96:97], v[104:105]
    v_pk_add_f32 v[98:99], v[98:99], v[106:107]
    v_pk_add_f32 v[100:101], v[100:101], v[108:109]
    v_pk_add_f32 v[102:103], v[102:103], v[110:111]
    v_pk_add_f32 v[112:113], v[112:113], v[120:121]
    v_pk_add_f32 v[114:115], v[114:115], v[122:123]
    v_pk_add_f32 v[116:117], v[116:117], v[124:125]
    v_pk_add_f32 v[118:119], v[118:119], v[126:127]
    v_add_f32_dpp v128, v128, v128 quad_perm:[1,0,3,2] row_mask:0xf bank_mask:0xf
    v_add_f32_dpp v129, v129, v129 quad_perm:[1,0,3,2] row_mask:0xf bank_mask:0xf
    v_add_f32_dpp v130, v130, v130 quad_perm:[1,0,3,2] row_mask:0xf bank_mask:0xf
    v_add_f32_dpp v131, v131, v131 quad_perm:[1,0,3,2] row_mask:0xf bank_mask:0xf
    v_pk_add_f32 v[64:65], v[64:65], v[80:81]
    v_pk_add_f32 v[66:67], v[66:67], v[82:83]
    v_pk_add_f32 v[68:69], v[68:69], v[84:85]
    v_pk_add_f32 v[70:71], v[70:71], v[86:87]
    v_pk_add_f32 v[96:97], v[96:97], v[112:113]
    v_pk_add_f32 v[98:99], v[98:99], v[114:115]
    v_pk_add_f32 v[100:101], v[100:101], v[116:117]
    v_pk_add_f32 v[102:103], v[102:103], v[118:119]
    v_add_f32_dpp v128, v128, v128 quad_perm:[2,3,0,1] row_mask:0xf bank_mask:0xf
    v_add_f32_dpp v129, v129, v129 quad_perm:[2,3,0,1] row_mask:0xf bank_mask:0xf
    v_add_f32_dpp v130, v130, v130 quad_perm:[2,3,0,1] row_mask:0xf bank_mask:0xf
    v_add_f32_dpp v131, v131, v131 quad_perm:[2,3,0,1] row_mask:0xf bank_mask:0xf
    v_pk_add_f32 v[64:65], v[64:65], v[96:97]
    v_pk_add_f32 v[66:67], v[66:67], v[98:99]
    v_pk_add_f32 v[68:69], v[68:69], v[100:101]
    v_pk_add_f32 v[70:71], v[70:71], v[102:103]
    v_add_f32_dpp v128, v128, v128 row_ror:4 row_mask:0xf bank_mask:0xf
    v_add_f32_dpp v129, v129, v129 row_ror:4 row_mask:0xf bank_mask:0xf
    v_add_f32_dpp v130, v130, v130 row_ror:4 row_mask:0xf bank_mask:0xf
    v_add_f32_dpp v131, v131, v131 row_ror:4 row_mask:0xf bank_mask:0xf
    v_cvt_pk_bf16_f32 v72, v64, v65
    v_cvt_pk_bf16_f32 v73, v66, v67
    v_cvt_pk_bf16_f32 v74, v68, v69
    v_cvt_pk_bf16_f32 v75, v70, v71
    v_cvt_pk_bf16_f32 v76, v128, v129
    v_cvt_pk_bf16_f32 v77, v130, v131
    ds_write_b64 v29, v[72:73] offset:0
    ds_write_b64 v29, v[74:75] offset:1024
    ds_write_b64 v29, v[76:77] offset:2048
    s_waitcnt lgkmcnt(0)
    s_barrier
    ds_read_b128 v[32:35], v28 offset:0
    ds_read_b128 v[36:39], v28 offset:1024
    ds_read_b128 v[40:43], v28 offset:2048
    ds_read_b128 v[44:47], v28 offset:3072
    ds_read_b128 v[48:51], v28 offset:4096
    ds_read_b128 v[52:55], v28 offset:5120
    s_waitcnt lgkmcnt(3)
    v_mfma_f32_16x16x32_bf16 v[88:91], v[40:43], v[224:227], 0
    v_mfma_f32_16x16x32_bf16 v[80:83], v[32:35], v[224:227], 0
    v_mfma_f32_16x16x32_bf16 v[84:87], v[36:39], v[224:227], 0
    v_mfma_f32_16x16x32_bf16 v[100:103], v[40:43], v[232:235], 0
    v_mfma_f32_16x16x32_bf16 v[92:95], v[32:35], v[232:235], 0
    v_mfma_f32_16x16x32_bf16 v[96:99], v[36:39], v[232:235], 0
    v_mfma_f32_16x16x32_bf16 v[112:115], v[40:43], v[240:243], 0
    v_mfma_f32_16x16x32_bf16 v[104:107], v[32:35], v[240:243], 0
    v_mfma_f32_16x16x32_bf16 v[108:111], v[36:39], v[240:243], 0
    v_mfma_f32_16x16x32_bf16 v[124:127], v[40:43], v[248:251], 0
    v_mfma_f32_16x16x32_bf16 v[116:119], v[32:35], v[248:251], 0
    v_mfma_f32_16x16x32_bf16 v[120:123], v[36:39], v[248:251], 0
    s_waitcnt lgkmcnt(0)
    v_mfma_f32_16x16x32_bf16 v[88:91], v[52:55], v[228:231], v[88:91]
    v_mfma_f32_16x16x32_bf16 v[80:83], v[44:47], v[228:231], v[80:83]
    v_mfma_f32_16x16x32_bf16 v[84:87], v[48:51], v[228:231], v[84:87]
    v_mfma_f32_16x16x32_bf16 v[100:103], v[52:55], v[236:239], v[100:103]
    v_mfma_f32_16x16x32_bf16 v[92:95], v[44:47], v[236:239], v[92:95]
    v_mfma_f32_16x16x32_bf16 v[96:99], v[48:51], v[236:239], v[96:99]
    v_mfma_f32_16x16x32_bf16 v[112:115], v[52:55], v[244:247], v[112:115]
    v_mfma_f32_16x16x32_bf16 v[104:107], v[44:47], v[244:247], v[104:107]
    v_mfma_f32_16x16x32_bf16 v[108:111], v[48:51], v[244:247], v[108:111]
    v_mfma_f32_16x16x32_bf16 v[124:127], v[52:55], v[252:255], v[124:127]
    v_mfma_f32_16x16x32_bf16 v[116:119], v[44:47], v[252:255], v[116:119]
    v_mfma_f32_16x16x32_bf16 v[120:123], v[48:51], v[252:255], v[120:123]
    v_add_f32 v88, 0x358637bd, v88
    v_add_f32 v100, 0x358637bd, v100
    s_nop 0
    v_add_f32 v112, 0x358637bd, v112
    s_nop 1
    v_add_f32 v124, 0x358637bd, v124
    v_rcp_f32 v88, v88
    v_rcp_f32 v100, v100
    v_rcp_f32 v112, v112
    v_rcp_f32 v124, v124
    v_pk_mul_f32 v[80:81], v[80:81], v[88:89] op_sel_hi:[1,0]
    v_pk_mul_f32 v[82:83], v[82:83], v[88:89] op_sel_hi:[1,0]
    v_pk_mul_f32 v[84:85], v[84:85], v[88:89] op_sel_hi:[1,0]
    v_pk_mul_f32 v[86:87], v[86:87], v[88:89] op_sel_hi:[1,0]
    v_cvt_pk_bf16_f32 v160, v80, v81
    v_cvt_pk_bf16_f32 v161, v82, v83
    v_cvt_pk_bf16_f32 v162, v84, v85
    v_cvt_pk_bf16_f32 v163, v86, v87
    buffer_store_dwordx4 v[160:163], v15, s[28:31], s50 offen offset:0 sc1
    v_pk_mul_f32 v[92:93], v[92:93], v[100:101] op_sel_hi:[1,0]
    v_pk_mul_f32 v[94:95], v[94:95], v[100:101] op_sel_hi:[1,0]
    v_pk_mul_f32 v[96:97], v[96:97], v[100:101] op_sel_hi:[1,0]
    v_pk_mul_f32 v[98:99], v[98:99], v[100:101] op_sel_hi:[1,0]
    v_cvt_pk_bf16_f32 v164, v92, v93
    v_cvt_pk_bf16_f32 v165, v94, v95
    v_cvt_pk_bf16_f32 v166, v96, v97
    v_cvt_pk_bf16_f32 v167, v98, v99
    buffer_store_dwordx4 v[164:167], v15, s[28:31], s50 offen offset:1024 sc1
    v_pk_mul_f32 v[104:105], v[104:105], v[112:113] op_sel_hi:[1,0]
    v_pk_mul_f32 v[106:107], v[106:107], v[112:113] op_sel_hi:[1,0]
    v_pk_mul_f32 v[108:109], v[108:109], v[112:113] op_sel_hi:[1,0]
    v_pk_mul_f32 v[110:111], v[110:111], v[112:113] op_sel_hi:[1,0]
    v_cvt_pk_bf16_f32 v168, v104, v105
    v_cvt_pk_bf16_f32 v169, v106, v107
    v_cvt_pk_bf16_f32 v170, v108, v109
    v_cvt_pk_bf16_f32 v171, v110, v111
    buffer_store_dwordx4 v[168:171], v15, s[28:31], s50 offen offset:2048 sc1
    v_pk_mul_f32 v[116:117], v[116:117], v[124:125] op_sel_hi:[1,0]
    v_pk_mul_f32 v[118:119], v[118:119], v[124:125] op_sel_hi:[1,0]
    v_pk_mul_f32 v[120:121], v[120:121], v[124:125] op_sel_hi:[1,0]
    v_pk_mul_f32 v[122:123], v[122:123], v[124:125] op_sel_hi:[1,0]
    v_cvt_pk_bf16_f32 v172, v116, v117
    v_cvt_pk_bf16_f32 v173, v118, v119
    v_cvt_pk_bf16_f32 v174, v120, v121
    v_cvt_pk_bf16_f32 v175, v122, v123
    buffer_store_dwordx4 v[172:175], v15, s[28:31], s50 offen offset:3072 sc1
    s_lshr_b32 s47, s41, 2
    s_lshl_b32 s47, s47, 5
    s_and_b32 s48, s41, 3
    s_add_u32 s47, s47, s48
    s_lshl_b32 s48, s40, 9
    s_add_u32 s47, s47, s48
    s_lshl_b32 s47, s47, 2
    s_add_u32 s47, s47, 21431296
    s_branch L_p2
L_k1_p1:
    v_lshrrev_b32 v15, 3, v1
    s_lshl_b32 s50, s40, 5
    s_add_u32 s50, s50, s43
    s_lshl_b32 s50, s50, 3
    v_add_u32 v15, s50, v15
    v_lshlrev_b32 v2, 11, v15
    v_bfe_u32 v15, v15, 1, 3
    v_and_b32 v28, 7, v1
    v_xor_b32 v15, v15, v28
    v_lshl_add_u32 v2, v15, 4, v2
    v_add_u32 v3, 0x10000, v2
    v_add_u32 v4, 0x20000, v2
    v_add_u32 v5, 0x30000, v2
    s_lshl_b32 s45, s47, 7
    s_add_u32 s82, s45, 0x40000
    s_mov_b32 s81, s48
    s_lshl_b32 s50, s2, 3
    s_add_u32 s50, s50, s42
    s_lshl_b32 s50, s50, 11
    v_lshlrev_b32 v15, 4, v1
    buffer_load_dwordx4 v[232:235], v15, s[20:23], s50 offen
    buffer_load_dwordx4 v[236:239], v15, s[20:23], s50 offen offset:1024
    s_add_u32 m0, s81, 0
    s_nop 0
    buffer_load_dwordx4 v2, s[20:23], s45 offen  lds
    s_add_u32 m0, s81, 4096
    s_nop 0
    buffer_load_dwordx4 v3, s[20:23], s45 offen  lds
    s_add_u32 m0, s81, 8192
    s_nop 0
    buffer_load_dwordx4 v4, s[20:23], s45 offen  lds
    s_add_u32 m0, s81, 12288
    s_nop 0
    buffer_load_dwordx4 v5, s[20:23], s45 offen  lds
    s_add_u32 m0, s81, 16384
    s_nop 0
    buffer_load_dwordx4 v2, s[20:23], s82 offen  lds
    s_add_u32 m0, s81, 20480
    s_nop 0
    buffer_load_dwordx4 v3, s[20:23], s82 offen  lds
    s_add_u32 m0, s81, 24576
    s_nop 0
    buffer_load_dwordx4 v4, s[20:23], s82 offen  lds
    s_add_u32 m0, s81, 28672
    s_nop 0
    buffer_load_dwordx4 v5, s[20:23], s82 offen  lds
    s_add_u32 s45, s45, 128
    s_and_b32 s45, s45, 0x7ff
    s_add_u32 s82, s45, 0x40000
    s_add_u32 s81, s81, 32768
    s_cmp_ge_u32 s81, 98304
    s_cselect_b32 s81, s48, s81
    s_mov_b32 s28, s18
    s_and_b32 s29, s19, 0xffff
    s_mov_b32 s30, 0x10000000
    s_mov_b32 s31, 0x00020000
    v_lshlrev_b32 v15, 4, v1
    s_mov_b32 s36, s8
    s_and_b32 s37, s9, 0xffff
    s_mov_b32 s38, 0x10000
    s_mov_b32 s39, 0x00020000
    s_mov_b32 s32, s16
    s_and_b32 s33, s17, 0xffff
    s_mov_b32 s34, 0x100
    s_mov_b32 s35, 0x00020000
    v_mov_b32 v16, 0x3f803f80
    v_mov_b32 v17, 0x3f803f80
    v_mov_b32 v18, 0x3f803f80
    v_mov_b32 v19, 0x3f803f80
    v_mov_b32 v20, 0
    v_mov_b32 v21, 0
    v_mov_b32 v22, 0
    v_mov_b32 v23, 0
    v_mov_b32 v24, 0
    v_mov_b32 v25, 0
    v_mov_b32 v26, 0
    v_mov_b32 v27, 0
    v_and_b32 v15, 15, v1
    s_lshl_b32 s50, s43, 6
    v_add_u32 v15, s50, v15
    v_lshlrev_b32 v6, 7, v15
    v_bfe_u32 v15, v1, 1, 3
    v_lshrrev_b32 v28, 4, v1
    v_xor_b32 v15, v15, v28
    v_lshl_add_u32 v6, v15, 4, v6
    s_mov_b32 s80, 0
    v_lshrrev_b32 v15, 4, v1
    v_lshlrev_b32 v15, 3, v15
    v_bfe_u32 v28, v1, 2, 2
    v_add_u32 v15, v15, v28
    v_lshlrev_b32 v15, 7, v15
    v_and_b32 v28, 3, v1
    v_lshl_add_u32 v15, v28, 3, v15
    v_add_u32 v15, 98304, v15
    v_bfe_u32 v28, v1, 3, 2
    v_xor_b32 v10, 2, v28
    v_lshl_add_u32 v10, v10, 5, v15
    v_xor_b32 v11, 3, v28
    v_lshl_add_u32 v11, v11, 5, v15
    v_mov_b32 v32, 0
    v_mov_b32 v33, 0
    v_mov_b32 v34, 0
    v_mov_b32 v35, 0
    v_mov_b32 v36, 0
    v_mov_b32 v37, 0
    v_mov_b32 v38, 0
    v_mov_b32 v39, 0
    v_mov_b32 v40, 0
    v_mov_b32 v41, 0
    v_mov_b32 v42, 0
    v_mov_b32 v43, 0
    v_mov_b32 v44, 0
    v_mov_b32 v45, 0
    v_mov_b32 v46, 0
    v_mov_b32 v47, 0
    v_mov_b32 v48, 0
    v_mov_b32 v49, 0
    v_mov_b32 v50, 0
    v_mov_b32 v51, 0
    v_mov_b32 v52, 0
    v_mov_b32 v53, 0
    v_mov_b32 v54, 0
    v_mov_b32 v55, 0
    v_mov_b32 v56, 0
    v_mov_b32 v57, 0
    v_mov_b32 v58, 0
    v_mov_b32 v59, 0
    v_mov_b32 v60, 0
    v_mov_b32 v61, 0
    v_mov_b32 v62, 0
    v_mov_b32 v63, 0
    v_mov_b32 v64, 0
    v_mov_b32 v65, 0
    v_mov_b32 v66, 0
    v_mov_b32 v67, 0
    v_mov_b32 v68, 0
    v_mov_b32 v69, 0
    v_mov_b32 v70, 0
    v_mov_b32 v71, 0
    v_mov_b32 v72, 0
    v_mov_b32 v73, 0
    v_mov_b32 v74, 0
    v_mov_b32 v75, 0
    v_mov_b32 v76, 0
    v_mov_b32 v77, 0
    v_mov_b32 v78, 0
    v_mov_b32 v79, 0
    v_mov_b32 v80, 0
    v_mov_b32 v81, 0
    v_mov_b32 v82, 0
    v_mov_b32 v83, 0
    v_mov_b32 v84, 0
    v_mov_b32 v85, 0
    v_mov_b32 v86, 0
    v_mov_b32 v87, 0
    v_mov_b32 v88, 0
    v_mov_b32 v89, 0
    v_mov_b32 v90, 0
    v_mov_b32 v91, 0
    v_mov_b32 v92, 0
    v_mov_b32 v93, 0
    v_mov_b32 v94, 0
    v_mov_b32 v95, 0
    v_mov_b32 v96, 0
    v_mov_b32 v97, 0
    v_mov_b32 v98, 0
    v_mov_b32 v99, 0
    v_mov_b32 v100, 0
    v_mov_b32 v101, 0
    v_mov_b32 v102, 0
    v_mov_b32 v103, 0
    v_mov_b32 v104, 0
    v_mov_b32 v105, 0
    v_mov_b32 v106, 0
    v_mov_b32 v107, 0
    v_mov_b32 v108, 0
    v_mov_b32 v109, 0
    v_mov_b32 v110, 0
    v_mov_b32 v111, 0
    v_mov_b32 v112, 0
    v_mov_b32 v113, 0
    v_mov_b32 v114, 0
    v_mov_b32 v115, 0
    v_mov_b32 v116, 0
    v_mov_b32 v117, 0
    v_mov_b32 v118, 0
    v_mov_b32 v119, 0
    v_mov_b32 v120, 0
    v_mov_b32 v121, 0
    v_mov_b32 v122, 0
    v_mov_b32 v123, 0
    v_mov_b32 v124, 0
    v_mov_b32 v125, 0
    v_mov_b32 v126, 0
    v_mov_b32 v127, 0
    s_waitcnt vmcnt(9)
    v_lshlrev_b32 v240, 16, v232
    v_and_b32 v241, 0xffff0000, v232
    v_lshlrev_b32 v242, 16, v233
    v_and_b32 v243, 0xffff0000, v233
    v_lshlrev_b32 v244, 16, v234
    v_and_b32 v245, 0xffff0000, v234
    v_lshlrev_b32 v246, 16, v235
    v_and_b32 v247, 0xffff0000, v235
    s_waitcnt vmcnt(8)
    v_lshlrev_b32 v248, 16, v236
    v_and_b32 v249, 0xffff0000, v236
    v_lshlrev_b32 v250, 16, v237
    v_and_b32 v251, 0xffff0000, v237
    v_lshlrev_b32 v252, 16, v238
    v_and_b32 v253, 0xffff0000, v238
    v_lshlrev_b32 v254, 16, v239
    v_and_b32 v255, 0xffff0000, v239
    v_pk_add_f32 v[232:233], v[240:241], v[242:243]
    v_pk_add_f32 v[234:235], v[244:245], v[246:247]
    v_pk_add_f32 v[236:237], v[248:249], v[250:251]
    v_pk_add_f32 v[238:239], v[252:253], v[254:255]
    v_pk_add_f32 v[232:233], v[232:233], v[234:235]
    v_pk_add_f32 v[236:237], v[236:237], v[238:239]
    v_pk_add_f32 v[232:233], v[232:233], v[236:237]
    v_add_f32 v232, v232, v233
    s_nop 1
    v_add_f32_dpp v232, v232, v232 row_ror:8 row_mask:0xf bank_mask:0xf
    s_nop 1
    v_add_f32_dpp v232, v232, v232 row_ror:4 row_mask:0xf bank_mask:0xf
    s_nop 1
    v_add_f32_dpp v232, v232, v232 row_ror:2 row_mask:0xf bank_mask:0xf
    s_nop 1
    v_add_f32_dpp v232, v232, v232 row_ror:1 row_mask:0xf bank_mask:0xf
    v_mov_b32 v233, v232
    s_nop 1
    v_permlane16_swap_b32 v232, v233
    v_add_f32 v232, v232, v233
    v_mov_b32 v233, v232
    s_nop 1
    v_permlane32_swap_b32 v232, v233
    v_add_f32 v232, v232, v233
    v_mul_f32 v28, 0xba800000, v232
    v_pk_add_f32 v[240:241], v[240:241], v[28:29] op_sel_hi:[1,0]
    v_pk_add_f32 v[242:243], v[242:243], v[28:29] op_sel_hi:[1,0]
    v_pk_add_f32 v[244:245], v[244:245], v[28:29] op_sel_hi:[1,0]
    v_pk_add_f32 v[246:247], v[246:247], v[28:29] op_sel_hi:[1,0]
    v_pk_add_f32 v[248:249], v[248:249], v[28:29] op_sel_hi:[1,0]
    v_pk_add_f32 v[250:251], v[250:251], v[28:29] op_sel_hi:[1,0]
    v_pk_add_f32 v[252:253], v[252:253], v[28:29] op_sel_hi:[1,0]
    v_pk_add_f32 v[254:255], v[254:255], v[28:29] op_sel_hi:[1,0]
    v_pk_mul_f32 v[232:233], v[240:241], v[240:241]
    v_pk_mul_f32 v[234:235], v[242:243], v[242:243]
    v_pk_fma_f32 v[232:233], v[244:245], v[244:245], v[232:233]
    v_pk_fma_f32 v[234:235], v[246:247], v[246:247], v[234:235]
    v_pk_fma_f32 v[232:233], v[248:249], v[248:249], v[232:233]
    v_pk_fma_f32 v[234:235], v[250:251], v[250:251], v[234:235]
    v_pk_fma_f32 v[232:233], v[252:253], v[252:253], v[232:233]
    v_pk_fma_f32 v[234:235], v[254:255], v[254:255], v[234:235]
    v_pk_add_f32 v[232:233], v[232:233], v[234:235]
    v_add_f32 v232, v232, v233
    s_nop 1
    v_add_f32_dpp v232, v232, v232 row_ror:8 row_mask:0xf bank_mask:0xf
    s_nop 1
    v_add_f32_dpp v232, v232, v232 row_ror:4 row_mask:0xf bank_mask:0xf
    s_nop 1
    v_add_f32_dpp v232, v232, v232 row_ror:2 row_mask:0xf bank_mask:0xf
    s_nop 1
    v_add_f32_dpp v232, v232, v232 row_ror:1 row_mask:0xf bank_mask:0xf
    v_mov_b32 v233, v232
    s_nop 1
    v_permlane16_swap_b32 v232, v233
    v_add_f32 v232, v232, v233
    v_mov_b32 v233, v232
    s_nop 1
    v_permlane32_swap_b32 v232, v233
    v_add_f32 v232, v232, v233
    v_mov_b32 v233, 0x3727c5ac
    v_fmac_f32 v233, 0x3a800000, v232
    v_rsq_f32 v239, v233
    v_cvt_pk_bf16_f32 v234, v28, v28
    v_mul_f32 v233, v233, v239
    v_and_b32 v234, 0xffff0000, v234
    v_sub_f32 v234, v28, v234
    v_cvt_pk_bf16_f32 v236, v28, v234
    v_cvt_pk_bf16_f32 v237, v28, v233
    v_and_b32 v235, 0xffff0000, v237
    v_sub_f32 v235, v233, v235
    v_cvt_pk_bf16_f32 v238, v235, 0
    s_add_u32 m0, s81, 0
    s_nop 0
    buffer_load_dwordx4 v2, s[20:23], s45 offen  lds
    s_add_u32 m0, s81, 4096
    s_nop 0
    buffer_load_dwordx4 v3, s[20:23], s45 offen  lds
    s_add_u32 m0, s81, 8192
    s_nop 0
    buffer_load_dwordx4 v4, s[20:23], s45 offen  lds
    s_add_u32 m0, s81, 12288
    s_nop 0
    buffer_load_dwordx4 v5, s[20:23], s45 offen  lds
    s_add_u32 m0, s81, 16384
    s_nop 0
    buffer_load_dwordx4 v2, s[20:23], s82 offen  lds
    s_add_u32 m0, s81, 20480
    s_nop 0
    buffer_load_dwordx4 v3, s[20:23], s82 offen  lds
    s_add_u32 m0, s81, 24576
    s_nop 0
    buffer_load_dwordx4 v4, s[20:23], s82 offen  lds
    s_add_u32 m0, s81, 28672
    s_nop 0
    buffer_load_dwordx4 v5, s[20:23], s82 offen  lds
    s_add_u32 s45, s45, 128
    s_and_b32 s45, s45, 0x7ff
    s_add_u32 s82, s45, 0x40000
    s_add_u32 s81, s81, 32768
    s_cmp_ge_u32 s81, 98304
    s_cselect_b32 s81, s48, s81
    s_lshl_b32 s50, s2, 3
    s_add_u32 s50, s50, s42
    s_mul_i32 s51, s50, 3584
    s_add_u32 s88, s88, s51
    s_addc_u32 s89, s89, 0
    s_lshl_b32 s51, s50, 10
    s_add_u32 s92, s92, s51
    s_addc_u32 s93, s93, 0
    s_waitcnt vmcnt(8)
    s_barrier
    v_mov_b32 v248, -1
    v_mov_b32 v249, -1
    v_mov_b32 v250, -1
    v_mov_b32 v251, -1
    s_lshl_b32 s50, s2, 3
    s_add_u32 s50, s50, s42
    s_lshl_b32 s50, s50, 4
    s_add_u32 s50, s50, 18874368
    s_mov_b64 exec, 1
    buffer_store_dwordx4 v[236:239], off, s[28:31], s50 sc1
    s_mov_b64 exec, -1
    s_lshl_b32 s50, s41, 1
    s_add_u32 s50, s50, s44
    s_lshl_b32 s50, s50, 3
    s_add_u32 s50, s50, s40
    s_lshl_b32 s50, s50, 9
    s_lshl_b32 s51, s43, 7
    s_add_u32 s50, s50, s51
    s_add_u32 s50, s50, 18939904
    v_lshlrev_b32 v15, 4, v1
    s_mov_b64 exec, 0xff
    buffer_store_dwordx4 v[248:251], v15, s[28:31], s50 offen sc1
    s_mov_b64 exec, -1
    s_lshl_b32 s54, s41, 3
    s_add_u32 s54, s54, s42
    s_lshl_b32 s54, s54, 9
    s_add_u32 s54, s54, 21364736
    s_lshl_b32 s51, s42, 11
    s_lshl_b32 s52, s41, 17
    s_add_u32 s51, s51, s52
    s_add_u32 s51, s51, 19267584
    s_lshl_b32 s52, s40, 14
    s_add_u32 s52, s52, s51
    s_lshl_b32 s55, s40, 6
    s_add_u32 s55, s55, s54
    v_lshlrev_b32 v15, 4, v1
    v_and_b32 v29, 48, v1
    buffer_store_dwordx4 v[248:251], v15, s[28:31], s52 offen offset:0 sc1
    buffer_store_dwordx4 v[248:251], v15, s[28:31], s52 offen offset:1024 sc1
    s_mov_b32 exec_lo, 0x00010001
    s_mov_b32 exec_hi, 0x00010001
    buffer_store_dwordx4 v[248:251], v29, s[28:31], s55 offen sc1
    s_mov_b64 exec, -1
    v_lshlrev_b32 v15, 4, v1
    s_lshl_b32 s50, s2, 3
    s_add_u32 s50, s50, s42
    s_lshl_b32 s50, s50, 11
    s_add_u32 s50, s50, 33554432
    buffer_store_dwordx4 v[248:251], v15, s[28:31], s50 offen offset:0 sc1
    buffer_store_dwordx4 v[248:251], v15, s[28:31], s50 offen offset:1024 sc1
    s_barrier
    v_add_u32 v8, s80, v6
    v_xor_b32 v9, 64, v8
    s_add_u32 s80, s80, 32768
    s_cmp_ge_u32 s80, 98304
    s_cselect_b32 s80, 0, s80
    ds_read_b64_tr_b16 v[160:161], v10 offset:0
    s_add_u32 m0, s81, 0
    ds_read_b64_tr_b16 v[162:163], v10 offset:512
    buffer_load_dwordx4 v2, s[20:23], s45 offen  lds
    ds_read_b64_tr_b16 v[204:205], v10 offset:4096
    ds_read_b64_tr_b16 v[206:207], v10 offset:4608
    ds_read_b128 v[144:147], v8 offset:0
    s_add_u32 m0, s81, 4096
    ds_read_b128 v[148:151], v8 offset:2048
    buffer_load_dwordx4 v3, s[20:23], s45 offen  lds
    ds_read_b128 v[152:155], v8 offset:4096
    ds_read_b128 v[156:159], v8 offset:6144
    ds_read_b128 v[188:191], v9 offset:0
    s_add_u32 m0, s81, 8192
    ds_read_b128 v[192:195], v9 offset:2048
    buffer_load_dwordx4 v4, s[20:23], s45 offen  lds
    ds_read_b128 v[196:199], v9 offset:4096
    ds_read_b128 v[200:203], v9 offset:6144
    ds_read_b64_tr_b16 v[164:165], v11 offset:0
    s_add_u32 m0, s81, 12288
    ds_read_b64_tr_b16 v[166:167], v11 offset:512
    buffer_load_dwordx4 v5, s[20:23], s45 offen  lds
    ds_read_b64_tr_b16 v[208:209], v11 offset:4096
    ds_read_b64_tr_b16 v[210:211], v11 offset:4608
    ds_read_b64_tr_b16 v[168:169], v10 offset:8192
    s_add_u32 m0, s81, 16384
    ds_read_b64_tr_b16 v[170:171], v10 offset:8704
    buffer_load_dwordx4 v2, s[20:23], s82 offen  lds
    ds_read_b64_tr_b16 v[212:213], v10 offset:12288
    ds_read_b64_tr_b16 v[214:215], v10 offset:12800
    ds_read_b64_tr_b16 v[172:173], v11 offset:8192
    s_add_u32 m0, s81, 20480
    ds_read_b64_tr_b16 v[174:175], v11 offset:8704
    buffer_load_dwordx4 v3, s[20:23], s82 offen  lds
    ds_read_b64_tr_b16 v[216:217], v11 offset:12288
    ds_read_b64_tr_b16 v[218:219], v11 offset:12800
    ds_read_b64_tr_b16 v[176:177], v10 offset:16384
    s_add_u32 m0, s81, 24576
    ds_read_b64_tr_b16 v[178:179], v10 offset:16896
    buffer_load_dwordx4 v4, s[20:23], s82 offen  lds
    ds_read_b64_tr_b16 v[220:221], v10 offset:20480
    ds_read_b64_tr_b16 v[222:223], v10 offset:20992
    ds_read_b64_tr_b16 v[180:181], v11 offset:16384
    s_add_u32 m0, s81, 28672
    ds_read_b64_tr_b16 v[182:183], v11 offset:16896
    buffer_load_dwordx4 v5, s[20:23], s82 offen  lds
    ds_read_b64_tr_b16 v[224:225], v11 offset:20480
    ds_read_b64_tr_b16 v[226:227], v11 offset:20992
    s_add_u32 s45, s45, 128
    s_and_b32 s45, s45, 0x7ff
    s_add_u32 s82, s45, 0x40000
    s_add_u32 s81, s81, 32768
    s_cmp_ge_u32 s81, 98304
    s_cselect_b32 s81, s48, s81
    s_waitcnt lgkmcnt(0)
    s_cmp_lg_u32 s86, 0
    s_cbranch_scc1 L_cs_2001
    s_cmp_lg_u32 s43, 0
    s_cbranch_scc1 L_cs_2002
    v_mfma_f32_16x16x32_bf16 v[20:23], v[16:19], v[160:163], v[20:23]
    v_mfma_f32_16x16x32_bf16 v[20:23], v[16:19], v[204:207], v[20:23]
    v_mfma_f32_16x16x32_bf16 v[24:27], v[16:19], v[176:179], v[24:27]
    v_mfma_f32_16x16x32_bf16 v[24:27], v[16:19], v[220:223], v[24:27]
    s_branch L_cs_2001
L_cs_2002:
    s_cmp_lg_u32 s43, 1
    s_cbranch_scc1 L_cs_2003
    v_mfma_f32_16x16x32_bf16 v[20:23], v[16:19], v[164:167], v[20:23]
    v_mfma_f32_16x16x32_bf16 v[20:23], v[16:19], v[208:211], v[20:23]
    v_mfma_f32_16x16x32_bf16 v[24:27], v[16:19], v[180:183], v[24:27]
    v_mfma_f32_16x16x32_bf16 v[24:27], v[16:19], v[224:227], v[24:27]
    s_branch L_cs_2001
L_cs_2003:
    s_cmp_lg_u32 s43, 2
    s_cbranch_scc1 L_cs_2004
    v_mfma_f32_16x16x32_bf16 v[20:23], v[16:19], v[168:171], v[20:23]
    v_mfma_f32_16x16x32_bf16 v[20:23], v[16:19], v[212:215], v[20:23]
    s_branch L_cs_2001
L_cs_2004:
    v_mfma_f32_16x16x32_bf16 v[20:23], v[16:19], v[172:175], v[20:23]
    v_mfma_f32_16x16x32_bf16 v[20:23], v[16:19], v[216:219], v[20:23]
L_cs_2001:
    s_waitcnt vmcnt(15)
    s_call_b64 s[100:101], L_sub_c0_2
    v_add_u32 v8, s80, v6
    v_xor_b32 v9, 64, v8
    s_add_u32 s80, s80, 32768
    s_cmp_ge_u32 s80, 98304
    s_cselect_b32 s80, 0, s80
    ds_read_b64_tr_b16 v[160:161], v10 offset:32768
    s_add_u32 m0, s81, 0
    ds_read_b64_tr_b16 v[162:163], v10 offset:33280
    buffer_load_dwordx4 v2, s[20:23], s45 offen  lds
    ds_read_b64_tr_b16 v[204:205], v10 offset:36864
    ds_read_b64_tr_b16 v[206:207], v10 offset:37376
    ds_read_b128 v[144:147], v8 offset:0
    s_add_u32 m0, s81, 4096
    ds_read_b128 v[148:151], v8 offset:2048
    buffer_load_dwordx4 v3, s[20:23], s45 offen  lds
    ds_read_b128 v[152:155], v8 offset:4096
    ds_read_b128 v[156:159], v8 offset:6144
    ds_read_b128 v[188:191], v9 offset:0
    s_add_u32 m0, s81, 8192
    ds_read_b128 v[192:195], v9 offset:2048
    buffer_load_dwordx4 v4, s[20:23], s45 offen  lds
    ds_read_b128 v[196:199], v9 offset:4096
    ds_read_b128 v[200:203], v9 offset:6144
    ds_read_b64_tr_b16 v[164:165], v11 offset:32768
    s_add_u32 m0, s81, 12288
    ds_read_b64_tr_b16 v[166:167], v11 offset:33280
    buffer_load_dwordx4 v5, s[20:23], s45 offen  lds
    ds_read_b64_tr_b16 v[208:209], v11 offset:36864
    ds_read_b64_tr_b16 v[210:211], v11 offset:37376
    ds_read_b64_tr_b16 v[168:169], v10 offset:40960
    s_add_u32 m0, s81, 16384
    ds_read_b64_tr_b16 v[170:171], v10 offset:41472
    buffer_load_dwordx4 v2, s[20:23], s82 offen  lds
    ds_read_b64_tr_b16 v[212:213], v10 offset:45056
    ds_read_b64_tr_b16 v[214:215], v10 offset:45568
    ds_read_b64_tr_b16 v[172:173], v11 offset:40960
    s_add_u32 m0, s81, 20480
    ds_read_b64_tr_b16 v[174:175], v11 offset:41472
    buffer_load_dwordx4 v3, s[20:23], s82 offen  lds
    ds_read_b64_tr_b16 v[216:217], v11 offset:45056
    ds_read_b64_tr_b16 v[218:219], v11 offset:45568
    ds_read_b64_tr_b16 v[176:177], v10 offset:49152
    s_add_u32 m0, s81, 24576
    ds_read_b64_tr_b16 v[178:179], v10 offset:49664
    buffer_load_dwordx4 v4, s[20:23], s82 offen  lds
    ds_read_b64_tr_b16 v[220:221], v10 offset:53248
    ds_read_b64_tr_b16 v[222:223], v10 offset:53760
    ds_read_b64_tr_b16 v[180:181], v11 offset:49152
    s_add_u32 m0, s81, 28672
    ds_read_b64_tr_b16 v[182:183], v11 offset:49664
    buffer_load_dwordx4 v5, s[20:23], s82 offen  lds
    ds_read_b64_tr_b16 v[224:225], v11 offset:53248
    ds_read_b64_tr_b16 v[226:227], v11 offset:53760
    s_add_u32 s45, s45, 128
    s_and_b32 s45, s45, 0x7ff
    s_add_u32 s82, s45, 0x40000
    s_add_u32 s81, s81, 32768
    s_cmp_ge_u32 s81, 98304
    s_cselect_b32 s81, s48, s81
    s_waitcnt lgkmcnt(0)
    s_cmp_lg_u32 s86, 0
    s_cbranch_scc1 L_cs_2005
    s_cmp_lg_u32 s43, 0
    s_cbranch_scc1 L_cs_2006
    v_mfma_f32_16x16x32_bf16 v[20:23], v[16:19], v[160:163], v[20:23]
    v_mfma_f32_16x16x32_bf16 v[20:23], v[16:19], v[204:207], v[20:23]
    v_mfma_f32_16x16x32_bf16 v[24:27], v[16:19], v[176:179], v[24:27]
    v_mfma_f32_16x16x32_bf16 v[24:27], v[16:19], v[220:223], v[24:27]
    s_branch L_cs_2005
L_cs_2006:
    s_cmp_lg_u32 s43, 1
    s_cbranch_scc1 L_cs_2007
    v_mfma_f32_16x16x32_bf16 v[20:23], v[16:19], v[164:167], v[20:23]
    v_mfma_f32_16x16x32_bf16 v[20:23], v[16:19], v[208:211], v[20:23]
    v_mfma_f32_16x16x32_bf16 v[24:27], v[16:19], v[180:183], v[24:27]
    v_mfma_f32_16x16x32_bf16 v[24:27], v[16:19], v[224:227], v[24:27]
    s_branch L_cs_2005
L_cs_2007:
    s_cmp_lg_u32 s43, 2
    s_cbranch_scc1 L_cs_2008
    v_mfma_f32_16x16x32_bf16 v[20:23], v[16:19], v[168:171], v[20:23]
    v_mfma_f32_16x16x32_bf16 v[20:23], v[16:19], v[212:215], v[20:23]
    s_branch L_cs_2005
L_cs_2008:
    v_mfma_f32_16x16x32_bf16 v[20:23], v[16:19], v[172:175], v[20:23]
    v_mfma_f32_16x16x32_bf16 v[20:23], v[16:19], v[216:219], v[20:23]
L_cs_2005:
    s_sub_u32 s86, s86, 1
    s_waitcnt vmcnt(8)
    s_call_b64 s[100:101], L_sub_c0_2
    v_add_u32 v8, s80, v6
    v_xor_b32 v9, 64, v8
    s_add_u32 s80, s80, 32768
    s_cmp_ge_u32 s80, 98304
    s_cselect_b32 s80, 0, s80
    ds_read_b64_tr_b16 v[160:161], v10 offset:0
    s_add_u32 m0, s81, 0
    ds_read_b64_tr_b16 v[162:163], v10 offset:512
    buffer_load_dwordx4 v2, s[20:23], s45 offen  lds
    ds_read_b64_tr_b16 v[204:205], v10 offset:4096
    ds_read_b64_tr_b16 v[206:207], v10 offset:4608
    ds_read_b128 v[144:147], v8 offset:0
    s_add_u32 m0, s81, 4096
    ds_read_b128 v[148:151], v8 offset:2048
    buffer_load_dwordx4 v3, s[20:23], s45 offen  lds
    ds_read_b128 v[152:155], v8 offset:4096
    ds_read_b128 v[156:159], v8 offset:6144
    ds_read_b128 v[188:191], v9 offset:0
    s_add_u32 m0, s81, 8192
    ds_read_b128 v[192:195], v9 offset:2048
    buffer_load_dwordx4 v4, s[20:23], s45 offen  lds
    ds_read_b128 v[196:199], v9 offset:4096
    ds_read_b128 v[200:203], v9 offset:6144
    ds_read_b64_tr_b16 v[164:165], v11 offset:0
    s_add_u32 m0, s81, 12288
    ds_read_b64_tr_b16 v[166:167], v11 offset:512
    buffer_load_dwordx4 v5, s[20:23], s45 offen  lds
    ds_read_b64_tr_b16 v[208:209], v11 offset:4096
    ds_read_b64_tr_b16 v[210:211], v11 offset:4608
    ds_read_b64_tr_b16 v[168:169], v10 offset:8192
    s_add_u32 m0, s81, 16384
    ds_read_b64_tr_b16 v[170:171], v10 offset:8704
    buffer_load_dwordx4 v2, s[20:23], s82 offen  lds
    ds_read_b64_tr_b16 v[212:213], v10 offset:12288
    ds_read_b64_tr_b16 v[214:215], v10 offset:12800
    ds_read_b64_tr_b16 v[172:173], v11 offset:8192
    s_add_u32 m0, s81, 20480
    ds_read_b64_tr_b16 v[174:175], v11 offset:8704
    buffer_load_dwordx4 v3, s[20:23], s82 offen  lds
    ds_read_b64_tr_b16 v[216:217], v11 offset:12288
    ds_read_b64_tr_b16 v[218:219], v11 offset:12800
    ds_read_b64_tr_b16 v[176:177], v10 offset:16384
    s_add_u32 m0, s81, 24576
    ds_read_b64_tr_b16 v[178:179], v10 offset:16896
    buffer_load_dwordx4 v4, s[20:23], s82 offen  lds
    ds_read_b64_tr_b16 v[220:221], v10 offset:20480
    ds_read_b64_tr_b16 v[222:223], v10 offset:20992
    ds_read_b64_tr_b16 v[180:181], v11 offset:16384
    s_add_u32 m0, s81, 28672
    ds_read_b64_tr_b16 v[182:183], v11 offset:16896
    buffer_load_dwordx4 v5, s[20:23], s82 offen  lds
    ds_read_b64_tr_b16 v[224:225], v11 offset:20480
    ds_read_b64_tr_b16 v[226:227], v11 offset:20992
    s_add_u32 s45, s45, 128
    s_and_b32 s45, s45, 0x7ff
    s_add_u32 s82, s45, 0x40000
    s_add_u32 s81, s81, 32768
    s_cmp_ge_u32 s81, 98304
    s_cselect_b32 s81, s48, s81
    s_waitcnt lgkmcnt(0)
    s_cmp_lg_u32 s86, 0
    s_cbranch_scc1 L_cs_2009
    s_cmp_lg_u32 s43, 0
    s_cbranch_scc1 L_cs_2010
    v_mfma_f32_16x16x32_bf16 v[20:23], v[16:19], v[160:163], v[20:23]
    v_mfma_f32_16x16x32_bf16 v[20:23], v[16:19], v[204:207], v[20:23]
    v_mfma_f32_16x16x32_bf16 v[24:27], v[16:19], v[176:179], v[24:27]
    v_mfma_f32_16x16x32_bf16 v[24:27], v[16:19], v[220:223], v[24:27]
    s_branch L_cs_2009
L_cs_2010:
    s_cmp_lg_u32 s43, 1
    s_cbranch_scc1 L_cs_2011
    v_mfma_f32_16x16x32_bf16 v[20:23], v[16:19], v[164:167], v[20:23]
    v_mfma_f32_16x16x32_bf16 v[20:23], v[16:19], v[208:211], v[20:23]
    v_mfma_f32_16x16x32_bf16 v[24:27], v[16:19], v[180:183], v[24:27]
    v_mfma_f32_16x16x32_bf16 v[24:27], v[16:19], v[224:227], v[24:27]
    s_branch L_cs_2009
L_cs_2011:
    s_cmp_lg_u32 s43, 2
    s_cbranch_scc1 L_cs_2012
    v_mfma_f32_16x16x32_bf16 v[20:23], v[16:19], v[168:171], v[20:23]
    v_mfma_f32_16x16x32_bf16 v[20:23], v[16:19], v[212:215], v[20:23]
    s_branch L_cs_2009
L_cs_2012:
    v_mfma_f32_16x16x32_bf16 v[20:23], v[16:19], v[172:175], v[20:23]
    v_mfma_f32_16x16x32_bf16 v[20:23], v[16:19], v[216:219], v[20:23]
L_cs_2009:
    s_waitcnt vmcnt(8)
    s_call_b64 s[100:101], L_sub_c0_1
    v_add_u32 v8, s80, v6
    v_xor_b32 v9, 64, v8
    s_add_u32 s80, s80, 32768
    s_cmp_ge_u32 s80, 98304
    s_cselect_b32 s80, 0, s80
    ds_read_b64_tr_b16 v[160:161], v10 offset:32768
    s_add_u32 m0, s81, 0
    ds_read_b64_tr_b16 v[162:163], v10 offset:33280
    buffer_load_dwordx4 v2, s[20:23], s45 offen  lds
    ds_read_b64_tr_b16 v[204:205], v10 offset:36864
    ds_read_b64_tr_b16 v[206:207], v10 offset:37376
    ds_read_b128 v[144:147], v8 offset:0
    s_add_u32 m0, s81, 4096
    ds_read_b128 v[148:151], v8 offset:2048
    buffer_load_dwordx4 v3, s[20:23], s45 offen  lds
    ds_read_b128 v[152:155], v8 offset:4096
    ds_read_b128 v[156:159], v8 offset:6144
    ds_read_b128 v[188:191], v9 offset:0
    s_add_u32 m0, s81, 8192
    ds_read_b128 v[192:195], v9 offset:2048
    buffer_load_dwordx4 v4, s[20:23], s45 offen  lds
    ds_read_b128 v[196:199], v9 offset:4096
    ds_read_b128 v[200:203], v9 offset:6144
    ds_read_b64_tr_b16 v[164:165], v11 offset:32768
    s_add_u32 m0, s81, 12288
    ds_read_b64_tr_b16 v[166:167], v11 offset:33280
    buffer_load_dwordx4 v5, s[20:23], s45 offen  lds
    ds_read_b64_tr_b16 v[208:209], v11 offset:36864
    ds_read_b64_tr_b16 v[210:211], v11 offset:37376
    ds_read_b64_tr_b16 v[168:169], v10 offset:40960
    s_add_u32 m0, s81, 16384
    ds_read_b64_tr_b16 v[170:171], v10 offset:41472
    buffer_load_dwordx4 v2, s[20:23], s82 offen  lds
    ds_read_b64_tr_b16 v[212:213], v10 offset:45056
    ds_read_b64_tr_b16 v[214:215], v10 offset:45568
    ds_read_b64_tr_b16 v[172:173], v11 offset:40960
    s_add_u32 m0, s81, 20480
    ds_read_b64_tr_b16 v[174:175], v11 offset:41472
    buffer_load_dwordx4 v3, s[20:23], s82 offen  lds
    ds_read_b64_tr_b16 v[216:217], v11 offset:45056
    ds_read_b64_tr_b16 v[218:219], v11 offset:45568
    ds_read_b64_tr_b16 v[176:177], v10 offset:49152
    s_add_u32 m0, s81, 24576
    ds_read_b64_tr_b16 v[178:179], v10 offset:49664
    buffer_load_dwordx4 v4, s[20:23], s82 offen  lds
    ds_read_b64_tr_b16 v[220:221], v10 offset:53248
    ds_read_b64_tr_b16 v[222:223], v10 offset:53760
    ds_read_b64_tr_b16 v[180:181], v11 offset:49152
    s_add_u32 m0, s81, 28672
    ds_read_b64_tr_b16 v[182:183], v11 offset:49664
    buffer_load_dwordx4 v5, s[20:23], s82 offen  lds
    ds_read_b64_tr_b16 v[224:225], v11 offset:53248
    ds_read_b64_tr_b16 v[226:227], v11 offset:53760
    s_add_u32 s45, s45, 128
    s_and_b32 s45, s45, 0x7ff
    s_add_u32 s82, s45, 0x40000
    s_add_u32 s81, s81, 32768
    s_cmp_ge_u32 s81, 98304
    s_cselect_b32 s81, s48, s81
    s_bfe_u32 s50, s2, 131075
    s_lshl_b32 s50, s50, 2
    s_add_u32 s50, s50, s43
    s_cmp_lg_u32 s50, 0
    s_cbranch_scc1 L_sig_2013
    s_mov_b64 exec, 1
    v_mov_b32 v15, 1
    buffer_store_byte v15, off, s[32:35], s2 sc1
    s_mov_b64 exec, -1
L_sig_2013:
    s_waitcnt lgkmcnt(0)
    s_cmp_lg_u32 s86, 0
    s_cbranch_scc1 L_cs_2014
    s_cmp_lg_u32 s43, 0
    s_cbranch_scc1 L_cs_2015
    v_mfma_f32_16x16x32_bf16 v[20:23], v[16:19], v[160:163], v[20:23]
    v_mfma_f32_16x16x32_bf16 v[20:23], v[16:19], v[204:207], v[20:23]
    v_mfma_f32_16x16x32_bf16 v[24:27], v[16:19], v[176:179], v[24:27]
    v_mfma_f32_16x16x32_bf16 v[24:27], v[16:19], v[220:223], v[24:27]
    s_branch L_cs_2014
L_cs_2015:
    s_cmp_lg_u32 s43, 1
    s_cbranch_scc1 L_cs_2016
    v_mfma_f32_16x16x32_bf16 v[20:23], v[16:19], v[164:167], v[20:23]
    v_mfma_f32_16x16x32_bf16 v[20:23], v[16:19], v[208:211], v[20:23]
    v_mfma_f32_16x16x32_bf16 v[24:27], v[16:19], v[180:183], v[24:27]
    v_mfma_f32_16x16x32_bf16 v[24:27], v[16:19], v[224:227], v[24:27]
    s_branch L_cs_2014
L_cs_2016:
    s_cmp_lg_u32 s43, 2
    s_cbranch_scc1 L_cs_2017
    v_mfma_f32_16x16x32_bf16 v[20:23], v[16:19], v[168:171], v[20:23]
    v_mfma_f32_16x16x32_bf16 v[20:23], v[16:19], v[212:215], v[20:23]
    s_branch L_cs_2014
L_cs_2017:
    v_mfma_f32_16x16x32_bf16 v[20:23], v[16:19], v[172:175], v[20:23]
    v_mfma_f32_16x16x32_bf16 v[20:23], v[16:19], v[216:219], v[20:23]
L_cs_2014:
    s_sub_u32 s86, s86, 1
    s_call_b64 s[100:101], L_sub_c0_2
    v_add_u32 v8, s80, v6
    v_xor_b32 v9, 64, v8
    s_add_u32 s80, s80, 32768
    s_cmp_ge_u32 s80, 98304
    s_cselect_b32 s80, 0, s80
    ds_read_b64_tr_b16 v[160:161], v10 offset:0
    s_add_u32 m0, s81, 0
    ds_read_b64_tr_b16 v[162:163], v10 offset:512
    buffer_load_dwordx4 v2, s[20:23], s45 offen  lds
    ds_read_b64_tr_b16 v[204:205], v10 offset:4096
    ds_read_b64_tr_b16 v[206:207], v10 offset:4608
    ds_read_b128 v[144:147], v8 offset:0
    s_add_u32 m0, s81, 4096
    ds_read_b128 v[148:151], v8 offset:2048
    buffer_load_dwordx4 v3, s[20:23], s45 offen  lds
    ds_read_b128 v[152:155], v8 offset:4096
    ds_read_b128 v[156:159], v8 offset:6144
    ds_read_b128 v[188:191], v9 offset:0
    s_add_u32 m0, s81, 8192
    ds_read_b128 v[192:195], v9 offset:2048
    buffer_load_dwordx4 v4, s[20:23], s45 offen  lds
    ds_read_b128 v[196:199], v9 offset:4096
    ds_read_b128 v[200:203], v9 offset:6144
    ds_read_b64_tr_b16 v[164:165], v11 offset:0
    s_add_u32 m0, s81, 12288
    ds_read_b64_tr_b16 v[166:167], v11 offset:512
    buffer_load_dwordx4 v5, s[20:23], s45 offen  lds
    ds_read_b64_tr_b16 v[208:209], v11 offset:4096
    ds_read_b64_tr_b16 v[210:211], v11 offset:4608
    ds_read_b64_tr_b16 v[168:169], v10 offset:8192
    s_add_u32 m0, s81, 16384
    ds_read_b64_tr_b16 v[170:171], v10 offset:8704
    buffer_load_dwordx4 v2, s[20:23], s82 offen  lds
    ds_read_b64_tr_b16 v[212:213], v10 offset:12288
    ds_read_b64_tr_b16 v[214:215], v10 offset:12800
    ds_read_b64_tr_b16 v[172:173], v11 offset:8192
    s_add_u32 m0, s81, 20480
    ds_read_b64_tr_b16 v[174:175], v11 offset:8704
    buffer_load_dwordx4 v3, s[20:23], s82 offen  lds
    ds_read_b64_tr_b16 v[216:217], v11 offset:12288
    ds_read_b64_tr_b16 v[218:219], v11 offset:12800
    ds_read_b64_tr_b16 v[176:177], v10 offset:16384
    s_add_u32 m0, s81, 24576
    ds_read_b64_tr_b16 v[178:179], v10 offset:16896
    buffer_load_dwordx4 v4, s[20:23], s82 offen  lds
    ds_read_b64_tr_b16 v[220:221], v10 offset:20480
    ds_read_b64_tr_b16 v[222:223], v10 offset:20992
    ds_read_b64_tr_b16 v[180:181], v11 offset:16384
    s_add_u32 m0, s81, 28672
    ds_read_b64_tr_b16 v[182:183], v11 offset:16896
    buffer_load_dwordx4 v5, s[20:23], s82 offen  lds
    ds_read_b64_tr_b16 v[224:225], v11 offset:20480
    ds_read_b64_tr_b16 v[226:227], v11 offset:20992
    s_add_u32 s45, s45, 128
    s_and_b32 s45, s45, 0x7ff
    s_add_u32 s82, s45, 0x40000
    s_add_u32 s81, s81, 32768
    s_cmp_ge_u32 s81, 98304
    s_cselect_b32 s81, s48, s81
    s_bfe_u32 s50, s2, 131075
    s_lshl_b32 s50, s50, 2
    s_add_u32 s50, s50, s43
    s_cmp_lg_u32 s50, 4
    s_cbranch_scc1 L_sig_2018
    s_mov_b64 exec, 1
    v_mov_b32 v15, 1
    buffer_store_byte v15, off, s[32:35], s2 sc1
    s_mov_b64 exec, -1
L_sig_2018:
    s_waitcnt lgkmcnt(0)
    s_cmp_lg_u32 s86, 0
    s_cbranch_scc1 L_cs_2019
    s_cmp_lg_u32 s43, 0
    s_cbranch_scc1 L_cs_2020
    v_mfma_f32_16x16x32_bf16 v[20:23], v[16:19], v[160:163], v[20:23]
    v_mfma_f32_16x16x32_bf16 v[20:23], v[16:19], v[204:207], v[20:23]
    v_mfma_f32_16x16x32_bf16 v[24:27], v[16:19], v[176:179], v[24:27]
    v_mfma_f32_16x16x32_bf16 v[24:27], v[16:19], v[220:223], v[24:27]
    s_branch L_cs_2019
L_cs_2020:
    s_cmp_lg_u32 s43, 1
    s_cbranch_scc1 L_cs_2021
    v_mfma_f32_16x16x32_bf16 v[20:23], v[16:19], v[164:167], v[20:23]
    v_mfma_f32_16x16x32_bf16 v[20:23], v[16:19], v[208:211], v[20:23]
    v_mfma_f32_16x16x32_bf16 v[24:27], v[16:19], v[180:183], v[24:27]
    v_mfma_f32_16x16x32_bf16 v[24:27], v[16:19], v[224:227], v[24:27]
    s_branch L_cs_2019
L_cs_2021:
    s_cmp_lg_u32 s43, 2
    s_cbranch_scc1 L_cs_2022
    v_mfma_f32_16x16x32_bf16 v[20:23], v[16:19], v[168:171], v[20:23]
    v_mfma_f32_16x16x32_bf16 v[20:23], v[16:19], v[212:215], v[20:23]
    s_branch L_cs_2019
L_cs_2022:
    v_mfma_f32_16x16x32_bf16 v[20:23], v[16:19], v[172:175], v[20:23]
    v_mfma_f32_16x16x32_bf16 v[20:23], v[16:19], v[216:219], v[20:23]
L_cs_2019:
    s_waitcnt vmcnt(8)
    s_call_b64 s[100:101], L_sub_c0_2
    v_add_u32 v8, s80, v6
    v_xor_b32 v9, 64, v8
    s_add_u32 s80, s80, 32768
    s_cmp_ge_u32 s80, 98304
    s_cselect_b32 s80, 0, s80
    ds_read_b64_tr_b16 v[160:161], v10 offset:32768
    s_add_u32 m0, s81, 0
    ds_read_b64_tr_b16 v[162:163], v10 offset:33280
    buffer_load_dwordx4 v2, s[20:23], s45 offen  lds
    ds_read_b64_tr_b16 v[204:205], v10 offset:36864
    ds_read_b64_tr_b16 v[206:207], v10 offset:37376
    ds_read_b128 v[144:147], v8 offset:0
    s_add_u32 m0, s81, 4096
    ds_read_b128 v[148:151], v8 offset:2048
    buffer_load_dwordx4 v3, s[20:23], s45 offen  lds
    ds_read_b128 v[152:155], v8 offset:4096
    ds_read_b128 v[156:159], v8 offset:6144
    ds_read_b128 v[188:191], v9 offset:0
    s_add_u32 m0, s81, 8192
    ds_read_b128 v[192:195], v9 offset:2048
    buffer_load_dwordx4 v4, s[20:23], s45 offen  lds
    ds_read_b128 v[196:199], v9 offset:4096
    ds_read_b128 v[200:203], v9 offset:6144
    ds_read_b64_tr_b16 v[164:165], v11 offset:32768
    s_add_u32 m0, s81, 12288
    ds_read_b64_tr_b16 v[166:167], v11 offset:33280
    buffer_load_dwordx4 v5, s[20:23], s45 offen  lds
    ds_read_b64_tr_b16 v[208:209], v11 offset:36864
    ds_read_b64_tr_b16 v[210:211], v11 offset:37376
    ds_read_b64_tr_b16 v[168:169], v10 offset:40960
    s_add_u32 m0, s81, 16384
    ds_read_b64_tr_b16 v[170:171], v10 offset:41472
    buffer_load_dwordx4 v2, s[20:23], s82 offen  lds
    ds_read_b64_tr_b16 v[212:213], v10 offset:45056
    ds_read_b64_tr_b16 v[214:215], v10 offset:45568
    ds_read_b64_tr_b16 v[172:173], v11 offset:40960
    s_add_u32 m0, s81, 20480
    ds_read_b64_tr_b16 v[174:175], v11 offset:41472
    buffer_load_dwordx4 v3, s[20:23], s82 offen  lds
    ds_read_b64_tr_b16 v[216:217], v11 offset:45056
    ds_read_b64_tr_b16 v[218:219], v11 offset:45568
    ds_read_b64_tr_b16 v[176:177], v10 offset:49152
    s_add_u32 m0, s81, 24576
    ds_read_b64_tr_b16 v[178:179], v10 offset:49664
    buffer_load_dwordx4 v4, s[20:23], s82 offen  lds
    ds_read_b64_tr_b16 v[220:221], v10 offset:53248
    ds_read_b64_tr_b16 v[222:223], v10 offset:53760
    ds_read_b64_tr_b16 v[180:181], v11 offset:49152
    s_add_u32 m0, s81, 28672
    ds_read_b64_tr_b16 v[182:183], v11 offset:49664
    buffer_load_dwordx4 v5, s[20:23], s82 offen  lds
    ds_read_b64_tr_b16 v[224:225], v11 offset:53248
    ds_read_b64_tr_b16 v[226:227], v11 offset:53760
    s_add_u32 s45, s45, 128
    s_and_b32 s45, s45, 0x7ff
    s_add_u32 s82, s45, 0x40000
    s_add_u32 s81, s81, 32768
    s_cmp_ge_u32 s81, 98304
    s_cselect_b32 s81, s48, s81
    s_bfe_u32 s50, s2, 131075
    s_lshl_b32 s50, s50, 2
    s_add_u32 s50, s50, s43
    s_cmp_lg_u32 s50, 8
    s_cbranch_scc1 L_sig_2023
    s_mov_b64 exec, 1
    v_mov_b32 v15, 1
    buffer_store_byte v15, off, s[32:35], s2 sc1
    s_mov_b64 exec, -1
L_sig_2023:
    s_waitcnt lgkmcnt(0)
    s_cmp_lg_u32 s86, 0
    s_cbranch_scc1 L_cs_2024
    s_cmp_lg_u32 s43, 0
    s_cbranch_scc1 L_cs_2025
    v_mfma_f32_16x16x32_bf16 v[20:23], v[16:19], v[160:163], v[20:23]
    v_mfma_f32_16x16x32_bf16 v[20:23], v[16:19], v[204:207], v[20:23]
    v_mfma_f32_16x16x32_bf16 v[24:27], v[16:19], v[176:179], v[24:27]
    v_mfma_f32_16x16x32_bf16 v[24:27], v[16:19], v[220:223], v[24:27]
    s_branch L_cs_2024
L_cs_2025:
    s_cmp_lg_u32 s43, 1
    s_cbranch_scc1 L_cs_2026
    v_mfma_f32_16x16x32_bf16 v[20:23], v[16:19], v[164:167], v[20:23]
    v_mfma_f32_16x16x32_bf16 v[20:23], v[16:19], v[208:211], v[20:23]
    v_mfma_f32_16x16x32_bf16 v[24:27], v[16:19], v[180:183], v[24:27]
    v_mfma_f32_16x16x32_bf16 v[24:27], v[16:19], v[224:227], v[24:27]
    s_branch L_cs_2024
L_cs_2026:
    s_cmp_lg_u32 s43, 2
    s_cbranch_scc1 L_cs_2027
    v_mfma_f32_16x16x32_bf16 v[20:23], v[16:19], v[168:171], v[20:23]
    v_mfma_f32_16x16x32_bf16 v[20:23], v[16:19], v[212:215], v[20:23]
    s_branch L_cs_2024
L_cs_2027:
    v_mfma_f32_16x16x32_bf16 v[20:23], v[16:19], v[172:175], v[20:23]
    v_mfma_f32_16x16x32_bf16 v[20:23], v[16:19], v[216:219], v[20:23]
L_cs_2024:
    s_sub_u32 s86, s86, 1
    s_waitcnt vmcnt(8)
    s_call_b64 s[100:101], L_sub_c0_2
    v_add_u32 v8, s80, v6
    v_xor_b32 v9, 64, v8
    s_add_u32 s80, s80, 32768
    s_cmp_ge_u32 s80, 98304
    s_cselect_b32 s80, 0, s80
    ds_read_b64_tr_b16 v[160:161], v10 offset:0
    s_add_u32 m0, s81, 0
    ds_read_b64_tr_b16 v[162:163], v10 offset:512
    buffer_load_dwordx4 v2, s[20:23], s45 offen  lds
    ds_read_b64_tr_b16 v[204:205], v10 offset:4096
    ds_read_b64_tr_b16 v[206:207], v10 offset:4608
    ds_read_b128 v[144:147], v8 offset:0
    s_add_u32 m0, s81, 4096
    ds_read_b128 v[148:151], v8 offset:2048
    buffer_load_dwordx4 v3, s[20:23], s45 offen  lds
    ds_read_b128 v[152:155], v8 offset:4096
    ds_read_b128 v[156:159], v8 offset:6144
    ds_read_b128 v[188:191], v9 offset:0
    s_add_u32 m0, s81, 8192
    ds_read_b128 v[192:195], v9 offset:2048
    buffer_load_dwordx4 v4, s[20:23], s45 offen  lds
    ds_read_b128 v[196:199], v9 offset:4096
    ds_read_b128 v[200:203], v9 offset:6144
    ds_read_b64_tr_b16 v[164:165], v11 offset:0
    s_add_u32 m0, s81, 12288
    ds_read_b64_tr_b16 v[166:167], v11 offset:512
    buffer_load_dwordx4 v5, s[20:23], s45 offen  lds
    ds_read_b64_tr_b16 v[208:209], v11 offset:4096
    ds_read_b64_tr_b16 v[210:211], v11 offset:4608
    ds_read_b64_tr_b16 v[168:169], v10 offset:8192
    s_add_u32 m0, s81, 16384
    ds_read_b64_tr_b16 v[170:171], v10 offset:8704
    buffer_load_dwordx4 v2, s[20:23], s82 offen  lds
    ds_read_b64_tr_b16 v[212:213], v10 offset:12288
    ds_read_b64_tr_b16 v[214:215], v10 offset:12800
    ds_read_b64_tr_b16 v[172:173], v11 offset:8192
    s_add_u32 m0, s81, 20480
    ds_read_b64_tr_b16 v[174:175], v11 offset:8704
    buffer_load_dwordx4 v3, s[20:23], s82 offen  lds
    ds_read_b64_tr_b16 v[216:217], v11 offset:12288
    ds_read_b64_tr_b16 v[218:219], v11 offset:12800
    ds_read_b64_tr_b16 v[176:177], v10 offset:16384
    s_add_u32 m0, s81, 24576
    ds_read_b64_tr_b16 v[178:179], v10 offset:16896
    buffer_load_dwordx4 v4, s[20:23], s82 offen  lds
    ds_read_b64_tr_b16 v[220:221], v10 offset:20480
    ds_read_b64_tr_b16 v[222:223], v10 offset:20992
    ds_read_b64_tr_b16 v[180:181], v11 offset:16384
    s_add_u32 m0, s81, 28672
    ds_read_b64_tr_b16 v[182:183], v11 offset:16896
    buffer_load_dwordx4 v5, s[20:23], s82 offen  lds
    ds_read_b64_tr_b16 v[224:225], v11 offset:20480
    ds_read_b64_tr_b16 v[226:227], v11 offset:20992
    s_add_u32 s45, s45, 128
    s_and_b32 s45, s45, 0x7ff
    s_add_u32 s82, s45, 0x40000
    s_add_u32 s81, s81, 32768
    s_cmp_ge_u32 s81, 98304
    s_cselect_b32 s81, s48, s81
    s_bfe_u32 s50, s2, 131075
    s_lshl_b32 s50, s50, 2
    s_add_u32 s50, s50, s43
    s_cmp_lg_u32 s50, 12
    s_cbranch_scc1 L_sig_2028
    s_mov_b64 exec, 1
    v_mov_b32 v15, 1
    buffer_store_byte v15, off, s[32:35], s2 sc1
    s_mov_b64 exec, -1
L_sig_2028:
    s_waitcnt lgkmcnt(0)
    s_load_dword s90, s[88:89], 0
    s_load_dword s90, s[88:89], 64
    s_load_dword s90, s[88:89], 128
    s_load_dword s90, s[88:89], 192
    s_load_dword s90, s[88:89], 256
    s_load_dword s90, s[88:89], 320
    s_load_dword s90, s[88:89], 384
    s_load_dword s90, s[88:89], 448
    s_cmp_lg_u32 s86, 0
    s_cbranch_scc1 L_cs_2029
    s_cmp_lg_u32 s43, 0
    s_cbranch_scc1 L_cs_2030
    v_mfma_f32_16x16x32_bf16 v[20:23], v[16:19], v[160:163], v[20:23]
    v_mfma_f32_16x16x32_bf16 v[20:23], v[16:19], v[204:207], v[20:23]
    v_mfma_f32_16x16x32_bf16 v[24:27], v[16:19], v[176:179], v[24:27]
    v_mfma_f32_16x16x32_bf16 v[24:27], v[16:19], v[220:223], v[24:27]
    s_branch L_cs_2029
L_cs_2030:
    s_cmp_lg_u32 s43, 1
    s_cbranch_scc1 L_cs_2031
    v_mfma_f32_16x16x32_bf16 v[20:23], v[16:19], v[164:167], v[20:23]
    v_mfma_f32_16x16x32_bf16 v[20:23], v[16:19], v[208:211], v[20:23]
    v_mfma_f32_16x16x32_bf16 v[24:27], v[16:19], v[180:183], v[24:27]
    v_mfma_f32_16x16x32_bf16 v[24:27], v[16:19], v[224:227], v[24:27]
    s_branch L_cs_2029
L_cs_2031:
    s_cmp_lg_u32 s43, 2
    s_cbranch_scc1 L_cs_2032
    v_mfma_f32_16x16x32_bf16 v[20:23], v[16:19], v[168:171], v[20:23]
    v_mfma_f32_16x16x32_bf16 v[20:23], v[16:19], v[212:215], v[20:23]
    s_branch L_cs_2029
L_cs_2032:
    v_mfma_f32_16x16x32_bf16 v[20:23], v[16:19], v[172:175], v[20:23]
    v_mfma_f32_16x16x32_bf16 v[20:23], v[16:19], v[216:219], v[20:23]
L_cs_2029:
    s_waitcnt vmcnt(8)
    s_call_b64 s[100:101], L_sub_c0_2
    v_add_u32 v8, s80, v6
    v_xor_b32 v9, 64, v8
    s_add_u32 s80, s80, 32768
    s_cmp_ge_u32 s80, 98304
    s_cselect_b32 s80, 0, s80
    ds_read_b64_tr_b16 v[160:161], v10 offset:32768
    s_add_u32 m0, s81, 0
    ds_read_b64_tr_b16 v[162:163], v10 offset:33280
    buffer_load_dwordx4 v2, s[20:23], s45 offen  lds
    ds_read_b64_tr_b16 v[204:205], v10 offset:36864
    ds_read_b64_tr_b16 v[206:207], v10 offset:37376
    ds_read_b128 v[144:147], v8 offset:0
    s_add_u32 m0, s81, 4096
    ds_read_b128 v[148:151], v8 offset:2048
    buffer_load_dwordx4 v3, s[20:23], s45 offen  lds
    ds_read_b128 v[152:155], v8 offset:4096
    ds_read_b128 v[156:159], v8 offset:6144
    ds_read_b128 v[188:191], v9 offset:0
    s_add_u32 m0, s81, 8192
    ds_read_b128 v[192:195], v9 offset:2048
    buffer_load_dwordx4 v4, s[20:23], s45 offen  lds
    ds_read_b128 v[196:199], v9 offset:4096
    ds_read_b128 v[200:203], v9 offset:6144
    ds_read_b64_tr_b16 v[164:165], v11 offset:32768
    s_add_u32 m0, s81, 12288
    ds_read_b64_tr_b16 v[166:167], v11 offset:33280
    buffer_load_dwordx4 v5, s[20:23], s45 offen  lds
    ds_read_b64_tr_b16 v[208:209], v11 offset:36864
    ds_read_b64_tr_b16 v[210:211], v11 offset:37376
    ds_read_b64_tr_b16 v[168:169], v10 offset:40960
    s_add_u32 m0, s81, 16384
    ds_read_b64_tr_b16 v[170:171], v10 offset:41472
    buffer_load_dwordx4 v2, s[20:23], s82 offen  lds
    ds_read_b64_tr_b16 v[212:213], v10 offset:45056
    ds_read_b64_tr_b16 v[214:215], v10 offset:45568
    ds_read_b64_tr_b16 v[172:173], v11 offset:40960
    s_add_u32 m0, s81, 20480
    ds_read_b64_tr_b16 v[174:175], v11 offset:41472
    buffer_load_dwordx4 v3, s[20:23], s82 offen  lds
    ds_read_b64_tr_b16 v[216:217], v11 offset:45056
    ds_read_b64_tr_b16 v[218:219], v11 offset:45568
    ds_read_b64_tr_b16 v[176:177], v10 offset:49152
    s_add_u32 m0, s81, 24576
    ds_read_b64_tr_b16 v[178:179], v10 offset:49664
    buffer_load_dwordx4 v4, s[20:23], s82 offen  lds
    ds_read_b64_tr_b16 v[220:221], v10 offset:53248
    ds_read_b64_tr_b16 v[222:223], v10 offset:53760
    ds_read_b64_tr_b16 v[180:181], v11 offset:49152
    s_add_u32 m0, s81, 28672
    ds_read_b64_tr_b16 v[182:183], v11 offset:49664
    buffer_load_dwordx4 v5, s[20:23], s82 offen  lds
    ds_read_b64_tr_b16 v[224:225], v11 offset:53248
    ds_read_b64_tr_b16 v[226:227], v11 offset:53760
    s_add_u32 s45, s45, 128
    s_and_b32 s45, s45, 0x7ff
    s_add_u32 s82, s45, 0x40000
    s_add_u32 s81, s81, 32768
    s_cmp_ge_u32 s81, 98304
    s_cselect_b32 s81, s48, s81
    s_add_u32 s88, s88, 512
    s_addc_u32 s89, s89, 0
    s_waitcnt lgkmcnt(0)
    s_load_dword s90, s[88:89], 0
    s_load_dword s90, s[88:89], 64
    s_load_dword s90, s[88:89], 128
    s_load_dword s90, s[88:89], 192
    s_load_dword s90, s[88:89], 256
    s_load_dword s90, s[88:89], 320
    s_load_dword s90, s[88:89], 384
    s_load_dword s90, s[88:89], 448
    s_cmp_lg_u32 s86, 0
    s_cbranch_scc1 L_cs_2033
    s_cmp_lg_u32 s43, 0
    s_cbranch_scc1 L_cs_2034
    v_mfma_f32_16x16x32_bf16 v[20:23], v[16:19], v[160:163], v[20:23]
    v_mfma_f32_16x16x32_bf16 v[20:23], v[16:19], v[204:207], v[20:23]
    v_mfma_f32_16x16x32_bf16 v[24:27], v[16:19], v[176:179], v[24:27]
    v_mfma_f32_16x16x32_bf16 v[24:27], v[16:19], v[220:223], v[24:27]
    s_branch L_cs_2033
L_cs_2034:
    s_cmp_lg_u32 s43, 1
    s_cbranch_scc1 L_cs_2035
    v_mfma_f32_16x16x32_bf16 v[20:23], v[16:19], v[164:167], v[20:23]
    v_mfma_f32_16x16x32_bf16 v[20:23], v[16:19], v[208:211], v[20:23]
    v_mfma_f32_16x16x32_bf16 v[24:27], v[16:19], v[180:183], v[24:27]
    v_mfma_f32_16x16x32_bf16 v[24:27], v[16:19], v[224:227], v[24:27]
    s_branch L_cs_2033
L_cs_2035:
    s_cmp_lg_u32 s43, 2
    s_cbranch_scc1 L_cs_2036
    v_mfma_f32_16x16x32_bf16 v[20:23], v[16:19], v[168:171], v[20:23]
    v_mfma_f32_16x16x32_bf16 v[20:23], v[16:19], v[212:215], v[20:23]
    s_branch L_cs_2033
L_cs_2036:
    v_mfma_f32_16x16x32_bf16 v[20:23], v[16:19], v[172:175], v[20:23]
    v_mfma_f32_16x16x32_bf16 v[20:23], v[16:19], v[216:219], v[20:23]
L_cs_2033:
    s_sub_u32 s86, s86, 1
    s_waitcnt vmcnt(8)
    s_call_b64 s[100:101], L_sub_c0_2
    s_lshl_b32 s50, s41, 1
    s_add_u32 s50, s50, s44
    s_lshl_b32 s50, s50, 3
    s_add_u32 s50, s50, s40
    s_lshl_b32 s50, s50, 9
    s_lshl_b32 s51, s43, 2
    s_add_u32 s50, s50, s51
    s_add_u32 s50, s50, 18939904
    v_lshlrev_b32 v15, 5, v1
    s_mov_b64 exec, 0xffff
    buffer_store_dword v20, v15, s[28:31], s50 offen sc1
    buffer_store_dword v24, v15, s[28:31], s50 offen offset:16 sc1
    s_mov_b64 exec, -1
    v_add_u32 v8, s80, v6
    v_xor_b32 v9, 64, v8
    s_add_u32 s80, s80, 32768
    s_cmp_ge_u32 s80, 98304
    s_cselect_b32 s80, 0, s80
    ds_read_b64_tr_b16 v[160:161], v10 offset:0
    s_add_u32 m0, s81, 0
    ds_read_b64_tr_b16 v[162:163], v10 offset:512
    buffer_load_dwordx4 v2, s[20:23], s45 offen  lds
    ds_read_b64_tr_b16 v[204:205], v10 offset:4096
    ds_read_b64_tr_b16 v[206:207], v10 offset:4608
    ds_read_b128 v[144:147], v8 offset:0
    s_add_u32 m0, s81, 4096
    ds_read_b128 v[148:151], v8 offset:2048
    buffer_load_dwordx4 v3, s[20:23], s45 offen  lds
    ds_read_b128 v[152:155], v8 offset:4096
    ds_read_b128 v[156:159], v8 offset:6144
    ds_read_b128 v[188:191], v9 offset:0
    s_add_u32 m0, s81, 8192
    ds_read_b128 v[192:195], v9 offset:2048
    buffer_load_dwordx4 v4, s[20:23], s45 offen  lds
    ds_read_b128 v[196:199], v9 offset:4096
    ds_read_b128 v[200:203], v9 offset:6144
    ds_read_b64_tr_b16 v[164:165], v11 offset:0
    s_add_u32 m0, s81, 12288
    ds_read_b64_tr_b16 v[166:167], v11 offset:512
    buffer_load_dwordx4 v5, s[20:23], s45 offen  lds
    ds_read_b64_tr_b16 v[208:209], v11 offset:4096
    ds_read_b64_tr_b16 v[210:211], v11 offset:4608
    ds_read_b64_tr_b16 v[168:169], v10 offset:8192
    s_add_u32 m0, s81, 16384
    ds_read_b64_tr_b16 v[170:171], v10 offset:8704
    buffer_load_dwordx4 v2, s[20:23], s82 offen  lds
    ds_read_b64_tr_b16 v[212:213], v10 offset:12288
    ds_read_b64_tr_b16 v[214:215], v10 offset:12800
    ds_read_b64_tr_b16 v[172:173], v11 offset:8192
    s_add_u32 m0, s81, 20480
    ds_read_b64_tr_b16 v[174:175], v11 offset:8704
    buffer_load_dwordx4 v3, s[20:23], s82 offen  lds
    ds_read_b64_tr_b16 v[216:217], v11 offset:12288
    ds_read_b64_tr_b16 v[218:219], v11 offset:12800
    ds_read_b64_tr_b16 v[176:177], v10 offset:16384
    s_add_u32 m0, s81, 24576
    ds_read_b64_tr_b16 v[178:179], v10 offset:16896
    buffer_load_dwordx4 v4, s[20:23], s82 offen  lds
    ds_read_b64_tr_b16 v[220:221], v10 offset:20480
    ds_read_b64_tr_b16 v[222:223], v10 offset:20992
    ds_read_b64_tr_b16 v[180:181], v11 offset:16384
    s_add_u32 m0, s81, 28672
    ds_read_b64_tr_b16 v[182:183], v11 offset:16896
    buffer_load_dwordx4 v5, s[20:23], s82 offen  lds
    ds_read_b64_tr_b16 v[224:225], v11 offset:20480
    ds_read_b64_tr_b16 v[226:227], v11 offset:20992
    s_add_u32 s45, s45, 128
    s_and_b32 s45, s45, 0x7ff
    s_add_u32 s82, s45, 0x40000
    s_add_u32 s81, s81, 32768
    s_cmp_ge_u32 s81, 98304
    s_cselect_b32 s81, s48, s81
    s_add_u32 s88, s88, 512
    s_addc_u32 s89, s89, 0
    s_waitcnt lgkmcnt(0)
    s_load_dword s90, s[88:89], 0
    s_load_dword s90, s[88:89], 64
    s_load_dword s90, s[88:89], 128
    s_load_dword s90, s[88:89], 192
    s_load_dword s90, s[88:89], 256
    s_load_dword s90, s[88:89], 320
    s_load_dword s90, s[88:89], 384
    s_load_dword s90, s[88:89], 448
    s_waitcnt vmcnt(10)
    s_call_b64 s[100:101], L_sub_c0_2
    s_mov_b32 s49, 2
L_loop_2057:
    v_add_u32 v8, s80, v6
    v_xor_b32 v9, 64, v8
    s_add_u32 s80, s80, 32768
    s_cmp_ge_u32 s80, 98304
    s_cselect_b32 s80, 0, s80
    ds_read_b64_tr_b16 v[160:161], v10 offset:32768
    s_add_u32 m0, s81, 0
    ds_read_b64_tr_b16 v[162:163], v10 offset:33280
    buffer_load_dwordx4 v2, s[20:23], s45 offen  lds
    ds_read_b64_tr_b16 v[204:205], v10 offset:36864
    ds_read_b64_tr_b16 v[206:207], v10 offset:37376
    ds_read_b128 v[144:147], v8 offset:0
    s_add_u32 m0, s81, 4096
    ds_read_b128 v[148:151], v8 offset:2048
    buffer_load_dwordx4 v3, s[20:23], s45 offen  lds
    ds_read_b128 v[152:155], v8 offset:4096
    ds_read_b128 v[156:159], v8 offset:6144
    ds_read_b128 v[188:191], v9 offset:0
    s_add_u32 m0, s81, 8192
    ds_read_b128 v[192:195], v9 offset:2048
    buffer_load_dwordx4 v4, s[20:23], s45 offen  lds
    ds_read_b128 v[196:199], v9 offset:4096
    ds_read_b128 v[200:203], v9 offset:6144
    ds_read_b64_tr_b16 v[164:165], v11 offset:32768
    s_add_u32 m0, s81, 12288
    ds_read_b64_tr_b16 v[166:167], v11 offset:33280
    buffer_load_dwordx4 v5, s[20:23], s45 offen  lds
    ds_read_b64_tr_b16 v[208:209], v11 offset:36864
    ds_read_b64_tr_b16 v[210:211], v11 offset:37376
    ds_read_b64_tr_b16 v[168:169], v10 offset:40960
    s_add_u32 m0, s81, 16384
    ds_read_b64_tr_b16 v[170:171], v10 offset:41472
    buffer_load_dwordx4 v2, s[20:23], s82 offen  lds
    ds_read_b64_tr_b16 v[212:213], v10 offset:45056
    ds_read_b64_tr_b16 v[214:215], v10 offset:45568
    ds_read_b64_tr_b16 v[172:173], v11 offset:40960
    s_add_u32 m0, s81, 20480
    ds_read_b64_tr_b16 v[174:175], v11 offset:41472
    buffer_load_dwordx4 v3, s[20:23], s82 offen  lds
    ds_read_b64_tr_b16 v[216:217], v11 offset:45056
    ds_read_b64_tr_b16 v[218:219], v11 offset:45568
    ds_read_b64_tr_b16 v[176:177], v10 offset:49152
    s_add_u32 m0, s81, 24576
    ds_read_b64_tr_b16 v[178:179], v10 offset:49664
    buffer_load_dwordx4 v4, s[20:23], s82 offen  lds
    ds_read_b64_tr_b16 v[220:221], v10 offset:53248
    ds_read_b64_tr_b16 v[222:223], v10 offset:53760
    ds_read_b64_tr_b16 v[180:181], v11 offset:49152
    s_add_u32 m0, s81, 28672
    ds_read_b64_tr_b16 v[182:183], v11 offset:49664
    buffer_load_dwordx4 v5, s[20:23], s82 offen  lds
    ds_read_b64_tr_b16 v[224:225], v11 offset:53248
    ds_read_b64_tr_b16 v[226:227], v11 offset:53760
    s_add_u32 s45, s45, 128
    s_and_b32 s45, s45, 0x7ff
    s_add_u32 s82, s45, 0x40000
    s_add_u32 s81, s81, 32768
    s_cmp_ge_u32 s81, 98304
    s_cselect_b32 s81, s48, s81
    s_add_u32 s88, s88, 512
    s_addc_u32 s89, s89, 0
    s_waitcnt lgkmcnt(0)
    s_load_dword s90, s[88:89], 0
    s_load_dword s90, s[88:89], 64
    s_load_dword s90, s[88:89], 128
    s_load_dword s90, s[88:89], 192
    s_load_dword s90, s[88:89], 256
    s_load_dword s90, s[88:89], 320
    s_load_dword s90, s[88:89], 384
    s_load_dword s90, s[88:89], 448
    s_waitcnt vmcnt(8)
    s_call_b64 s[100:101], L_sub_c0_2
    v_add_u32 v8, s80, v6
    v_xor_b32 v9, 64, v8
    s_add_u32 s80, s80, 32768
    s_cmp_ge_u32 s80, 98304
    s_cselect_b32 s80, 0, s80
    ds_read_b64_tr_b16 v[160:161], v10 offset:0
    s_add_u32 m0, s81, 0
    ds_read_b64_tr_b16 v[162:163], v10 offset:512
    buffer_load_dwordx4 v2, s[20:23], s45 offen  lds
    ds_read_b64_tr_b16 v[204:205], v10 offset:4096
    ds_read_b64_tr_b16 v[206:207], v10 offset:4608
    ds_read_b128 v[144:147], v8 offset:0
    s_add_u32 m0, s81, 4096
    ds_read_b128 v[148:151], v8 offset:2048
    buffer_load_dwordx4 v3, s[20:23], s45 offen  lds
    ds_read_b128 v[152:155], v8 offset:4096
    ds_read_b128 v[156:159], v8 offset:6144
    ds_read_b128 v[188:191], v9 offset:0
    s_add_u32 m0, s81, 8192
    ds_read_b128 v[192:195], v9 offset:2048
    buffer_load_dwordx4 v4, s[20:23], s45 offen  lds
    ds_read_b128 v[196:199], v9 offset:4096
    ds_read_b128 v[200:203], v9 offset:6144
    ds_read_b64_tr_b16 v[164:165], v11 offset:0
    s_add_u32 m0, s81, 12288
    ds_read_b64_tr_b16 v[166:167], v11 offset:512
    buffer_load_dwordx4 v5, s[20:23], s45 offen  lds
    ds_read_b64_tr_b16 v[208:209], v11 offset:4096
    ds_read_b64_tr_b16 v[210:211], v11 offset:4608
    ds_read_b64_tr_b16 v[168:169], v10 offset:8192
    s_add_u32 m0, s81, 16384
    ds_read_b64_tr_b16 v[170:171], v10 offset:8704
    buffer_load_dwordx4 v2, s[20:23], s82 offen  lds
    ds_read_b64_tr_b16 v[212:213], v10 offset:12288
    ds_read_b64_tr_b16 v[214:215], v10 offset:12800
    ds_read_b64_tr_b16 v[172:173], v11 offset:8192
    s_add_u32 m0, s81, 20480
    ds_read_b64_tr_b16 v[174:175], v11 offset:8704
    buffer_load_dwordx4 v3, s[20:23], s82 offen  lds
    ds_read_b64_tr_b16 v[216:217], v11 offset:12288
    ds_read_b64_tr_b16 v[218:219], v11 offset:12800
    ds_read_b64_tr_b16 v[176:177], v10 offset:16384
    s_add_u32 m0, s81, 24576
    ds_read_b64_tr_b16 v[178:179], v10 offset:16896
    buffer_load_dwordx4 v4, s[20:23], s82 offen  lds
    ds_read_b64_tr_b16 v[220:221], v10 offset:20480
    ds_read_b64_tr_b16 v[222:223], v10 offset:20992
    ds_read_b64_tr_b16 v[180:181], v11 offset:16384
    s_add_u32 m0, s81, 28672
    ds_read_b64_tr_b16 v[182:183], v11 offset:16896
    buffer_load_dwordx4 v5, s[20:23], s82 offen  lds
    ds_read_b64_tr_b16 v[224:225], v11 offset:20480
    ds_read_b64_tr_b16 v[226:227], v11 offset:20992
    s_add_u32 s45, s45, 128
    s_and_b32 s45, s45, 0x7ff
    s_add_u32 s82, s45, 0x40000
    s_add_u32 s81, s81, 32768
    s_cmp_ge_u32 s81, 98304
    s_cselect_b32 s81, s48, s81
    s_add_u32 s88, s88, 512
    s_addc_u32 s89, s89, 0
    s_waitcnt lgkmcnt(0)
    s_load_dword s90, s[88:89], 0
    s_load_dword s90, s[88:89], 64
    s_load_dword s90, s[88:89], 128
    s_load_dword s90, s[88:89], 192
    s_load_dword s90, s[88:89], 256
    s_load_dword s90, s[88:89], 320
    s_load_dword s90, s[88:89], 384
    s_load_dword s90, s[88:89], 448
    s_waitcnt vmcnt(8)
    s_call_b64 s[100:101], L_sub_c0_2
    s_sub_u32 s49, s49, 1
    s_cmp_lg_u32 s49, 0
    s_cbranch_scc1 L_loop_2057
    v_add_u32 v8, s80, v6
    v_xor_b32 v9, 64, v8
    s_add_u32 s80, s80, 32768
    s_cmp_ge_u32 s80, 98304
    s_cselect_b32 s80, 0, s80
    ds_read_b64_tr_b16 v[160:161], v10 offset:32768
    s_add_u32 m0, s81, 0
    ds_read_b64_tr_b16 v[162:163], v10 offset:33280
    buffer_load_dwordx4 v2, s[20:23], s45 offen  lds
    ds_read_b64_tr_b16 v[204:205], v10 offset:36864
    ds_read_b64_tr_b16 v[206:207], v10 offset:37376
    ds_read_b128 v[144:147], v8 offset:0
    s_add_u32 m0, s81, 4096
    ds_read_b128 v[148:151], v8 offset:2048
    buffer_load_dwordx4 v3, s[20:23], s45 offen  lds
    ds_read_b128 v[152:155], v8 offset:4096
    ds_read_b128 v[156:159], v8 offset:6144
    ds_read_b128 v[188:191], v9 offset:0
    s_add_u32 m0, s81, 8192
    ds_read_b128 v[192:195], v9 offset:2048
    buffer_load_dwordx4 v4, s[20:23], s45 offen  lds
    ds_read_b128 v[196:199], v9 offset:4096
    ds_read_b128 v[200:203], v9 offset:6144
    ds_read_b64_tr_b16 v[164:165], v11 offset:32768
    s_add_u32 m0, s81, 12288
    ds_read_b64_tr_b16 v[166:167], v11 offset:33280
    buffer_load_dwordx4 v5, s[20:23], s45 offen  lds
    ds_read_b64_tr_b16 v[208:209], v11 offset:36864
    ds_read_b64_tr_b16 v[210:211], v11 offset:37376
    ds_read_b64_tr_b16 v[168:169], v10 offset:40960
    s_add_u32 m0, s81, 16384
    ds_read_b64_tr_b16 v[170:171], v10 offset:41472
    buffer_load_dwordx4 v2, s[20:23], s82 offen  lds
    ds_read_b64_tr_b16 v[212:213], v10 offset:45056
    ds_read_b64_tr_b16 v[214:215], v10 offset:45568
    ds_read_b64_tr_b16 v[172:173], v11 offset:40960
    s_add_u32 m0, s81, 20480
    ds_read_b64_tr_b16 v[174:175], v11 offset:41472
    buffer_load_dwordx4 v3, s[20:23], s82 offen  lds
    ds_read_b64_tr_b16 v[216:217], v11 offset:45056
    ds_read_b64_tr_b16 v[218:219], v11 offset:45568
    ds_read_b64_tr_b16 v[176:177], v10 offset:49152
    s_add_u32 m0, s81, 24576
    ds_read_b64_tr_b16 v[178:179], v10 offset:49664
    buffer_load_dwordx4 v4, s[20:23], s82 offen  lds
    ds_read_b64_tr_b16 v[220:221], v10 offset:53248
    ds_read_b64_tr_b16 v[222:223], v10 offset:53760
    ds_read_b64_tr_b16 v[180:181], v11 offset:49152
    s_add_u32 m0, s81, 28672
    ds_read_b64_tr_b16 v[182:183], v11 offset:49664
    buffer_load_dwordx4 v5, s[20:23], s82 offen  lds
    ds_read_b64_tr_b16 v[224:225], v11 offset:53248
    ds_read_b64_tr_b16 v[226:227], v11 offset:53760
    s_add_u32 s45, s45, 128
    s_and_b32 s45, s45, 0x7ff
    s_add_u32 s82, s45, 0x40000
    s_add_u32 s81, s81, 32768
    s_cmp_ge_u32 s81, 98304
    s_cselect_b32 s81, s48, s81
    s_mov_b64 s[88:89], s[92:93]
    v_and_b32 v7, 15, v1
    v_lshrrev_b32 v0, 4, v1
    v_lshlrev_b32 v0, 10, v0
    v_lshl_add_u32 v0, v7, 5, v0
    v_lshlrev_b32 v7, 4, v7
    s_lshl_b32 s50, s40, 2
    s_add_u32 s50, s50, s43
    s_lshl_b32 s50, s50, 10
    s_add_u32 s94, s50, 18874368
    s_lshl_b32 s95, s41, 13
    s_add_u32 s95, s95, 18944000
    buffer_load_dwordx4 v[232:235], v7, s[28:31], s94 offen offset:0 sc1
    buffer_load_dwordx4 v[236:239], v7, s[28:31], s94 offen offset:256 sc1
    buffer_load_dwordx4 v[240:243], v7, s[28:31], s94 offen offset:512 sc1
    buffer_load_dwordx4 v[244:247], v7, s[28:31], s94 offen offset:768 sc1
    s_waitcnt lgkmcnt(0)
    s_load_dword s90, s[88:89], 0
    s_load_dword s90, s[88:89], 64
    s_load_dword s90, s[88:89], 128
    s_load_dword s90, s[88:89], 192
    s_load_dword s90, s[88:89], 256
    s_load_dword s90, s[88:89], 320
    s_load_dword s90, s[88:89], 384
    s_load_dword s90, s[88:89], 448
    s_waitcnt vmcnt(12)
    s_call_b64 s[100:101], L_sub_c0_2
    v_add_u32 v8, s80, v6
    v_xor_b32 v9, 64, v8
    s_add_u32 s80, s80, 32768
    s_cmp_ge_u32 s80, 98304
    s_cselect_b32 s80, 0, s80
    ds_read_b64_tr_b16 v[160:161], v10 offset:0
    ds_read_b64_tr_b16 v[162:163], v10 offset:512
    ds_read_b64_tr_b16 v[204:205], v10 offset:4096
    ds_read_b64_tr_b16 v[206:207], v10 offset:4608
    ds_read_b128 v[144:147], v8 offset:0
    ds_read_b128 v[148:151], v8 offset:2048
    ds_read_b128 v[152:155], v8 offset:4096
    ds_read_b128 v[156:159], v8 offset:6144
    ds_read_b128 v[188:191], v9 offset:0
    ds_read_b128 v[192:195], v9 offset:2048
    ds_read_b128 v[196:199], v9 offset:4096
    ds_read_b128 v[200:203], v9 offset:6144
    ds_read_b64_tr_b16 v[164:165], v11 offset:0
    ds_read_b64_tr_b16 v[166:167], v11 offset:512
    ds_read_b64_tr_b16 v[208:209], v11 offset:4096
    ds_read_b64_tr_b16 v[210:211], v11 offset:4608
    ds_read_b64_tr_b16 v[168:169], v10 offset:8192
    ds_read_b64_tr_b16 v[170:171], v10 offset:8704
    ds_read_b64_tr_b16 v[212:213], v10 offset:12288
    ds_read_b64_tr_b16 v[214:215], v10 offset:12800
    ds_read_b64_tr_b16 v[172:173], v11 offset:8192
    ds_read_b64_tr_b16 v[174:175], v11 offset:8704
    ds_read_b64_tr_b16 v[216:217], v11 offset:12288
    ds_read_b64_tr_b16 v[218:219], v11 offset:12800
    ds_read_b64_tr_b16 v[176:177], v10 offset:16384
    ds_read_b64_tr_b16 v[178:179], v10 offset:16896
    ds_read_b64_tr_b16 v[220:221], v10 offset:20480
    ds_read_b64_tr_b16 v[222:223], v10 offset:20992
    ds_read_b64_tr_b16 v[180:181], v11 offset:16384
    ds_read_b64_tr_b16 v[182:183], v11 offset:16896
    ds_read_b64_tr_b16 v[224:225], v11 offset:20480
    ds_read_b64_tr_b16 v[226:227], v11 offset:20992
    s_add_u32 s88, s88, 512
    s_addc_u32 s89, s89, 0
    buffer_load_dwordx4 v[20:23], v0, s[28:31], s95 offen offset:0 sc1
    buffer_load_dwordx4 v[24:27], v0, s[28:31], s95 offen offset:16 sc1
    buffer_load_dwordx4 v[248:251], v0, s[28:31], s95 offen offset:512 sc1
    buffer_load_dwordx4 v[252:255], v0, s[28:31], s95 offen offset:528 sc1
    s_waitcnt lgkmcnt(0)
    s_load_dword s90, s[88:89], 0
    s_load_dword s90, s[88:89], 64
    s_load_dword s90, s[88:89], 128
    s_load_dword s90, s[88:89], 192
    s_load_dword s90, s[88:89], 256
    s_load_dword s90, s[88:89], 320
    s_load_dword s90, s[88:89], 384
    s_load_dword s90, s[88:89], 448
    s_waitcnt vmcnt(8)
    s_call_b64 s[100:101], L_sub_c0_2
    v_add_u32 v8, s80, v6
    v_xor_b32 v9, 64, v8
    s_add_u32 s80, s80, 32768
    s_cmp_ge_u32 s80, 98304
    s_cselect_b32 s80, 0, s80
    ds_read_b64_tr_b16 v[160:161], v10 offset:32768
    ds_read_b64_tr_b16 v[162:163], v10 offset:33280
    ds_read_b64_tr_b16 v[204:205], v10 offset:36864
    ds_read_b64_tr_b16 v[206:207], v10 offset:37376
    ds_read_b128 v[144:147], v8 offset:0
    ds_read_b128 v[148:151], v8 offset:2048
    ds_read_b128 v[152:155], v8 offset:4096
    ds_read_b128 v[156:159], v8 offset:6144
    ds_read_b128 v[188:191], v9 offset:0
    ds_read_b128 v[192:195], v9 offset:2048
    ds_read_b128 v[196:199], v9 offset:4096
    ds_read_b128 v[200:203], v9 offset:6144
    ds_read_b64_tr_b16 v[164:165], v11 offset:32768
    ds_read_b64_tr_b16 v[166:167], v11 offset:33280
    ds_read_b64_tr_b16 v[208:209], v11 offset:36864
    ds_read_b64_tr_b16 v[210:211], v11 offset:37376
    ds_read_b64_tr_b16 v[168:169], v10 offset:40960
    ds_read_b64_tr_b16 v[170:171], v10 offset:41472
    ds_read_b64_tr_b16 v[212:213], v10 offset:45056
    ds_read_b64_tr_b16 v[214:215], v10 offset:45568
    ds_read_b64_tr_b16 v[172:173], v11 offset:40960
    ds_read_b64_tr_b16 v[174:175], v11 offset:41472
    ds_read_b64_tr_b16 v[216:217], v11 offset:45056
    ds_read_b64_tr_b16 v[218:219], v11 offset:45568
    ds_read_b64_tr_b16 v[176:177], v10 offset:49152
    ds_read_b64_tr_b16 v[178:179], v10 offset:49664
    ds_read_b64_tr_b16 v[220:221], v10 offset:53248
    ds_read_b64_tr_b16 v[222:223], v10 offset:53760
    ds_read_b64_tr_b16 v[180:181], v11 offset:49152
    ds_read_b64_tr_b16 v[182:183], v11 offset:49664
    ds_read_b64_tr_b16 v[224:225], v11 offset:53248
    ds_read_b64_tr_b16 v[226:227], v11 offset:53760
    s_waitcnt lgkmcnt(0)
    s_call_b64 s[100:101], L_sub_c0_3
    s_mov_b32 s57, 0x3fb8aa3b
    s_mov_b32 s63, 0x20000
L_poll_2037:
    s_waitcnt vmcnt(1)
    v_pk_add_f32 v[144:145], v[20:21], v[248:249]
    v_pk_add_f32 v[146:147], v[22:23], v[250:251]
    s_waitcnt vmcnt(0)
    v_pk_add_f32 v[148:149], v[24:25], v[252:253]
    v_pk_add_f32 v[150:151], v[26:27], v[254:255]
    v_pk_add_f32 v[152:153], v[144:145], v[146:147]
    v_add_f32 v154, v235, v239
    v_add_f32 v155, v243, v247
    v_pk_add_f32 v[152:153], v[152:153], v[148:149]
    v_pk_add_f32 v[152:153], v[152:153], v[154:155]
    v_cmp_u_f32 vcc, v152, v153
    s_nop 0
    s_cmp_eq_u64 vcc, 0
    s_cbranch_scc1 L_go_2038
    s_sleep 4
    buffer_load_dwordx4 v[20:23], v0, s[28:31], s95 offen offset:0 sc1
    buffer_load_dwordx4 v[24:27], v0, s[28:31], s95 offen offset:16 sc1
    buffer_load_dwordx4 v[248:251], v0, s[28:31], s95 offen offset:512 sc1
    buffer_load_dwordx4 v[252:255], v0, s[28:31], s95 offen offset:528 sc1
    buffer_load_dwordx4 v[232:235], v7, s[28:31], s94 offen offset:0 sc1
    buffer_load_dwordx4 v[236:239], v7, s[28:31], s94 offen offset:256 sc1
    buffer_load_dwordx4 v[240:243], v7, s[28:31], s94 offen offset:512 sc1
    buffer_load_dwordx4 v[244:247], v7, s[28:31], s94 offen offset:768 sc1
    s_waitcnt vmcnt(0)
    s_sub_u32 s63, s63, 1
    s_cmp_lg_u32 s63, 0
    s_cbranch_scc1 L_poll_2037
L_go_2038:
    v_and_b32 v7, 15, v1
    v_lshlrev_b32 v7, 2, v7
    s_lshl_b32 s50, s42, 8
    s_add_u32 s50, s50, 110592
    v_add_u32 v7, s50, v7
    v_and_b32 v0, 48, v1
    v_add_u32 v0, s50, v0
    ds_write_b32 v7, v235 offset:0
    ds_write_b32 v7, v239 offset:64
    ds_write_b32 v7, v243 offset:128
    ds_write_b32 v7, v247 offset:192
    ds_read_b128 v[128:131], v0 offset:0
    ds_read_b128 v[132:135], v0 offset:64
    ds_read_b128 v[136:139], v0 offset:128
    ds_read_b128 v[140:143], v0 offset:192
    v_mul_f32 v216, s57, v235
    v_mov_b32 v235, 0
    v_mul_f32 v218, s57, v239
    v_mov_b32 v239, 0
    v_mul_f32 v220, s57, v243
    v_mov_b32 v243, 0
    v_mul_f32 v222, s57, v247
    v_mov_b32 v247, 0
    v_cvt_pk_bf16_f32 v160, v144, v144
    v_and_b32 v156, 0xffff0000, v160
    v_sub_f32 v144, v144, v156
    v_cvt_pk_bf16_f32 v161, v144, 0
    v_mov_b32 v162, 0
    v_mov_b32 v163, 0
    v_cvt_pk_bf16_f32 v164, v145, v145
    v_and_b32 v157, 0xffff0000, v164
    v_sub_f32 v145, v145, v157
    v_cvt_pk_bf16_f32 v165, v145, 0
    v_mov_b32 v166, 0
    v_mov_b32 v167, 0
    v_cvt_pk_bf16_f32 v168, v146, v146
    v_and_b32 v156, 0xffff0000, v168
    v_sub_f32 v146, v146, v156
    v_cvt_pk_bf16_f32 v169, v146, 0
    v_mov_b32 v170, 0
    v_mov_b32 v171, 0
    v_cvt_pk_bf16_f32 v172, v147, v147
    v_and_b32 v157, 0xffff0000, v172
    v_sub_f32 v147, v147, v157
    v_cvt_pk_bf16_f32 v173, v147, 0
    v_mov_b32 v174, 0
    v_mov_b32 v175, 0
    v_cvt_pk_bf16_f32 v176, v148, v148
    v_and_b32 v156, 0xffff0000, v176
    v_sub_f32 v148, v148, v156
    v_cvt_pk_bf16_f32 v177, v148, 0
    v_mov_b32 v178, 0
    v_mov_b32 v179, 0
    v_cvt_pk_bf16_f32 v180, v149, v149
    v_and_b32 v157, 0xffff0000, v180
    v_sub_f32 v149, v149, v157
    v_cvt_pk_bf16_f32 v181, v149, 0
    v_mov_b32 v182, 0
    v_mov_b32 v183, 0
    v_mfma_f32_16x16x32_bf16 v[32:35], v[160:163], v[232:235], v[32:35]
    v_mfma_f32_16x16x32_bf16 v[36:39], v[160:163], v[236:239], v[36:39]
    v_mfma_f32_16x16x32_bf16 v[40:43], v[160:163], v[240:243], v[40:43]
    v_mfma_f32_16x16x32_bf16 v[44:47], v[160:163], v[244:247], v[44:47]
    v_mfma_f32_16x16x32_bf16 v[48:51], v[164:167], v[232:235], v[48:51]
    v_mfma_f32_16x16x32_bf16 v[52:55], v[164:167], v[236:239], v[52:55]
    v_mfma_f32_16x16x32_bf16 v[56:59], v[164:167], v[240:243], v[56:59]
    v_mfma_f32_16x16x32_bf16 v[60:63], v[164:167], v[244:247], v[60:63]
    v_mfma_f32_16x16x32_bf16 v[64:67], v[168:171], v[232:235], v[64:67]
    v_mfma_f32_16x16x32_bf16 v[68:71], v[168:171], v[236:239], v[68:71]
    v_mfma_f32_16x16x32_bf16 v[72:75], v[168:171], v[240:243], v[72:75]
    v_mfma_f32_16x16x32_bf16 v[76:79], v[168:171], v[244:247], v[76:79]
    v_mfma_f32_16x16x32_bf16 v[80:83], v[172:175], v[232:235], v[80:83]
    v_mfma_f32_16x16x32_bf16 v[84:87], v[172:175], v[236:239], v[84:87]
    v_mfma_f32_16x16x32_bf16 v[88:91], v[172:175], v[240:243], v[88:91]
    v_mfma_f32_16x16x32_bf16 v[92:95], v[172:175], v[244:247], v[92:95]
    v_mfma_f32_16x16x32_bf16 v[96:99], v[232:235], v[176:179], v[96:99]
    v_mfma_f32_16x16x32_bf16 v[100:103], v[236:239], v[176:179], v[100:103]
    v_mfma_f32_16x16x32_bf16 v[104:107], v[240:243], v[176:179], v[104:107]
    v_mfma_f32_16x16x32_bf16 v[108:111], v[244:247], v[176:179], v[108:111]
    v_mfma_f32_16x16x32_bf16 v[112:115], v[232:235], v[180:183], v[112:115]
    v_mfma_f32_16x16x32_bf16 v[116:119], v[236:239], v[180:183], v[116:119]
    v_mfma_f32_16x16x32_bf16 v[120:123], v[240:243], v[180:183], v[120:123]
    v_mfma_f32_16x16x32_bf16 v[124:127], v[244:247], v[180:183], v[124:127]
    v_lshrrev_b32 v15, 2, v1
    v_lshlrev_b32 v15, 6, v15
    v_and_b32 v28, 3, v1
    v_lshl_add_u32 v15, v28, 3, v15
    s_lshl_b32 s50, s44, 11
    s_add_u32 s50, s50, 122880
    v_add_u32 v15, s50, v15
    ds_read_b64_tr_b16 v[224:225], v15 offset:0
    ds_read_b64_tr_b16 v[226:227], v15 offset:1024
    ds_read_b64_tr_b16 v[228:229], v15 offset:32
    ds_read_b64_tr_b16 v[230:231], v15 offset:1056
    s_mul_i32 s50, s44, 49152
    s_lshl_b32 s51, s43, 12
    s_add_u32 s51, s51, s50
    v_lshlrev_b32 v15, 4, v1
    v_add_u32 v28, s51, v15
    s_waitcnt lgkmcnt(7)
    v_pk_mul_f32 v[96:97], v[96:97], v[128:129]
    v_pk_mul_f32 v[98:99], v[98:99], v[130:131]
    s_waitcnt lgkmcnt(6)
    v_pk_mul_f32 v[100:101], v[100:101], v[132:133]
    v_pk_mul_f32 v[102:103], v[102:103], v[134:135]
    s_waitcnt lgkmcnt(5)
    v_pk_mul_f32 v[104:105], v[104:105], v[136:137]
    v_pk_mul_f32 v[106:107], v[106:107], v[138:139]
    s_waitcnt lgkmcnt(4)
    v_pk_mul_f32 v[108:109], v[108:109], v[140:141]
    v_pk_mul_f32 v[110:111], v[110:111], v[142:143]
    v_pk_mul_f32 v[112:113], v[112:113], v[128:129]
    v_pk_mul_f32 v[114:115], v[114:115], v[130:131]
    v_pk_mul_f32 v[116:117], v[116:117], v[132:133]
    v_pk_mul_f32 v[118:119], v[118:119], v[134:135]
    v_pk_mul_f32 v[120:121], v[120:121], v[136:137]
    v_pk_mul_f32 v[122:123], v[122:123], v[138:139]
    v_pk_mul_f32 v[124:125], v[124:125], v[140:141]
    v_pk_mul_f32 v[126:127], v[126:127], v[142:143]
    v_cvt_pk_bf16_f32 v240, v96, v97
    v_cvt_pk_bf16_f32 v241, v98, v99
    v_cvt_pk_bf16_f32 v242, v100, v101
    v_cvt_pk_bf16_f32 v243, v102, v103
    v_cvt_pk_bf16_f32 v244, v104, v105
    v_cvt_pk_bf16_f32 v245, v106, v107
    v_cvt_pk_bf16_f32 v246, v108, v109
    v_cvt_pk_bf16_f32 v247, v110, v111
    ds_write_b128 v28, v[240:243] offset:32768
    ds_write_b128 v28, v[244:247] offset:33792
    v_cvt_pk_bf16_f32 v248, v112, v113
    v_cvt_pk_bf16_f32 v249, v114, v115
    v_cvt_pk_bf16_f32 v250, v116, v117
    v_cvt_pk_bf16_f32 v251, v118, v119
    v_cvt_pk_bf16_f32 v252, v120, v121
    v_cvt_pk_bf16_f32 v253, v122, v123
    v_cvt_pk_bf16_f32 v254, v124, v125
    v_cvt_pk_bf16_f32 v255, v126, v127
    ds_write_b128 v28, v[248:251] offset:34816
    ds_write_b128 v28, v[252:255] offset:35840
    v_bfe_u32 v208, v1, 1, 2
    v_lshlrev_b32 v208, 2, v208
    v_and_b32 v209, 1, v1
    v_or_b32 v208, v208, v209
    v_bfe_u32 v209, v1, 3, 1
    v_lshl_or_b32 v208, v209, 1, v208
    v_lshrrev_b32 v209, 4, v1
    v_xor_b32 v208, v208, v209
    v_and_b32 v209, 15, v1
    v_lshlrev_b32 v209, 7, v209
    s_lshl_b32 s51, s43, 13
    s_add_u32 s51, s51, s50
    v_add_u32 v209, s51, v209
    v_xor_b32 v200, 0, v208
    v_lshl_add_u32 v200, v200, 3, v209
    v_xor_b32 v201, 4, v208
    v_lshl_add_u32 v201, v201, 3, v209
    v_xor_b32 v202, 8, v208
    v_lshl_add_u32 v202, v202, 3, v209
    v_xor_b32 v203, 12, v208
    v_lshl_add_u32 v203, v203, 3, v209
    v_lshrrev_b32 v209, 2, v1
    v_bfe_u32 v208, v209, 1, 2
    v_lshlrev_b32 v208, 2, v208
    v_and_b32 v205, 1, v209
    v_or_b32 v208, v208, v205
    v_bfe_u32 v205, v209, 3, 1
    v_lshl_or_b32 v208, v205, 1, v208
    v_and_b32 v205, 3, v1
    v_xor_b32 v208, v208, v205
    s_lshl_b32 s51, s43, 2
    v_xor_b32 v208, s51, v208
    v_lshlrev_b32 v209, 7, v209
    v_add_u32 v209, s50, v209
    v_lshl_add_u32 v204, v208, 3, v209
    v_add_u32 v205, s50, v15
    v_cvt_pk_bf16_f32 v144, v64, v65
    v_cvt_pk_bf16_f32 v145, v66, v67
    v_cvt_pk_bf16_f32 v146, v80, v81
    v_cvt_pk_bf16_f32 v147, v82, v83
    v_cvt_pk_bf16_f32 v148, v68, v69
    v_cvt_pk_bf16_f32 v149, v70, v71
    v_cvt_pk_bf16_f32 v150, v84, v85
    v_cvt_pk_bf16_f32 v151, v86, v87
    s_waitcnt lgkmcnt(6)
    v_mfma_f32_16x16x32_bf16 v[64:67], v[224:227], v[144:147], 0
    s_waitcnt lgkmcnt(4)
    v_mfma_f32_16x16x32_bf16 v[80:83], v[228:231], v[144:147], 0
    v_cvt_pk_bf16_f32 v152, v72, v73
    v_cvt_pk_bf16_f32 v153, v74, v75
    v_cvt_pk_bf16_f32 v154, v88, v89
    v_cvt_pk_bf16_f32 v155, v90, v91
    v_mfma_f32_16x16x32_bf16 v[68:71], v[224:227], v[148:151], 0
    v_mfma_f32_16x16x32_bf16 v[84:87], v[228:231], v[148:151], 0
    v_cvt_pk_bf16_f32 v156, v76, v77
    v_cvt_pk_bf16_f32 v157, v78, v79
    v_cvt_pk_bf16_f32 v158, v92, v93
    v_cvt_pk_bf16_f32 v159, v94, v95
    v_mfma_f32_16x16x32_bf16 v[72:75], v[224:227], v[152:155], 0
    v_mfma_f32_16x16x32_bf16 v[88:91], v[228:231], v[152:155], 0
    v_mfma_f32_16x16x32_bf16 v[76:79], v[224:227], v[156:159], 0
    v_mfma_f32_16x16x32_bf16 v[92:95], v[228:231], v[156:159], 0
    v_max3_f32 v192, v64, v65, v66
    v_min3_f32 v196, v64, v65, v66
    v_max3_f32 v192, v192, v67, v80
    v_min3_f32 v196, v196, v67, v80
    v_max3_f32 v192, v192, v81, v82
    v_min3_f32 v196, v196, v81, v82
    v_max_f32 v192, v192, v83
    v_min_f32 v196, v196, v83
    v_max3_f32 v193, v68, v69, v70
    v_min3_f32 v197, v68, v69, v70
    v_max3_f32 v193, v193, v71, v84
    v_min3_f32 v197, v197, v71, v84
    v_max3_f32 v193, v193, v85, v86
    v_min3_f32 v197, v197, v85, v86
    v_max_f32 v193, v193, v87
    v_min_f32 v197, v197, v87
    v_max3_f32 v194, v72, v73, v74
    v_min3_f32 v198, v72, v73, v74
    v_max3_f32 v194, v194, v75, v88
    v_min3_f32 v198, v198, v75, v88
    v_max3_f32 v194, v194, v89, v90
    v_min3_f32 v198, v198, v89, v90
    v_max_f32 v194, v194, v91
    v_min_f32 v198, v198, v91
    v_max3_f32 v195, v76, v77, v78
    v_min3_f32 v199, v76, v77, v78
    v_max3_f32 v195, v195, v79, v92
    v_min3_f32 v199, v199, v79, v92
    v_max3_f32 v195, v195, v93, v94
    v_min3_f32 v199, v199, v93, v94
    v_max_f32 v195, v195, v95
    v_min_f32 v199, v199, v95
    v_permlane32_swap_b32 v192, v193
    v_permlane32_swap_b32 v194, v195
    v_permlane32_swap_b32 v196, v197
    v_permlane32_swap_b32 v198, v199
    v_max_f32 v192, v192, v193
    v_max_f32 v194, v194, v195
    v_min_f32 v196, v196, v197
    v_min_f32 v198, v198, v199
    v_permlane16_swap_b32 v192, v194
    s_nop 0
    v_permlane16_swap_b32 v196, v198
    v_max_f32 v192, v192, v194
    v_min_f32 v196, v196, v198
    v_mov_b32 v194, v192
    v_mov_b32 v198, v196
    s_nop 0
    v_permlane16_swap_b32 v192, v194
    v_permlane16_swap_b32 v196, v198
    v_mov_b32 v193, v192
    v_mov_b32 v195, v194
    v_mov_b32 v197, v196
    v_mov_b32 v199, v198
    v_permlane32_swap_b32 v192, v193
    v_permlane32_swap_b32 v194, v195
    v_permlane32_swap_b32 v196, v197
    v_permlane32_swap_b32 v198, v199
    v_mul_f32 v144, v192, v216
    v_mul_f32 v146, v196, v216
    v_mul_f32 v148, v193, v218
    v_mul_f32 v150, v197, v218
    v_mul_f32 v152, v194, v220
    v_mul_f32 v154, v198, v220
    v_mul_f32 v156, v195, v222
    v_mul_f32 v158, v199, v222
    v_pk_fma_f32 v[160:161], v[64:65], v[216:217], v[144:145] op_sel_hi:[1,0,0] neg_lo:[0,0,1] neg_hi:[0,0,1]
    v_pk_fma_f32 v[162:163], v[66:67], v[216:217], v[144:145] op_sel_hi:[1,0,0] neg_lo:[0,0,1] neg_hi:[0,0,1]
    v_pk_fma_f32 v[164:165], v[80:81], v[216:217], v[144:145] op_sel_hi:[1,0,0] neg_lo:[0,0,1] neg_hi:[0,0,1]
    v_pk_fma_f32 v[166:167], v[82:83], v[216:217], v[144:145] op_sel_hi:[1,0,0] neg_lo:[0,0,1] neg_hi:[0,0,1]
    v_pk_fma_f32 v[64:65], v[64:65], v[216:217], v[146:147] op_sel_hi:[1,0,0] neg_lo:[1,0,0] neg_hi:[1,0,0]
    v_pk_fma_f32 v[66:67], v[66:67], v[216:217], v[146:147] op_sel_hi:[1,0,0] neg_lo:[1,0,0] neg_hi:[1,0,0]
    v_pk_fma_f32 v[80:81], v[80:81], v[216:217], v[146:147] op_sel_hi:[1,0,0] neg_lo:[1,0,0] neg_hi:[1,0,0]
    v_pk_fma_f32 v[82:83], v[82:83], v[216:217], v[146:147] op_sel_hi:[1,0,0] neg_lo:[1,0,0] neg_hi:[1,0,0]
    v_exp_f32 v160, v160
    v_exp_f32 v161, v161
    v_exp_f32 v162, v162
    v_exp_f32 v163, v163
    v_exp_f32 v164, v164
    v_exp_f32 v165, v165
    v_exp_f32 v166, v166
    v_exp_f32 v167, v167
    v_exp_f32 v64, v64
    v_exp_f32 v65, v65
    v_exp_f32 v66, v66
    v_exp_f32 v67, v67
    v_exp_f32 v80, v80
    v_exp_f32 v81, v81
    v_exp_f32 v82, v82
    v_exp_f32 v83, v83
    v_pk_add_f32 v[232:233], v[160:161], v[162:163]
    v_pk_add_f32 v[234:235], v[164:165], v[166:167]
    v_pk_add_f32 v[236:237], v[64:65], v[66:67]
    v_pk_add_f32 v[238:239], v[80:81], v[82:83]
    v_pk_add_f32 v[232:233], v[232:233], v[234:235]
    v_pk_add_f32 v[236:237], v[236:237], v[238:239]
    v_add_f32 v192, v232, v233
    v_add_f32 v196, v236, v237
    v_pk_fma_f32 v[168:169], v[68:69], v[218:219], v[148:149] op_sel_hi:[1,0,0] neg_lo:[0,0,1] neg_hi:[0,0,1]
    v_pk_fma_f32 v[170:171], v[70:71], v[218:219], v[148:149] op_sel_hi:[1,0,0] neg_lo:[0,0,1] neg_hi:[0,0,1]
    v_pk_fma_f32 v[172:173], v[84:85], v[218:219], v[148:149] op_sel_hi:[1,0,0] neg_lo:[0,0,1] neg_hi:[0,0,1]
    v_pk_fma_f32 v[174:175], v[86:87], v[218:219], v[148:149] op_sel_hi:[1,0,0] neg_lo:[0,0,1] neg_hi:[0,0,1]
    v_pk_fma_f32 v[68:69], v[68:69], v[218:219], v[150:151] op_sel_hi:[1,0,0] neg_lo:[1,0,0] neg_hi:[1,0,0]
    v_pk_fma_f32 v[70:71], v[70:71], v[218:219], v[150:151] op_sel_hi:[1,0,0] neg_lo:[1,0,0] neg_hi:[1,0,0]
    v_pk_fma_f32 v[84:85], v[84:85], v[218:219], v[150:151] op_sel_hi:[1,0,0] neg_lo:[1,0,0] neg_hi:[1,0,0]
    v_pk_fma_f32 v[86:87], v[86:87], v[218:219], v[150:151] op_sel_hi:[1,0,0] neg_lo:[1,0,0] neg_hi:[1,0,0]
    v_exp_f32 v168, v168
    v_exp_f32 v169, v169
    v_exp_f32 v170, v170
    v_exp_f32 v171, v171
    v_exp_f32 v172, v172
    v_exp_f32 v173, v173
    v_exp_f32 v174, v174
    v_exp_f32 v175, v175
    v_exp_f32 v68, v68
    v_exp_f32 v69, v69
    v_exp_f32 v70, v70
    v_exp_f32 v71, v71
    v_exp_f32 v84, v84
    v_exp_f32 v85, v85
    v_exp_f32 v86, v86
    v_exp_f32 v87, v87
    v_pk_add_f32 v[232:233], v[168:169], v[170:171]
    v_pk_add_f32 v[234:235], v[172:173], v[174:175]
    v_pk_add_f32 v[236:237], v[68:69], v[70:71]
    v_pk_add_f32 v[238:239], v[84:85], v[86:87]
    v_pk_add_f32 v[232:233], v[232:233], v[234:235]
    v_pk_add_f32 v[236:237], v[236:237], v[238:239]
    v_add_f32 v193, v232, v233
    v_add_f32 v197, v236, v237
    v_pk_fma_f32 v[176:177], v[72:73], v[220:221], v[152:153] op_sel_hi:[1,0,0] neg_lo:[0,0,1] neg_hi:[0,0,1]
    v_pk_fma_f32 v[178:179], v[74:75], v[220:221], v[152:153] op_sel_hi:[1,0,0] neg_lo:[0,0,1] neg_hi:[0,0,1]
    v_pk_fma_f32 v[180:181], v[88:89], v[220:221], v[152:153] op_sel_hi:[1,0,0] neg_lo:[0,0,1] neg_hi:[0,0,1]
    v_pk_fma_f32 v[182:183], v[90:91], v[220:221], v[152:153] op_sel_hi:[1,0,0] neg_lo:[0,0,1] neg_hi:[0,0,1]
    v_pk_fma_f32 v[72:73], v[72:73], v[220:221], v[154:155] op_sel_hi:[1,0,0] neg_lo:[1,0,0] neg_hi:[1,0,0]
    v_pk_fma_f32 v[74:75], v[74:75], v[220:221], v[154:155] op_sel_hi:[1,0,0] neg_lo:[1,0,0] neg_hi:[1,0,0]
    v_pk_fma_f32 v[88:89], v[88:89], v[220:221], v[154:155] op_sel_hi:[1,0,0] neg_lo:[1,0,0] neg_hi:[1,0,0]
    v_pk_fma_f32 v[90:91], v[90:91], v[220:221], v[154:155] op_sel_hi:[1,0,0] neg_lo:[1,0,0] neg_hi:[1,0,0]
    v_exp_f32 v176, v176
    v_exp_f32 v177, v177
    v_exp_f32 v178, v178
    v_exp_f32 v179, v179
    v_exp_f32 v180, v180
    v_exp_f32 v181, v181
    v_exp_f32 v182, v182
    v_exp_f32 v183, v183
    v_exp_f32 v72, v72
    v_exp_f32 v73, v73
    v_exp_f32 v74, v74
    v_exp_f32 v75, v75
    v_exp_f32 v88, v88
    v_exp_f32 v89, v89
    v_exp_f32 v90, v90
    v_exp_f32 v91, v91
    v_pk_add_f32 v[232:233], v[176:177], v[178:179]
    v_pk_add_f32 v[234:235], v[180:181], v[182:183]
    v_pk_add_f32 v[236:237], v[72:73], v[74:75]
    v_pk_add_f32 v[238:239], v[88:89], v[90:91]
    v_pk_add_f32 v[232:233], v[232:233], v[234:235]
    v_pk_add_f32 v[236:237], v[236:237], v[238:239]
    v_add_f32 v194, v232, v233
    v_add_f32 v198, v236, v237
    v_pk_fma_f32 v[184:185], v[76:77], v[222:223], v[156:157] op_sel_hi:[1,0,0] neg_lo:[0,0,1] neg_hi:[0,0,1]
    v_pk_fma_f32 v[186:187], v[78:79], v[222:223], v[156:157] op_sel_hi:[1,0,0] neg_lo:[0,0,1] neg_hi:[0,0,1]
    v_pk_fma_f32 v[188:189], v[92:93], v[222:223], v[156:157] op_sel_hi:[1,0,0] neg_lo:[0,0,1] neg_hi:[0,0,1]
    v_pk_fma_f32 v[190:191], v[94:95], v[222:223], v[156:157] op_sel_hi:[1,0,0] neg_lo:[0,0,1] neg_hi:[0,0,1]
    v_pk_fma_f32 v[76:77], v[76:77], v[222:223], v[158:159] op_sel_hi:[1,0,0] neg_lo:[1,0,0] neg_hi:[1,0,0]
    v_pk_fma_f32 v[78:79], v[78:79], v[222:223], v[158:159] op_sel_hi:[1,0,0] neg_lo:[1,0,0] neg_hi:[1,0,0]
    v_pk_fma_f32 v[92:93], v[92:93], v[222:223], v[158:159] op_sel_hi:[1,0,0] neg_lo:[1,0,0] neg_hi:[1,0,0]
    v_pk_fma_f32 v[94:95], v[94:95], v[222:223], v[158:159] op_sel_hi:[1,0,0] neg_lo:[1,0,0] neg_hi:[1,0,0]
    v_exp_f32 v184, v184
    v_exp_f32 v185, v185
    v_exp_f32 v186, v186
    v_exp_f32 v187, v187
    v_exp_f32 v188, v188
    v_exp_f32 v189, v189
    v_exp_f32 v190, v190
    v_exp_f32 v191, v191
    v_exp_f32 v76, v76
    v_exp_f32 v77, v77
    v_exp_f32 v78, v78
    v_exp_f32 v79, v79
    v_exp_f32 v92, v92
    v_exp_f32 v93, v93
    v_exp_f32 v94, v94
    v_exp_f32 v95, v95
    v_pk_add_f32 v[232:233], v[184:185], v[186:187]
    v_pk_add_f32 v[234:235], v[188:189], v[190:191]
    v_pk_add_f32 v[236:237], v[76:77], v[78:79]
    v_pk_add_f32 v[238:239], v[92:93], v[94:95]
    v_pk_add_f32 v[232:233], v[232:233], v[234:235]
    v_pk_add_f32 v[236:237], v[236:237], v[238:239]
    v_add_f32 v195, v232, v233
    v_add_f32 v199, v236, v237
    v_permlane32_swap_b32 v192, v193
    v_permlane32_swap_b32 v194, v195
    v_permlane32_swap_b32 v196, v197
    v_permlane32_swap_b32 v198, v199
    v_add_f32 v192, v192, v193
    v_add_f32 v194, v194, v195
    v_add_f32 v196, v196, v197
    v_add_f32 v198, v198, v199
    v_permlane16_swap_b32 v192, v194
    s_nop 0
    v_permlane16_swap_b32 v196, v198
    v_add_f32 v192, v192, v194
    v_add_f32 v196, v196, v198
    v_mov_b32 v194, v192
    v_mov_b32 v198, v196
    s_nop 0
    v_permlane16_swap_b32 v192, v194
    v_permlane16_swap_b32 v196, v198
    v_mov_b32 v193, v192
    v_mov_b32 v195, v194
    v_mov_b32 v197, v196
    v_mov_b32 v199, v198
    v_permlane32_swap_b32 v192, v193
    v_permlane32_swap_b32 v194, v195
    v_permlane32_swap_b32 v196, v197
    v_permlane32_swap_b32 v198, v199
    v_rcp_f32 v144, v192
    v_rcp_f32 v146, v196
    v_rcp_f32 v148, v193
    v_rcp_f32 v150, v197
    v_rcp_f32 v152, v194
    v_rcp_f32 v154, v198
    v_rcp_f32 v156, v195
    v_rcp_f32 v158, v199
    v_pk_mul_f32 v[160:161], v[160:161], v[144:145] op_sel_hi:[1,0]
    v_pk_mul_f32 v[162:163], v[162:163], v[144:145] op_sel_hi:[1,0]
    v_pk_mul_f32 v[164:165], v[164:165], v[144:145] op_sel_hi:[1,0]
    v_pk_mul_f32 v[166:167], v[166:167], v[144:145] op_sel_hi:[1,0]
    v_pk_mul_f32 v[64:65], v[64:65], v[146:147] op_sel_hi:[1,0]
    v_pk_mul_f32 v[66:67], v[66:67], v[146:147] op_sel_hi:[1,0]
    v_pk_mul_f32 v[80:81], v[80:81], v[146:147] op_sel_hi:[1,0]
    v_pk_mul_f32 v[82:83], v[82:83], v[146:147] op_sel_hi:[1,0]
    v_cvt_pk_bf16_f32 v96, v160, v161
    v_cvt_pk_bf16_f32 v97, v162, v163
    v_cvt_pk_bf16_f32 v98, v164, v165
    v_cvt_pk_bf16_f32 v99, v166, v167
    v_cvt_pk_bf16_f32 v100, v64, v65
    v_cvt_pk_bf16_f32 v101, v66, v67
    v_cvt_pk_bf16_f32 v102, v80, v81
    v_cvt_pk_bf16_f32 v103, v82, v83
    ds_write_b64 v200, v[96:97] offset:0
    ds_write_b64 v201, v[98:99] offset:0
    ds_write_b64 v202, v[100:101] offset:0
    ds_write_b64 v203, v[102:103] offset:0
    v_pk_mul_f32 v[168:169], v[168:169], v[148:149] op_sel_hi:[1,0]
    v_pk_mul_f32 v[170:171], v[170:171], v[148:149] op_sel_hi:[1,0]
    v_pk_mul_f32 v[172:173], v[172:173], v[148:149] op_sel_hi:[1,0]
    v_pk_mul_f32 v[174:175], v[174:175], v[148:149] op_sel_hi:[1,0]
    v_pk_mul_f32 v[68:69], v[68:69], v[150:151] op_sel_hi:[1,0]
    v_pk_mul_f32 v[70:71], v[70:71], v[150:151] op_sel_hi:[1,0]
    v_pk_mul_f32 v[84:85], v[84:85], v[150:151] op_sel_hi:[1,0]
    v_pk_mul_f32 v[86:87], v[86:87], v[150:151] op_sel_hi:[1,0]
    v_cvt_pk_bf16_f32 v104, v168, v169
    v_cvt_pk_bf16_f32 v105, v170, v171
    v_cvt_pk_bf16_f32 v106, v172, v173
    v_cvt_pk_bf16_f32 v107, v174, v175
    v_cvt_pk_bf16_f32 v108, v68, v69
    v_cvt_pk_bf16_f32 v109, v70, v71
    v_cvt_pk_bf16_f32 v110, v84, v85
    v_cvt_pk_bf16_f32 v111, v86, v87
    ds_write_b64 v200, v[104:105] offset:2048
    ds_write_b64 v201, v[106:107] offset:2048
    ds_write_b64 v202, v[108:109] offset:2048
    ds_write_b64 v203, v[110:111] offset:2048
    v_pk_mul_f32 v[176:177], v[176:177], v[152:153] op_sel_hi:[1,0]
    v_pk_mul_f32 v[178:179], v[178:179], v[152:153] op_sel_hi:[1,0]
    v_pk_mul_f32 v[180:181], v[180:181], v[152:153] op_sel_hi:[1,0]
    v_pk_mul_f32 v[182:183], v[182:183], v[152:153] op_sel_hi:[1,0]
    v_pk_mul_f32 v[72:73], v[72:73], v[154:155] op_sel_hi:[1,0]
    v_pk_mul_f32 v[74:75], v[74:75], v[154:155] op_sel_hi:[1,0]
    v_pk_mul_f32 v[88:89], v[88:89], v[154:155] op_sel_hi:[1,0]
    v_pk_mul_f32 v[90:91], v[90:91], v[154:155] op_sel_hi:[1,0]
    v_cvt_pk_bf16_f32 v112, v176, v177
    v_cvt_pk_bf16_f32 v113, v178, v179
    v_cvt_pk_bf16_f32 v114, v180, v181
    v_cvt_pk_bf16_f32 v115, v182, v183
    v_cvt_pk_bf16_f32 v116, v72, v73
    v_cvt_pk_bf16_f32 v117, v74, v75
    v_cvt_pk_bf16_f32 v118, v88, v89
    v_cvt_pk_bf16_f32 v119, v90, v91
    ds_write_b64 v200, v[112:113] offset:4096
    ds_write_b64 v201, v[114:115] offset:4096
    ds_write_b64 v202, v[116:117] offset:4096
    ds_write_b64 v203, v[118:119] offset:4096
    v_pk_mul_f32 v[184:185], v[184:185], v[156:157] op_sel_hi:[1,0]
    v_pk_mul_f32 v[186:187], v[186:187], v[156:157] op_sel_hi:[1,0]
    v_pk_mul_f32 v[188:189], v[188:189], v[156:157] op_sel_hi:[1,0]
    v_pk_mul_f32 v[190:191], v[190:191], v[156:157] op_sel_hi:[1,0]
    v_pk_mul_f32 v[76:77], v[76:77], v[158:159] op_sel_hi:[1,0]
    v_pk_mul_f32 v[78:79], v[78:79], v[158:159] op_sel_hi:[1,0]
    v_pk_mul_f32 v[92:93], v[92:93], v[158:159] op_sel_hi:[1,0]
    v_pk_mul_f32 v[94:95], v[94:95], v[158:159] op_sel_hi:[1,0]
    v_cvt_pk_bf16_f32 v120, v184, v185
    v_cvt_pk_bf16_f32 v121, v186, v187
    v_cvt_pk_bf16_f32 v122, v188, v189
    v_cvt_pk_bf16_f32 v123, v190, v191
    v_cvt_pk_bf16_f32 v124, v76, v77
    v_cvt_pk_bf16_f32 v125, v78, v79
    v_cvt_pk_bf16_f32 v126, v92, v93
    v_cvt_pk_bf16_f32 v127, v94, v95
    ds_write_b64 v200, v[120:121] offset:6144
    ds_write_b64 v201, v[122:123] offset:6144
    ds_write_b64 v202, v[124:125] offset:6144
    ds_write_b64 v203, v[126:127] offset:6144
    s_lshl_b32 s54, s41, 3
    s_add_u32 s54, s54, s42
    s_lshl_b32 s54, s54, 9
    s_add_u32 s54, s54, 21364736
    s_lshl_b32 s51, s42, 11
    s_lshl_b32 s52, s41, 17
    s_add_u32 s51, s51, s52
    s_add_u32 s51, s51, 19267584
    s_lshl_b32 s52, s40, 14
    s_add_u32 s52, s52, s51
    s_lshl_b32 s55, s40, 6
    s_add_u32 s55, s55, s54
    v_and_b32 v29, 48, v1
    s_waitcnt lgkmcnt(0)
    s_barrier
    ds_read_b64_tr_b16 v[160:161], v204 offset:0
    ds_read_b64_tr_b16 v[162:163], v204 offset:2048
    ds_read_b128 v[64:67], v205 offset:32768
    ds_read_b128 v[68:71], v205 offset:34816
    ds_read_b64_tr_b16 v[164:165], v204 offset:4096
    ds_read_b64_tr_b16 v[166:167], v204 offset:6144
    ds_read_b128 v[72:75], v205 offset:33792
    ds_read_b128 v[76:79], v205 offset:35840
    ds_read_b64_tr_b16 v[168:169], v204 offset:8192
    ds_read_b64_tr_b16 v[170:171], v204 offset:10240
    ds_read_b128 v[80:83], v205 offset:36864
    ds_read_b128 v[84:87], v205 offset:38912
    ds_read_b64_tr_b16 v[172:173], v204 offset:12288
    ds_read_b64_tr_b16 v[174:175], v204 offset:14336
    ds_read_b128 v[88:91], v205 offset:37888
    ds_read_b128 v[92:95], v205 offset:39936
    ds_read_b64_tr_b16 v[176:177], v204 offset:16384
    ds_read_b64_tr_b16 v[178:179], v204 offset:18432
    ds_read_b128 v[96:99], v205 offset:40960
    ds_read_b128 v[100:103], v205 offset:43008
    ds_read_b64_tr_b16 v[180:181], v204 offset:20480
    ds_read_b64_tr_b16 v[182:183], v204 offset:22528
    ds_read_b128 v[104:107], v205 offset:41984
    ds_read_b128 v[108:111], v205 offset:44032
    ds_read_b64_tr_b16 v[184:185], v204 offset:24576
    ds_read_b64_tr_b16 v[186:187], v204 offset:26624
    ds_read_b128 v[112:115], v205 offset:45056
    ds_read_b128 v[116:119], v205 offset:47104
    ds_read_b64_tr_b16 v[188:189], v204 offset:28672
    ds_read_b64_tr_b16 v[190:191], v204 offset:30720
    ds_read_b128 v[120:123], v205 offset:46080
    ds_read_b128 v[124:127], v205 offset:48128
    s_waitcnt lgkmcnt(15)
    v_mfma_f32_16x16x32_bf16 v[132:135], v[160:163], v[64:67], 0
    s_waitcnt lgkmcnt(15)
    v_mfma_f32_16x16x32_bf16 v[136:139], v[160:163], v[68:71], 0
    v_mfma_f32_16x16x32_bf16 v[140:143], v[160:163], v[16:19], 0
    s_waitcnt lgkmcnt(15)
    v_mfma_f32_16x16x32_bf16 v[132:135], v[164:167], v[72:75], v[132:135]
    s_waitcnt lgkmcnt(15)
    v_mfma_f32_16x16x32_bf16 v[136:139], v[164:167], v[76:79], v[136:139]
    v_mfma_f32_16x16x32_bf16 v[140:143], v[164:167], v[16:19], v[140:143]
    s_waitcnt lgkmcnt(15)
    v_mfma_f32_16x16x32_bf16 v[132:135], v[168:171], v[80:83], v[132:135]
    s_waitcnt lgkmcnt(15)
    v_mfma_f32_16x16x32_bf16 v[136:139], v[168:171], v[84:87], v[136:139]
    v_mfma_f32_16x16x32_bf16 v[140:143], v[168:171], v[16:19], v[140:143]
    s_waitcnt lgkmcnt(15)
    v_mfma_f32_16x16x32_bf16 v[132:135], v[172:175], v[88:91], v[132:135]
    s_waitcnt lgkmcnt(15)
    v_mfma_f32_16x16x32_bf16 v[136:139], v[172:175], v[92:95], v[136:139]
    v_mfma_f32_16x16x32_bf16 v[140:143], v[172:175], v[16:19], v[140:143]
    s_waitcnt lgkmcnt(13)
    v_mfma_f32_16x16x32_bf16 v[132:135], v[176:179], v[96:99], v[132:135]
    s_waitcnt lgkmcnt(12)
    v_mfma_f32_16x16x32_bf16 v[136:139], v[176:179], v[100:103], v[136:139]
    v_mfma_f32_16x16x32_bf16 v[140:143], v[176:179], v[16:19], v[140:143]
    s_waitcnt lgkmcnt(9)
    v_mfma_f32_16x16x32_bf16 v[132:135], v[180:183], v[104:107], v[132:135]
    s_waitcnt lgkmcnt(8)
    v_mfma_f32_16x16x32_bf16 v[136:139], v[180:183], v[108:111], v[136:139]
    v_mfma_f32_16x16x32_bf16 v[140:143], v[180:183], v[16:19], v[140:143]
    s_waitcnt lgkmcnt(5)
    v_mfma_f32_16x16x32_bf16 v[132:135], v[184:187], v[112:115], v[132:135]
    s_waitcnt lgkmcnt(4)
    v_mfma_f32_16x16x32_bf16 v[136:139], v[184:187], v[116:119], v[136:139]
    v_mfma_f32_16x16x32_bf16 v[140:143], v[184:187], v[16:19], v[140:143]
    s_waitcnt lgkmcnt(1)
    v_mfma_f32_16x16x32_bf16 v[132:135], v[188:191], v[120:123], v[132:135]
    s_waitcnt lgkmcnt(0)
    v_mfma_f32_16x16x32_bf16 v[136:139], v[188:191], v[124:127], v[136:139]
    v_mfma_f32_16x16x32_bf16 v[140:143], v[188:191], v[16:19], v[140:143]
    s_nop 4
    buffer_store_dwordx4 v[132:135], v15, s[28:31], s52 offen offset:0 sc1
    s_nop 0
    buffer_store_dwordx4 v[136:139], v15, s[28:31], s52 offen offset:1024 sc1
    s_mov_b32 exec_lo, 0x00010001
    s_mov_b32 exec_hi, 0x00010001
    buffer_store_dwordx4 v[140:143], v29, s[28:31], s55 offen sc1
    s_mov_b64 exec, -1
    v_and_b32 v28, 7, v1
    v_lshl_add_u32 v29, v28, 6, v29
    v_cvt_pk_bf16_f32 v144, v32, v33
    v_cvt_pk_bf16_f32 v145, v34, v35
    v_cvt_pk_bf16_f32 v146, v48, v49
    v_cvt_pk_bf16_f32 v147, v50, v51
    v_cvt_pk_bf16_f32 v148, v36, v37
    v_cvt_pk_bf16_f32 v149, v38, v39
    v_cvt_pk_bf16_f32 v150, v52, v53
    v_cvt_pk_bf16_f32 v151, v54, v55
    v_mfma_f32_16x16x32_bf16 v[32:35], v[224:227], v[144:147], 0
    v_mfma_f32_16x16x32_bf16 v[48:51], v[228:231], v[144:147], 0
    v_cvt_pk_bf16_f32 v152, v40, v41
    v_cvt_pk_bf16_f32 v153, v42, v43
    v_cvt_pk_bf16_f32 v154, v56, v57
    v_cvt_pk_bf16_f32 v155, v58, v59
    v_mfma_f32_16x16x32_bf16 v[36:39], v[224:227], v[148:151], 0
    v_mfma_f32_16x16x32_bf16 v[52:55], v[228:231], v[148:151], 0
    v_cvt_pk_bf16_f32 v156, v44, v45
    v_cvt_pk_bf16_f32 v157, v46, v47
    v_cvt_pk_bf16_f32 v158, v60, v61
    v_cvt_pk_bf16_f32 v159, v62, v63
    v_mfma_f32_16x16x32_bf16 v[40:43], v[224:227], v[152:155], 0
    v_mfma_f32_16x16x32_bf16 v[56:59], v[228:231], v[152:155], 0
    v_mfma_f32_16x16x32_bf16 v[44:47], v[224:227], v[156:159], 0
    v_mfma_f32_16x16x32_bf16 v[60:63], v[228:231], v[156:159], 0
    v_max3_f32 v192, v32, v33, v34
    v_min3_f32 v196, v32, v33, v34
    v_max3_f32 v192, v192, v35, v48
    v_min3_f32 v196, v196, v35, v48
    v_max3_f32 v192, v192, v49, v50
    v_min3_f32 v196, v196, v49, v50
    v_max_f32 v192, v192, v51
    v_min_f32 v196, v196, v51
    v_max3_f32 v193, v36, v37, v38
    v_min3_f32 v197, v36, v37, v38
    v_max3_f32 v193, v193, v39, v52
    v_min3_f32 v197, v197, v39, v52
    v_max3_f32 v193, v193, v53, v54
    v_min3_f32 v197, v197, v53, v54
    v_max_f32 v193, v193, v55
    v_min_f32 v197, v197, v55
    v_max3_f32 v194, v40, v41, v42
    v_min3_f32 v198, v40, v41, v42
    v_max3_f32 v194, v194, v43, v56
    v_min3_f32 v198, v198, v43, v56
    v_max3_f32 v194, v194, v57, v58
    v_min3_f32 v198, v198, v57, v58
    v_max_f32 v194, v194, v59
    v_min_f32 v198, v198, v59
    v_max3_f32 v195, v44, v45, v46
    v_min3_f32 v199, v44, v45, v46
    v_max3_f32 v195, v195, v47, v60
    v_min3_f32 v199, v199, v47, v60
    v_max3_f32 v195, v195, v61, v62
    v_min3_f32 v199, v199, v61, v62
    v_max_f32 v195, v195, v63
    v_min_f32 v199, v199, v63
    v_permlane32_swap_b32 v192, v193
    v_permlane32_swap_b32 v194, v195
    v_permlane32_swap_b32 v196, v197
    v_permlane32_swap_b32 v198, v199
    v_max_f32 v192, v192, v193
    v_max_f32 v194, v194, v195
    v_min_f32 v196, v196, v197
    v_min_f32 v198, v198, v199
    v_permlane16_swap_b32 v192, v194
    s_nop 0
    v_permlane16_swap_b32 v196, v198
    v_max_f32 v192, v192, v194
    v_min_f32 v196, v196, v198
    v_mov_b32 v194, v192
    v_mov_b32 v198, v196
    s_nop 0
    v_permlane16_swap_b32 v192, v194
    v_permlane16_swap_b32 v196, v198
    v_mov_b32 v193, v192
    v_mov_b32 v195, v194
    v_mov_b32 v197, v196
    v_mov_b32 v199, v198
    v_permlane32_swap_b32 v192, v193
    v_permlane32_swap_b32 v194, v195
    v_permlane32_swap_b32 v196, v197
    v_permlane32_swap_b32 v198, v199
    v_mul_f32 v144, v192, v216
    v_mul_f32 v146, v196, v216
    v_mul_f32 v148, v193, v218
    v_mul_f32 v150, v197, v218
    v_mul_f32 v152, v194, v220
    v_mul_f32 v154, v198, v220
    v_mul_f32 v156, v195, v222
    v_mul_f32 v158, v199, v222
    v_pk_fma_f32 v[160:161], v[32:33], v[216:217], v[144:145] op_sel_hi:[1,0,0] neg_lo:[0,0,1] neg_hi:[0,0,1]
    v_pk_fma_f32 v[162:163], v[34:35], v[216:217], v[144:145] op_sel_hi:[1,0,0] neg_lo:[0,0,1] neg_hi:[0,0,1]
    v_pk_fma_f32 v[164:165], v[48:49], v[216:217], v[144:145] op_sel_hi:[1,0,0] neg_lo:[0,0,1] neg_hi:[0,0,1]
    v_pk_fma_f32 v[166:167], v[50:51], v[216:217], v[144:145] op_sel_hi:[1,0,0] neg_lo:[0,0,1] neg_hi:[0,0,1]
    v_pk_fma_f32 v[32:33], v[32:33], v[216:217], v[146:147] op_sel_hi:[1,0,0] neg_lo:[1,0,0] neg_hi:[1,0,0]
    v_pk_fma_f32 v[34:35], v[34:35], v[216:217], v[146:147] op_sel_hi:[1,0,0] neg_lo:[1,0,0] neg_hi:[1,0,0]
    v_pk_fma_f32 v[48:49], v[48:49], v[216:217], v[146:147] op_sel_hi:[1,0,0] neg_lo:[1,0,0] neg_hi:[1,0,0]
    v_pk_fma_f32 v[50:51], v[50:51], v[216:217], v[146:147] op_sel_hi:[1,0,0] neg_lo:[1,0,0] neg_hi:[1,0,0]
    v_exp_f32 v160, v160
    v_exp_f32 v161, v161
    v_exp_f32 v162, v162
    v_exp_f32 v163, v163
    v_exp_f32 v164, v164
    v_exp_f32 v165, v165
    v_exp_f32 v166, v166
    v_exp_f32 v167, v167
    v_exp_f32 v32, v32
    v_exp_f32 v33, v33
    v_exp_f32 v34, v34
    v_exp_f32 v35, v35
    v_exp_f32 v48, v48
    v_exp_f32 v49, v49
    v_exp_f32 v50, v50
    v_exp_f32 v51, v51
    v_pk_add_f32 v[232:233], v[160:161], v[162:163]
    v_pk_add_f32 v[234:235], v[164:165], v[166:167]
    v_pk_add_f32 v[236:237], v[32:33], v[34:35]
    v_pk_add_f32 v[238:239], v[48:49], v[50:51]
    v_pk_add_f32 v[232:233], v[232:233], v[234:235]
    v_pk_add_f32 v[236:237], v[236:237], v[238:239]
    v_add_f32 v192, v232, v233
    v_add_f32 v196, v236, v237
    v_pk_fma_f32 v[168:169], v[36:37], v[218:219], v[148:149] op_sel_hi:[1,0,0] neg_lo:[0,0,1] neg_hi:[0,0,1]
    v_pk_fma_f32 v[170:171], v[38:39], v[218:219], v[148:149] op_sel_hi:[1,0,0] neg_lo:[0,0,1] neg_hi:[0,0,1]
    v_pk_fma_f32 v[172:173], v[52:53], v[218:219], v[148:149] op_sel_hi:[1,0,0] neg_lo:[0,0,1] neg_hi:[0,0,1]
    v_pk_fma_f32 v[174:175], v[54:55], v[218:219], v[148:149] op_sel_hi:[1,0,0] neg_lo:[0,0,1] neg_hi:[0,0,1]
    v_pk_fma_f32 v[36:37], v[36:37], v[218:219], v[150:151] op_sel_hi:[1,0,0] neg_lo:[1,0,0] neg_hi:[1,0,0]
    v_pk_fma_f32 v[38:39], v[38:39], v[218:219], v[150:151] op_sel_hi:[1,0,0] neg_lo:[1,0,0] neg_hi:[1,0,0]
    v_pk_fma_f32 v[52:53], v[52:53], v[218:219], v[150:151] op_sel_hi:[1,0,0] neg_lo:[1,0,0] neg_hi:[1,0,0]
    v_pk_fma_f32 v[54:55], v[54:55], v[218:219], v[150:151] op_sel_hi:[1,0,0] neg_lo:[1,0,0] neg_hi:[1,0,0]
    v_exp_f32 v168, v168
    v_exp_f32 v169, v169
    v_exp_f32 v170, v170
    v_exp_f32 v171, v171
    v_exp_f32 v172, v172
    v_exp_f32 v173, v173
    v_exp_f32 v174, v174
    v_exp_f32 v175, v175
    v_exp_f32 v36, v36
    v_exp_f32 v37, v37
    v_exp_f32 v38, v38
    v_exp_f32 v39, v39
    v_exp_f32 v52, v52
    v_exp_f32 v53, v53
    v_exp_f32 v54, v54
    v_exp_f32 v55, v55
    v_pk_add_f32 v[232:233], v[168:169], v[170:171]
    v_pk_add_f32 v[234:235], v[172:173], v[174:175]
    v_pk_add_f32 v[236:237], v[36:37], v[38:39]
    v_pk_add_f32 v[238:239], v[52:53], v[54:55]
    v_pk_add_f32 v[232:233], v[232:233], v[234:235]
    v_pk_add_f32 v[236:237], v[236:237], v[238:239]
    v_add_f32 v193, v232, v233
    v_add_f32 v197, v236, v237
    s_add_u32 s52, s51, 0
    buffer_load_dwordx4 v[64:67], v15, s[28:31], s52 offen offset:0 sc1
    buffer_load_dwordx4 v[68:71], v15, s[28:31], s52 offen offset:1024 sc1
    s_add_u32 s52, s51, 16384
    buffer_load_dwordx4 v[72:75], v15, s[28:31], s52 offen offset:0 sc1
    buffer_load_dwordx4 v[76:79], v15, s[28:31], s52 offen offset:1024 sc1
    s_add_u32 s52, s51, 32768
    buffer_load_dwordx4 v[80:83], v15, s[28:31], s52 offen offset:0 sc1
    buffer_load_dwordx4 v[84:87], v15, s[28:31], s52 offen offset:1024 sc1
    s_add_u32 s52, s51, 49152
    buffer_load_dwordx4 v[88:91], v15, s[28:31], s52 offen offset:0 sc1
    buffer_load_dwordx4 v[92:95], v15, s[28:31], s52 offen offset:1024 sc1
    s_add_u32 s52, s51, 65536
    buffer_load_dwordx4 v[96:99], v15, s[28:31], s52 offen offset:0 sc1
    buffer_load_dwordx4 v[100:103], v15, s[28:31], s52 offen offset:1024 sc1
    s_add_u32 s52, s51, 81920
    buffer_load_dwordx4 v[104:107], v15, s[28:31], s52 offen offset:0 sc1
    buffer_load_dwordx4 v[108:111], v15, s[28:31], s52 offen offset:1024 sc1
    s_add_u32 s52, s51, 98304
    buffer_load_dwordx4 v[112:115], v15, s[28:31], s52 offen offset:0 sc1
    buffer_load_dwordx4 v[116:119], v15, s[28:31], s52 offen offset:1024 sc1
    s_add_u32 s52, s51, 114688
    buffer_load_dwordx4 v[120:123], v15, s[28:31], s52 offen offset:0 sc1
    buffer_load_dwordx4 v[124:127], v15, s[28:31], s52 offen offset:1024 sc1
    buffer_load_dwordx4 v[128:131], v29, s[28:31], s54 offen sc1
    v_pk_fma_f32 v[176:177], v[40:41], v[220:221], v[152:153] op_sel_hi:[1,0,0] neg_lo:[0,0,1] neg_hi:[0,0,1]
    v_pk_fma_f32 v[178:179], v[42:43], v[220:221], v[152:153] op_sel_hi:[1,0,0] neg_lo:[0,0,1] neg_hi:[0,0,1]
    v_pk_fma_f32 v[180:181], v[56:57], v[220:221], v[152:153] op_sel_hi:[1,0,0] neg_lo:[0,0,1] neg_hi:[0,0,1]
    v_pk_fma_f32 v[182:183], v[58:59], v[220:221], v[152:153] op_sel_hi:[1,0,0] neg_lo:[0,0,1] neg_hi:[0,0,1]
    v_pk_fma_f32 v[40:41], v[40:41], v[220:221], v[154:155] op_sel_hi:[1,0,0] neg_lo:[1,0,0] neg_hi:[1,0,0]
    v_pk_fma_f32 v[42:43], v[42:43], v[220:221], v[154:155] op_sel_hi:[1,0,0] neg_lo:[1,0,0] neg_hi:[1,0,0]
    v_pk_fma_f32 v[56:57], v[56:57], v[220:221], v[154:155] op_sel_hi:[1,0,0] neg_lo:[1,0,0] neg_hi:[1,0,0]
    v_pk_fma_f32 v[58:59], v[58:59], v[220:221], v[154:155] op_sel_hi:[1,0,0] neg_lo:[1,0,0] neg_hi:[1,0,0]
    v_exp_f32 v176, v176
    v_exp_f32 v177, v177
    v_exp_f32 v178, v178
    v_exp_f32 v179, v179
    v_exp_f32 v180, v180
    v_exp_f32 v181, v181
    v_exp_f32 v182, v182
    v_exp_f32 v183, v183
    v_exp_f32 v40, v40
    v_exp_f32 v41, v41
    v_exp_f32 v42, v42
    v_exp_f32 v43, v43
    v_exp_f32 v56, v56
    v_exp_f32 v57, v57
    v_exp_f32 v58, v58
    v_exp_f32 v59, v59
    v_pk_add_f32 v[232:233], v[176:177], v[178:179]
    v_pk_add_f32 v[234:235], v[180:181], v[182:183]
    v_pk_add_f32 v[236:237], v[40:41], v[42:43]
    v_pk_add_f32 v[238:239], v[56:57], v[58:59]
    v_pk_add_f32 v[232:233], v[232:233], v[234:235]
    v_pk_add_f32 v[236:237], v[236:237], v[238:239]
    v_add_f32 v194, v232, v233
    v_add_f32 v198, v236, v237
    v_pk_fma_f32 v[184:185], v[44:45], v[222:223], v[156:157] op_sel_hi:[1,0,0] neg_lo:[0,0,1] neg_hi:[0,0,1]
    v_pk_fma_f32 v[186:187], v[46:47], v[222:223], v[156:157] op_sel_hi:[1,0,0] neg_lo:[0,0,1] neg_hi:[0,0,1]
    v_pk_fma_f32 v[188:189], v[60:61], v[222:223], v[156:157] op_sel_hi:[1,0,0] neg_lo:[0,0,1] neg_hi:[0,0,1]
    v_pk_fma_f32 v[190:191], v[62:63], v[222:223], v[156:157] op_sel_hi:[1,0,0] neg_lo:[0,0,1] neg_hi:[0,0,1]
    v_pk_fma_f32 v[44:45], v[44:45], v[222:223], v[158:159] op_sel_hi:[1,0,0] neg_lo:[1,0,0] neg_hi:[1,0,0]
    v_pk_fma_f32 v[46:47], v[46:47], v[222:223], v[158:159] op_sel_hi:[1,0,0] neg_lo:[1,0,0] neg_hi:[1,0,0]
    v_pk_fma_f32 v[60:61], v[60:61], v[222:223], v[158:159] op_sel_hi:[1,0,0] neg_lo:[1,0,0] neg_hi:[1,0,0]
    v_pk_fma_f32 v[62:63], v[62:63], v[222:223], v[158:159] op_sel_hi:[1,0,0] neg_lo:[1,0,0] neg_hi:[1,0,0]
    v_exp_f32 v184, v184
    v_exp_f32 v185, v185
    v_exp_f32 v186, v186
    v_exp_f32 v187, v187
    v_exp_f32 v188, v188
    v_exp_f32 v189, v189
    v_exp_f32 v190, v190
    v_exp_f32 v191, v191
    v_exp_f32 v44, v44
    v_exp_f32 v45, v45
    v_exp_f32 v46, v46
    v_exp_f32 v47, v47
    v_exp_f32 v60, v60
    v_exp_f32 v61, v61
    v_exp_f32 v62, v62
    v_exp_f32 v63, v63
    v_pk_add_f32 v[232:233], v[184:185], v[186:187]
    v_pk_add_f32 v[234:235], v[188:189], v[190:191]
    v_pk_add_f32 v[236:237], v[44:45], v[46:47]
    v_pk_add_f32 v[238:239], v[60:61], v[62:63]
    v_pk_add_f32 v[232:233], v[232:233], v[234:235]
    v_pk_add_f32 v[236:237], v[236:237], v[238:239]
    v_add_f32 v195, v232, v233
    v_add_f32 v199, v236, v237
    v_permlane32_swap_b32 v192, v193
    v_permlane32_swap_b32 v194, v195
    v_permlane32_swap_b32 v196, v197
    v_permlane32_swap_b32 v198, v199
    v_add_f32 v192, v192, v193
    v_add_f32 v194, v194, v195
    v_add_f32 v196, v196, v197
    v_add_f32 v198, v198, v199
    v_permlane16_swap_b32 v192, v194
    s_nop 0
    v_permlane16_swap_b32 v196, v198
    v_add_f32 v192, v192, v194
    v_add_f32 v196, v196, v198
    v_mov_b32 v194, v192
    v_mov_b32 v198, v196
    s_nop 0
    v_permlane16_swap_b32 v192, v194
    v_permlane16_swap_b32 v196, v198
    v_mov_b32 v193, v192
    v_mov_b32 v195, v194
    v_mov_b32 v197, v196
    v_mov_b32 v199, v198
    v_permlane32_swap_b32 v192, v193
    v_permlane32_swap_b32 v194, v195
    v_permlane32_swap_b32 v196, v197
    v_permlane32_swap_b32 v198, v199
    v_rcp_f32 v144, v192
    v_rcp_f32 v146, v196
    v_rcp_f32 v148, v193
    v_rcp_f32 v150, v197
    v_rcp_f32 v152, v194
    v_rcp_f32 v154, v198
    v_rcp_f32 v156, v195
    v_rcp_f32 v158, v199
    v_pk_mul_f32 v[160:161], v[160:161], v[144:145] op_sel_hi:[1,0]
    v_pk_mul_f32 v[162:163], v[162:163], v[144:145] op_sel_hi:[1,0]
    v_pk_mul_f32 v[164:165], v[164:165], v[144:145] op_sel_hi:[1,0]
    v_pk_mul_f32 v[166:167], v[166:167], v[144:145] op_sel_hi:[1,0]
    v_pk_mul_f32 v[32:33], v[32:33], v[146:147] op_sel_hi:[1,0]
    v_pk_mul_f32 v[34:35], v[34:35], v[146:147] op_sel_hi:[1,0]
    v_pk_mul_f32 v[48:49], v[48:49], v[146:147] op_sel_hi:[1,0]
    v_pk_mul_f32 v[50:51], v[50:51], v[146:147] op_sel_hi:[1,0]
    v_cvt_pk_bf16_f32 v224, v160, v161
    v_cvt_pk_bf16_f32 v225, v162, v163
    v_cvt_pk_bf16_f32 v226, v164, v165
    v_cvt_pk_bf16_f32 v227, v166, v167
    v_cvt_pk_bf16_f32 v228, v32, v33
    v_cvt_pk_bf16_f32 v229, v34, v35
    v_cvt_pk_bf16_f32 v230, v48, v49
    v_cvt_pk_bf16_f32 v231, v50, v51
    v_pk_mul_f32 v[168:169], v[168:169], v[148:149] op_sel_hi:[1,0]
    v_pk_mul_f32 v[170:171], v[170:171], v[148:149] op_sel_hi:[1,0]
    v_pk_mul_f32 v[172:173], v[172:173], v[148:149] op_sel_hi:[1,0]
    v_pk_mul_f32 v[174:175], v[174:175], v[148:149] op_sel_hi:[1,0]
    v_pk_mul_f32 v[36:37], v[36:37], v[150:151] op_sel_hi:[1,0]
    v_pk_mul_f32 v[38:39], v[38:39], v[150:151] op_sel_hi:[1,0]
    v_pk_mul_f32 v[52:53], v[52:53], v[150:151] op_sel_hi:[1,0]
    v_pk_mul_f32 v[54:55], v[54:55], v[150:151] op_sel_hi:[1,0]
    v_cvt_pk_bf16_f32 v232, v168, v169
    v_cvt_pk_bf16_f32 v233, v170, v171
    v_cvt_pk_bf16_f32 v234, v172, v173
    v_cvt_pk_bf16_f32 v235, v174, v175
    v_cvt_pk_bf16_f32 v236, v36, v37
    v_cvt_pk_bf16_f32 v237, v38, v39
    v_cvt_pk_bf16_f32 v238, v52, v53
    v_cvt_pk_bf16_f32 v239, v54, v55
    v_pk_mul_f32 v[176:177], v[176:177], v[152:153] op_sel_hi:[1,0]
    v_pk_mul_f32 v[178:179], v[178:179], v[152:153] op_sel_hi:[1,0]
    v_pk_mul_f32 v[180:181], v[180:181], v[152:153] op_sel_hi:[1,0]
    v_pk_mul_f32 v[182:183], v[182:183], v[152:153] op_sel_hi:[1,0]
    v_pk_mul_f32 v[40:41], v[40:41], v[154:155] op_sel_hi:[1,0]
    v_pk_mul_f32 v[42:43], v[42:43], v[154:155] op_sel_hi:[1,0]
    v_pk_mul_f32 v[56:57], v[56:57], v[154:155] op_sel_hi:[1,0]
    v_pk_mul_f32 v[58:59], v[58:59], v[154:155] op_sel_hi:[1,0]
    v_cvt_pk_bf16_f32 v240, v176, v177
    v_cvt_pk_bf16_f32 v241, v178, v179
    v_cvt_pk_bf16_f32 v242, v180, v181
    v_cvt_pk_bf16_f32 v243, v182, v183
    v_cvt_pk_bf16_f32 v244, v40, v41
    v_cvt_pk_bf16_f32 v245, v42, v43
    v_cvt_pk_bf16_f32 v246, v56, v57
    v_cvt_pk_bf16_f32 v247, v58, v59
    v_pk_mul_f32 v[184:185], v[184:185], v[156:157] op_sel_hi:[1,0]
    v_pk_mul_f32 v[186:187], v[186:187], v[156:157] op_sel_hi:[1,0]
    v_pk_mul_f32 v[188:189], v[188:189], v[156:157] op_sel_hi:[1,0]
    v_pk_mul_f32 v[190:191], v[190:191], v[156:157] op_sel_hi:[1,0]
    v_pk_mul_f32 v[44:45], v[44:45], v[158:159] op_sel_hi:[1,0]
    v_pk_mul_f32 v[46:47], v[46:47], v[158:159] op_sel_hi:[1,0]
    v_pk_mul_f32 v[60:61], v[60:61], v[158:159] op_sel_hi:[1,0]
    v_pk_mul_f32 v[62:63], v[62:63], v[158:159] op_sel_hi:[1,0]
    v_cvt_pk_bf16_f32 v248, v184, v185
    v_cvt_pk_bf16_f32 v249, v186, v187
    v_cvt_pk_bf16_f32 v250, v188, v189
    v_cvt_pk_bf16_f32 v251, v190, v191
    v_cvt_pk_bf16_f32 v252, v44, v45
    v_cvt_pk_bf16_f32 v253, v46, v47
    v_cvt_pk_bf16_f32 v254, v60, v61
    v_cvt_pk_bf16_f32 v255, v62, v63
    s_mov_b32 s63, 0x20000
L_poll_2047:
    s_waitcnt vmcnt(0)
    v_cmp_eq_u32 vcc, -1, v128
    s_nop 0
    s_cmp_lg_u64 vcc, 0
    s_cselect_b32 s56, 0x100, 0
    v_cmp_eq_u32 vcc, -1, v64
    v_cmp_eq_u32 s[58:59], -1, v68
    s_nop 0
    s_or_b64 vcc, vcc, s[58:59]
    s_cselect_b32 s57, 1, 0
    s_or_b32 s56, s56, s57
    v_cmp_eq_u32 vcc, -1, v72
    v_cmp_eq_u32 s[58:59], -1, v76
    s_nop 0
    s_or_b64 vcc, vcc, s[58:59]
    s_cselect_b32 s57, 2, 0
    s_or_b32 s56, s56, s57
    v_cmp_eq_u32 vcc, -1, v80
    v_cmp_eq_u32 s[58:59], -1, v84
    s_nop 0
    s_or_b64 vcc, vcc, s[58:59]
    s_cselect_b32 s57, 4, 0
    s_or_b32 s56, s56, s57
    v_cmp_eq_u32 vcc, -1, v88
    v_cmp_eq_u32 s[58:59], -1, v92
    s_nop 0
    s_or_b64 vcc, vcc, s[58:59]
    s_cselect_b32 s57, 8, 0
    s_or_b32 s56, s56, s57
    v_cmp_eq_u32 vcc, -1, v96
    v_cmp_eq_u32 s[58:59], -1, v100
    s_nop 0
    s_or_b64 vcc, vcc, s[58:59]
    s_cselect_b32 s57, 16, 0
    s_or_b32 s56, s56, s57
    v_cmp_eq_u32 vcc, -1, v104
    v_cmp_eq_u32 s[58:59], -1, v108
    s_nop 0
    s_or_b64 vcc, vcc, s[58:59]
    s_cselect_b32 s57, 32, 0
    s_or_b32 s56, s56, s57
    v_cmp_eq_u32 vcc, -1, v112
    v_cmp_eq_u32 s[58:59], -1, v116
    s_nop 0
    s_or_b64 vcc, vcc, s[58:59]
    s_cselect_b32 s57, 64, 0
    s_or_b32 s56, s56, s57
    v_cmp_eq_u32 vcc, -1, v120
    v_cmp_eq_u32 s[58:59], -1, v124
    s_nop 0
    s_or_b64 vcc, vcc, s[58:59]
    s_cselect_b32 s57, 128, 0
    s_or_b32 s56, s56, s57
    s_cmp_eq_u32 s56, 0
    s_cbranch_scc1 L_go_2048
    s_sleep 4
    s_bitcmp0_b32 s56, 0
    s_cbranch_scc1 L_sk_2049
    s_add_u32 s52, s51, 0
    buffer_load_dwordx4 v[64:67], v15, s[28:31], s52 offen offset:0 sc1
    buffer_load_dwordx4 v[68:71], v15, s[28:31], s52 offen offset:1024 sc1
L_sk_2049:
    s_bitcmp0_b32 s56, 1
    s_cbranch_scc1 L_sk_2050
    s_add_u32 s52, s51, 16384
    buffer_load_dwordx4 v[72:75], v15, s[28:31], s52 offen offset:0 sc1
    buffer_load_dwordx4 v[76:79], v15, s[28:31], s52 offen offset:1024 sc1
L_sk_2050:
    s_bitcmp0_b32 s56, 2
    s_cbranch_scc1 L_sk_2051
    s_add_u32 s52, s51, 32768
    buffer_load_dwordx4 v[80:83], v15, s[28:31], s52 offen offset:0 sc1
    buffer_load_dwordx4 v[84:87], v15, s[28:31], s52 offen offset:1024 sc1
L_sk_2051:
    s_bitcmp0_b32 s56, 3
    s_cbranch_scc1 L_sk_2052
    s_add_u32 s52, s51, 49152
    buffer_load_dwordx4 v[88:91], v15, s[28:31], s52 offen offset:0 sc1
    buffer_load_dwordx4 v[92:95], v15, s[28:31], s52 offen offset:1024 sc1
L_sk_2052:
    s_bitcmp0_b32 s56, 4
    s_cbranch_scc1 L_sk_2053
    s_add_u32 s52, s51, 65536
    buffer_load_dwordx4 v[96:99], v15, s[28:31], s52 offen offset:0 sc1
    buffer_load_dwordx4 v[100:103], v15, s[28:31], s52 offen offset:1024 sc1
L_sk_2053:
    s_bitcmp0_b32 s56, 5
    s_cbranch_scc1 L_sk_2054
    s_add_u32 s52, s51, 81920
    buffer_load_dwordx4 v[104:107], v15, s[28:31], s52 offen offset:0 sc1
    buffer_load_dwordx4 v[108:111], v15, s[28:31], s52 offen offset:1024 sc1
L_sk_2054:
    s_bitcmp0_b32 s56, 6
    s_cbranch_scc1 L_sk_2055
    s_add_u32 s52, s51, 98304
    buffer_load_dwordx4 v[112:115], v15, s[28:31], s52 offen offset:0 sc1
    buffer_load_dwordx4 v[116:119], v15, s[28:31], s52 offen offset:1024 sc1
L_sk_2055:
    s_bitcmp0_b32 s56, 7
    s_cbranch_scc1 L_sk_2056
    s_add_u32 s52, s51, 114688
    buffer_load_dwordx4 v[120:123], v15, s[28:31], s52 offen offset:0 sc1
    buffer_load_dwordx4 v[124:127], v15, s[28:31], s52 offen offset:1024 sc1
L_sk_2056:
    buffer_load_dwordx4 v[128:131], v29, s[28:31], s54 offen sc1
    s_sub_u32 s63, s63, 1
    s_cmp_lg_u32 s63, 0
    s_cbranch_scc1 L_poll_2047
L_go_2048:
    s_mul_i32 s50, s44, 6144
    s_add_u32 s50, s50, 98304
    v_add_u32 v28, s50, v15
    s_lshr_b32 s51, s43, 1
    s_mul_i32 s51, s51, 3072
    s_and_b32 s52, s43, 1
    s_lshl_b32 s52, s52, 3
    s_add_u32 s51, s51, s52
    v_add_u32 v29, s51, v28
    s_lshl_b32 s50, s40, 1
    s_lshr_b32 s51, s43, 1
    s_add_u32 s50, s50, s51
    s_lshl_b32 s50, s50, 5
    s_lshl_b32 s51, s41, 1
    s_add_u32 s50, s50, s51
    s_add_u32 s50, s50, s44
    s_lshl_b32 s50, s50, 13
    s_and_b32 s51, s43, 1
    s_lshl_b32 s51, s51, 12
    s_add_u32 s50, s50, s51
    s_add_u32 s50, s50, 14680064
    s_waitcnt vmcnt(0)
    v_pk_add_f32 v[64:65], v[64:65], v[72:73]
    v_pk_add_f32 v[66:67], v[66:67], v[74:75]
    v_pk_add_f32 v[68:69], v[68:69], v[76:77]
    v_pk_add_f32 v[70:71], v[70:71], v[78:79]
    v_pk_add_f32 v[80:81], v[80:81], v[88:89]
    v_pk_add_f32 v[82:83], v[82:83], v[90:91]
    v_pk_add_f32 v[84:85], v[84:85], v[92:93]
    v_pk_add_f32 v[86:87], v[86:87], v[94:95]
    v_pk_add_f32 v[96:97], v[96:97], v[104:105]
    v_pk_add_f32 v[98:99], v[98:99], v[106:107]
    v_pk_add_f32 v[100:101], v[100:101], v[108:109]
    v_pk_add_f32 v[102:103], v[102:103], v[110:111]
    v_pk_add_f32 v[112:113], v[112:113], v[120:121]
    v_pk_add_f32 v[114:115], v[114:115], v[122:123]
    v_pk_add_f32 v[116:117], v[116:117], v[124:125]
    v_pk_add_f32 v[118:119], v[118:119], v[126:127]
    v_add_f32_dpp v128, v128, v128 quad_perm:[1,0,3,2] row_mask:0xf bank_mask:0xf
    v_add_f32_dpp v129, v129, v129 quad_perm:[1,0,3,2] row_mask:0xf bank_mask:0xf
    v_add_f32_dpp v130, v130, v130 quad_perm:[1,0,3,2] row_mask:0xf bank_mask:0xf
    v_add_f32_dpp v131, v131, v131 quad_perm:[1,0,3,2] row_mask:0xf bank_mask:0xf
    v_pk_add_f32 v[64:65], v[64:65], v[80:81]
    v_pk_add_f32 v[66:67], v[66:67], v[82:83]
    v_pk_add_f32 v[68:69], v[68:69], v[84:85]
    v_pk_add_f32 v[70:71], v[70:71], v[86:87]
    v_pk_add_f32 v[96:97], v[96:97], v[112:113]
    v_pk_add_f32 v[98:99], v[98:99], v[114:115]
    v_pk_add_f32 v[100:101], v[100:101], v[116:117]
    v_pk_add_f32 v[102:103], v[102:103], v[118:119]
    v_add_f32_dpp v128, v128, v128 quad_perm:[2,3,0,1] row_mask:0xf bank_mask:0xf
    v_add_f32_dpp v129, v129, v129 quad_perm:[2,3,0,1] row_mask:0xf bank_mask:0xf
    v_add_f32_dpp v130, v130, v130 quad_perm:[2,3,0,1] row_mask:0xf bank_mask:0xf
    v_add_f32_dpp v131, v131, v131 quad_perm:[2,3,0,1] row_mask:0xf bank_mask:0xf
    v_pk_add_f32 v[64:65], v[64:65], v[96:97]
    v_pk_add_f32 v[66:67], v[66:67], v[98:99]
    v_pk_add_f32 v[68:69], v[68:69], v[100:101]
    v_pk_add_f32 v[70:71], v[70:71], v[102:103]
    v_add_f32_dpp v128, v128, v128 row_ror:4 row_mask:0xf bank_mask:0xf
    v_add_f32_dpp v129, v129, v129 row_ror:4 row_mask:0xf bank_mask:0xf
    v_add_f32_dpp v130, v130, v130 row_ror:4 row_mask:0xf bank_mask:0xf
    v_add_f32_dpp v131, v131, v131 row_ror:4 row_mask:0xf bank_mask:0xf
    v_cvt_pk_bf16_f32 v72, v64, v65
    v_cvt_pk_bf16_f32 v73, v66, v67
    v_cvt_pk_bf16_f32 v74, v68, v69
    v_cvt_pk_bf16_f32 v75, v70, v71
    v_cvt_pk_bf16_f32 v76, v128, v129
    v_cvt_pk_bf16_f32 v77, v130, v131
    ds_write_b64 v29, v[72:73] offset:0
    ds_write_b64 v29, v[74:75] offset:1024
    ds_write_b64 v29, v[76:77] offset:2048
    s_waitcnt lgkmcnt(0)
    s_barrier
    ds_read_b128 v[32:35], v28 offset:0
    ds_read_b128 v[36:39], v28 offset:1024
    ds_read_b128 v[40:43], v28 offset:2048
    ds_read_b128 v[44:47], v28 offset:3072
    ds_read_b128 v[48:51], v28 offset:4096
    ds_read_b128 v[52:55], v28 offset:5120
    s_waitcnt lgkmcnt(3)
    v_mfma_f32_16x16x32_bf16 v[88:91], v[40:43], v[224:227], 0
    v_mfma_f32_16x16x32_bf16 v[80:83], v[32:35], v[224:227], 0
    v_mfma_f32_16x16x32_bf16 v[84:87], v[36:39], v[224:227], 0
    v_mfma_f32_16x16x32_bf16 v[100:103], v[40:43], v[232:235], 0
    v_mfma_f32_16x16x32_bf16 v[92:95], v[32:35], v[232:235], 0
    v_mfma_f32_16x16x32_bf16 v[96:99], v[36:39], v[232:235], 0
    v_mfma_f32_16x16x32_bf16 v[112:115], v[40:43], v[240:243], 0
    v_mfma_f32_16x16x32_bf16 v[104:107], v[32:35], v[240:243], 0
    v_mfma_f32_16x16x32_bf16 v[108:111], v[36:39], v[240:243], 0
    v_mfma_f32_16x16x32_bf16 v[124:127], v[40:43], v[248:251], 0
    v_mfma_f32_16x16x32_bf16 v[116:119], v[32:35], v[248:251], 0
    v_mfma_f32_16x16x32_bf16 v[120:123], v[36:39], v[248:251], 0
    s_waitcnt lgkmcnt(0)
    v_mfma_f32_16x16x32_bf16 v[88:91], v[52:55], v[228:231], v[88:91]
    v_mfma_f32_16x16x32_bf16 v[80:83], v[44:47], v[228:231], v[80:83]
    v_mfma_f32_16x16x32_bf16 v[84:87], v[48:51], v[228:231], v[84:87]
    v_mfma_f32_16x16x32_bf16 v[100:103], v[52:55], v[236:239], v[100:103]
    v_mfma_f32_16x16x32_bf16 v[92:95], v[44:47], v[236:239], v[92:95]
    v_mfma_f32_16x16x32_bf16 v[96:99], v[48:51], v[236:239], v[96:99]
    v_mfma_f32_16x16x32_bf16 v[112:115], v[52:55], v[244:247], v[112:115]
    v_mfma_f32_16x16x32_bf16 v[104:107], v[44:47], v[244:247], v[104:107]
    v_mfma_f32_16x16x32_bf16 v[108:111], v[48:51], v[244:247], v[108:111]
    v_mfma_f32_16x16x32_bf16 v[124:127], v[52:55], v[252:255], v[124:127]
    v_mfma_f32_16x16x32_bf16 v[116:119], v[44:47], v[252:255], v[116:119]
    v_mfma_f32_16x16x32_bf16 v[120:123], v[48:51], v[252:255], v[120:123]
    v_add_f32 v88, 0x358637bd, v88
    v_add_f32 v100, 0x358637bd, v100
    s_nop 0
    v_add_f32 v112, 0x358637bd, v112
    s_nop 1
    v_add_f32 v124, 0x358637bd, v124
    v_rcp_f32 v88, v88
    v_rcp_f32 v100, v100
    v_rcp_f32 v112, v112
    v_rcp_f32 v124, v124
    v_pk_mul_f32 v[80:81], v[80:81], v[88:89] op_sel_hi:[1,0]
    v_pk_mul_f32 v[82:83], v[82:83], v[88:89] op_sel_hi:[1,0]
    v_pk_mul_f32 v[84:85], v[84:85], v[88:89] op_sel_hi:[1,0]
    v_pk_mul_f32 v[86:87], v[86:87], v[88:89] op_sel_hi:[1,0]
    v_cvt_pk_bf16_f32 v160, v80, v81
    v_cvt_pk_bf16_f32 v161, v82, v83
    v_cvt_pk_bf16_f32 v162, v84, v85
    v_cvt_pk_bf16_f32 v163, v86, v87
    buffer_store_dwordx4 v[160:163], v15, s[28:31], s50 offen offset:0 sc1
    v_pk_mul_f32 v[92:93], v[92:93], v[100:101] op_sel_hi:[1,0]
    v_pk_mul_f32 v[94:95], v[94:95], v[100:101] op_sel_hi:[1,0]
    v_pk_mul_f32 v[96:97], v[96:97], v[100:101] op_sel_hi:[1,0]
    v_pk_mul_f32 v[98:99], v[98:99], v[100:101] op_sel_hi:[1,0]
    v_cvt_pk_bf16_f32 v164, v92, v93
    v_cvt_pk_bf16_f32 v165, v94, v95
    v_cvt_pk_bf16_f32 v166, v96, v97
    v_cvt_pk_bf16_f32 v167, v98, v99
    buffer_store_dwordx4 v[164:167], v15, s[28:31], s50 offen offset:1024 sc1
    v_pk_mul_f32 v[104:105], v[104:105], v[112:113] op_sel_hi:[1,0]
    v_pk_mul_f32 v[106:107], v[106:107], v[112:113] op_sel_hi:[1,0]
    v_pk_mul_f32 v[108:109], v[108:109], v[112:113] op_sel_hi:[1,0]
    v_pk_mul_f32 v[110:111], v[110:111], v[112:113] op_sel_hi:[1,0]
    v_cvt_pk_bf16_f32 v168, v104, v105
    v_cvt_pk_bf16_f32 v169, v106, v107
    v_cvt_pk_bf16_f32 v170, v108, v109
    v_cvt_pk_bf16_f32 v171, v110, v111
    buffer_store_dwordx4 v[168:171], v15, s[28:31], s50 offen offset:2048 sc1
    v_pk_mul_f32 v[116:117], v[116:117], v[124:125] op_sel_hi:[1,0]
    v_pk_mul_f32 v[118:119], v[118:119], v[124:125] op_sel_hi:[1,0]
    v_pk_mul_f32 v[120:121], v[120:121], v[124:125] op_sel_hi:[1,0]
    v_pk_mul_f32 v[122:123], v[122:123], v[124:125] op_sel_hi:[1,0]
    v_cvt_pk_bf16_f32 v172, v116, v117
    v_cvt_pk_bf16_f32 v173, v118, v119
    v_cvt_pk_bf16_f32 v174, v120, v121
    v_cvt_pk_bf16_f32 v175, v122, v123
    buffer_store_dwordx4 v[172:175], v15, s[28:31], s50 offen offset:3072 sc1
    s_lshr_b32 s47, s41, 2
    s_lshl_b32 s47, s47, 5
    s_and_b32 s48, s41, 3
    s_add_u32 s47, s47, s48
    s_lshl_b32 s48, s40, 9
    s_add_u32 s47, s47, s48
    s_lshl_b32 s47, s47, 2
    s_add_u32 s47, s47, 21431296
    s_branch L_p2
L_k1_p2:
    s_mov_b32 s24, s12
    s_and_b32 s25, s13, 0xffff
    s_mov_b32 s26, 0x700000
    s_mov_b32 s27, 0x00020000
    v_lshrrev_b32 v15, 3, v1
    s_lshl_b32 s50, s43, 3
    v_add_u32 v15, s50, v15
    s_mov_b32 s51, 7168
    v_mul_lo_u32 v2, v15, s51
    v_bfe_u32 v15, v1, 4, 1
    s_and_b32 s50, s43, 1
    s_lshl_b32 s50, s50, 1
    v_or_b32 v15, s50, v15
    v_lshlrev_b32 v15, 1, v15
    v_and_b32 v28, 7, v1
    v_xor_b32 v15, v15, v28
    v_lshl_add_u32 v2, v15, 4, v2
    s_mul_i32 s50, s41, 448
    s_and_b32 s50, s50, 0xffffff80
    v_add_u32 v2, s50, v2
    v_add_u32 v3, 229376, v2
    s_mul_i32 s46, s47, 458752
    s_lshl_b32 s50, s2, 3
    s_add_u32 s50, s50, s42
    s_lshl_b32 s50, s50, 11
    v_lshlrev_b32 v15, 4, v1
    buffer_load_dwordx4 v[232:235], v15, s[20:23], s50 offen
    buffer_load_dwordx4 v[236:239], v15, s[20:23], s50 offen offset:1024
    s_add_u32 m0, s48, 98304
    s_nop 0
    buffer_load_dwordx4 v2, s[24:27], s46 offen  lds
    s_add_u32 m0, s48, 102400
    s_nop 0
    buffer_load_dwordx4 v3, s[24:27], s46 offen  lds
    s_add_u32 m0, s48, 106368
    s_nop 0
    buffer_load_dwordx4 v2, s[24:27], s46 offen offset:128  lds
    s_add_u32 m0, s48, 110464
    s_nop 0
    buffer_load_dwordx4 v3, s[24:27], s46 offen offset:128  lds
    s_add_u32 m0, s48, 114432
    s_nop 0
    buffer_load_dwordx4 v2, s[24:27], s46 offen offset:256  lds
    s_add_u32 m0, s48, 118528
    s_nop 0
    buffer_load_dwordx4 v3, s[24:27], s46 offen offset:256  lds
    s_add_u32 m0, s48, 122496
    s_nop 0
    buffer_load_dwordx4 v2, s[24:27], s46 offen offset:384  lds
    s_add_u32 m0, s48, 126592
    s_nop 0
    buffer_load_dwordx4 v3, s[24:27], s46 offen offset:384  lds
    s_add_u32 s47, s47, 1
    s_and_b32 s47, s47, 15
    s_mul_i32 s46, s47, 458752
    s_mov_b32 s28, s18
    s_and_b32 s29, s19, 0xffff
    s_mov_b32 s30, 0x10000000
    s_mov_b32 s31, 0x00020000
    v_lshlrev_b32 v15, 4, v1
    s_mov_b32 s36, s14
    s_and_b32 s37, s15, 0xffff
    s_mov_b32 s38, 0x1c00
    s_mov_b32 s39, 0x00020000
    s_mov_b32 s32, s16
    s_and_b32 s33, s17, 0xffff
    s_mov_b32 s34, 0x100
    s_mov_b32 s35, 0x00020000
    v_mov_b32 v16, 0x3f803f80
    v_mov_b32 v17, 0x3f803f80
    v_mov_b32 v18, 0x3f803f80
    v_mov_b32 v19, 0x3f803f80
    v_mov_b32 v20, 0
    v_mov_b32 v21, 0
    v_mov_b32 v22, 0
    v_mov_b32 v23, 0
    v_mov_b32 v24, 0
    v_mov_b32 v25, 0
    v_mov_b32 v26, 0
    v_mov_b32 v27, 0
    v_and_b32 v15, 15, v1
    s_lshl_b32 s50, s43, 6
    v_add_u32 v15, s50, v15
    v_lshlrev_b32 v6, 7, v15
    v_bfe_u32 v15, v1, 1, 3
    v_lshrrev_b32 v28, 4, v1
    v_xor_b32 v15, v15, v28
    v_lshl_add_u32 v6, v15, 4, v6
    s_mov_b32 s80, 0
    v_lshrrev_b32 v15, 4, v1
    v_lshlrev_b32 v15, 3, v15
    v_bfe_u32 v28, v1, 2, 2
    v_add_u32 v15, v15, v28
    v_lshlrev_b32 v15, 7, v15
    v_and_b32 v28, 3, v1
    v_lshl_add_u32 v15, v28, 3, v15
    v_add_u32 v15, 98304, v15
    v_bfe_u32 v28, v1, 3, 2
    s_and_b32 s50, s41, 1
    s_lshl_b32 s50, s50, 1
    s_add_u32 s51, s50, 6
    s_and_b32 s52, s51, 3
    s_lshr_b32 s53, s51, 2
    s_lshl_b32 s53, s53, 13
    v_xor_b32 v14, s52, v28
    v_lshl_add_u32 v14, v14, 5, v15
    v_add_u32 v14, s53, v14
    s_add_u32 s51, s50, 0
    s_and_b32 s52, s51, 3
    s_lshr_b32 s53, s51, 2
    s_lshl_b32 s53, s53, 13
    v_xor_b32 v10, s52, v28
    v_lshl_add_u32 v10, v10, 5, v15
    v_add_u32 v10, s53, v10
    s_add_u32 s51, s50, 1
    s_and_b32 s52, s51, 3
    s_lshr_b32 s53, s51, 2
    s_lshl_b32 s53, s53, 13
    v_xor_b32 v11, s52, v28
    v_lshl_add_u32 v11, v11, 5, v15
    v_add_u32 v11, s53, v11
    s_add_u32 s51, s50, 2
    s_and_b32 s52, s51, 3
    s_lshr_b32 s53, s51, 2
    s_lshl_b32 s53, s53, 13
    v_xor_b32 v12, s52, v28
    v_lshl_add_u32 v12, v12, 5, v15
    v_add_u32 v12, s53, v12
    s_add_u32 s51, s50, 3
    s_and_b32 s52, s51, 3
    s_lshr_b32 s53, s51, 2
    s_lshl_b32 s53, s53, 13
    v_xor_b32 v13, s52, v28
    v_lshl_add_u32 v13, v13, 5, v15
    v_add_u32 v13, s53, v13
    v_mov_b32 v32, 0
    v_mov_b32 v33, 0
    v_mov_b32 v34, 0
    v_mov_b32 v35, 0
    v_mov_b32 v36, 0
    v_mov_b32 v37, 0
    v_mov_b32 v38, 0
    v_mov_b32 v39, 0
    v_mov_b32 v40, 0
    v_mov_b32 v41, 0
    v_mov_b32 v42, 0
    v_mov_b32 v43, 0
    v_mov_b32 v44, 0
    v_mov_b32 v45, 0
    v_mov_b32 v46, 0
    v_mov_b32 v47, 0
    v_mov_b32 v48, 0
    v_mov_b32 v49, 0
    v_mov_b32 v50, 0
    v_mov_b32 v51, 0
    v_mov_b32 v52, 0
    v_mov_b32 v53, 0
    v_mov_b32 v54, 0
    v_mov_b32 v55, 0
    v_mov_b32 v56, 0
    v_mov_b32 v57, 0
    v_mov_b32 v58, 0
    v_mov_b32 v59, 0
    v_mov_b32 v60, 0
    v_mov_b32 v61, 0
    v_mov_b32 v62, 0
    v_mov_b32 v63, 0
    v_mov_b32 v64, 0
    v_mov_b32 v65, 0
    v_mov_b32 v66, 0
    v_mov_b32 v67, 0
    v_mov_b32 v68, 0
    v_mov_b32 v69, 0
    v_mov_b32 v70, 0
    v_mov_b32 v71, 0
    v_mov_b32 v72, 0
    v_mov_b32 v73, 0
    v_mov_b32 v74, 0
    v_mov_b32 v75, 0
    v_mov_b32 v76, 0
    v_mov_b32 v77, 0
    v_mov_b32 v78, 0
    v_mov_b32 v79, 0
    v_mov_b32 v80, 0
    v_mov_b32 v81, 0
    v_mov_b32 v82, 0
    v_mov_b32 v83, 0
    v_mov_b32 v84, 0
    v_mov_b32 v85, 0
    v_mov_b32 v86, 0
    v_mov_b32 v87, 0
    v_mov_b32 v88, 0
    v_mov_b32 v89, 0
    v_mov_b32 v90, 0
    v_mov_b32 v91, 0
    v_mov_b32 v92, 0
    v_mov_b32 v93, 0
    v_mov_b32 v94, 0
    v_mov_b32 v95, 0
    v_mov_b32 v96, 0
    v_mov_b32 v97, 0
    v_mov_b32 v98, 0
    v_mov_b32 v99, 0
    v_mov_b32 v100, 0
    v_mov_b32 v101, 0
    v_mov_b32 v102, 0
    v_mov_b32 v103, 0
    v_mov_b32 v104, 0
    v_mov_b32 v105, 0
    v_mov_b32 v106, 0
    v_mov_b32 v107, 0
    v_mov_b32 v108, 0
    v_mov_b32 v109, 0
    v_mov_b32 v110, 0
    v_mov_b32 v111, 0
    v_mov_b32 v112, 0
    v_mov_b32 v113, 0
    v_mov_b32 v114, 0
    v_mov_b32 v115, 0
    v_mov_b32 v116, 0
    v_mov_b32 v117, 0
    v_mov_b32 v118, 0
    v_mov_b32 v119, 0
    v_mov_b32 v120, 0
    v_mov_b32 v121, 0
    v_mov_b32 v122, 0
    v_mov_b32 v123, 0
    v_mov_b32 v124, 0
    v_mov_b32 v125, 0
    v_mov_b32 v126, 0
    v_mov_b32 v127, 0
    v_mov_b32 v128, 0
    v_mov_b32 v129, 0
    v_mov_b32 v130, 0
    v_mov_b32 v131, 0
    v_mov_b32 v132, 0
    v_mov_b32 v133, 0
    v_mov_b32 v134, 0
    v_mov_b32 v135, 0
    v_mov_b32 v136, 0
    v_mov_b32 v137, 0
    v_mov_b32 v138, 0
    v_mov_b32 v139, 0
    v_mov_b32 v140, 0
    v_mov_b32 v141, 0
    v_mov_b32 v142, 0
    v_mov_b32 v143, 0
    s_waitcnt vmcnt(9)
    v_lshlrev_b32 v240, 16, v232
    v_and_b32 v241, 0xffff0000, v232
    v_lshlrev_b32 v242, 16, v233
    v_and_b32 v243, 0xffff0000, v233
    v_lshlrev_b32 v244, 16, v234
    v_and_b32 v245, 0xffff0000, v234
    v_lshlrev_b32 v246, 16, v235
    v_and_b32 v247, 0xffff0000, v235
    s_waitcnt vmcnt(8)
    v_lshlrev_b32 v248, 16, v236
    v_and_b32 v249, 0xffff0000, v236
    v_lshlrev_b32 v250, 16, v237
    v_and_b32 v251, 0xffff0000, v237
    v_lshlrev_b32 v252, 16, v238
    v_and_b32 v253, 0xffff0000, v238
    v_lshlrev_b32 v254, 16, v239
    v_and_b32 v255, 0xffff0000, v239
    v_pk_add_f32 v[232:233], v[240:241], v[242:243]
    v_pk_add_f32 v[234:235], v[244:245], v[246:247]
    v_pk_add_f32 v[236:237], v[248:249], v[250:251]
    v_pk_add_f32 v[238:239], v[252:253], v[254:255]
    v_pk_add_f32 v[232:233], v[232:233], v[234:235]
    v_pk_add_f32 v[236:237], v[236:237], v[238:239]
    v_pk_add_f32 v[232:233], v[232:233], v[236:237]
    v_add_f32 v232, v232, v233
    s_nop 1
    v_add_f32_dpp v232, v232, v232 row_ror:8 row_mask:0xf bank_mask:0xf
    s_nop 1
    v_add_f32_dpp v232, v232, v232 row_ror:4 row_mask:0xf bank_mask:0xf
    s_nop 1
    v_add_f32_dpp v232, v232, v232 row_ror:2 row_mask:0xf bank_mask:0xf
    s_nop 1
    v_add_f32_dpp v232, v232, v232 row_ror:1 row_mask:0xf bank_mask:0xf
    v_mov_b32 v233, v232
    s_nop 1
    v_permlane16_swap_b32 v232, v233
    v_add_f32 v232, v232, v233
    v_mov_b32 v233, v232
    s_nop 1
    v_permlane32_swap_b32 v232, v233
    v_add_f32 v232, v232, v233
    v_mul_f32 v28, 0xba800000, v232
    v_pk_add_f32 v[240:241], v[240:241], v[28:29] op_sel_hi:[1,0]
    v_pk_add_f32 v[242:243], v[242:243], v[28:29] op_sel_hi:[1,0]
    v_pk_add_f32 v[244:245], v[244:245], v[28:29] op_sel_hi:[1,0]
    v_pk_add_f32 v[246:247], v[246:247], v[28:29] op_sel_hi:[1,0]
    v_pk_add_f32 v[248:249], v[248:249], v[28:29] op_sel_hi:[1,0]
    v_pk_add_f32 v[250:251], v[250:251], v[28:29] op_sel_hi:[1,0]
    v_pk_add_f32 v[252:253], v[252:253], v[28:29] op_sel_hi:[1,0]
    v_pk_add_f32 v[254:255], v[254:255], v[28:29] op_sel_hi:[1,0]
    v_pk_mul_f32 v[232:233], v[240:241], v[240:241]
    v_pk_mul_f32 v[234:235], v[242:243], v[242:243]
    v_pk_fma_f32 v[232:233], v[244:245], v[244:245], v[232:233]
    v_pk_fma_f32 v[234:235], v[246:247], v[246:247], v[234:235]
    v_pk_fma_f32 v[232:233], v[248:249], v[248:249], v[232:233]
    v_pk_fma_f32 v[234:235], v[250:251], v[250:251], v[234:235]
    v_pk_fma_f32 v[232:233], v[252:253], v[252:253], v[232:233]
    v_pk_fma_f32 v[234:235], v[254:255], v[254:255], v[234:235]
    v_pk_add_f32 v[232:233], v[232:233], v[234:235]
    v_add_f32 v232, v232, v233
    s_nop 1
    v_add_f32_dpp v232, v232, v232 row_ror:8 row_mask:0xf bank_mask:0xf
    s_nop 1
    v_add_f32_dpp v232, v232, v232 row_ror:4 row_mask:0xf bank_mask:0xf
    s_nop 1
    v_add_f32_dpp v232, v232, v232 row_ror:2 row_mask:0xf bank_mask:0xf
    s_nop 1
    v_add_f32_dpp v232, v232, v232 row_ror:1 row_mask:0xf bank_mask:0xf
    v_mov_b32 v233, v232
    s_nop 1
    v_permlane16_swap_b32 v232, v233
    v_add_f32 v232, v232, v233
    v_mov_b32 v233, v232
    s_nop 1
    v_permlane32_swap_b32 v232, v233
    v_add_f32 v232, v232, v233
    v_mov_b32 v233, 0x3727c5ac
    v_fmac_f32 v233, 0x3a800000, v232
    v_rsq_f32 v239, v233
    v_cvt_pk_bf16_f32 v234, v28, v28
    v_mul_f32 v233, v233, v239
    v_and_b32 v234, 0xffff0000, v234
    v_sub_f32 v234, v28, v234
    v_cvt_pk_bf16_f32 v236, v28, v234
    v_cvt_pk_bf16_f32 v237, v28, v233
    v_and_b32 v235, 0xffff0000, v237
    v_sub_f32 v235, v233, v235
    v_cvt_pk_bf16_f32 v238, v235, 0
    s_add_u32 m0, s48, 131072
    s_nop 0
    buffer_load_dwordx4 v2, s[24:27], s46 offen  lds
    s_add_u32 m0, s48, 135168
    s_nop 0
    buffer_load_dwordx4 v3, s[24:27], s46 offen  lds
    s_add_u32 m0, s48, 139136
    s_nop 0
    buffer_load_dwordx4 v2, s[24:27], s46 offen offset:128  lds
    s_add_u32 m0, s48, 143232
    s_nop 0
    buffer_load_dwordx4 v3, s[24:27], s46 offen offset:128  lds
    s_add_u32 m0, s48, 147200
    s_nop 0
    buffer_load_dwordx4 v2, s[24:27], s46 offen offset:256  lds
    s_add_u32 m0, s48, 151296
    s_nop 0
    buffer_load_dwordx4 v3, s[24:27], s46 offen offset:256  lds
    s_add_u32 m0, s48, 155264
    s_nop 0
    buffer_load_dwordx4 v2, s[24:27], s46 offen offset:384  lds
    s_add_u32 m0, s48, 159360
    s_nop 0
    buffer_load_dwordx4 v3, s[24:27], s46 offen offset:384  lds
    s_add_u32 s47, s47, 1
    s_and_b32 s47, s47, 15
    s_mul_i32 s46, s47, 458752
    s_lshl_b32 s50, s2, 3
    s_add_u32 s50, s50, s42
    s_mul_i32 s51, s50, 3584
    s_add_u32 s88, s88, s51
    s_addc_u32 s89, s89, 0
    s_lshl_b32 s51, s50, 10
    s_add_u32 s92, s92, s51
    s_addc_u32 s93, s93, 0
    s_waitcnt vmcnt(8)
    s_barrier
    v_add_u32 v8, s80, v6
    v_xor_b32 v9, 64, v8
    s_add_u32 s80, s80, 32768
    s_cmp_ge_u32 s80, 98304
    s_cselect_b32 s80, 0, s80
    ds_read_b64_tr_b16 v[160:161], v14 offset:0
    ds_read_b64_tr_b16 v[162:163], v14 offset:512
    ds_read_b64_tr_b16 v[204:205], v14 offset:4096
    ds_read_b64_tr_b16 v[206:207], v14 offset:4608
    ds_read_b128 v[144:147], v8 offset:0
    ds_read_b128 v[148:151], v8 offset:2048
    ds_read_b128 v[152:155], v8 offset:4096
    ds_read_b128 v[156:159], v8 offset:6144
    ds_read_b128 v[188:191], v9 offset:0
    ds_read_b128 v[192:195], v9 offset:2048
    ds_read_b128 v[196:199], v9 offset:4096
    ds_read_b128 v[200:203], v9 offset:6144
    ds_read_b64_tr_b16 v[164:165], v10 offset:0
    ds_read_b64_tr_b16 v[166:167], v10 offset:512
    ds_read_b64_tr_b16 v[208:209], v10 offset:4096
    ds_read_b64_tr_b16 v[210:211], v10 offset:4608
    ds_read_b64_tr_b16 v[168:169], v11 offset:0
    ds_read_b64_tr_b16 v[170:171], v11 offset:512
    ds_read_b64_tr_b16 v[212:213], v11 offset:4096
    ds_read_b64_tr_b16 v[214:215], v11 offset:4608
    ds_read_b64_tr_b16 v[172:173], v12 offset:0
    ds_read_b64_tr_b16 v[174:175], v12 offset:512
    ds_read_b64_tr_b16 v[216:217], v12 offset:4096
    ds_read_b64_tr_b16 v[218:219], v12 offset:4608
    ds_read_b64_tr_b16 v[176:177], v13 offset:0
    ds_read_b64_tr_b16 v[178:179], v13 offset:512
    ds_read_b64_tr_b16 v[220:221], v13 offset:4096
    ds_read_b64_tr_b16 v[222:223], v13 offset:4608
    ds_read_b64_tr_b16 v[180:181], v10 offset:8192
    ds_read_b64_tr_b16 v[182:183], v10 offset:8704
    ds_read_b64_tr_b16 v[224:225], v10 offset:12288
    ds_read_b64_tr_b16 v[226:227], v10 offset:12800
    ds_read_b64_tr_b16 v[184:185], v11 offset:8192
    ds_read_b64_tr_b16 v[186:187], v11 offset:8704
    ds_read_b64_tr_b16 v[228:229], v11 offset:12288
    ds_read_b64_tr_b16 v[230:231], v11 offset:12800
    v_mov_b32 v248, -1
    v_mov_b32 v249, -1
    v_mov_b32 v250, -1
    v_mov_b32 v251, -1
    s_lshl_b32 s50, s2, 3
    s_add_u32 s50, s50, s42
    s_lshl_b32 s50, s50, 4
    s_add_u32 s50, s50, 18874368
    s_mov_b64 exec, 1
    buffer_store_dwordx4 v[236:239], off, s[28:31], s50 sc1
    s_mov_b64 exec, -1
    s_lshl_b32 s50, s41, 1
    s_add_u32 s50, s50, s44
    s_lshl_b32 s50, s50, 3
    s_add_u32 s50, s50, s40
    s_lshl_b32 s50, s50, 9
    s_lshl_b32 s51, s43, 7
    s_add_u32 s50, s50, s51
    s_add_u32 s50, s50, 19070976
    v_lshlrev_b32 v15, 4, v1
    s_mov_b64 exec, 0xff
    buffer_store_dwordx4 v[248:251], v15, s[28:31], s50 offen sc1
    s_mov_b64 exec, -1
    v_lshlrev_b32 v15, 4, v1
    s_lshl_b32 s50, s2, 3
    s_add_u32 s50, s50, s42
    s_lshl_b32 s50, s50, 11
    s_add_u32 s50, s50, 33554432
    buffer_store_dwordx4 v[248:251], v15, s[28:31], s50 offen offset:0 sc1
    buffer_store_dwordx4 v[248:251], v15, s[28:31], s50 offen offset:1024 sc1
    s_cmp_lg_u32 s43, 0
    s_cbranch_scc1 L_skip_3001
    s_lshr_b32 s50, s41, 1
    s_lshl_b32 s50, s50, 5
    s_and_b32 s51, s41, 1
    s_add_u32 s50, s50, s51
    s_lshl_b32 s51, s40, 9
    s_add_u32 s50, s50, s51
    s_lshl_b32 s50, s50, 2
    s_add_u32 s50, s50, 21430272
    v_mov_b32 v15, 0
    s_mov_b64 exec, 1
    buffer_store_dword v15, off, s[28:31], s50 sc1
    s_add_u32 s50, s50, 16384
    buffer_store_dword v15, off, s[28:31], s50 sc1
    s_mov_b64 exec, -1
L_skip_3001:
    s_waitcnt lgkmcnt(0)
    s_cmp_lg_u32 s86, 0
    s_cbranch_scc1 L_cs_3002
    s_cmp_lg_u32 s43, 0
    s_cbranch_scc1 L_cs_3003
    v_mfma_f32_16x16x32_bf16 v[20:23], v[16:19], v[160:163], v[20:23]
    v_mfma_f32_16x16x32_bf16 v[20:23], v[16:19], v[204:207], v[20:23]
    v_mfma_f32_16x16x32_bf16 v[24:27], v[16:19], v[176:179], v[24:27]
    v_mfma_f32_16x16x32_bf16 v[24:27], v[16:19], v[220:223], v[24:27]
    s_branch L_cs_3002
L_cs_3003:
    s_cmp_lg_u32 s43, 1
    s_cbranch_scc1 L_cs_3004
    v_mfma_f32_16x16x32_bf16 v[20:23], v[16:19], v[164:167], v[20:23]
    v_mfma_f32_16x16x32_bf16 v[20:23], v[16:19], v[208:211], v[20:23]
    v_mfma_f32_16x16x32_bf16 v[24:27], v[16:19], v[180:183], v[24:27]
    v_mfma_f32_16x16x32_bf16 v[24:27], v[16:19], v[224:227], v[24:27]
    s_branch L_cs_3002
L_cs_3004:
    s_cmp_lg_u32 s43, 2
    s_cbranch_scc1 L_cs_3005
    v_mfma_f32_16x16x32_bf16 v[20:23], v[16:19], v[168:171], v[20:23]
    v_mfma_f32_16x16x32_bf16 v[20:23], v[16:19], v[212:215], v[20:23]
    v_mfma_f32_16x16x32_bf16 v[24:27], v[16:19], v[184:187], v[24:27]
    v_mfma_f32_16x16x32_bf16 v[24:27], v[16:19], v[228:231], v[24:27]
    s_branch L_cs_3002
L_cs_3005:
    v_mfma_f32_16x16x32_bf16 v[20:23], v[16:19], v[172:175], v[20:23]
    v_mfma_f32_16x16x32_bf16 v[20:23], v[16:19], v[216:219], v[20:23]
L_cs_3002:
    s_call_b64 s[100:101], L_sub_c1_0
    v_add_u32 v8, s80, v6
    v_xor_b32 v9, 64, v8
    s_add_u32 s80, s80, 32768
    s_cmp_ge_u32 s80, 98304
    s_cselect_b32 s80, 0, s80
    ds_read_b64_tr_b16 v[160:161], v14 offset:32768
    s_add_u32 m0, s48, 98304
    ds_read_b64_tr_b16 v[162:163], v14 offset:33280
    buffer_load_dwordx4 v2, s[24:27], s46 offen  lds
    ds_read_b64_tr_b16 v[204:205], v14 offset:36864
    ds_read_b64_tr_b16 v[206:207], v14 offset:37376
    ds_read_b128 v[144:147], v8 offset:0
    s_add_u32 m0, s48, 102400
    ds_read_b128 v[148:151], v8 offset:2048
    buffer_load_dwordx4 v3, s[24:27], s46 offen  lds
    ds_read_b128 v[152:155], v8 offset:4096
    ds_read_b128 v[156:159], v8 offset:6144
    ds_read_b128 v[188:191], v9 offset:0
    s_add_u32 m0, s48, 106368
    ds_read_b128 v[192:195], v9 offset:2048
    buffer_load_dwordx4 v2, s[24:27], s46 offen offset:128  lds
    ds_read_b128 v[196:199], v9 offset:4096
    ds_read_b128 v[200:203], v9 offset:6144
    ds_read_b64_tr_b16 v[164:165], v10 offset:32768
    s_add_u32 m0, s48, 110464
    ds_read_b64_tr_b16 v[166:167], v10 offset:33280
    buffer_load_dwordx4 v3, s[24:27], s46 offen offset:128  lds
    ds_read_b64_tr_b16 v[208:209], v10 offset:36864
    ds_read_b64_tr_b16 v[210:211], v10 offset:37376
    ds_read_b64_tr_b16 v[168:169], v11 offset:32768
    s_add_u32 m0, s48, 114432
    ds_read_b64_tr_b16 v[170:171], v11 offset:33280
    buffer_load_dwordx4 v2, s[24:27], s46 offen offset:256  lds
    ds_read_b64_tr_b16 v[212:213], v11 offset:36864
    ds_read_b64_tr_b16 v[214:215], v11 offset:37376
    ds_read_b64_tr_b16 v[172:173], v12 offset:32768
    s_add_u32 m0, s48, 118528
    ds_read_b64_tr_b16 v[174:175], v12 offset:33280
    buffer_load_dwordx4 v3, s[24:27], s46 offen offset:256  lds
    ds_read_b64_tr_b16 v[216:217], v12 offset:36864
    ds_read_b64_tr_b16 v[218:219], v12 offset:37376
    ds_read_b64_tr_b16 v[176:177], v13 offset:32768
    s_add_u32 m0, s48, 122496
    ds_read_b64_tr_b16 v[178:179], v13 offset:33280
    buffer_load_dwordx4 v2, s[24:27], s46 offen offset:384  lds
    ds_read_b64_tr_b16 v[220:221], v13 offset:36864
    ds_read_b64_tr_b16 v[222:223], v13 offset:37376
    ds_read_b64_tr_b16 v[180:181], v10 offset:40960
    s_add_u32 m0, s48, 126592
    ds_read_b64_tr_b16 v[182:183], v10 offset:41472
    buffer_load_dwordx4 v3, s[24:27], s46 offen offset:384  lds
    ds_read_b64_tr_b16 v[224:225], v10 offset:45056
    ds_read_b64_tr_b16 v[226:227], v10 offset:45568
    ds_read_b64_tr_b16 v[184:185], v11 offset:40960
    ds_read_b64_tr_b16 v[186:187], v11 offset:41472
    ds_read_b64_tr_b16 v[228:229], v11 offset:45056
    ds_read_b64_tr_b16 v[230:231], v11 offset:45568
    s_add_u32 s47, s47, 1
    s_and_b32 s47, s47, 15
    s_mul_i32 s46, s47, 458752
    s_waitcnt lgkmcnt(0)
    s_cmp_lg_u32 s86, 0
    s_cbranch_scc1 L_cs_3006
    s_cmp_lg_u32 s43, 0
    s_cbranch_scc1 L_cs_3007
    v_mfma_f32_16x16x32_bf16 v[20:23], v[16:19], v[160:163], v[20:23]
    v_mfma_f32_16x16x32_bf16 v[20:23], v[16:19], v[204:207], v[20:23]
    v_mfma_f32_16x16x32_bf16 v[24:27], v[16:19], v[176:179], v[24:27]
    v_mfma_f32_16x16x32_bf16 v[24:27], v[16:19], v[220:223], v[24:27]
    s_branch L_cs_3006
L_cs_3007:
    s_cmp_lg_u32 s43, 1
    s_cbranch_scc1 L_cs_3008
    v_mfma_f32_16x16x32_bf16 v[20:23], v[16:19], v[164:167], v[20:23]
    v_mfma_f32_16x16x32_bf16 v[20:23], v[16:19], v[208:211], v[20:23]
    v_mfma_f32_16x16x32_bf16 v[24:27], v[16:19], v[180:183], v[24:27]
    v_mfma_f32_16x16x32_bf16 v[24:27], v[16:19], v[224:227], v[24:27]
    s_branch L_cs_3006
L_cs_3008:
    s_cmp_lg_u32 s43, 2
    s_cbranch_scc1 L_cs_3009
    v_mfma_f32_16x16x32_bf16 v[20:23], v[16:19], v[168:171], v[20:23]
    v_mfma_f32_16x16x32_bf16 v[20:23], v[16:19], v[212:215], v[20:23]
    v_mfma_f32_16x16x32_bf16 v[24:27], v[16:19], v[184:187], v[24:27]
    v_mfma_f32_16x16x32_bf16 v[24:27], v[16:19], v[228:231], v[24:27]
    s_branch L_cs_3006
L_cs_3009:
    v_mfma_f32_16x16x32_bf16 v[20:23], v[16:19], v[172:175], v[20:23]
    v_mfma_f32_16x16x32_bf16 v[20:23], v[16:19], v[216:219], v[20:23]
L_cs_3006:
    s_sub_u32 s86, s86, 1
    s_mov_b32 s49, 2
L_loop_3040:
    s_call_b64 s[100:101], L_sub_c1_1
    v_add_u32 v8, s80, v6
    v_xor_b32 v9, 64, v8
    s_add_u32 s80, s80, 32768
    s_cmp_ge_u32 s80, 98304
    s_cselect_b32 s80, 0, s80
    ds_read_b64_tr_b16 v[160:161], v14 offset:0
    s_add_u32 m0, s48, 131072
    ds_read_b64_tr_b16 v[162:163], v14 offset:512
    buffer_load_dwordx4 v2, s[24:27], s46 offen  lds
    ds_read_b64_tr_b16 v[204:205], v14 offset:4096
    ds_read_b64_tr_b16 v[206:207], v14 offset:4608
    ds_read_b128 v[144:147], v8 offset:0
    s_add_u32 m0, s48, 135168
    ds_read_b128 v[148:151], v8 offset:2048
    buffer_load_dwordx4 v3, s[24:27], s46 offen  lds
    ds_read_b128 v[152:155], v8 offset:4096
    ds_read_b128 v[156:159], v8 offset:6144
    ds_read_b128 v[188:191], v9 offset:0
    s_add_u32 m0, s48, 139136
    ds_read_b128 v[192:195], v9 offset:2048
    buffer_load_dwordx4 v2, s[24:27], s46 offen offset:128  lds
    ds_read_b128 v[196:199], v9 offset:4096
    ds_read_b128 v[200:203], v9 offset:6144
    ds_read_b64_tr_b16 v[164:165], v10 offset:0
    s_add_u32 m0, s48, 143232
    ds_read_b64_tr_b16 v[166:167], v10 offset:512
    buffer_load_dwordx4 v3, s[24:27], s46 offen offset:128  lds
    ds_read_b64_tr_b16 v[208:209], v10 offset:4096
    ds_read_b64_tr_b16 v[210:211], v10 offset:4608
    ds_read_b64_tr_b16 v[168:169], v11 offset:0
    s_add_u32 m0, s48, 147200
    ds_read_b64_tr_b16 v[170:171], v11 offset:512
    buffer_load_dwordx4 v2, s[24:27], s46 offen offset:256  lds
    ds_read_b64_tr_b16 v[212:213], v11 offset:4096
    ds_read_b64_tr_b16 v[214:215], v11 offset:4608
    ds_read_b64_tr_b16 v[172:173], v12 offset:0
    s_add_u32 m0, s48, 151296
    ds_read_b64_tr_b16 v[174:175], v12 offset:512
    buffer_load_dwordx4 v3, s[24:27], s46 offen offset:256  lds
    ds_read_b64_tr_b16 v[216:217], v12 offset:4096
    ds_read_b64_tr_b16 v[218:219], v12 offset:4608
    ds_read_b64_tr_b16 v[176:177], v13 offset:0
    s_add_u32 m0, s48, 155264
    ds_read_b64_tr_b16 v[178:179], v13 offset:512
    buffer_load_dwordx4 v2, s[24:27], s46 offen offset:384  lds
    ds_read_b64_tr_b16 v[220:221], v13 offset:4096
    ds_read_b64_tr_b16 v[222:223], v13 offset:4608
    ds_read_b64_tr_b16 v[180:181], v10 offset:8192
    s_add_u32 m0, s48, 159360
    ds_read_b64_tr_b16 v[182:183], v10 offset:8704
    buffer_load_dwordx4 v3, s[24:27], s46 offen offset:384  lds
    ds_read_b64_tr_b16 v[224:225], v10 offset:12288
    ds_read_b64_tr_b16 v[226:227], v10 offset:12800
    ds_read_b64_tr_b16 v[184:185], v11 offset:8192
    ds_read_b64_tr_b16 v[186:187], v11 offset:8704
    ds_read_b64_tr_b16 v[228:229], v11 offset:12288
    ds_read_b64_tr_b16 v[230:231], v11 offset:12800
    s_add_u32 s47, s47, 1
    s_and_b32 s47, s47, 15
    s_mul_i32 s46, s47, 458752
    s_waitcnt lgkmcnt(0)
    s_cmp_lg_u32 s86, 0
    s_cbranch_scc1 L_cs_3010
    s_cmp_lg_u32 s43, 0
    s_cbranch_scc1 L_cs_3011
    v_mfma_f32_16x16x32_bf16 v[20:23], v[16:19], v[160:163], v[20:23]
    v_mfma_f32_16x16x32_bf16 v[20:23], v[16:19], v[204:207], v[20:23]
    v_mfma_f32_16x16x32_bf16 v[24:27], v[16:19], v[176:179], v[24:27]
    v_mfma_f32_16x16x32_bf16 v[24:27], v[16:19], v[220:223], v[24:27]
    s_branch L_cs_3010
L_cs_3011:
    s_cmp_lg_u32 s43, 1
    s_cbranch_scc1 L_cs_3012
    v_mfma_f32_16x16x32_bf16 v[20:23], v[16:19], v[164:167], v[20:23]
    v_mfma_f32_16x16x32_bf16 v[20:23], v[16:19], v[208:211], v[20:23]
    v_mfma_f32_16x16x32_bf16 v[24:27], v[16:19], v[180:183], v[24:27]
    v_mfma_f32_16x16x32_bf16 v[24:27], v[16:19], v[224:227], v[24:27]
    s_branch L_cs_3010
L_cs_3012:
    s_cmp_lg_u32 s43, 2
    s_cbranch_scc1 L_cs_3013
    v_mfma_f32_16x16x32_bf16 v[20:23], v[16:19], v[168:171], v[20:23]
    v_mfma_f32_16x16x32_bf16 v[20:23], v[16:19], v[212:215], v[20:23]
    v_mfma_f32_16x16x32_bf16 v[24:27], v[16:19], v[184:187], v[24:27]
    v_mfma_f32_16x16x32_bf16 v[24:27], v[16:19], v[228:231], v[24:27]
    s_branch L_cs_3010
L_cs_3013:
    v_mfma_f32_16x16x32_bf16 v[20:23], v[16:19], v[172:175], v[20:23]
    v_mfma_f32_16x16x32_bf16 v[20:23], v[16:19], v[216:219], v[20:23]
L_cs_3010:
    s_call_b64 s[100:101], L_sub_c1_1
    v_add_u32 v8, s80, v6
    v_xor_b32 v9, 64, v8
    s_add_u32 s80, s80, 32768
    s_cmp_ge_u32 s80, 98304
    s_cselect_b32 s80, 0, s80
    ds_read_b64_tr_b16 v[160:161], v14 offset:32768
    s_add_u32 m0, s48, 98304
    ds_read_b64_tr_b16 v[162:163], v14 offset:33280
    buffer_load_dwordx4 v2, s[24:27], s46 offen  lds
    ds_read_b64_tr_b16 v[204:205], v14 offset:36864
    ds_read_b64_tr_b16 v[206:207], v14 offset:37376
    ds_read_b128 v[144:147], v8 offset:0
    s_add_u32 m0, s48, 102400
    ds_read_b128 v[148:151], v8 offset:2048
    buffer_load_dwordx4 v3, s[24:27], s46 offen  lds
    ds_read_b128 v[152:155], v8 offset:4096
    ds_read_b128 v[156:159], v8 offset:6144
    ds_read_b128 v[188:191], v9 offset:0
    s_add_u32 m0, s48, 106368
    ds_read_b128 v[192:195], v9 offset:2048
    buffer_load_dwordx4 v2, s[24:27], s46 offen offset:128  lds
    ds_read_b128 v[196:199], v9 offset:4096
    ds_read_b128 v[200:203], v9 offset:6144
    ds_read_b64_tr_b16 v[164:165], v10 offset:32768
    s_add_u32 m0, s48, 110464
    ds_read_b64_tr_b16 v[166:167], v10 offset:33280
    buffer_load_dwordx4 v3, s[24:27], s46 offen offset:128  lds
    ds_read_b64_tr_b16 v[208:209], v10 offset:36864
    ds_read_b64_tr_b16 v[210:211], v10 offset:37376
    ds_read_b64_tr_b16 v[168:169], v11 offset:32768
    s_add_u32 m0, s48, 114432
    ds_read_b64_tr_b16 v[170:171], v11 offset:33280
    buffer_load_dwordx4 v2, s[24:27], s46 offen offset:256  lds
    ds_read_b64_tr_b16 v[212:213], v11 offset:36864
    ds_read_b64_tr_b16 v[214:215], v11 offset:37376
    ds_read_b64_tr_b16 v[172:173], v12 offset:32768
    s_add_u32 m0, s48, 118528
    ds_read_b64_tr_b16 v[174:175], v12 offset:33280
    buffer_load_dwordx4 v3, s[24:27], s46 offen offset:256  lds
    ds_read_b64_tr_b16 v[216:217], v12 offset:36864
    ds_read_b64_tr_b16 v[218:219], v12 offset:37376
    ds_read_b64_tr_b16 v[176:177], v13 offset:32768
    s_add_u32 m0, s48, 122496
    ds_read_b64_tr_b16 v[178:179], v13 offset:33280
    buffer_load_dwordx4 v2, s[24:27], s46 offen offset:384  lds
    ds_read_b64_tr_b16 v[220:221], v13 offset:36864
    ds_read_b64_tr_b16 v[222:223], v13 offset:37376
    ds_read_b64_tr_b16 v[180:181], v10 offset:40960
    s_add_u32 m0, s48, 126592
    ds_read_b64_tr_b16 v[182:183], v10 offset:41472
    buffer_load_dwordx4 v3, s[24:27], s46 offen offset:384  lds
    ds_read_b64_tr_b16 v[224:225], v10 offset:45056
    ds_read_b64_tr_b16 v[226:227], v10 offset:45568
    ds_read_b64_tr_b16 v[184:185], v11 offset:40960
    ds_read_b64_tr_b16 v[186:187], v11 offset:41472
    ds_read_b64_tr_b16 v[228:229], v11 offset:45056
    ds_read_b64_tr_b16 v[230:231], v11 offset:45568
    s_add_u32 s47, s47, 1
    s_and_b32 s47, s47, 15
    s_mul_i32 s46, s47, 458752
    s_waitcnt lgkmcnt(0)
    s_cmp_lg_u32 s86, 0
    s_cbranch_scc1 L_cs_3014
    s_cmp_lg_u32 s43, 0
    s_cbranch_scc1 L_cs_3015
    v_mfma_f32_16x16x32_bf16 v[20:23], v[16:19], v[160:163], v[20:23]
    v_mfma_f32_16x16x32_bf16 v[20:23], v[16:19], v[204:207], v[20:23]
    v_mfma_f32_16x16x32_bf16 v[24:27], v[16:19], v[176:179], v[24:27]
    v_mfma_f32_16x16x32_bf16 v[24:27], v[16:19], v[220:223], v[24:27]
    s_branch L_cs_3014
L_cs_3015:
    s_cmp_lg_u32 s43, 1
    s_cbranch_scc1 L_cs_3016
    v_mfma_f32_16x16x32_bf16 v[20:23], v[16:19], v[164:167], v[20:23]
    v_mfma_f32_16x16x32_bf16 v[20:23], v[16:19], v[208:211], v[20:23]
    v_mfma_f32_16x16x32_bf16 v[24:27], v[16:19], v[180:183], v[24:27]
    v_mfma_f32_16x16x32_bf16 v[24:27], v[16:19], v[224:227], v[24:27]
    s_branch L_cs_3014
L_cs_3016:
    s_cmp_lg_u32 s43, 2
    s_cbranch_scc1 L_cs_3017
    v_mfma_f32_16x16x32_bf16 v[20:23], v[16:19], v[168:171], v[20:23]
    v_mfma_f32_16x16x32_bf16 v[20:23], v[16:19], v[212:215], v[20:23]
    v_mfma_f32_16x16x32_bf16 v[24:27], v[16:19], v[184:187], v[24:27]
    v_mfma_f32_16x16x32_bf16 v[24:27], v[16:19], v[228:231], v[24:27]
    s_branch L_cs_3014
L_cs_3017:
    v_mfma_f32_16x16x32_bf16 v[20:23], v[16:19], v[172:175], v[20:23]
    v_mfma_f32_16x16x32_bf16 v[20:23], v[16:19], v[216:219], v[20:23]
L_cs_3014:
    s_sub_u32 s86, s86, 1
    s_sub_u32 s49, s49, 1
    s_cmp_lg_u32 s49, 0
    s_cbranch_scc1 L_loop_3040
    s_call_b64 s[100:101], L_sub_c1_1
    v_add_u32 v8, s80, v6
    v_xor_b32 v9, 64, v8
    s_add_u32 s80, s80, 32768
    s_cmp_ge_u32 s80, 98304
    s_cselect_b32 s80, 0, s80
    ds_read_b64_tr_b16 v[160:161], v14 offset:0
    s_add_u32 m0, s48, 131072
    ds_read_b64_tr_b16 v[162:163], v14 offset:512
    buffer_load_dwordx4 v2, s[24:27], s46 offen  lds
    ds_read_b64_tr_b16 v[204:205], v14 offset:4096
    ds_read_b64_tr_b16 v[206:207], v14 offset:4608
    ds_read_b128 v[144:147], v8 offset:0
    s_add_u32 m0, s48, 135168
    ds_read_b128 v[148:151], v8 offset:2048
    buffer_load_dwordx4 v3, s[24:27], s46 offen  lds
    ds_read_b128 v[152:155], v8 offset:4096
    ds_read_b128 v[156:159], v8 offset:6144
    ds_read_b128 v[188:191], v9 offset:0
    s_add_u32 m0, s48, 139136
    ds_read_b128 v[192:195], v9 offset:2048
    buffer_load_dwordx4 v2, s[24:27], s46 offen offset:128  lds
    ds_read_b128 v[196:199], v9 offset:4096
    ds_read_b128 v[200:203], v9 offset:6144
    ds_read_b64_tr_b16 v[164:165], v10 offset:0
    s_add_u32 m0, s48, 143232
    ds_read_b64_tr_b16 v[166:167], v10 offset:512
    buffer_load_dwordx4 v3, s[24:27], s46 offen offset:128  lds
    ds_read_b64_tr_b16 v[208:209], v10 offset:4096
    ds_read_b64_tr_b16 v[210:211], v10 offset:4608
    ds_read_b64_tr_b16 v[168:169], v11 offset:0
    s_add_u32 m0, s48, 147200
    ds_read_b64_tr_b16 v[170:171], v11 offset:512
    buffer_load_dwordx4 v2, s[24:27], s46 offen offset:256  lds
    ds_read_b64_tr_b16 v[212:213], v11 offset:4096
    ds_read_b64_tr_b16 v[214:215], v11 offset:4608
    ds_read_b64_tr_b16 v[172:173], v12 offset:0
    s_add_u32 m0, s48, 151296
    ds_read_b64_tr_b16 v[174:175], v12 offset:512
    buffer_load_dwordx4 v3, s[24:27], s46 offen offset:256  lds
    ds_read_b64_tr_b16 v[216:217], v12 offset:4096
    ds_read_b64_tr_b16 v[218:219], v12 offset:4608
    ds_read_b64_tr_b16 v[176:177], v13 offset:0
    s_add_u32 m0, s48, 155264
    ds_read_b64_tr_b16 v[178:179], v13 offset:512
    buffer_load_dwordx4 v2, s[24:27], s46 offen offset:384  lds
    ds_read_b64_tr_b16 v[220:221], v13 offset:4096
    ds_read_b64_tr_b16 v[222:223], v13 offset:4608
    ds_read_b64_tr_b16 v[180:181], v10 offset:8192
    s_add_u32 m0, s48, 159360
    ds_read_b64_tr_b16 v[182:183], v10 offset:8704
    buffer_load_dwordx4 v3, s[24:27], s46 offen offset:384  lds
    ds_read_b64_tr_b16 v[224:225], v10 offset:12288
    ds_read_b64_tr_b16 v[226:227], v10 offset:12800
    ds_read_b64_tr_b16 v[184:185], v11 offset:8192
    ds_read_b64_tr_b16 v[186:187], v11 offset:8704
    ds_read_b64_tr_b16 v[228:229], v11 offset:12288
    ds_read_b64_tr_b16 v[230:231], v11 offset:12800
    s_add_u32 s47, s47, 1
    s_and_b32 s47, s47, 15
    s_mul_i32 s46, s47, 458752
    s_waitcnt lgkmcnt(0)
    s_load_dword s90, s[88:89], 0
    s_load_dword s90, s[88:89], 64
    s_load_dword s90, s[88:89], 128
    s_load_dword s90, s[88:89], 192
    s_load_dword s90, s[88:89], 256
    s_load_dword s90, s[88:89], 320
    s_load_dword s90, s[88:89], 384
    s_load_dword s90, s[88:89], 448
    s_cmp_lg_u32 s86, 0
    s_cbranch_scc1 L_cs_3026
    s_cmp_lg_u32 s43, 0
    s_cbranch_scc1 L_cs_3027
    v_mfma_f32_16x16x32_bf16 v[20:23], v[16:19], v[160:163], v[20:23]
    v_mfma_f32_16x16x32_bf16 v[20:23], v[16:19], v[204:207], v[20:23]
    v_mfma_f32_16x16x32_bf16 v[24:27], v[16:19], v[176:179], v[24:27]
    v_mfma_f32_16x16x32_bf16 v[24:27], v[16:19], v[220:223], v[24:27]
    s_branch L_cs_3026
L_cs_3027:
    s_cmp_lg_u32 s43, 1
    s_cbranch_scc1 L_cs_3028
    v_mfma_f32_16x16x32_bf16 v[20:23], v[16:19], v[164:167], v[20:23]
    v_mfma_f32_16x16x32_bf16 v[20:23], v[16:19], v[208:211], v[20:23]
    v_mfma_f32_16x16x32_bf16 v[24:27], v[16:19], v[180:183], v[24:27]
    v_mfma_f32_16x16x32_bf16 v[24:27], v[16:19], v[224:227], v[24:27]
    s_branch L_cs_3026
L_cs_3028:
    s_cmp_lg_u32 s43, 2
    s_cbranch_scc1 L_cs_3029
    v_mfma_f32_16x16x32_bf16 v[20:23], v[16:19], v[168:171], v[20:23]
    v_mfma_f32_16x16x32_bf16 v[20:23], v[16:19], v[212:215], v[20:23]
    v_mfma_f32_16x16x32_bf16 v[24:27], v[16:19], v[184:187], v[24:27]
    v_mfma_f32_16x16x32_bf16 v[24:27], v[16:19], v[228:231], v[24:27]
    s_branch L_cs_3026
L_cs_3029:
    v_mfma_f32_16x16x32_bf16 v[20:23], v[16:19], v[172:175], v[20:23]
    v_mfma_f32_16x16x32_bf16 v[20:23], v[16:19], v[216:219], v[20:23]
L_cs_3026:
    s_call_b64 s[100:101], L_sub_c1_1
    v_add_u32 v8, s80, v6
    v_xor_b32 v9, 64, v8
    s_add_u32 s80, s80, 32768
    s_cmp_ge_u32 s80, 98304
    s_cselect_b32 s80, 0, s80
    ds_read_b64_tr_b16 v[160:161], v14 offset:32768
    s_add_u32 m0, s48, 98304
    ds_read_b64_tr_b16 v[162:163], v14 offset:33280
    buffer_load_dwordx4 v2, s[24:27], s46 offen  lds
    ds_read_b64_tr_b16 v[204:205], v14 offset:36864
    ds_read_b64_tr_b16 v[206:207], v14 offset:37376
    ds_read_b128 v[144:147], v8 offset:0
    s_add_u32 m0, s48, 102400
    ds_read_b128 v[148:151], v8 offset:2048
    buffer_load_dwordx4 v3, s[24:27], s46 offen  lds
    ds_read_b128 v[152:155], v8 offset:4096
    ds_read_b128 v[156:159], v8 offset:6144
    ds_read_b128 v[188:191], v9 offset:0
    s_add_u32 m0, s48, 106368
    ds_read_b128 v[192:195], v9 offset:2048
    buffer_load_dwordx4 v2, s[24:27], s46 offen offset:128  lds
    ds_read_b128 v[196:199], v9 offset:4096
    ds_read_b128 v[200:203], v9 offset:6144
    ds_read_b64_tr_b16 v[164:165], v10 offset:32768
    s_add_u32 m0, s48, 110464
    ds_read_b64_tr_b16 v[166:167], v10 offset:33280
    buffer_load_dwordx4 v3, s[24:27], s46 offen offset:128  lds
    ds_read_b64_tr_b16 v[208:209], v10 offset:36864
    ds_read_b64_tr_b16 v[210:211], v10 offset:37376
    ds_read_b64_tr_b16 v[168:169], v11 offset:32768
    s_add_u32 m0, s48, 114432
    ds_read_b64_tr_b16 v[170:171], v11 offset:33280
    buffer_load_dwordx4 v2, s[24:27], s46 offen offset:256  lds
    ds_read_b64_tr_b16 v[212:213], v11 offset:36864
    ds_read_b64_tr_b16 v[214:215], v11 offset:37376
    ds_read_b64_tr_b16 v[172:173], v12 offset:32768
    s_add_u32 m0, s48, 118528
    ds_read_b64_tr_b16 v[174:175], v12 offset:33280
    buffer_load_dwordx4 v3, s[24:27], s46 offen offset:256  lds
    ds_read_b64_tr_b16 v[216:217], v12 offset:36864
    ds_read_b64_tr_b16 v[218:219], v12 offset:37376
    ds_read_b64_tr_b16 v[176:177], v13 offset:32768
    s_add_u32 m0, s48, 122496
    ds_read_b64_tr_b16 v[178:179], v13 offset:33280
    buffer_load_dwordx4 v2, s[24:27], s46 offen offset:384  lds
    ds_read_b64_tr_b16 v[220:221], v13 offset:36864
    ds_read_b64_tr_b16 v[222:223], v13 offset:37376
    ds_read_b64_tr_b16 v[180:181], v10 offset:40960
    s_add_u32 m0, s48, 126592
    ds_read_b64_tr_b16 v[182:183], v10 offset:41472
    buffer_load_dwordx4 v3, s[24:27], s46 offen offset:384  lds
    ds_read_b64_tr_b16 v[224:225], v10 offset:45056
    ds_read_b64_tr_b16 v[226:227], v10 offset:45568
    ds_read_b64_tr_b16 v[184:185], v11 offset:40960
    ds_read_b64_tr_b16 v[186:187], v11 offset:41472
    ds_read_b64_tr_b16 v[228:229], v11 offset:45056
    ds_read_b64_tr_b16 v[230:231], v11 offset:45568
    s_add_u32 s47, s47, 1
    s_and_b32 s47, s47, 15
    s_mul_i32 s46, s47, 458752
    s_add_u32 s88, s88, 512
    s_addc_u32 s89, s89, 0
    s_waitcnt lgkmcnt(0)
    s_load_dword s90, s[88:89], 0
    s_load_dword s90, s[88:89], 64
    s_load_dword s90, s[88:89], 128
    s_load_dword s90, s[88:89], 192
    s_load_dword s90, s[88:89], 256
    s_load_dword s90, s[88:89], 320
    s_load_dword s90, s[88:89], 384
    s_load_dword s90, s[88:89], 448
    s_cmp_lg_u32 s86, 0
    s_cbranch_scc1 L_cs_3030
    s_cmp_lg_u32 s43, 0
    s_cbranch_scc1 L_cs_3031
    v_mfma_f32_16x16x32_bf16 v[20:23], v[16:19], v[160:163], v[20:23]
    v_mfma_f32_16x16x32_bf16 v[20:23], v[16:19], v[204:207], v[20:23]
    v_mfma_f32_16x16x32_bf16 v[24:27], v[16:19], v[176:179], v[24:27]
    v_mfma_f32_16x16x32_bf16 v[24:27], v[16:19], v[220:223], v[24:27]
    s_branch L_cs_3030
L_cs_3031:
    s_cmp_lg_u32 s43, 1
    s_cbranch_scc1 L_cs_3032
    v_mfma_f32_16x16x32_bf16 v[20:23], v[16:19], v[164:167], v[20:23]
    v_mfma_f32_16x16x32_bf16 v[20:23], v[16:19], v[208:211], v[20:23]
    v_mfma_f32_16x16x32_bf16 v[24:27], v[16:19], v[180:183], v[24:27]
    v_mfma_f32_16x16x32_bf16 v[24:27], v[16:19], v[224:227], v[24:27]
    s_branch L_cs_3030
L_cs_3032:
    s_cmp_lg_u32 s43, 2
    s_cbranch_scc1 L_cs_3033
    v_mfma_f32_16x16x32_bf16 v[20:23], v[16:19], v[168:171], v[20:23]
    v_mfma_f32_16x16x32_bf16 v[20:23], v[16:19], v[212:215], v[20:23]
    v_mfma_f32_16x16x32_bf16 v[24:27], v[16:19], v[184:187], v[24:27]
    v_mfma_f32_16x16x32_bf16 v[24:27], v[16:19], v[228:231], v[24:27]
    s_branch L_cs_3030
L_cs_3033:
    v_mfma_f32_16x16x32_bf16 v[20:23], v[16:19], v[172:175], v[20:23]
    v_mfma_f32_16x16x32_bf16 v[20:23], v[16:19], v[216:219], v[20:23]
L_cs_3030:
    s_sub_u32 s86, s86, 1
    s_call_b64 s[100:101], L_sub_c1_1
    s_lshl_b32 s50, s41, 1
    s_add_u32 s50, s50, s44
    s_lshl_b32 s50, s50, 3
    s_add_u32 s50, s50, s40
    s_lshl_b32 s50, s50, 9
    s_lshl_b32 s51, s43, 2
    s_add_u32 s50, s50, s51
    s_add_u32 s50, s50, 19070976
    v_lshlrev_b32 v15, 5, v1
    s_mov_b64 exec, 0xffff
    buffer_store_dword v20, v15, s[28:31], s50 offen sc1
    buffer_store_dword v24, v15, s[28:31], s50 offen offset:16 sc1
    s_mov_b64 exec, -1
    v_add_u32 v8, s80, v6
    v_xor_b32 v9, 64, v8
    s_add_u32 s80, s80, 32768
    s_cmp_ge_u32 s80, 98304
    s_cselect_b32 s80, 0, s80
    ds_read_b64_tr_b16 v[160:161], v14 offset:0
    s_add_u32 m0, s48, 131072
    ds_read_b64_tr_b16 v[162:163], v14 offset:512
    buffer_load_dwordx4 v2, s[24:27], s46 offen  lds
    ds_read_b64_tr_b16 v[204:205], v14 offset:4096
    ds_read_b64_tr_b16 v[206:207], v14 offset:4608
    ds_read_b128 v[144:147], v8 offset:0
    s_add_u32 m0, s48, 135168
    ds_read_b128 v[148:151], v8 offset:2048
    buffer_load_dwordx4 v3, s[24:27], s46 offen  lds
    ds_read_b128 v[152:155], v8 offset:4096
    ds_read_b128 v[156:159], v8 offset:6144
    ds_read_b128 v[188:191], v9 offset:0
    s_add_u32 m0, s48, 139136
    ds_read_b128 v[192:195], v9 offset:2048
    buffer_load_dwordx4 v2, s[24:27], s46 offen offset:128  lds
    ds_read_b128 v[196:199], v9 offset:4096
    ds_read_b128 v[200:203], v9 offset:6144
    ds_read_b64_tr_b16 v[164:165], v10 offset:0
    s_add_u32 m0, s48, 143232
    ds_read_b64_tr_b16 v[166:167], v10 offset:512
    buffer_load_dwordx4 v3, s[24:27], s46 offen offset:128  lds
    ds_read_b64_tr_b16 v[208:209], v10 offset:4096
    ds_read_b64_tr_b16 v[210:211], v10 offset:4608
    ds_read_b64_tr_b16 v[168:169], v11 offset:0
    s_add_u32 m0, s48, 147200
    ds_read_b64_tr_b16 v[170:171], v11 offset:512
    buffer_load_dwordx4 v2, s[24:27], s46 offen offset:256  lds
    ds_read_b64_tr_b16 v[212:213], v11 offset:4096
    ds_read_b64_tr_b16 v[214:215], v11 offset:4608
    ds_read_b64_tr_b16 v[172:173], v12 offset:0
    s_add_u32 m0, s48, 151296
    ds_read_b64_tr_b16 v[174:175], v12 offset:512
    buffer_load_dwordx4 v3, s[24:27], s46 offen offset:256  lds
    ds_read_b64_tr_b16 v[216:217], v12 offset:4096
    ds_read_b64_tr_b16 v[218:219], v12 offset:4608
    ds_read_b64_tr_b16 v[176:177], v13 offset:0
    s_add_u32 m0, s48, 155264
    ds_read_b64_tr_b16 v[178:179], v13 offset:512
    buffer_load_dwordx4 v2, s[24:27], s46 offen offset:384  lds
    ds_read_b64_tr_b16 v[220:221], v13 offset:4096
    ds_read_b64_tr_b16 v[222:223], v13 offset:4608
    ds_read_b64_tr_b16 v[180:181], v10 offset:8192
    s_add_u32 m0, s48, 159360
    ds_read_b64_tr_b16 v[182:183], v10 offset:8704
    buffer_load_dwordx4 v3, s[24:27], s46 offen offset:384  lds
    ds_read_b64_tr_b16 v[224:225], v10 offset:12288
    ds_read_b64_tr_b16 v[226:227], v10 offset:12800
    ds_read_b64_tr_b16 v[184:185], v11 offset:8192
    ds_read_b64_tr_b16 v[186:187], v11 offset:8704
    ds_read_b64_tr_b16 v[228:229], v11 offset:12288
    ds_read_b64_tr_b16 v[230:231], v11 offset:12800
    s_add_u32 s47, s47, 1
    s_and_b32 s47, s47, 15
    s_mul_i32 s46, s47, 458752
    s_add_u32 s88, s88, 512
    s_addc_u32 s89, s89, 0
    s_waitcnt lgkmcnt(0)
    s_load_dword s90, s[88:89], 0
    s_load_dword s90, s[88:89], 64
    s_load_dword s90, s[88:89], 128
    s_load_dword s90, s[88:89], 192
    s_load_dword s90, s[88:89], 256
    s_load_dword s90, s[88:89], 320
    s_load_dword s90, s[88:89], 384
    s_load_dword s90, s[88:89], 448
    s_call_b64 s[100:101], L_sub_c1_1
    v_add_u32 v8, s80, v6
    v_xor_b32 v9, 64, v8
    s_add_u32 s80, s80, 32768
    s_cmp_ge_u32 s80, 98304
    s_cselect_b32 s80, 0, s80
    ds_read_b64_tr_b16 v[160:161], v14 offset:32768
    s_add_u32 m0, s48, 98304
    ds_read_b64_tr_b16 v[162:163], v14 offset:33280
    buffer_load_dwordx4 v2, s[24:27], s46 offen  lds
    ds_read_b64_tr_b16 v[204:205], v14 offset:36864
    ds_read_b64_tr_b16 v[206:207], v14 offset:37376
    ds_read_b128 v[144:147], v8 offset:0
    s_add_u32 m0, s48, 102400
    ds_read_b128 v[148:151], v8 offset:2048
    buffer_load_dwordx4 v3, s[24:27], s46 offen  lds
    ds_read_b128 v[152:155], v8 offset:4096
    ds_read_b128 v[156:159], v8 offset:6144
    ds_read_b128 v[188:191], v9 offset:0
    s_add_u32 m0, s48, 106368
    ds_read_b128 v[192:195], v9 offset:2048
    buffer_load_dwordx4 v2, s[24:27], s46 offen offset:128  lds
    ds_read_b128 v[196:199], v9 offset:4096
    ds_read_b128 v[200:203], v9 offset:6144
    ds_read_b64_tr_b16 v[164:165], v10 offset:32768
    s_add_u32 m0, s48, 110464
    ds_read_b64_tr_b16 v[166:167], v10 offset:33280
    buffer_load_dwordx4 v3, s[24:27], s46 offen offset:128  lds
    ds_read_b64_tr_b16 v[208:209], v10 offset:36864
    ds_read_b64_tr_b16 v[210:211], v10 offset:37376
    ds_read_b64_tr_b16 v[168:169], v11 offset:32768
    s_add_u32 m0, s48, 114432
    ds_read_b64_tr_b16 v[170:171], v11 offset:33280
    buffer_load_dwordx4 v2, s[24:27], s46 offen offset:256  lds
    ds_read_b64_tr_b16 v[212:213], v11 offset:36864
    ds_read_b64_tr_b16 v[214:215], v11 offset:37376
    ds_read_b64_tr_b16 v[172:173], v12 offset:32768
    s_add_u32 m0, s48, 118528
    ds_read_b64_tr_b16 v[174:175], v12 offset:33280
    buffer_load_dwordx4 v3, s[24:27], s46 offen offset:256  lds
    ds_read_b64_tr_b16 v[216:217], v12 offset:36864
    ds_read_b64_tr_b16 v[218:219], v12 offset:37376
    ds_read_b64_tr_b16 v[176:177], v13 offset:32768
    s_add_u32 m0, s48, 122496
    ds_read_b64_tr_b16 v[178:179], v13 offset:33280
    buffer_load_dwordx4 v2, s[24:27], s46 offen offset:384  lds
    ds_read_b64_tr_b16 v[220:221], v13 offset:36864
    ds_read_b64_tr_b16 v[222:223], v13 offset:37376
    ds_read_b64_tr_b16 v[180:181], v10 offset:40960
    s_add_u32 m0, s48, 126592
    ds_read_b64_tr_b16 v[182:183], v10 offset:41472
    buffer_load_dwordx4 v3, s[24:27], s46 offen offset:384  lds
    ds_read_b64_tr_b16 v[224:225], v10 offset:45056
    ds_read_b64_tr_b16 v[226:227], v10 offset:45568
    ds_read_b64_tr_b16 v[184:185], v11 offset:40960
    ds_read_b64_tr_b16 v[186:187], v11 offset:41472
    ds_read_b64_tr_b16 v[228:229], v11 offset:45056
    ds_read_b64_tr_b16 v[230:231], v11 offset:45568
    s_add_u32 s47, s47, 1
    s_and_b32 s47, s47, 15
    s_mul_i32 s46, s47, 458752
    s_add_u32 s88, s88, 512
    s_addc_u32 s89, s89, 0
    s_waitcnt lgkmcnt(0)
    s_load_dword s90, s[88:89], 0
    s_load_dword s90, s[88:89], 64
    s_load_dword s90, s[88:89], 128
    s_load_dword s90, s[88:89], 192
    s_load_dword s90, s[88:89], 256
    s_load_dword s90, s[88:89], 320
    s_load_dword s90, s[88:89], 384
    s_load_dword s90, s[88:89], 448
    s_call_b64 s[100:101], L_sub_c1_1
    v_add_u32 v8, s80, v6
    v_xor_b32 v9, 64, v8
    s_add_u32 s80, s80, 32768
    s_cmp_ge_u32 s80, 98304
    s_cselect_b32 s80, 0, s80
    ds_read_b64_tr_b16 v[160:161], v14 offset:0
    s_add_u32 m0, s48, 131072
    ds_read_b64_tr_b16 v[162:163], v14 offset:512
    buffer_load_dwordx4 v2, s[24:27], s46 offen  lds
    ds_read_b64_tr_b16 v[204:205], v14 offset:4096
    ds_read_b64_tr_b16 v[206:207], v14 offset:4608
    ds_read_b128 v[144:147], v8 offset:0
    s_add_u32 m0, s48, 135168
    ds_read_b128 v[148:151], v8 offset:2048
    buffer_load_dwordx4 v3, s[24:27], s46 offen  lds
    ds_read_b128 v[152:155], v8 offset:4096
    ds_read_b128 v[156:159], v8 offset:6144
    ds_read_b128 v[188:191], v9 offset:0
    s_add_u32 m0, s48, 139136
    ds_read_b128 v[192:195], v9 offset:2048
    buffer_load_dwordx4 v2, s[24:27], s46 offen offset:128  lds
    ds_read_b128 v[196:199], v9 offset:4096
    ds_read_b128 v[200:203], v9 offset:6144
    ds_read_b64_tr_b16 v[164:165], v10 offset:0
    s_add_u32 m0, s48, 143232
    ds_read_b64_tr_b16 v[166:167], v10 offset:512
    buffer_load_dwordx4 v3, s[24:27], s46 offen offset:128  lds
    ds_read_b64_tr_b16 v[208:209], v10 offset:4096
    ds_read_b64_tr_b16 v[210:211], v10 offset:4608
    ds_read_b64_tr_b16 v[168:169], v11 offset:0
    s_add_u32 m0, s48, 147200
    ds_read_b64_tr_b16 v[170:171], v11 offset:512
    buffer_load_dwordx4 v2, s[24:27], s46 offen offset:256  lds
    ds_read_b64_tr_b16 v[212:213], v11 offset:4096
    ds_read_b64_tr_b16 v[214:215], v11 offset:4608
    ds_read_b64_tr_b16 v[172:173], v12 offset:0
    s_add_u32 m0, s48, 151296
    ds_read_b64_tr_b16 v[174:175], v12 offset:512
    buffer_load_dwordx4 v3, s[24:27], s46 offen offset:256  lds
    ds_read_b64_tr_b16 v[216:217], v12 offset:4096
    ds_read_b64_tr_b16 v[218:219], v12 offset:4608
    ds_read_b64_tr_b16 v[176:177], v13 offset:0
    s_add_u32 m0, s48, 155264
    ds_read_b64_tr_b16 v[178:179], v13 offset:512
    buffer_load_dwordx4 v2, s[24:27], s46 offen offset:384  lds
    ds_read_b64_tr_b16 v[220:221], v13 offset:4096
    ds_read_b64_tr_b16 v[222:223], v13 offset:4608
    ds_read_b64_tr_b16 v[180:181], v10 offset:8192
    s_add_u32 m0, s48, 159360
    ds_read_b64_tr_b16 v[182:183], v10 offset:8704
    buffer_load_dwordx4 v3, s[24:27], s46 offen offset:384  lds
    ds_read_b64_tr_b16 v[224:225], v10 offset:12288
    ds_read_b64_tr_b16 v[226:227], v10 offset:12800
    ds_read_b64_tr_b16 v[184:185], v11 offset:8192
    ds_read_b64_tr_b16 v[186:187], v11 offset:8704
    ds_read_b64_tr_b16 v[228:229], v11 offset:12288
    ds_read_b64_tr_b16 v[230:231], v11 offset:12800
    s_add_u32 s47, s47, 1
    s_and_b32 s47, s47, 15
    s_mul_i32 s46, s47, 458752
    s_add_u32 s88, s88, 512
    s_addc_u32 s89, s89, 0
    v_lshrrev_b32 v15, 4, v1
    v_cmp_eq_u32 vcc, 0, v15
    v_add_u32 v15, -1, v15
    v_and_b32 v7, 15, v1
    v_lshlrev_b32 v7, 1, v7
    v_lshl_add_u32 v0, v15, 5, v7
    v_add_u32 v7, 192, v7
    s_mul_i32 s51, s41, 448
    v_cndmask_b32 v7, v0, v7, vcc
    v_add_u32 v0, 128, v0
    buffer_load_ushort v30, v7, s[36:39], s51 offen
    buffer_load_ushort v31, v0, s[36:39], s51 offen
    s_waitcnt lgkmcnt(0)
    s_load_dword s90, s[88:89], 0
    s_load_dword s90, s[88:89], 64
    s_load_dword s90, s[88:89], 128
    s_load_dword s90, s[88:89], 192
    s_load_dword s90, s[88:89], 256
    s_load_dword s90, s[88:89], 320
    s_load_dword s90, s[88:89], 384
    s_load_dword s90, s[88:89], 448
    s_call_b64 s[100:101], L_sub_c1_1
    v_add_u32 v8, s80, v6
    v_xor_b32 v9, 64, v8
    s_add_u32 s80, s80, 32768
    s_cmp_ge_u32 s80, 98304
    s_cselect_b32 s80, 0, s80
    ds_read_b64_tr_b16 v[160:161], v14 offset:32768
    s_add_u32 m0, s48, 98304
    ds_read_b64_tr_b16 v[162:163], v14 offset:33280
    buffer_load_dwordx4 v2, s[24:27], s46 offen  lds
    ds_read_b64_tr_b16 v[204:205], v14 offset:36864
    ds_read_b64_tr_b16 v[206:207], v14 offset:37376
    ds_read_b128 v[144:147], v8 offset:0
    s_add_u32 m0, s48, 102400
    ds_read_b128 v[148:151], v8 offset:2048
    buffer_load_dwordx4 v3, s[24:27], s46 offen  lds
    ds_read_b128 v[152:155], v8 offset:4096
    ds_read_b128 v[156:159], v8 offset:6144
    ds_read_b128 v[188:191], v9 offset:0
    s_add_u32 m0, s48, 106368
    ds_read_b128 v[192:195], v9 offset:2048
    buffer_load_dwordx4 v2, s[24:27], s46 offen offset:128  lds
    ds_read_b128 v[196:199], v9 offset:4096
    ds_read_b128 v[200:203], v9 offset:6144
    ds_read_b64_tr_b16 v[164:165], v10 offset:32768
    s_add_u32 m0, s48, 110464
    ds_read_b64_tr_b16 v[166:167], v10 offset:33280
    buffer_load_dwordx4 v3, s[24:27], s46 offen offset:128  lds
    ds_read_b64_tr_b16 v[208:209], v10 offset:36864
    ds_read_b64_tr_b16 v[210:211], v10 offset:37376
    ds_read_b64_tr_b16 v[168:169], v11 offset:32768
    s_add_u32 m0, s48, 114432
    ds_read_b64_tr_b16 v[170:171], v11 offset:33280
    buffer_load_dwordx4 v2, s[24:27], s46 offen offset:256  lds
    ds_read_b64_tr_b16 v[212:213], v11 offset:36864
    ds_read_b64_tr_b16 v[214:215], v11 offset:37376
    ds_read_b64_tr_b16 v[172:173], v12 offset:32768
    s_add_u32 m0, s48, 118528
    ds_read_b64_tr_b16 v[174:175], v12 offset:33280
    buffer_load_dwordx4 v3, s[24:27], s46 offen offset:256  lds
    ds_read_b64_tr_b16 v[216:217], v12 offset:36864
    ds_read_b64_tr_b16 v[218:219], v12 offset:37376
    ds_read_b64_tr_b16 v[176:177], v13 offset:32768
    s_add_u32 m0, s48, 122496
    ds_read_b64_tr_b16 v[178:179], v13 offset:33280
    buffer_load_dwordx4 v2, s[24:27], s46 offen offset:384  lds
    ds_read_b64_tr_b16 v[220:221], v13 offset:36864
    ds_read_b64_tr_b16 v[222:223], v13 offset:37376
    ds_read_b64_tr_b16 v[180:181], v10 offset:40960
    s_add_u32 m0, s48, 126592
    ds_read_b64_tr_b16 v[182:183], v10 offset:41472
    buffer_load_dwordx4 v3, s[24:27], s46 offen offset:384  lds
    ds_read_b64_tr_b16 v[224:225], v10 offset:45056
    ds_read_b64_tr_b16 v[226:227], v10 offset:45568
    ds_read_b64_tr_b16 v[184:185], v11 offset:40960
    ds_read_b64_tr_b16 v[186:187], v11 offset:41472
    ds_read_b64_tr_b16 v[228:229], v11 offset:45056
    ds_read_b64_tr_b16 v[230:231], v11 offset:45568
    s_add_u32 s47, s47, 1
    s_and_b32 s47, s47, 15
    s_mul_i32 s46, s47, 458752
    s_add_u32 s88, s88, 512
    s_addc_u32 s89, s89, 0
    v_lshlrev_b32 v29, 2, v1
    s_cmp_lg_u32 s43, 0
    s_cbranch_scc1 L_skip_3034
    buffer_load_dword v28, v29, s[32:35], 0 offen sc1
L_skip_3034:
    s_waitcnt lgkmcnt(0)
    s_load_dword s90, s[88:89], 0
    s_load_dword s90, s[88:89], 64
    s_load_dword s90, s[88:89], 128
    s_load_dword s90, s[88:89], 192
    s_load_dword s90, s[88:89], 256
    s_load_dword s90, s[88:89], 320
    s_load_dword s90, s[88:89], 384
    s_load_dword s90, s[88:89], 448
    s_call_b64 s[100:101], L_sub_c1_1
    v_add_u32 v8, s80, v6
    v_xor_b32 v9, 64, v8
    s_add_u32 s80, s80, 32768
    s_cmp_ge_u32 s80, 98304
    s_cselect_b32 s80, 0, s80
    ds_read_b64_tr_b16 v[160:161], v14 offset:0
    s_add_u32 m0, s48, 131072
    ds_read_b64_tr_b16 v[162:163], v14 offset:512
    buffer_load_dwordx4 v2, s[24:27], s46 offen  lds
    ds_read_b64_tr_b16 v[204:205], v14 offset:4096
    ds_read_b64_tr_b16 v[206:207], v14 offset:4608
    ds_read_b128 v[144:147], v8 offset:0
    s_add_u32 m0, s48, 135168
    ds_read_b128 v[148:151], v8 offset:2048
    buffer_load_dwordx4 v3, s[24:27], s46 offen  lds
    ds_read_b128 v[152:155], v8 offset:4096
    ds_read_b128 v[156:159], v8 offset:6144
    ds_read_b128 v[188:191], v9 offset:0
    s_add_u32 m0, s48, 139136
    ds_read_b128 v[192:195], v9 offset:2048
    buffer_load_dwordx4 v2, s[24:27], s46 offen offset:128  lds
    ds_read_b128 v[196:199], v9 offset:4096
    ds_read_b128 v[200:203], v9 offset:6144
    ds_read_b64_tr_b16 v[164:165], v10 offset:0
    s_add_u32 m0, s48, 143232
    ds_read_b64_tr_b16 v[166:167], v10 offset:512
    buffer_load_dwordx4 v3, s[24:27], s46 offen offset:128  lds
    ds_read_b64_tr_b16 v[208:209], v10 offset:4096
    ds_read_b64_tr_b16 v[210:211], v10 offset:4608
    ds_read_b64_tr_b16 v[168:169], v11 offset:0
    s_add_u32 m0, s48, 147200
    ds_read_b64_tr_b16 v[170:171], v11 offset:512
    buffer_load_dwordx4 v2, s[24:27], s46 offen offset:256  lds
    ds_read_b64_tr_b16 v[212:213], v11 offset:4096
    ds_read_b64_tr_b16 v[214:215], v11 offset:4608
    ds_read_b64_tr_b16 v[172:173], v12 offset:0
    s_add_u32 m0, s48, 151296
    ds_read_b64_tr_b16 v[174:175], v12 offset:512
    buffer_load_dwordx4 v3, s[24:27], s46 offen offset:256  lds
    ds_read_b64_tr_b16 v[216:217], v12 offset:4096
    ds_read_b64_tr_b16 v[218:219], v12 offset:4608
    ds_read_b64_tr_b16 v[176:177], v13 offset:0
    s_add_u32 m0, s48, 155264
    ds_read_b64_tr_b16 v[178:179], v13 offset:512
    buffer_load_dwordx4 v2, s[24:27], s46 offen offset:384  lds
    ds_read_b64_tr_b16 v[220:221], v13 offset:4096
    ds_read_b64_tr_b16 v[222:223], v13 offset:4608
    ds_read_b64_tr_b16 v[180:181], v10 offset:8192
    s_add_u32 m0, s48, 159360
    ds_read_b64_tr_b16 v[182:183], v10 offset:8704
    buffer_load_dwordx4 v3, s[24:27], s46 offen offset:384  lds
    ds_read_b64_tr_b16 v[224:225], v10 offset:12288
    ds_read_b64_tr_b16 v[226:227], v10 offset:12800
    ds_read_b64_tr_b16 v[184:185], v11 offset:8192
    ds_read_b64_tr_b16 v[186:187], v11 offset:8704
    ds_read_b64_tr_b16 v[228:229], v11 offset:12288
    ds_read_b64_tr_b16 v[230:231], v11 offset:12800
    s_add_u32 s47, s47, 1
    s_and_b32 s47, s47, 15
    s_mul_i32 s46, s47, 458752
    s_add_u32 s88, s88, 512
    s_addc_u32 s89, s89, 0
    s_cmp_lg_u32 s43, 0
    s_cbranch_scc1 L_skip_3035
    v_mov_b32 v15, 0x01010101
    s_mov_b32 s63, 0x20000
L_poll_3036:
    v_and_b32 v28, v28, v15
    v_cmp_ne_u32 vcc, v28, v15
    s_nop 0
    s_cmp_eq_u64 vcc, 0
    s_cbranch_scc1 L_go_3037
    s_sleep 8
    buffer_load_dword v28, v29, s[32:35], 0 offen sc1
    s_waitcnt vmcnt(0)
    s_sub_u32 s63, s63, 1
    s_cmp_lg_u32 s63, 0
    s_cbranch_scc1 L_poll_3036
L_go_3037:
L_skip_3035:
    s_waitcnt lgkmcnt(0)
    s_load_dword s90, s[88:89], 0
    s_load_dword s90, s[88:89], 64
    s_load_dword s90, s[88:89], 128
    s_load_dword s90, s[88:89], 192
    s_load_dword s90, s[88:89], 256
    s_load_dword s90, s[88:89], 320
    s_load_dword s90, s[88:89], 384
    s_load_dword s90, s[88:89], 448
    s_call_b64 s[100:101], L_sub_c1_1
    v_add_u32 v8, s80, v6
    v_xor_b32 v9, 64, v8
    s_add_u32 s80, s80, 32768
    s_cmp_ge_u32 s80, 98304
    s_cselect_b32 s80, 0, s80
    ds_read_b64_tr_b16 v[160:161], v14 offset:32768
    s_add_u32 m0, s48, 98304
    ds_read_b64_tr_b16 v[162:163], v14 offset:33280
    buffer_load_dwordx4 v2, s[24:27], s46 offen  lds
    ds_read_b64_tr_b16 v[204:205], v14 offset:36864
    ds_read_b64_tr_b16 v[206:207], v14 offset:37376
    ds_read_b128 v[144:147], v8 offset:0
    s_add_u32 m0, s48, 102400
    ds_read_b128 v[148:151], v8 offset:2048
    buffer_load_dwordx4 v3, s[24:27], s46 offen  lds
    ds_read_b128 v[152:155], v8 offset:4096
    ds_read_b128 v[156:159], v8 offset:6144
    ds_read_b128 v[188:191], v9 offset:0
    s_add_u32 m0, s48, 106368
    ds_read_b128 v[192:195], v9 offset:2048
    buffer_load_dwordx4 v2, s[24:27], s46 offen offset:128  lds
    ds_read_b128 v[196:199], v9 offset:4096
    ds_read_b128 v[200:203], v9 offset:6144
    ds_read_b64_tr_b16 v[164:165], v10 offset:32768
    s_add_u32 m0, s48, 110464
    ds_read_b64_tr_b16 v[166:167], v10 offset:33280
    buffer_load_dwordx4 v3, s[24:27], s46 offen offset:128  lds
    ds_read_b64_tr_b16 v[208:209], v10 offset:36864
    ds_read_b64_tr_b16 v[210:211], v10 offset:37376
    ds_read_b64_tr_b16 v[168:169], v11 offset:32768
    s_add_u32 m0, s48, 114432
    ds_read_b64_tr_b16 v[170:171], v11 offset:33280
    buffer_load_dwordx4 v2, s[24:27], s46 offen offset:256  lds
    ds_read_b64_tr_b16 v[212:213], v11 offset:36864
    ds_read_b64_tr_b16 v[214:215], v11 offset:37376
    ds_read_b64_tr_b16 v[172:173], v12 offset:32768
    s_add_u32 m0, s48, 118528
    ds_read_b64_tr_b16 v[174:175], v12 offset:33280
    buffer_load_dwordx4 v3, s[24:27], s46 offen offset:256  lds
    ds_read_b64_tr_b16 v[216:217], v12 offset:36864
    ds_read_b64_tr_b16 v[218:219], v12 offset:37376
    ds_read_b64_tr_b16 v[176:177], v13 offset:32768
    s_add_u32 m0, s48, 122496
    ds_read_b64_tr_b16 v[178:179], v13 offset:33280
    buffer_load_dwordx4 v2, s[24:27], s46 offen offset:384  lds
    ds_read_b64_tr_b16 v[220:221], v13 offset:36864
    ds_read_b64_tr_b16 v[222:223], v13 offset:37376
    ds_read_b64_tr_b16 v[180:181], v10 offset:40960
    s_add_u32 m0, s48, 126592
    ds_read_b64_tr_b16 v[182:183], v10 offset:41472
    buffer_load_dwordx4 v3, s[24:27], s46 offen offset:384  lds
    ds_read_b64_tr_b16 v[224:225], v10 offset:45056
    ds_read_b64_tr_b16 v[226:227], v10 offset:45568
    ds_read_b64_tr_b16 v[184:185], v11 offset:40960
    ds_read_b64_tr_b16 v[186:187], v11 offset:41472
    ds_read_b64_tr_b16 v[228:229], v11 offset:45056
    ds_read_b64_tr_b16 v[230:231], v11 offset:45568
    s_add_u32 s47, s47, 1
    s_and_b32 s47, s47, 15
    s_mul_i32 s46, s47, 458752
    s_mov_b64 s[88:89], s[92:93]
    v_and_b32 v7, 15, v1
    v_lshrrev_b32 v0, 4, v1
    v_lshlrev_b32 v0, 10, v0
    v_lshl_add_u32 v0, v7, 5, v0
    v_lshlrev_b32 v7, 4, v7
    s_lshl_b32 s50, s40, 2
    s_add_u32 s50, s50, s43
    s_lshl_b32 s50, s50, 10
    s_add_u32 s94, s50, 18874368
    s_lshl_b32 s95, s41, 13
    s_add_u32 s95, s95, 19070976
    buffer_load_dwordx4 v[232:235], v7, s[28:31], s94 offen offset:0 sc1
    buffer_load_dwordx4 v[236:239], v7, s[28:31], s94 offen offset:256 sc1
    buffer_load_dwordx4 v[240:243], v7, s[28:31], s94 offen offset:512 sc1
    buffer_load_dwordx4 v[244:247], v7, s[28:31], s94 offen offset:768 sc1
    s_waitcnt lgkmcnt(0)
    s_load_dword s90, s[88:89], 0
    s_load_dword s90, s[88:89], 64
    s_load_dword s90, s[88:89], 128
    s_load_dword s90, s[88:89], 192
    s_load_dword s90, s[88:89], 256
    s_load_dword s90, s[88:89], 320
    s_load_dword s90, s[88:89], 384
    s_load_dword s90, s[88:89], 448
    s_call_b64 s[100:101], L_sub_c1_1
    v_add_u32 v8, s80, v6
    v_xor_b32 v9, 64, v8
    s_add_u32 s80, s80, 32768
    s_cmp_ge_u32 s80, 98304
    s_cselect_b32 s80, 0, s80
    ds_read_b64_tr_b16 v[160:161], v14 offset:0
    s_add_u32 m0, s48, 131072
    ds_read_b64_tr_b16 v[162:163], v14 offset:512
    buffer_load_dwordx4 v2, s[24:27], s46 offen  lds
    ds_read_b64_tr_b16 v[204:205], v14 offset:4096
    ds_read_b64_tr_b16 v[206:207], v14 offset:4608
    ds_read_b128 v[144:147], v8 offset:0
    s_add_u32 m0, s48, 135168
    ds_read_b128 v[148:151], v8 offset:2048
    buffer_load_dwordx4 v3, s[24:27], s46 offen  lds
    ds_read_b128 v[152:155], v8 offset:4096
    ds_read_b128 v[156:159], v8 offset:6144
    ds_read_b128 v[188:191], v9 offset:0
    s_add_u32 m0, s48, 139136
    ds_read_b128 v[192:195], v9 offset:2048
    buffer_load_dwordx4 v2, s[24:27], s46 offen offset:128  lds
    ds_read_b128 v[196:199], v9 offset:4096
    ds_read_b128 v[200:203], v9 offset:6144
    ds_read_b64_tr_b16 v[164:165], v10 offset:0
    s_add_u32 m0, s48, 143232
    ds_read_b64_tr_b16 v[166:167], v10 offset:512
    buffer_load_dwordx4 v3, s[24:27], s46 offen offset:128  lds
    ds_read_b64_tr_b16 v[208:209], v10 offset:4096
    ds_read_b64_tr_b16 v[210:211], v10 offset:4608
    ds_read_b64_tr_b16 v[168:169], v11 offset:0
    s_add_u32 m0, s48, 147200
    ds_read_b64_tr_b16 v[170:171], v11 offset:512
    buffer_load_dwordx4 v2, s[24:27], s46 offen offset:256  lds
    ds_read_b64_tr_b16 v[212:213], v11 offset:4096
    ds_read_b64_tr_b16 v[214:215], v11 offset:4608
    ds_read_b64_tr_b16 v[172:173], v12 offset:0
    s_add_u32 m0, s48, 151296
    ds_read_b64_tr_b16 v[174:175], v12 offset:512
    buffer_load_dwordx4 v3, s[24:27], s46 offen offset:256  lds
    ds_read_b64_tr_b16 v[216:217], v12 offset:4096
    ds_read_b64_tr_b16 v[218:219], v12 offset:4608
    ds_read_b64_tr_b16 v[176:177], v13 offset:0
    s_add_u32 m0, s48, 155264
    ds_read_b64_tr_b16 v[178:179], v13 offset:512
    buffer_load_dwordx4 v2, s[24:27], s46 offen offset:384  lds
    ds_read_b64_tr_b16 v[220:221], v13 offset:4096
    ds_read_b64_tr_b16 v[222:223], v13 offset:4608
    ds_read_b64_tr_b16 v[180:181], v10 offset:8192
    s_add_u32 m0, s48, 159360
    ds_read_b64_tr_b16 v[182:183], v10 offset:8704
    buffer_load_dwordx4 v3, s[24:27], s46 offen offset:384  lds
    ds_read_b64_tr_b16 v[224:225], v10 offset:12288
    ds_read_b64_tr_b16 v[226:227], v10 offset:12800
    ds_read_b64_tr_b16 v[184:185], v11 offset:8192
    ds_read_b64_tr_b16 v[186:187], v11 offset:8704
    ds_read_b64_tr_b16 v[228:229], v11 offset:12288
    ds_read_b64_tr_b16 v[230:231], v11 offset:12800
    s_add_u32 s47, s47, 1
    s_and_b32 s47, s47, 15
    s_mul_i32 s46, s47, 458752
    s_add_u32 s88, s88, 512
    s_addc_u32 s89, s89, 0
    buffer_load_dwordx4 v[20:23], v0, s[28:31], s95 offen offset:0 sc1
    buffer_load_dwordx4 v[24:27], v0, s[28:31], s95 offen offset:16 sc1
    buffer_load_dwordx4 v[248:251], v0, s[28:31], s95 offen offset:512 sc1
    buffer_load_dwordx4 v[252:255], v0, s[28:31], s95 offen offset:528 sc1
    s_waitcnt lgkmcnt(0)
    s_load_dword s90, s[88:89], 0
    s_load_dword s90, s[88:89], 64
    s_load_dword s90, s[88:89], 128
    s_load_dword s90, s[88:89], 192
    s_load_dword s90, s[88:89], 256
    s_load_dword s90, s[88:89], 320
    s_load_dword s90, s[88:89], 384
    s_load_dword s90, s[88:89], 448
    s_call_b64 s[100:101], L_sub_c1_1
    v_add_u32 v8, s80, v6
    v_xor_b32 v9, 64, v8
    s_add_u32 s80, s80, 32768
    s_cmp_ge_u32 s80, 98304
    s_cselect_b32 s80, 0, s80
    ds_read_b64_tr_b16 v[160:161], v14 offset:32768
    ds_read_b64_tr_b16 v[162:163], v14 offset:33280
    ds_read_b64_tr_b16 v[204:205], v14 offset:36864
    ds_read_b64_tr_b16 v[206:207], v14 offset:37376
    ds_read_b128 v[144:147], v8 offset:0
    ds_read_b128 v[148:151], v8 offset:2048
    ds_read_b128 v[152:155], v8 offset:4096
    ds_read_b128 v[156:159], v8 offset:6144
    ds_read_b128 v[188:191], v9 offset:0
    ds_read_b128 v[192:195], v9 offset:2048
    ds_read_b128 v[196:199], v9 offset:4096
    ds_read_b128 v[200:203], v9 offset:6144
    ds_read_b64_tr_b16 v[164:165], v10 offset:32768
    ds_read_b64_tr_b16 v[166:167], v10 offset:33280
    ds_read_b64_tr_b16 v[208:209], v10 offset:36864
    ds_read_b64_tr_b16 v[210:211], v10 offset:37376
    ds_read_b64_tr_b16 v[168:169], v11 offset:32768
    ds_read_b64_tr_b16 v[170:171], v11 offset:33280
    ds_read_b64_tr_b16 v[212:213], v11 offset:36864
    ds_read_b64_tr_b16 v[214:215], v11 offset:37376
    ds_read_b64_tr_b16 v[172:173], v12 offset:32768
    ds_read_b64_tr_b16 v[174:175], v12 offset:33280
    ds_read_b64_tr_b16 v[216:217], v12 offset:36864
    ds_read_b64_tr_b16 v[218:219], v12 offset:37376
    ds_read_b64_tr_b16 v[176:177], v13 offset:32768
    ds_read_b64_tr_b16 v[178:179], v13 offset:33280
    ds_read_b64_tr_b16 v[220:221], v13 offset:36864
    ds_read_b64_tr_b16 v[222:223], v13 offset:37376
    ds_read_b64_tr_b16 v[180:181], v10 offset:40960
    ds_read_b64_tr_b16 v[182:183], v10 offset:41472
    ds_read_b64_tr_b16 v[224:225], v10 offset:45056
    ds_read_b64_tr_b16 v[226:227], v10 offset:45568
    ds_read_b64_tr_b16 v[184:185], v11 offset:40960
    ds_read_b64_tr_b16 v[186:187], v11 offset:41472
    ds_read_b64_tr_b16 v[228:229], v11 offset:45056
    ds_read_b64_tr_b16 v[230:231], v11 offset:45568
    s_waitcnt lgkmcnt(0)
    s_call_b64 s[100:101], L_sub_c1_2
    s_mov_b32 s57, 0x3fb8aa3b
    s_mov_b32 s63, 0x20000
L_poll_3038:
    v_pk_add_f32 v[144:145], v[20:21], v[248:249]
    v_pk_add_f32 v[146:147], v[22:23], v[250:251]
    v_pk_add_f32 v[148:149], v[24:25], v[252:253]
    v_pk_add_f32 v[150:151], v[26:27], v[254:255]
    v_pk_add_f32 v[152:153], v[144:145], v[146:147]
    v_add_f32 v154, v235, v239
    v_add_f32 v155, v243, v247
    v_pk_add_f32 v[152:153], v[152:153], v[148:149]
    v_add_f32 v154, v154, v150
    v_pk_add_f32 v[152:153], v[152:153], v[154:155]
    v_cmp_u_f32 vcc, v152, v153
    s_nop 0
    s_cmp_eq_u64 vcc, 0
    s_cbranch_scc1 L_go_3039
    s_sleep 4
    buffer_load_dwordx4 v[20:23], v0, s[28:31], s95 offen offset:0 sc1
    buffer_load_dwordx4 v[24:27], v0, s[28:31], s95 offen offset:16 sc1
    buffer_load_dwordx4 v[248:251], v0, s[28:31], s95 offen offset:512 sc1
    buffer_load_dwordx4 v[252:255], v0, s[28:31], s95 offen offset:528 sc1
    buffer_load_dwordx4 v[232:235], v7, s[28:31], s94 offen offset:0 sc1
    buffer_load_dwordx4 v[236:239], v7, s[28:31], s94 offen offset:256 sc1
    buffer_load_dwordx4 v[240:243], v7, s[28:31], s94 offen offset:512 sc1
    buffer_load_dwordx4 v[244:247], v7, s[28:31], s94 offen offset:768 sc1
    s_waitcnt vmcnt(0)
    s_sub_u32 s63, s63, 1
    s_cmp_lg_u32 s63, 0
    s_cbranch_scc1 L_poll_3038
L_go_3039:
    v_mul_f32 v216, s57, v235
    v_mov_b32 v235, 0
    v_mul_f32 v218, s57, v239
    v_mov_b32 v239, 0
    v_mul_f32 v220, s57, v243
    v_mov_b32 v243, 0
    v_mul_f32 v222, s57, v247
    v_mov_b32 v247, 0
    s_mov_b32 vcc_lo, 0xffff
    s_mov_b32 vcc_hi, 0x0
    v_cvt_pk_bf16_f32 v160, v144, v144
    v_and_b32 v156, 0xffff0000, v160
    v_sub_f32 v144, v144, v156
    v_cndmask_b32 v162, 0, v30, vcc
    v_lshlrev_b32 v156, 16, v162
    v_cvt_pk_bf16_f32 v161, v144, v156
    v_mov_b32 v163, 0
    s_mov_b32 vcc_lo, 0xffff0000
    s_mov_b32 vcc_hi, 0x0
    v_cvt_pk_bf16_f32 v164, v145, v145
    v_and_b32 v157, 0xffff0000, v164
    v_sub_f32 v145, v145, v157
    v_cndmask_b32 v166, 0, v30, vcc
    v_lshlrev_b32 v157, 16, v166
    v_cvt_pk_bf16_f32 v165, v145, v157
    v_mov_b32 v167, 0
    s_mov_b32 vcc_lo, 0x0
    s_mov_b32 vcc_hi, 0xffff
    v_cvt_pk_bf16_f32 v168, v146, v146
    v_and_b32 v156, 0xffff0000, v168
    v_sub_f32 v146, v146, v156
    v_cndmask_b32 v170, 0, v30, vcc
    v_lshlrev_b32 v156, 16, v170
    v_cvt_pk_bf16_f32 v169, v146, v156
    v_mov_b32 v171, 0
    s_mov_b32 vcc_lo, 0x0
    s_mov_b32 vcc_hi, 0xffff0000
    v_cvt_pk_bf16_f32 v172, v147, v147
    v_and_b32 v157, 0xffff0000, v172
    v_sub_f32 v147, v147, v157
    v_cndmask_b32 v174, 0, v30, vcc
    v_lshlrev_b32 v157, 16, v174
    v_cvt_pk_bf16_f32 v173, v147, v157
    v_mov_b32 v175, 0
    s_mov_b32 vcc_lo, 0xffff
    s_mov_b32 vcc_hi, 0x0
    v_cvt_pk_bf16_f32 v176, v148, v148
    v_and_b32 v156, 0xffff0000, v176
    v_sub_f32 v148, v148, v156
    v_cndmask_b32 v178, 0, v31, vcc
    v_lshlrev_b32 v156, 16, v178
    v_cvt_pk_bf16_f32 v177, v148, v156
    v_mov_b32 v179, 0
    s_mov_b32 vcc_lo, 0xffff0000
    s_mov_b32 vcc_hi, 0x0
    v_cvt_pk_bf16_f32 v180, v149, v149
    v_and_b32 v157, 0xffff0000, v180
    v_sub_f32 v149, v149, v157
    v_cndmask_b32 v182, 0, v31, vcc
    v_lshlrev_b32 v157, 16, v182
    v_cvt_pk_bf16_f32 v181, v149, v157
    v_mov_b32 v183, 0
    s_mov_b32 vcc_lo, 0x0
    s_mov_b32 vcc_hi, 0xffff
    v_cvt_pk_bf16_f32 v184, v150, v150
    v_and_b32 v156, 0xffff0000, v184
    v_sub_f32 v150, v150, v156
    v_cndmask_b32 v186, 0, v31, vcc
    v_lshlrev_b32 v156, 16, v186
    v_cvt_pk_bf16_f32 v185, v150, v156
    v_mov_b32 v187, 0
    v_mfma_f32_16x16x32_bf16 v[32:35], v[160:163], v[232:235], v[32:35]
    v_mfma_f32_16x16x32_bf16 v[36:39], v[160:163], v[236:239], v[36:39]
    v_mfma_f32_16x16x32_bf16 v[40:43], v[160:163], v[240:243], v[40:43]
    v_mfma_f32_16x16x32_bf16 v[44:47], v[160:163], v[244:247], v[44:47]
    v_mfma_f32_16x16x32_bf16 v[48:51], v[164:167], v[232:235], v[48:51]
    v_mfma_f32_16x16x32_bf16 v[52:55], v[164:167], v[236:239], v[52:55]
    v_mfma_f32_16x16x32_bf16 v[56:59], v[164:167], v[240:243], v[56:59]
    v_mfma_f32_16x16x32_bf16 v[60:63], v[164:167], v[244:247], v[60:63]
    v_mfma_f32_16x16x32_bf16 v[64:67], v[168:171], v[232:235], v[64:67]
    v_mfma_f32_16x16x32_bf16 v[68:71], v[168:171], v[236:239], v[68:71]
    v_mfma_f32_16x16x32_bf16 v[72:75], v[168:171], v[240:243], v[72:75]
    v_mfma_f32_16x16x32_bf16 v[76:79], v[168:171], v[244:247], v[76:79]
    v_mfma_f32_16x16x32_bf16 v[80:83], v[172:175], v[232:235], v[80:83]
    v_mfma_f32_16x16x32_bf16 v[84:87], v[172:175], v[236:239], v[84:87]
    v_mfma_f32_16x16x32_bf16 v[88:91], v[172:175], v[240:243], v[88:91]
    v_mfma_f32_16x16x32_bf16 v[92:95], v[172:175], v[244:247], v[92:95]
    v_mfma_f32_16x16x32_bf16 v[96:99], v[176:179], v[232:235], v[96:99]
    v_mfma_f32_16x16x32_bf16 v[100:103], v[176:179], v[236:239], v[100:103]
    v_mfma_f32_16x16x32_bf16 v[104:107], v[176:179], v[240:243], v[104:107]
    v_mfma_f32_16x16x32_bf16 v[108:111], v[176:179], v[244:247], v[108:111]
    v_mfma_f32_16x16x32_bf16 v[112:115], v[180:183], v[232:235], v[112:115]
    v_mfma_f32_16x16x32_bf16 v[116:119], v[180:183], v[236:239], v[116:119]
    v_mfma_f32_16x16x32_bf16 v[120:123], v[180:183], v[240:243], v[120:123]
    v_mfma_f32_16x16x32_bf16 v[124:127], v[180:183], v[244:247], v[124:127]
    v_mfma_f32_16x16x32_bf16 v[128:131], v[184:187], v[232:235], v[128:131]
    v_mfma_f32_16x16x32_bf16 v[132:135], v[184:187], v[236:239], v[132:135]
    v_mfma_f32_16x16x32_bf16 v[136:139], v[184:187], v[240:243], v[136:139]
    v_mfma_f32_16x16x32_bf16 v[140:143], v[184:187], v[244:247], v[140:143]
    s_lshl_b32 s50, s40, 1
    s_lshr_b32 s51, s43, 1
    s_add_u32 s50, s50, s51
    s_mul_i32 s50, s50, 112
    s_mul_i32 s51, s41, 7
    s_add_u32 s50, s50, s51
    s_lshl_b32 s50, s50, 13
    s_and_b32 s51, s43, 1
    s_lshl_b32 s51, s51, 12
    s_add_u32 s50, s50, s51
    s_add_u32 s50, s50, 0
    s_lshl_b32 s52, s44, 3
    s_add_u32 s51, s50, s52
    s_add_u32 s51, s51, 24576
    s_lshl_b32 s52, s44, 15
    s_add_u32 s50, s50, s52
    v_lshlrev_b32 v15, 4, v1
    v_pk_mul_f32 v[144:145], v[32:33], v[216:217] op_sel_hi:[1,0]
    v_pk_mul_f32 v[146:147], v[34:35], v[216:217] op_sel_hi:[1,0]
    v_exp_f32 v144, v144
    v_exp_f32 v145, v145
    v_exp_f32 v146, v146
    v_exp_f32 v147, v147
    v_pk_fma_f32 v[152:153], v[144:145], -0.5, -1.0 op_sel_hi:[1,0,0]
    v_pk_fma_f32 v[154:155], v[146:147], -0.5, -1.0 op_sel_hi:[1,0,0]
    v_pk_fma_f32 v[144:145], v[144:145], v[152:153], -1.0 op_sel_hi:[1,1,0]
    v_pk_fma_f32 v[146:147], v[146:147], v[154:155], -1.0 op_sel_hi:[1,1,0]
    v_rcp_f32 v144, v144
    v_rcp_f32 v145, v145
    v_rcp_f32 v146, v146
    v_rcp_f32 v147, v147
    v_pk_fma_f32 v[144:145], v[144:145], v[32:33], v[32:33]
    v_pk_fma_f32 v[146:147], v[146:147], v[34:35], v[34:35]
    v_cvt_pk_bf16_f32 v176, v144, v145
    v_cvt_pk_bf16_f32 v177, v146, v147
    buffer_store_dwordx2 v[176:177], v15, s[28:31], s51 offen offset:0 sc1
    v_pk_mul_f32 v[160:161], v[36:37], v[218:219] op_sel_hi:[1,0]
    v_pk_mul_f32 v[162:163], v[38:39], v[218:219] op_sel_hi:[1,0]
    v_exp_f32 v160, v160
    v_exp_f32 v161, v161
    v_exp_f32 v162, v162
    v_exp_f32 v163, v163
    v_pk_fma_f32 v[168:169], v[160:161], -0.5, -1.0 op_sel_hi:[1,0,0]
    v_pk_fma_f32 v[170:171], v[162:163], -0.5, -1.0 op_sel_hi:[1,0,0]
    v_pk_fma_f32 v[160:161], v[160:161], v[168:169], -1.0 op_sel_hi:[1,1,0]
    v_pk_fma_f32 v[162:163], v[162:163], v[170:171], -1.0 op_sel_hi:[1,1,0]
    v_rcp_f32 v160, v160
    v_rcp_f32 v161, v161
    v_rcp_f32 v162, v162
    v_rcp_f32 v163, v163
    v_pk_fma_f32 v[160:161], v[160:161], v[36:37], v[36:37]
    v_pk_fma_f32 v[162:163], v[162:163], v[38:39], v[38:39]
    v_cvt_pk_bf16_f32 v180, v160, v161
    v_cvt_pk_bf16_f32 v181, v162, v163
    buffer_store_dwordx2 v[180:181], v15, s[28:31], s51 offen offset:1024 sc1
    v_pk_mul_f32 v[144:145], v[40:41], v[220:221] op_sel_hi:[1,0]
    v_pk_mul_f32 v[146:147], v[42:43], v[220:221] op_sel_hi:[1,0]
    v_exp_f32 v144, v144
    v_exp_f32 v145, v145
    v_exp_f32 v146, v146
    v_exp_f32 v147, v147
    v_pk_fma_f32 v[152:153], v[144:145], -0.5, -1.0 op_sel_hi:[1,0,0]
    v_pk_fma_f32 v[154:155], v[146:147], -0.5, -1.0 op_sel_hi:[1,0,0]
    v_pk_fma_f32 v[144:145], v[144:145], v[152:153], -1.0 op_sel_hi:[1,1,0]
    v_pk_fma_f32 v[146:147], v[146:147], v[154:155], -1.0 op_sel_hi:[1,1,0]
    v_rcp_f32 v144, v144
    v_rcp_f32 v145, v145
    v_rcp_f32 v146, v146
    v_rcp_f32 v147, v147
    v_pk_fma_f32 v[144:145], v[144:145], v[40:41], v[40:41]
    v_pk_fma_f32 v[146:147], v[146:147], v[42:43], v[42:43]
    v_cvt_pk_bf16_f32 v184, v144, v145
    v_cvt_pk_bf16_f32 v185, v146, v147
    buffer_store_dwordx2 v[184:185], v15, s[28:31], s51 offen offset:2048 sc1
    v_pk_mul_f32 v[160:161], v[44:45], v[222:223] op_sel_hi:[1,0]
    v_pk_mul_f32 v[162:163], v[46:47], v[222:223] op_sel_hi:[1,0]
    v_exp_f32 v160, v160
    v_exp_f32 v161, v161
    v_exp_f32 v162, v162
    v_exp_f32 v163, v163
    v_pk_fma_f32 v[168:169], v[160:161], -0.5, -1.0 op_sel_hi:[1,0,0]
    v_pk_fma_f32 v[170:171], v[162:163], -0.5, -1.0 op_sel_hi:[1,0,0]
    v_pk_fma_f32 v[160:161], v[160:161], v[168:169], -1.0 op_sel_hi:[1,1,0]
    v_pk_fma_f32 v[162:163], v[162:163], v[170:171], -1.0 op_sel_hi:[1,1,0]
    v_rcp_f32 v160, v160
    v_rcp_f32 v161, v161
    v_rcp_f32 v162, v162
    v_rcp_f32 v163, v163
    v_pk_fma_f32 v[160:161], v[160:161], v[44:45], v[44:45]
    v_pk_fma_f32 v[162:163], v[162:163], v[46:47], v[46:47]
    v_cvt_pk_bf16_f32 v188, v160, v161
    v_cvt_pk_bf16_f32 v189, v162, v163
    buffer_store_dwordx2 v[188:189], v15, s[28:31], s51 offen offset:3072 sc1
    v_pk_mul_f32 v[144:145], v[48:49], v[216:217] op_sel_hi:[1,0]
    v_pk_mul_f32 v[146:147], v[50:51], v[216:217] op_sel_hi:[1,0]
    v_pk_mul_f32 v[148:149], v[64:65], v[216:217] op_sel_hi:[1,0]
    v_pk_mul_f32 v[150:151], v[66:67], v[216:217] op_sel_hi:[1,0]
    v_exp_f32 v144, v144
    v_exp_f32 v145, v145
    v_exp_f32 v146, v146
    v_exp_f32 v147, v147
    v_exp_f32 v148, v148
    v_exp_f32 v149, v149
    v_exp_f32 v150, v150
    v_exp_f32 v151, v151
    v_pk_fma_f32 v[152:153], v[144:145], -0.5, -1.0 op_sel_hi:[1,0,0]
    v_pk_fma_f32 v[154:155], v[146:147], -0.5, -1.0 op_sel_hi:[1,0,0]
    v_pk_fma_f32 v[156:157], v[148:149], -0.5, -1.0 op_sel_hi:[1,0,0]
    v_pk_fma_f32 v[158:159], v[150:151], -0.5, -1.0 op_sel_hi:[1,0,0]
    v_pk_fma_f32 v[144:145], v[144:145], v[152:153], -1.0 op_sel_hi:[1,1,0]
    v_pk_fma_f32 v[146:147], v[146:147], v[154:155], -1.0 op_sel_hi:[1,1,0]
    v_pk_fma_f32 v[148:149], v[148:149], v[156:157], -1.0 op_sel_hi:[1,1,0]
    v_pk_fma_f32 v[150:151], v[150:151], v[158:159], -1.0 op_sel_hi:[1,1,0]
    v_rcp_f32 v144, v144
    v_rcp_f32 v145, v145
    v_rcp_f32 v146, v146
    v_rcp_f32 v147, v147
    v_rcp_f32 v148, v148
    v_rcp_f32 v149, v149
    v_rcp_f32 v150, v150
    v_rcp_f32 v151, v151
    v_pk_fma_f32 v[144:145], v[144:145], v[48:49], v[48:49]
    v_pk_fma_f32 v[146:147], v[146:147], v[50:51], v[50:51]
    v_pk_fma_f32 v[148:149], v[148:149], v[64:65], v[64:65]
    v_pk_fma_f32 v[150:151], v[150:151], v[66:67], v[66:67]
    v_cvt_pk_bf16_f32 v176, v144, v145
    v_cvt_pk_bf16_f32 v177, v146, v147
    v_cvt_pk_bf16_f32 v178, v148, v149
    v_cvt_pk_bf16_f32 v179, v150, v151
    buffer_store_dwordx4 v[176:179], v15, s[28:31], s50 offen offset:0 sc1
    v_pk_mul_f32 v[160:161], v[52:53], v[218:219] op_sel_hi:[1,0]
    v_pk_mul_f32 v[162:163], v[54:55], v[218:219] op_sel_hi:[1,0]
    v_pk_mul_f32 v[164:165], v[68:69], v[218:219] op_sel_hi:[1,0]
    v_pk_mul_f32 v[166:167], v[70:71], v[218:219] op_sel_hi:[1,0]
    v_exp_f32 v160, v160
    v_exp_f32 v161, v161
    v_exp_f32 v162, v162
    v_exp_f32 v163, v163
    v_exp_f32 v164, v164
    v_exp_f32 v165, v165
    v_exp_f32 v166, v166
    v_exp_f32 v167, v167
    v_pk_fma_f32 v[168:169], v[160:161], -0.5, -1.0 op_sel_hi:[1,0,0]
    v_pk_fma_f32 v[170:171], v[162:163], -0.5, -1.0 op_sel_hi:[1,0,0]
    v_pk_fma_f32 v[172:173], v[164:165], -0.5, -1.0 op_sel_hi:[1,0,0]
    v_pk_fma_f32 v[174:175], v[166:167], -0.5, -1.0 op_sel_hi:[1,0,0]
    v_pk_fma_f32 v[160:161], v[160:161], v[168:169], -1.0 op_sel_hi:[1,1,0]
    v_pk_fma_f32 v[162:163], v[162:163], v[170:171], -1.0 op_sel_hi:[1,1,0]
    v_pk_fma_f32 v[164:165], v[164:165], v[172:173], -1.0 op_sel_hi:[1,1,0]
    v_pk_fma_f32 v[166:167], v[166:167], v[174:175], -1.0 op_sel_hi:[1,1,0]
    v_rcp_f32 v160, v160
    v_rcp_f32 v161, v161
    v_rcp_f32 v162, v162
    v_rcp_f32 v163, v163
    v_rcp_f32 v164, v164
    v_rcp_f32 v165, v165
    v_rcp_f32 v166, v166
    v_rcp_f32 v167, v167
    v_pk_fma_f32 v[160:161], v[160:161], v[52:53], v[52:53]
    v_pk_fma_f32 v[162:163], v[162:163], v[54:55], v[54:55]
    v_pk_fma_f32 v[164:165], v[164:165], v[68:69], v[68:69]
    v_pk_fma_f32 v[166:167], v[166:167], v[70:71], v[70:71]
    v_cvt_pk_bf16_f32 v180, v160, v161
    v_cvt_pk_bf16_f32 v181, v162, v163
    v_cvt_pk_bf16_f32 v182, v164, v165
    v_cvt_pk_bf16_f32 v183, v166, v167
    buffer_store_dwordx4 v[180:183], v15, s[28:31], s50 offen offset:1024 sc1
    v_pk_mul_f32 v[144:145], v[56:57], v[220:221] op_sel_hi:[1,0]
    v_pk_mul_f32 v[146:147], v[58:59], v[220:221] op_sel_hi:[1,0]
    v_pk_mul_f32 v[148:149], v[72:73], v[220:221] op_sel_hi:[1,0]
    v_pk_mul_f32 v[150:151], v[74:75], v[220:221] op_sel_hi:[1,0]
    v_exp_f32 v144, v144
    v_exp_f32 v145, v145
    v_exp_f32 v146, v146
    v_exp_f32 v147, v147
    v_exp_f32 v148, v148
    v_exp_f32 v149, v149
    v_exp_f32 v150, v150
    v_exp_f32 v151, v151
    v_pk_fma_f32 v[152:153], v[144:145], -0.5, -1.0 op_sel_hi:[1,0,0]
    v_pk_fma_f32 v[154:155], v[146:147], -0.5, -1.0 op_sel_hi:[1,0,0]
    v_pk_fma_f32 v[156:157], v[148:149], -0.5, -1.0 op_sel_hi:[1,0,0]
    v_pk_fma_f32 v[158:159], v[150:151], -0.5, -1.0 op_sel_hi:[1,0,0]
    v_pk_fma_f32 v[144:145], v[144:145], v[152:153], -1.0 op_sel_hi:[1,1,0]
    v_pk_fma_f32 v[146:147], v[146:147], v[154:155], -1.0 op_sel_hi:[1,1,0]
    v_pk_fma_f32 v[148:149], v[148:149], v[156:157], -1.0 op_sel_hi:[1,1,0]
    v_pk_fma_f32 v[150:151], v[150:151], v[158:159], -1.0 op_sel_hi:[1,1,0]
    v_rcp_f32 v144, v144
    v_rcp_f32 v145, v145
    v_rcp_f32 v146, v146
    v_rcp_f32 v147, v147
    v_rcp_f32 v148, v148
    v_rcp_f32 v149, v149
    v_rcp_f32 v150, v150
    v_rcp_f32 v151, v151
    v_pk_fma_f32 v[144:145], v[144:145], v[56:57], v[56:57]
    v_pk_fma_f32 v[146:147], v[146:147], v[58:59], v[58:59]
    v_pk_fma_f32 v[148:149], v[148:149], v[72:73], v[72:73]
    v_pk_fma_f32 v[150:151], v[150:151], v[74:75], v[74:75]
    v_cvt_pk_bf16_f32 v184, v144, v145
    v_cvt_pk_bf16_f32 v185, v146, v147
    v_cvt_pk_bf16_f32 v186, v148, v149
    v_cvt_pk_bf16_f32 v187, v150, v151
    buffer_store_dwordx4 v[184:187], v15, s[28:31], s50 offen offset:2048 sc1
    v_pk_mul_f32 v[160:161], v[60:61], v[222:223] op_sel_hi:[1,0]
    v_pk_mul_f32 v[162:163], v[62:63], v[222:223] op_sel_hi:[1,0]
    v_pk_mul_f32 v[164:165], v[76:77], v[222:223] op_sel_hi:[1,0]
    v_pk_mul_f32 v[166:167], v[78:79], v[222:223] op_sel_hi:[1,0]
    v_exp_f32 v160, v160
    v_exp_f32 v161, v161
    v_exp_f32 v162, v162
    v_exp_f32 v163, v163
    v_exp_f32 v164, v164
    v_exp_f32 v165, v165
    v_exp_f32 v166, v166
    v_exp_f32 v167, v167
    v_pk_fma_f32 v[168:169], v[160:161], -0.5, -1.0 op_sel_hi:[1,0,0]
    v_pk_fma_f32 v[170:171], v[162:163], -0.5, -1.0 op_sel_hi:[1,0,0]
    v_pk_fma_f32 v[172:173], v[164:165], -0.5, -1.0 op_sel_hi:[1,0,0]
    v_pk_fma_f32 v[174:175], v[166:167], -0.5, -1.0 op_sel_hi:[1,0,0]
    v_pk_fma_f32 v[160:161], v[160:161], v[168:169], -1.0 op_sel_hi:[1,1,0]
    v_pk_fma_f32 v[162:163], v[162:163], v[170:171], -1.0 op_sel_hi:[1,1,0]
    v_pk_fma_f32 v[164:165], v[164:165], v[172:173], -1.0 op_sel_hi:[1,1,0]
    v_pk_fma_f32 v[166:167], v[166:167], v[174:175], -1.0 op_sel_hi:[1,1,0]
    v_rcp_f32 v160, v160
    v_rcp_f32 v161, v161
    v_rcp_f32 v162, v162
    v_rcp_f32 v163, v163
    v_rcp_f32 v164, v164
    v_rcp_f32 v165, v165
    v_rcp_f32 v166, v166
    v_rcp_f32 v167, v167
    v_pk_fma_f32 v[160:161], v[160:161], v[60:61], v[60:61]
    v_pk_fma_f32 v[162:163], v[162:163], v[62:63], v[62:63]
    v_pk_fma_f32 v[164:165], v[164:165], v[76:77], v[76:77]
    v_pk_fma_f32 v[166:167], v[166:167], v[78:79], v[78:79]
    v_cvt_pk_bf16_f32 v188, v160, v161
    v_cvt_pk_bf16_f32 v189, v162, v163
    v_cvt_pk_bf16_f32 v190, v164, v165
    v_cvt_pk_bf16_f32 v191, v166, v167
    buffer_store_dwordx4 v[188:191], v15, s[28:31], s50 offen offset:3072 sc1
    s_add_u32 s50, s50, 8192
    v_pk_mul_f32 v[144:145], v[80:81], v[216:217] op_sel_hi:[1,0]
    v_pk_mul_f32 v[146:147], v[82:83], v[216:217] op_sel_hi:[1,0]
    v_pk_mul_f32 v[148:149], v[96:97], v[216:217] op_sel_hi:[1,0]
    v_pk_mul_f32 v[150:151], v[98:99], v[216:217] op_sel_hi:[1,0]
    v_exp_f32 v144, v144
    v_exp_f32 v145, v145
    v_exp_f32 v146, v146
    v_exp_f32 v147, v147
    v_exp_f32 v148, v148
    v_exp_f32 v149, v149
    v_exp_f32 v150, v150
    v_exp_f32 v151, v151
    v_pk_fma_f32 v[152:153], v[144:145], -0.5, -1.0 op_sel_hi:[1,0,0]
    v_pk_fma_f32 v[154:155], v[146:147], -0.5, -1.0 op_sel_hi:[1,0,0]
    v_pk_fma_f32 v[156:157], v[148:149], -0.5, -1.0 op_sel_hi:[1,0,0]
    v_pk_fma_f32 v[158:159], v[150:151], -0.5, -1.0 op_sel_hi:[1,0,0]
    v_pk_fma_f32 v[144:145], v[144:145], v[152:153], -1.0 op_sel_hi:[1,1,0]
    v_pk_fma_f32 v[146:147], v[146:147], v[154:155], -1.0 op_sel_hi:[1,1,0]
    v_pk_fma_f32 v[148:149], v[148:149], v[156:157], -1.0 op_sel_hi:[1,1,0]
    v_pk_fma_f32 v[150:151], v[150:151], v[158:159], -1.0 op_sel_hi:[1,1,0]
    v_rcp_f32 v144, v144
    v_rcp_f32 v145, v145
    v_rcp_f32 v146, v146
    v_rcp_f32 v147, v147
    v_rcp_f32 v148, v148
    v_rcp_f32 v149, v149
    v_rcp_f32 v150, v150
    v_rcp_f32 v151, v151
    v_pk_fma_f32 v[144:145], v[144:145], v[80:81], v[80:81]
    v_pk_fma_f32 v[146:147], v[146:147], v[82:83], v[82:83]
    v_pk_fma_f32 v[148:149], v[148:149], v[96:97], v[96:97]
    v_pk_fma_f32 v[150:151], v[150:151], v[98:99], v[98:99]
    v_cvt_pk_bf16_f32 v176, v144, v145
    v_cvt_pk_bf16_f32 v177, v146, v147
    v_cvt_pk_bf16_f32 v178, v148, v149
    v_cvt_pk_bf16_f32 v179, v150, v151
    buffer_store_dwordx4 v[176:179], v15, s[28:31], s50 offen offset:0 sc1
    v_pk_mul_f32 v[160:161], v[84:85], v[218:219] op_sel_hi:[1,0]
    v_pk_mul_f32 v[162:163], v[86:87], v[218:219] op_sel_hi:[1,0]
    v_pk_mul_f32 v[164:165], v[100:101], v[218:219] op_sel_hi:[1,0]
    v_pk_mul_f32 v[166:167], v[102:103], v[218:219] op_sel_hi:[1,0]
    v_exp_f32 v160, v160
    v_exp_f32 v161, v161
    v_exp_f32 v162, v162
    v_exp_f32 v163, v163
    v_exp_f32 v164, v164
    v_exp_f32 v165, v165
    v_exp_f32 v166, v166
    v_exp_f32 v167, v167
    v_pk_fma_f32 v[168:169], v[160:161], -0.5, -1.0 op_sel_hi:[1,0,0]
    v_pk_fma_f32 v[170:171], v[162:163], -0.5, -1.0 op_sel_hi:[1,0,0]
    v_pk_fma_f32 v[172:173], v[164:165], -0.5, -1.0 op_sel_hi:[1,0,0]
    v_pk_fma_f32 v[174:175], v[166:167], -0.5, -1.0 op_sel_hi:[1,0,0]
    v_pk_fma_f32 v[160:161], v[160:161], v[168:169], -1.0 op_sel_hi:[1,1,0]
    v_pk_fma_f32 v[162:163], v[162:163], v[170:171], -1.0 op_sel_hi:[1,1,0]
    v_pk_fma_f32 v[164:165], v[164:165], v[172:173], -1.0 op_sel_hi:[1,1,0]
    v_pk_fma_f32 v[166:167], v[166:167], v[174:175], -1.0 op_sel_hi:[1,1,0]
    v_rcp_f32 v160, v160
    v_rcp_f32 v161, v161
    v_rcp_f32 v162, v162
    v_rcp_f32 v163, v163
    v_rcp_f32 v164, v164
    v_rcp_f32 v165, v165
    v_rcp_f32 v166, v166
    v_rcp_f32 v167, v167
    v_pk_fma_f32 v[160:161], v[160:161], v[84:85], v[84:85]
    v_pk_fma_f32 v[162:163], v[162:163], v[86:87], v[86:87]
    v_pk_fma_f32 v[164:165], v[164:165], v[100:101], v[100:101]
    v_pk_fma_f32 v[166:167], v[166:167], v[102:103], v[102:103]
    v_cvt_pk_bf16_f32 v180, v160, v161
    v_cvt_pk_bf16_f32 v181, v162, v163
    v_cvt_pk_bf16_f32 v182, v164, v165
    v_cvt_pk_bf16_f32 v183, v166, v167
    buffer_store_dwordx4 v[180:183], v15, s[28:31], s50 offen offset:1024 sc1
    v_pk_mul_f32 v[144:145], v[88:89], v[220:221] op_sel_hi:[1,0]
    v_pk_mul_f32 v[146:147], v[90:91], v[220:221] op_sel_hi:[1,0]
    v_pk_mul_f32 v[148:149], v[104:105], v[220:221] op_sel_hi:[1,0]
    v_pk_mul_f32 v[150:151], v[106:107], v[220:221] op_sel_hi:[1,0]
    v_exp_f32 v144, v144
    v_exp_f32 v145, v145
    v_exp_f32 v146, v146
    v_exp_f32 v147, v147
    v_exp_f32 v148, v148
    v_exp_f32 v149, v149
    v_exp_f32 v150, v150
    v_exp_f32 v151, v151
    v_pk_fma_f32 v[152:153], v[144:145], -0.5, -1.0 op_sel_hi:[1,0,0]
    v_pk_fma_f32 v[154:155], v[146:147], -0.5, -1.0 op_sel_hi:[1,0,0]
    v_pk_fma_f32 v[156:157], v[148:149], -0.5, -1.0 op_sel_hi:[1,0,0]
    v_pk_fma_f32 v[158:159], v[150:151], -0.5, -1.0 op_sel_hi:[1,0,0]
    v_pk_fma_f32 v[144:145], v[144:145], v[152:153], -1.0 op_sel_hi:[1,1,0]
    v_pk_fma_f32 v[146:147], v[146:147], v[154:155], -1.0 op_sel_hi:[1,1,0]
    v_pk_fma_f32 v[148:149], v[148:149], v[156:157], -1.0 op_sel_hi:[1,1,0]
    v_pk_fma_f32 v[150:151], v[150:151], v[158:159], -1.0 op_sel_hi:[1,1,0]
    v_rcp_f32 v144, v144
    v_rcp_f32 v145, v145
    v_rcp_f32 v146, v146
    v_rcp_f32 v147, v147
    v_rcp_f32 v148, v148
    v_rcp_f32 v149, v149
    v_rcp_f32 v150, v150
    v_rcp_f32 v151, v151
    v_pk_fma_f32 v[144:145], v[144:145], v[88:89], v[88:89]
    v_pk_fma_f32 v[146:147], v[146:147], v[90:91], v[90:91]
    v_pk_fma_f32 v[148:149], v[148:149], v[104:105], v[104:105]
    v_pk_fma_f32 v[150:151], v[150:151], v[106:107], v[106:107]
    v_cvt_pk_bf16_f32 v184, v144, v145
    v_cvt_pk_bf16_f32 v185, v146, v147
    v_cvt_pk_bf16_f32 v186, v148, v149
    v_cvt_pk_bf16_f32 v187, v150, v151
    buffer_store_dwordx4 v[184:187], v15, s[28:31], s50 offen offset:2048 sc1
    v_pk_mul_f32 v[160:161], v[92:93], v[222:223] op_sel_hi:[1,0]
    v_pk_mul_f32 v[162:163], v[94:95], v[222:223] op_sel_hi:[1,0]
    v_pk_mul_f32 v[164:165], v[108:109], v[222:223] op_sel_hi:[1,0]
    v_pk_mul_f32 v[166:167], v[110:111], v[222:223] op_sel_hi:[1,0]
    v_exp_f32 v160, v160
    v_exp_f32 v161, v161
    v_exp_f32 v162, v162
    v_exp_f32 v163, v163
    v_exp_f32 v164, v164
    v_exp_f32 v165, v165
    v_exp_f32 v166, v166
    v_exp_f32 v167, v167
    v_pk_fma_f32 v[168:169], v[160:161], -0.5, -1.0 op_sel_hi:[1,0,0]
    v_pk_fma_f32 v[170:171], v[162:163], -0.5, -1.0 op_sel_hi:[1,0,0]
    v_pk_fma_f32 v[172:173], v[164:165], -0.5, -1.0 op_sel_hi:[1,0,0]
    v_pk_fma_f32 v[174:175], v[166:167], -0.5, -1.0 op_sel_hi:[1,0,0]
    v_pk_fma_f32 v[160:161], v[160:161], v[168:169], -1.0 op_sel_hi:[1,1,0]
    v_pk_fma_f32 v[162:163], v[162:163], v[170:171], -1.0 op_sel_hi:[1,1,0]
    v_pk_fma_f32 v[164:165], v[164:165], v[172:173], -1.0 op_sel_hi:[1,1,0]
    v_pk_fma_f32 v[166:167], v[166:167], v[174:175], -1.0 op_sel_hi:[1,1,0]
    v_rcp_f32 v160, v160
    v_rcp_f32 v161, v161
    v_rcp_f32 v162, v162
    v_rcp_f32 v163, v163
    v_rcp_f32 v164, v164
    v_rcp_f32 v165, v165
    v_rcp_f32 v166, v166
    v_rcp_f32 v167, v167
    v_pk_fma_f32 v[160:161], v[160:161], v[92:93], v[92:93]
    v_pk_fma_f32 v[162:163], v[162:163], v[94:95], v[94:95]
    v_pk_fma_f32 v[164:165], v[164:165], v[108:109], v[108:109]
    v_pk_fma_f32 v[166:167], v[166:167], v[110:111], v[110:111]
    v_cvt_pk_bf16_f32 v188, v160, v161
    v_cvt_pk_bf16_f32 v189, v162, v163
    v_cvt_pk_bf16_f32 v190, v164, v165
    v_cvt_pk_bf16_f32 v191, v166, v167
    buffer_store_dwordx4 v[188:191], v15, s[28:31], s50 offen offset:3072 sc1
    s_add_u32 s50, s50, 8192
    v_pk_mul_f32 v[144:145], v[112:113], v[216:217] op_sel_hi:[1,0]
    v_pk_mul_f32 v[146:147], v[114:115], v[216:217] op_sel_hi:[1,0]
    v_pk_mul_f32 v[148:149], v[128:129], v[216:217] op_sel_hi:[1,0]
    v_pk_mul_f32 v[150:151], v[130:131], v[216:217] op_sel_hi:[1,0]
    v_exp_f32 v144, v144
    v_exp_f32 v145, v145
    v_exp_f32 v146, v146
    v_exp_f32 v147, v147
    v_exp_f32 v148, v148
    v_exp_f32 v149, v149
    v_exp_f32 v150, v150
    v_exp_f32 v151, v151
    v_pk_fma_f32 v[152:153], v[144:145], -0.5, -1.0 op_sel_hi:[1,0,0]
    v_pk_fma_f32 v[154:155], v[146:147], -0.5, -1.0 op_sel_hi:[1,0,0]
    v_pk_fma_f32 v[156:157], v[148:149], -0.5, -1.0 op_sel_hi:[1,0,0]
    v_pk_fma_f32 v[158:159], v[150:151], -0.5, -1.0 op_sel_hi:[1,0,0]
    v_pk_fma_f32 v[144:145], v[144:145], v[152:153], -1.0 op_sel_hi:[1,1,0]
    v_pk_fma_f32 v[146:147], v[146:147], v[154:155], -1.0 op_sel_hi:[1,1,0]
    v_pk_fma_f32 v[148:149], v[148:149], v[156:157], -1.0 op_sel_hi:[1,1,0]
    v_pk_fma_f32 v[150:151], v[150:151], v[158:159], -1.0 op_sel_hi:[1,1,0]
    v_rcp_f32 v144, v144
    v_rcp_f32 v145, v145
    v_rcp_f32 v146, v146
    v_rcp_f32 v147, v147
    v_rcp_f32 v148, v148
    v_rcp_f32 v149, v149
    v_rcp_f32 v150, v150
    v_rcp_f32 v151, v151
    v_pk_fma_f32 v[144:145], v[144:145], v[112:113], v[112:113]
    v_pk_fma_f32 v[146:147], v[146:147], v[114:115], v[114:115]
    v_pk_fma_f32 v[148:149], v[148:149], v[128:129], v[128:129]
    v_pk_fma_f32 v[150:151], v[150:151], v[130:131], v[130:131]
    v_cvt_pk_bf16_f32 v176, v144, v145
    v_cvt_pk_bf16_f32 v177, v146, v147
    v_cvt_pk_bf16_f32 v178, v148, v149
    v_cvt_pk_bf16_f32 v179, v150, v151
    buffer_store_dwordx4 v[176:179], v15, s[28:31], s50 offen offset:0 sc1
    v_pk_mul_f32 v[160:161], v[116:117], v[218:219] op_sel_hi:[1,0]
    v_pk_mul_f32 v[162:163], v[118:119], v[218:219] op_sel_hi:[1,0]
    v_pk_mul_f32 v[164:165], v[132:133], v[218:219] op_sel_hi:[1,0]
    v_pk_mul_f32 v[166:167], v[134:135], v[218:219] op_sel_hi:[1,0]
    v_exp_f32 v160, v160
    v_exp_f32 v161, v161
    v_exp_f32 v162, v162
    v_exp_f32 v163, v163
    v_exp_f32 v164, v164
    v_exp_f32 v165, v165
    v_exp_f32 v166, v166
    v_exp_f32 v167, v167
    v_pk_fma_f32 v[168:169], v[160:161], -0.5, -1.0 op_sel_hi:[1,0,0]
    v_pk_fma_f32 v[170:171], v[162:163], -0.5, -1.0 op_sel_hi:[1,0,0]
    v_pk_fma_f32 v[172:173], v[164:165], -0.5, -1.0 op_sel_hi:[1,0,0]
    v_pk_fma_f32 v[174:175], v[166:167], -0.5, -1.0 op_sel_hi:[1,0,0]
    v_pk_fma_f32 v[160:161], v[160:161], v[168:169], -1.0 op_sel_hi:[1,1,0]
    v_pk_fma_f32 v[162:163], v[162:163], v[170:171], -1.0 op_sel_hi:[1,1,0]
    v_pk_fma_f32 v[164:165], v[164:165], v[172:173], -1.0 op_sel_hi:[1,1,0]
    v_pk_fma_f32 v[166:167], v[166:167], v[174:175], -1.0 op_sel_hi:[1,1,0]
    v_rcp_f32 v160, v160
    v_rcp_f32 v161, v161
    v_rcp_f32 v162, v162
    v_rcp_f32 v163, v163
    v_rcp_f32 v164, v164
    v_rcp_f32 v165, v165
    v_rcp_f32 v166, v166
    v_rcp_f32 v167, v167
    v_pk_fma_f32 v[160:161], v[160:161], v[116:117], v[116:117]
    v_pk_fma_f32 v[162:163], v[162:163], v[118:119], v[118:119]
    v_pk_fma_f32 v[164:165], v[164:165], v[132:133], v[132:133]
    v_pk_fma_f32 v[166:167], v[166:167], v[134:135], v[134:135]
    v_cvt_pk_bf16_f32 v180, v160, v161
    v_cvt_pk_bf16_f32 v181, v162, v163
    v_cvt_pk_bf16_f32 v182, v164, v165
    v_cvt_pk_bf16_f32 v183, v166, v167
    buffer_store_dwordx4 v[180:183], v15, s[28:31], s50 offen offset:1024 sc1
    v_pk_mul_f32 v[144:145], v[120:121], v[220:221] op_sel_hi:[1,0]
    v_pk_mul_f32 v[146:147], v[122:123], v[220:221] op_sel_hi:[1,0]
    v_pk_mul_f32 v[148:149], v[136:137], v[220:221] op_sel_hi:[1,0]
    v_pk_mul_f32 v[150:151], v[138:139], v[220:221] op_sel_hi:[1,0]
    v_exp_f32 v144, v144
    v_exp_f32 v145, v145
    v_exp_f32 v146, v146
    v_exp_f32 v147, v147
    v_exp_f32 v148, v148
    v_exp_f32 v149, v149
    v_exp_f32 v150, v150
    v_exp_f32 v151, v151
    v_pk_fma_f32 v[152:153], v[144:145], -0.5, -1.0 op_sel_hi:[1,0,0]
    v_pk_fma_f32 v[154:155], v[146:147], -0.5, -1.0 op_sel_hi:[1,0,0]
    v_pk_fma_f32 v[156:157], v[148:149], -0.5, -1.0 op_sel_hi:[1,0,0]
    v_pk_fma_f32 v[158:159], v[150:151], -0.5, -1.0 op_sel_hi:[1,0,0]
    v_pk_fma_f32 v[144:145], v[144:145], v[152:153], -1.0 op_sel_hi:[1,1,0]
    v_pk_fma_f32 v[146:147], v[146:147], v[154:155], -1.0 op_sel_hi:[1,1,0]
    v_pk_fma_f32 v[148:149], v[148:149], v[156:157], -1.0 op_sel_hi:[1,1,0]
    v_pk_fma_f32 v[150:151], v[150:151], v[158:159], -1.0 op_sel_hi:[1,1,0]
    v_rcp_f32 v144, v144
    v_rcp_f32 v145, v145
    v_rcp_f32 v146, v146
    v_rcp_f32 v147, v147
    v_rcp_f32 v148, v148
    v_rcp_f32 v149, v149
    v_rcp_f32 v150, v150
    v_rcp_f32 v151, v151
    v_pk_fma_f32 v[144:145], v[144:145], v[120:121], v[120:121]
    v_pk_fma_f32 v[146:147], v[146:147], v[122:123], v[122:123]
    v_pk_fma_f32 v[148:149], v[148:149], v[136:137], v[136:137]
    v_pk_fma_f32 v[150:151], v[150:151], v[138:139], v[138:139]
    v_cvt_pk_bf16_f32 v184, v144, v145
    v_cvt_pk_bf16_f32 v185, v146, v147
    v_cvt_pk_bf16_f32 v186, v148, v149
    v_cvt_pk_bf16_f32 v187, v150, v151
    buffer_store_dwordx4 v[184:187], v15, s[28:31], s50 offen offset:2048 sc1
    v_pk_mul_f32 v[160:161], v[124:125], v[222:223] op_sel_hi:[1,0]
    v_pk_mul_f32 v[162:163], v[126:127], v[222:223] op_sel_hi:[1,0]
    v_pk_mul_f32 v[164:165], v[140:141], v[222:223] op_sel_hi:[1,0]
    v_pk_mul_f32 v[166:167], v[142:143], v[222:223] op_sel_hi:[1,0]
    v_exp_f32 v160, v160
    v_exp_f32 v161, v161
    v_exp_f32 v162, v162
    v_exp_f32 v163, v163
    v_exp_f32 v164, v164
    v_exp_f32 v165, v165
    v_exp_f32 v166, v166
    v_exp_f32 v167, v167
    v_pk_fma_f32 v[168:169], v[160:161], -0.5, -1.0 op_sel_hi:[1,0,0]
    v_pk_fma_f32 v[170:171], v[162:163], -0.5, -1.0 op_sel_hi:[1,0,0]
    v_pk_fma_f32 v[172:173], v[164:165], -0.5, -1.0 op_sel_hi:[1,0,0]
    v_pk_fma_f32 v[174:175], v[166:167], -0.5, -1.0 op_sel_hi:[1,0,0]
    v_pk_fma_f32 v[160:161], v[160:161], v[168:169], -1.0 op_sel_hi:[1,1,0]
    v_pk_fma_f32 v[162:163], v[162:163], v[170:171], -1.0 op_sel_hi:[1,1,0]
    v_pk_fma_f32 v[164:165], v[164:165], v[172:173], -1.0 op_sel_hi:[1,1,0]
    v_pk_fma_f32 v[166:167], v[166:167], v[174:175], -1.0 op_sel_hi:[1,1,0]
    v_rcp_f32 v160, v160
    v_rcp_f32 v161, v161
    v_rcp_f32 v162, v162
    v_rcp_f32 v163, v163
    v_rcp_f32 v164, v164
    v_rcp_f32 v165, v165
    v_rcp_f32 v166, v166
    v_rcp_f32 v167, v167
    v_pk_fma_f32 v[160:161], v[160:161], v[124:125], v[124:125]
    v_pk_fma_f32 v[162:163], v[162:163], v[126:127], v[126:127]
    v_pk_fma_f32 v[164:165], v[164:165], v[140:141], v[140:141]
    v_pk_fma_f32 v[166:167], v[166:167], v[142:143], v[142:143]
    v_cvt_pk_bf16_f32 v188, v160, v161
    v_cvt_pk_bf16_f32 v189, v162, v163
    v_cvt_pk_bf16_f32 v190, v164, v165
    v_cvt_pk_bf16_f32 v191, v166, v167
    buffer_store_dwordx4 v[188:191], v15, s[28:31], s50 offen offset:3072 sc1
    s_lshr_b32 s47, s41, 1
    s_lshl_b32 s47, s47, 5
    s_and_b32 s48, s41, 1
    s_add_u32 s47, s47, s48
    s_lshl_b32 s48, s40, 9
    s_add_u32 s47, s47, s48
    s_lshl_b32 s47, s47, 2
    s_add_u32 s47, s47, 21430272
    s_branch L_p2
L_k1_p3:
    v_lshrrev_b32 v15, 3, v1
    s_lshl_b32 s50, s40, 5
    s_add_u32 s50, s50, s43
    s_lshl_b32 s50, s50, 3
    v_add_u32 v15, s50, v15
    v_lshlrev_b32 v2, 11, v15
    v_bfe_u32 v15, v15, 1, 3
    v_and_b32 v28, 7, v1
    v_xor_b32 v15, v15, v28
    v_lshl_add_u32 v2, v15, 4, v2
    v_add_u32 v3, 0x10000, v2
    v_add_u32 v4, 0x20000, v2
    v_add_u32 v5, 0x30000, v2
    s_lshl_b32 s45, s47, 7
    s_add_u32 s82, s45, 0x40000
    s_mov_b32 s81, s48
    s_lshl_b32 s50, s2, 3
    s_add_u32 s50, s50, s42
    s_lshl_b32 s50, s50, 11
    v_lshlrev_b32 v15, 4, v1
    buffer_load_dwordx4 v[232:235], v15, s[20:23], s50 offen
    buffer_load_dwordx4 v[236:239], v15, s[20:23], s50 offen offset:1024
    s_add_u32 m0, s81, 0
    s_nop 0
    buffer_load_dwordx4 v2, s[20:23], s45 offen  lds
    s_add_u32 m0, s81, 4096
    s_nop 0
    buffer_load_dwordx4 v3, s[20:23], s45 offen  lds
    s_add_u32 m0, s81, 8192
    s_nop 0
    buffer_load_dwordx4 v4, s[20:23], s45 offen  lds
    s_add_u32 m0, s81, 12288
    s_nop 0
    buffer_load_dwordx4 v5, s[20:23], s45 offen  lds
    s_add_u32 m0, s81, 16384
    s_nop 0
    buffer_load_dwordx4 v2, s[20:23], s82 offen  lds
    s_add_u32 m0, s81, 20480
    s_nop 0
    buffer_load_dwordx4 v3, s[20:23], s82 offen  lds
    s_add_u32 m0, s81, 24576
    s_nop 0
    buffer_load_dwordx4 v4, s[20:23], s82 offen  lds
    s_add_u32 m0, s81, 28672
    s_nop 0
    buffer_load_dwordx4 v5, s[20:23], s82 offen  lds
    s_add_u32 s45, s45, 128
    s_and_b32 s45, s45, 0x7ff
    s_add_u32 s82, s45, 0x40000
    s_add_u32 s81, s81, 32768
    s_cmp_ge_u32 s81, 98304
    s_cselect_b32 s81, s48, s81
    s_mov_b32 s28, s18
    s_and_b32 s29, s19, 0xffff
    s_mov_b32 s30, 0x10000000
    s_mov_b32 s31, 0x00020000
    v_lshlrev_b32 v15, 4, v1
    s_mov_b32 s36, s14
    s_and_b32 s37, s15, 0xffff
    s_mov_b32 s38, 0x1c00
    s_mov_b32 s39, 0x00020000
    s_mov_b32 s32, s16
    s_and_b32 s33, s17, 0xffff
    s_mov_b32 s34, 0x100
    s_mov_b32 s35, 0x00020000
    v_mov_b32 v16, 0x3f803f80
    v_mov_b32 v17, 0x3f803f80
    v_mov_b32 v18, 0x3f803f80
    v_mov_b32 v19, 0x3f803f80
    v_mov_b32 v20, 0
    v_mov_b32 v21, 0
    v_mov_b32 v22, 0
    v_mov_b32 v23, 0
    v_mov_b32 v24, 0
    v_mov_b32 v25, 0
    v_mov_b32 v26, 0
    v_mov_b32 v27, 0
    v_and_b32 v15, 15, v1
    s_lshl_b32 s50, s43, 6
    v_add_u32 v15, s50, v15
    v_lshlrev_b32 v6, 7, v15
    v_bfe_u32 v15, v1, 1, 3
    v_lshrrev_b32 v28, 4, v1
    v_xor_b32 v15, v15, v28
    v_lshl_add_u32 v6, v15, 4, v6
    s_mov_b32 s80, 0
    v_lshrrev_b32 v15, 4, v1
    v_lshlrev_b32 v15, 3, v15
    v_bfe_u32 v28, v1, 2, 2
    v_add_u32 v15, v15, v28
    v_lshlrev_b32 v15, 7, v15
    v_and_b32 v28, 3, v1
    v_lshl_add_u32 v15, v28, 3, v15
    v_add_u32 v15, 98304, v15
    v_bfe_u32 v28, v1, 3, 2
    s_and_b32 s50, s41, 1
    s_lshl_b32 s50, s50, 1
    s_add_u32 s51, s50, 7
    s_and_b32 s52, s51, 3
    s_lshr_b32 s53, s51, 2
    s_lshl_b32 s53, s53, 13
    v_xor_b32 v14, s52, v28
    v_lshl_add_u32 v14, v14, 5, v15
    v_add_u32 v14, s53, v14
    s_add_u32 s51, s50, 8
    s_and_b32 s52, s51, 3
    s_lshr_b32 s53, s51, 2
    s_lshl_b32 s53, s53, 13
    v_xor_b32 v10, s52, v28
    v_lshl_add_u32 v10, v10, 5, v15
    v_add_u32 v10, s53, v10
    s_add_u32 s51, s50, 9
    s_and_b32 s52, s51, 3
    s_lshr_b32 s53, s51, 2
    s_lshl_b32 s53, s53, 13
    v_xor_b32 v11, s52, v28
    v_lshl_add_u32 v11, v11, 5, v15
    v_add_u32 v11, s53, v11
    s_add_u32 s51, s50, 10
    s_and_b32 s52, s51, 3
    s_lshr_b32 s53, s51, 2
    s_lshl_b32 s53, s53, 13
    v_xor_b32 v12, s52, v28
    v_lshl_add_u32 v12, v12, 5, v15
    v_add_u32 v12, s53, v12
    s_add_u32 s51, s50, 11
    s_and_b32 s52, s51, 3
    s_lshr_b32 s53, s51, 2
    s_lshl_b32 s53, s53, 13
    v_xor_b32 v13, s52, v28
    v_lshl_add_u32 v13, v13, 5, v15
    v_add_u32 v13, s53, v13
    v_mov_b32 v32, 0
    v_mov_b32 v33, 0
    v_mov_b32 v34, 0
    v_mov_b32 v35, 0
    v_mov_b32 v36, 0
    v_mov_b32 v37, 0
    v_mov_b32 v38, 0
    v_mov_b32 v39, 0
    v_mov_b32 v40, 0
    v_mov_b32 v41, 0
    v_mov_b32 v42, 0
    v_mov_b32 v43, 0
    v_mov_b32 v44, 0
    v_mov_b32 v45, 0
    v_mov_b32 v46, 0
    v_mov_b32 v47, 0
    v_mov_b32 v48, 0
    v_mov_b32 v49, 0
    v_mov_b32 v50, 0
    v_mov_b32 v51, 0
    v_mov_b32 v52, 0
    v_mov_b32 v53, 0
    v_mov_b32 v54, 0
    v_mov_b32 v55, 0
    v_mov_b32 v56, 0
    v_mov_b32 v57, 0
    v_mov_b32 v58, 0
    v_mov_b32 v59, 0
    v_mov_b32 v60, 0
    v_mov_b32 v61, 0
    v_mov_b32 v62, 0
    v_mov_b32 v63, 0
    v_mov_b32 v64, 0
    v_mov_b32 v65, 0
    v_mov_b32 v66, 0
    v_mov_b32 v67, 0
    v_mov_b32 v68, 0
    v_mov_b32 v69, 0
    v_mov_b32 v70, 0
    v_mov_b32 v71, 0
    v_mov_b32 v72, 0
    v_mov_b32 v73, 0
    v_mov_b32 v74, 0
    v_mov_b32 v75, 0
    v_mov_b32 v76, 0
    v_mov_b32 v77, 0
    v_mov_b32 v78, 0
    v_mov_b32 v79, 0
    v_mov_b32 v80, 0
    v_mov_b32 v81, 0
    v_mov_b32 v82, 0
    v_mov_b32 v83, 0
    v_mov_b32 v84, 0
    v_mov_b32 v85, 0
    v_mov_b32 v86, 0
    v_mov_b32 v87, 0
    v_mov_b32 v88, 0
    v_mov_b32 v89, 0
    v_mov_b32 v90, 0
    v_mov_b32 v91, 0
    v_mov_b32 v92, 0
    v_mov_b32 v93, 0
    v_mov_b32 v94, 0
    v_mov_b32 v95, 0
    v_mov_b32 v96, 0
    v_mov_b32 v97, 0
    v_mov_b32 v98, 0
    v_mov_b32 v99, 0
    v_mov_b32 v100, 0
    v_mov_b32 v101, 0
    v_mov_b32 v102, 0
    v_mov_b32 v103, 0
    v_mov_b32 v104, 0
    v_mov_b32 v105, 0
    v_mov_b32 v106, 0
    v_mov_b32 v107, 0
    v_mov_b32 v108, 0
    v_mov_b32 v109, 0
    v_mov_b32 v110, 0
    v_mov_b32 v111, 0
    v_mov_b32 v112, 0
    v_mov_b32 v113, 0
    v_mov_b32 v114, 0
    v_mov_b32 v115, 0
    v_mov_b32 v116, 0
    v_mov_b32 v117, 0
    v_mov_b32 v118, 0
    v_mov_b32 v119, 0
    v_mov_b32 v120, 0
    v_mov_b32 v121, 0
    v_mov_b32 v122, 0
    v_mov_b32 v123, 0
    v_mov_b32 v124, 0
    v_mov_b32 v125, 0
    v_mov_b32 v126, 0
    v_mov_b32 v127, 0
    v_mov_b32 v128, 0
    v_mov_b32 v129, 0
    v_mov_b32 v130, 0
    v_mov_b32 v131, 0
    v_mov_b32 v132, 0
    v_mov_b32 v133, 0
    v_mov_b32 v134, 0
    v_mov_b32 v135, 0
    v_mov_b32 v136, 0
    v_mov_b32 v137, 0
    v_mov_b32 v138, 0
    v_mov_b32 v139, 0
    v_mov_b32 v140, 0
    v_mov_b32 v141, 0
    v_mov_b32 v142, 0
    v_mov_b32 v143, 0
    s_waitcnt vmcnt(9)
    v_lshlrev_b32 v240, 16, v232
    v_and_b32 v241, 0xffff0000, v232
    v_lshlrev_b32 v242, 16, v233
    v_and_b32 v243, 0xffff0000, v233
    v_lshlrev_b32 v244, 16, v234
    v_and_b32 v245, 0xffff0000, v234
    v_lshlrev_b32 v246, 16, v235
    v_and_b32 v247, 0xffff0000, v235
    s_waitcnt vmcnt(8)
    v_lshlrev_b32 v248, 16, v236
    v_and_b32 v249, 0xffff0000, v236
    v_lshlrev_b32 v250, 16, v237
    v_and_b32 v251, 0xffff0000, v237
    v_lshlrev_b32 v252, 16, v238
    v_and_b32 v253, 0xffff0000, v238
    v_lshlrev_b32 v254, 16, v239
    v_and_b32 v255, 0xffff0000, v239
    v_pk_add_f32 v[232:233], v[240:241], v[242:243]
    v_pk_add_f32 v[234:235], v[244:245], v[246:247]
    v_pk_add_f32 v[236:237], v[248:249], v[250:251]
    v_pk_add_f32 v[238:239], v[252:253], v[254:255]
    v_pk_add_f32 v[232:233], v[232:233], v[234:235]
    v_pk_add_f32 v[236:237], v[236:237], v[238:239]
    v_pk_add_f32 v[232:233], v[232:233], v[236:237]
    v_add_f32 v232, v232, v233
    s_nop 1
    v_add_f32_dpp v232, v232, v232 row_ror:8 row_mask:0xf bank_mask:0xf
    s_nop 1
    v_add_f32_dpp v232, v232, v232 row_ror:4 row_mask:0xf bank_mask:0xf
    s_nop 1
    v_add_f32_dpp v232, v232, v232 row_ror:2 row_mask:0xf bank_mask:0xf
    s_nop 1
    v_add_f32_dpp v232, v232, v232 row_ror:1 row_mask:0xf bank_mask:0xf
    v_mov_b32 v233, v232
    s_nop 1
    v_permlane16_swap_b32 v232, v233
    v_add_f32 v232, v232, v233
    v_mov_b32 v233, v232
    s_nop 1
    v_permlane32_swap_b32 v232, v233
    v_add_f32 v232, v232, v233
    v_mul_f32 v28, 0xba800000, v232
    v_pk_add_f32 v[240:241], v[240:241], v[28:29] op_sel_hi:[1,0]
    v_pk_add_f32 v[242:243], v[242:243], v[28:29] op_sel_hi:[1,0]
    v_pk_add_f32 v[244:245], v[244:245], v[28:29] op_sel_hi:[1,0]
    v_pk_add_f32 v[246:247], v[246:247], v[28:29] op_sel_hi:[1,0]
    v_pk_add_f32 v[248:249], v[248:249], v[28:29] op_sel_hi:[1,0]
    v_pk_add_f32 v[250:251], v[250:251], v[28:29] op_sel_hi:[1,0]
    v_pk_add_f32 v[252:253], v[252:253], v[28:29] op_sel_hi:[1,0]
    v_pk_add_f32 v[254:255], v[254:255], v[28:29] op_sel_hi:[1,0]
    v_pk_mul_f32 v[232:233], v[240:241], v[240:241]
    v_pk_mul_f32 v[234:235], v[242:243], v[242:243]
    v_pk_fma_f32 v[232:233], v[244:245], v[244:245], v[232:233]
    v_pk_fma_f32 v[234:235], v[246:247], v[246:247], v[234:235]
    v_pk_fma_f32 v[232:233], v[248:249], v[248:249], v[232:233]
    v_pk_fma_f32 v[234:235], v[250:251], v[250:251], v[234:235]
    v_pk_fma_f32 v[232:233], v[252:253], v[252:253], v[232:233]
    v_pk_fma_f32 v[234:235], v[254:255], v[254:255], v[234:235]
    v_pk_add_f32 v[232:233], v[232:233], v[234:235]
    v_add_f32 v232, v232, v233
    s_nop 1
    v_add_f32_dpp v232, v232, v232 row_ror:8 row_mask:0xf bank_mask:0xf
    s_nop 1
    v_add_f32_dpp v232, v232, v232 row_ror:4 row_mask:0xf bank_mask:0xf
    s_nop 1
    v_add_f32_dpp v232, v232, v232 row_ror:2 row_mask:0xf bank_mask:0xf
    s_nop 1
    v_add_f32_dpp v232, v232, v232 row_ror:1 row_mask:0xf bank_mask:0xf
    v_mov_b32 v233, v232
    s_nop 1
    v_permlane16_swap_b32 v232, v233
    v_add_f32 v232, v232, v233
    v_mov_b32 v233, v232
    s_nop 1
    v_permlane32_swap_b32 v232, v233
    v_add_f32 v232, v232, v233
    v_mov_b32 v233, 0x3727c5ac
    v_fmac_f32 v233, 0x3a800000, v232
    v_rsq_f32 v239, v233
    v_cvt_pk_bf16_f32 v234, v28, v28
    v_mul_f32 v233, v233, v239
    v_and_b32 v234, 0xffff0000, v234
    v_sub_f32 v234, v28, v234
    v_cvt_pk_bf16_f32 v236, v28, v234
    v_cvt_pk_bf16_f32 v237, v28, v233
    v_and_b32 v235, 0xffff0000, v237
    v_sub_f32 v235, v233, v235
    v_cvt_pk_bf16_f32 v238, v235, 0
    s_add_u32 m0, s81, 0
    s_nop 0
    buffer_load_dwordx4 v2, s[20:23], s45 offen  lds
    s_add_u32 m0, s81, 4096
    s_nop 0
    buffer_load_dwordx4 v3, s[20:23], s45 offen  lds
    s_add_u32 m0, s81, 8192
    s_nop 0
    buffer_load_dwordx4 v4, s[20:23], s45 offen  lds
    s_add_u32 m0, s81, 12288
    s_nop 0
    buffer_load_dwordx4 v5, s[20:23], s45 offen  lds
    s_add_u32 m0, s81, 16384
    s_nop 0
    buffer_load_dwordx4 v2, s[20:23], s82 offen  lds
    s_add_u32 m0, s81, 20480
    s_nop 0
    buffer_load_dwordx4 v3, s[20:23], s82 offen  lds
    s_add_u32 m0, s81, 24576
    s_nop 0
    buffer_load_dwordx4 v4, s[20:23], s82 offen  lds
    s_add_u32 m0, s81, 28672
    s_nop 0
    buffer_load_dwordx4 v5, s[20:23], s82 offen  lds
    s_add_u32 s45, s45, 128
    s_and_b32 s45, s45, 0x7ff
    s_add_u32 s82, s45, 0x40000
    s_add_u32 s81, s81, 32768
    s_cmp_ge_u32 s81, 98304
    s_cselect_b32 s81, s48, s81
    s_lshl_b32 s50, s2, 3
    s_add_u32 s50, s50, s42
    s_mul_i32 s51, s50, 3584
    s_add_u32 s88, s88, s51
    s_addc_u32 s89, s89, 0
    s_lshl_b32 s51, s50, 10
    s_add_u32 s92, s92, s51
    s_addc_u32 s93, s93, 0
    s_waitcnt vmcnt(8)
    s_barrier
    v_mov_b32 v248, -1
    v_mov_b32 v249, -1
    v_mov_b32 v250, -1
    v_mov_b32 v251, -1
    s_lshl_b32 s50, s2, 3
    s_add_u32 s50, s50, s42
    s_lshl_b32 s50, s50, 4
    s_add_u32 s50, s50, 18874368
    s_mov_b64 exec, 1
    buffer_store_dwordx4 v[236:239], off, s[28:31], s50 sc1
    s_mov_b64 exec, -1
    s_lshl_b32 s50, s41, 1
    s_add_u32 s50, s50, s44
    s_lshl_b32 s50, s50, 3
    s_add_u32 s50, s50, s40
    s_lshl_b32 s50, s50, 9
    s_lshl_b32 s51, s43, 7
    s_add_u32 s50, s50, s51
    s_add_u32 s50, s50, 19070976
    v_lshlrev_b32 v15, 4, v1
    s_mov_b64 exec, 0xff
    buffer_store_dwordx4 v[248:251], v15, s[28:31], s50 offen sc1
    s_mov_b64 exec, -1
    v_lshlrev_b32 v15, 4, v1
    s_lshl_b32 s50, s2, 3
    s_add_u32 s50, s50, s42
    s_lshl_b32 s50, s50, 11
    s_add_u32 s50, s50, 33554432
    buffer_store_dwordx4 v[248:251], v15, s[28:31], s50 offen offset:0 sc1
    buffer_store_dwordx4 v[248:251], v15, s[28:31], s50 offen offset:1024 sc1
    s_barrier
    v_add_u32 v8, s80, v6
    v_xor_b32 v9, 64, v8
    s_add_u32 s80, s80, 32768
    s_cmp_ge_u32 s80, 98304
    s_cselect_b32 s80, 0, s80
    ds_read_b64_tr_b16 v[160:161], v14 offset:0
    s_add_u32 m0, s81, 0
    ds_read_b64_tr_b16 v[162:163], v14 offset:512
    buffer_load_dwordx4 v2, s[20:23], s45 offen  lds
    ds_read_b64_tr_b16 v[204:205], v14 offset:4096
    ds_read_b64_tr_b16 v[206:207], v14 offset:4608
    ds_read_b128 v[144:147], v8 offset:0
    s_add_u32 m0, s81, 4096
    ds_read_b128 v[148:151], v8 offset:2048
    buffer_load_dwordx4 v3, s[20:23], s45 offen  lds
    ds_read_b128 v[152:155], v8 offset:4096
    ds_read_b128 v[156:159], v8 offset:6144
    ds_read_b128 v[188:191], v9 offset:0
    s_add_u32 m0, s81, 8192
    ds_read_b128 v[192:195], v9 offset:2048
    buffer_load_dwordx4 v4, s[20:23], s45 offen  lds
    ds_read_b128 v[196:199], v9 offset:4096
    ds_read_b128 v[200:203], v9 offset:6144
    ds_read_b64_tr_b16 v[164:165], v10 offset:0
    s_add_u32 m0, s81, 12288
    ds_read_b64_tr_b16 v[166:167], v10 offset:512
    buffer_load_dwordx4 v5, s[20:23], s45 offen  lds
    ds_read_b64_tr_b16 v[208:209], v10 offset:4096
    ds_read_b64_tr_b16 v[210:211], v10 offset:4608
    ds_read_b64_tr_b16 v[168:169], v11 offset:0
    s_add_u32 m0, s81, 16384
    ds_read_b64_tr_b16 v[170:171], v11 offset:512
    buffer_load_dwordx4 v2, s[20:23], s82 offen  lds
    ds_read_b64_tr_b16 v[212:213], v11 offset:4096
    ds_read_b64_tr_b16 v[214:215], v11 offset:4608
    ds_read_b64_tr_b16 v[172:173], v12 offset:0
    s_add_u32 m0, s81, 20480
    ds_read_b64_tr_b16 v[174:175], v12 offset:512
    buffer_load_dwordx4 v3, s[20:23], s82 offen  lds
    ds_read_b64_tr_b16 v[216:217], v12 offset:4096
    ds_read_b64_tr_b16 v[218:219], v12 offset:4608
    ds_read_b64_tr_b16 v[176:177], v13 offset:0
    s_add_u32 m0, s81, 24576
    ds_read_b64_tr_b16 v[178:179], v13 offset:512
    buffer_load_dwordx4 v4, s[20:23], s82 offen  lds
    ds_read_b64_tr_b16 v[220:221], v13 offset:4096
    ds_read_b64_tr_b16 v[222:223], v13 offset:4608
    ds_read_b64_tr_b16 v[180:181], v10 offset:8192
    s_add_u32 m0, s81, 28672
    ds_read_b64_tr_b16 v[182:183], v10 offset:8704
    buffer_load_dwordx4 v5, s[20:23], s82 offen  lds
    ds_read_b64_tr_b16 v[224:225], v10 offset:12288
    ds_read_b64_tr_b16 v[226:227], v10 offset:12800
    ds_read_b64_tr_b16 v[184:185], v11 offset:8192
    ds_read_b64_tr_b16 v[186:187], v11 offset:8704
    ds_read_b64_tr_b16 v[228:229], v11 offset:12288
    ds_read_b64_tr_b16 v[230:231], v11 offset:12800
    s_add_u32 s45, s45, 128
    s_and_b32 s45, s45, 0x7ff
    s_add_u32 s82, s45, 0x40000
    s_add_u32 s81, s81, 32768
    s_cmp_ge_u32 s81, 98304
    s_cselect_b32 s81, s48, s81
    s_waitcnt lgkmcnt(0)
    s_cmp_lg_u32 s86, 0
    s_cbranch_scc1 L_cs_4001
    s_cmp_lg_u32 s43, 0
    s_cbranch_scc1 L_cs_4002
    v_mfma_f32_16x16x32_bf16 v[20:23], v[16:19], v[160:163], v[20:23]
    v_mfma_f32_16x16x32_bf16 v[20:23], v[16:19], v[204:207], v[20:23]
    v_mfma_f32_16x16x32_bf16 v[24:27], v[16:19], v[176:179], v[24:27]
    v_mfma_f32_16x16x32_bf16 v[24:27], v[16:19], v[220:223], v[24:27]
    s_branch L_cs_4001
L_cs_4002:
    s_cmp_lg_u32 s43, 1
    s_cbranch_scc1 L_cs_4003
    v_mfma_f32_16x16x32_bf16 v[20:23], v[16:19], v[164:167], v[20:23]
    v_mfma_f32_16x16x32_bf16 v[20:23], v[16:19], v[208:211], v[20:23]
    v_mfma_f32_16x16x32_bf16 v[24:27], v[16:19], v[180:183], v[24:27]
    v_mfma_f32_16x16x32_bf16 v[24:27], v[16:19], v[224:227], v[24:27]
    s_branch L_cs_4001
L_cs_4003:
    s_cmp_lg_u32 s43, 2
    s_cbranch_scc1 L_cs_4004
    v_mfma_f32_16x16x32_bf16 v[20:23], v[16:19], v[168:171], v[20:23]
    v_mfma_f32_16x16x32_bf16 v[20:23], v[16:19], v[212:215], v[20:23]
    v_mfma_f32_16x16x32_bf16 v[24:27], v[16:19], v[184:187], v[24:27]
    v_mfma_f32_16x16x32_bf16 v[24:27], v[16:19], v[228:231], v[24:27]
    s_branch L_cs_4001
L_cs_4004:
    v_mfma_f32_16x16x32_bf16 v[20:23], v[16:19], v[172:175], v[20:23]
    v_mfma_f32_16x16x32_bf16 v[20:23], v[16:19], v[216:219], v[20:23]
L_cs_4001:
    s_waitcnt vmcnt(12)
    s_call_b64 s[100:101], L_sub_c1_2
    v_add_u32 v8, s80, v6
    v_xor_b32 v9, 64, v8
    s_add_u32 s80, s80, 32768
    s_cmp_ge_u32 s80, 98304
    s_cselect_b32 s80, 0, s80
    ds_read_b64_tr_b16 v[160:161], v14 offset:32768
    s_add_u32 m0, s81, 0
    ds_read_b64_tr_b16 v[162:163], v14 offset:33280
    buffer_load_dwordx4 v2, s[20:23], s45 offen  lds
    ds_read_b64_tr_b16 v[204:205], v14 offset:36864
    ds_read_b64_tr_b16 v[206:207], v14 offset:37376
    ds_read_b128 v[144:147], v8 offset:0
    s_add_u32 m0, s81, 4096
    ds_read_b128 v[148:151], v8 offset:2048
    buffer_load_dwordx4 v3, s[20:23], s45 offen  lds
    ds_read_b128 v[152:155], v8 offset:4096
    ds_read_b128 v[156:159], v8 offset:6144
    ds_read_b128 v[188:191], v9 offset:0
    s_add_u32 m0, s81, 8192
    ds_read_b128 v[192:195], v9 offset:2048
    buffer_load_dwordx4 v4, s[20:23], s45 offen  lds
    ds_read_b128 v[196:199], v9 offset:4096
    ds_read_b128 v[200:203], v9 offset:6144
    ds_read_b64_tr_b16 v[164:165], v10 offset:32768
    s_add_u32 m0, s81, 12288
    ds_read_b64_tr_b16 v[166:167], v10 offset:33280
    buffer_load_dwordx4 v5, s[20:23], s45 offen  lds
    ds_read_b64_tr_b16 v[208:209], v10 offset:36864
    ds_read_b64_tr_b16 v[210:211], v10 offset:37376
    ds_read_b64_tr_b16 v[168:169], v11 offset:32768
    s_add_u32 m0, s81, 16384
    ds_read_b64_tr_b16 v[170:171], v11 offset:33280
    buffer_load_dwordx4 v2, s[20:23], s82 offen  lds
    ds_read_b64_tr_b16 v[212:213], v11 offset:36864
    ds_read_b64_tr_b16 v[214:215], v11 offset:37376
    ds_read_b64_tr_b16 v[172:173], v12 offset:32768
    s_add_u32 m0, s81, 20480
    ds_read_b64_tr_b16 v[174:175], v12 offset:33280
    buffer_load_dwordx4 v3, s[20:23], s82 offen  lds
    ds_read_b64_tr_b16 v[216:217], v12 offset:36864
    ds_read_b64_tr_b16 v[218:219], v12 offset:37376
    ds_read_b64_tr_b16 v[176:177], v13 offset:32768
    s_add_u32 m0, s81, 24576
    ds_read_b64_tr_b16 v[178:179], v13 offset:33280
    buffer_load_dwordx4 v4, s[20:23], s82 offen  lds
    ds_read_b64_tr_b16 v[220:221], v13 offset:36864
    ds_read_b64_tr_b16 v[222:223], v13 offset:37376
    ds_read_b64_tr_b16 v[180:181], v10 offset:40960
    s_add_u32 m0, s81, 28672
    ds_read_b64_tr_b16 v[182:183], v10 offset:41472
    buffer_load_dwordx4 v5, s[20:23], s82 offen  lds
    ds_read_b64_tr_b16 v[224:225], v10 offset:45056
    ds_read_b64_tr_b16 v[226:227], v10 offset:45568
    ds_read_b64_tr_b16 v[184:185], v11 offset:40960
    ds_read_b64_tr_b16 v[186:187], v11 offset:41472
    ds_read_b64_tr_b16 v[228:229], v11 offset:45056
    ds_read_b64_tr_b16 v[230:231], v11 offset:45568
    s_add_u32 s45, s45, 128
    s_and_b32 s45, s45, 0x7ff
    s_add_u32 s82, s45, 0x40000
    s_add_u32 s81, s81, 32768
    s_cmp_ge_u32 s81, 98304
    s_cselect_b32 s81, s48, s81
    s_waitcnt lgkmcnt(0)
    s_cmp_lg_u32 s86, 0
    s_cbranch_scc1 L_cs_4005
    s_cmp_lg_u32 s43, 0
    s_cbranch_scc1 L_cs_4006
    v_mfma_f32_16x16x32_bf16 v[20:23], v[16:19], v[160:163], v[20:23]
    v_mfma_f32_16x16x32_bf16 v[20:23], v[16:19], v[204:207], v[20:23]
    v_mfma_f32_16x16x32_bf16 v[24:27], v[16:19], v[176:179], v[24:27]
    v_mfma_f32_16x16x32_bf16 v[24:27], v[16:19], v[220:223], v[24:27]
    s_branch L_cs_4005
L_cs_4006:
    s_cmp_lg_u32 s43, 1
    s_cbranch_scc1 L_cs_4007
    v_mfma_f32_16x16x32_bf16 v[20:23], v[16:19], v[164:167], v[20:23]
    v_mfma_f32_16x16x32_bf16 v[20:23], v[16:19], v[208:211], v[20:23]
    v_mfma_f32_16x16x32_bf16 v[24:27], v[16:19], v[180:183], v[24:27]
    v_mfma_f32_16x16x32_bf16 v[24:27], v[16:19], v[224:227], v[24:27]
    s_branch L_cs_4005
L_cs_4007:
    s_cmp_lg_u32 s43, 2
    s_cbranch_scc1 L_cs_4008
    v_mfma_f32_16x16x32_bf16 v[20:23], v[16:19], v[168:171], v[20:23]
    v_mfma_f32_16x16x32_bf16 v[20:23], v[16:19], v[212:215], v[20:23]
    v_mfma_f32_16x16x32_bf16 v[24:27], v[16:19], v[184:187], v[24:27]
    v_mfma_f32_16x16x32_bf16 v[24:27], v[16:19], v[228:231], v[24:27]
    s_branch L_cs_4005
L_cs_4008:
    v_mfma_f32_16x16x32_bf16 v[20:23], v[16:19], v[172:175], v[20:23]
    v_mfma_f32_16x16x32_bf16 v[20:23], v[16:19], v[216:219], v[20:23]
L_cs_4005:
    s_sub_u32 s86, s86, 1
    s_waitcnt vmcnt(8)
    s_call_b64 s[100:101], L_sub_c1_2
    v_add_u32 v8, s80, v6
    v_xor_b32 v9, 64, v8
    s_add_u32 s80, s80, 32768
    s_cmp_ge_u32 s80, 98304
    s_cselect_b32 s80, 0, s80
    ds_read_b64_tr_b16 v[160:161], v14 offset:0
    s_add_u32 m0, s81, 0
    ds_read_b64_tr_b16 v[162:163], v14 offset:512
    buffer_load_dwordx4 v2, s[20:23], s45 offen  lds
    ds_read_b64_tr_b16 v[204:205], v14 offset:4096
    ds_read_b64_tr_b16 v[206:207], v14 offset:4608
    ds_read_b128 v[144:147], v8 offset:0
    s_add_u32 m0, s81, 4096
    ds_read_b128 v[148:151], v8 offset:2048
    buffer_load_dwordx4 v3, s[20:23], s45 offen  lds
    ds_read_b128 v[152:155], v8 offset:4096
    ds_read_b128 v[156:159], v8 offset:6144
    ds_read_b128 v[188:191], v9 offset:0
    s_add_u32 m0, s81, 8192
    ds_read_b128 v[192:195], v9 offset:2048
    buffer_load_dwordx4 v4, s[20:23], s45 offen  lds
    ds_read_b128 v[196:199], v9 offset:4096
    ds_read_b128 v[200:203], v9 offset:6144
    ds_read_b64_tr_b16 v[164:165], v10 offset:0
    s_add_u32 m0, s81, 12288
    ds_read_b64_tr_b16 v[166:167], v10 offset:512
    buffer_load_dwordx4 v5, s[20:23], s45 offen  lds
    ds_read_b64_tr_b16 v[208:209], v10 offset:4096
    ds_read_b64_tr_b16 v[210:211], v10 offset:4608
    ds_read_b64_tr_b16 v[168:169], v11 offset:0
    s_add_u32 m0, s81, 16384
    ds_read_b64_tr_b16 v[170:171], v11 offset:512
    buffer_load_dwordx4 v2, s[20:23], s82 offen  lds
    ds_read_b64_tr_b16 v[212:213], v11 offset:4096
    ds_read_b64_tr_b16 v[214:215], v11 offset:4608
    ds_read_b64_tr_b16 v[172:173], v12 offset:0
    s_add_u32 m0, s81, 20480
    ds_read_b64_tr_b16 v[174:175], v12 offset:512
    buffer_load_dwordx4 v3, s[20:23], s82 offen  lds
    ds_read_b64_tr_b16 v[216:217], v12 offset:4096
    ds_read_b64_tr_b16 v[218:219], v12 offset:4608
    ds_read_b64_tr_b16 v[176:177], v13 offset:0
    s_add_u32 m0, s81, 24576
    ds_read_b64_tr_b16 v[178:179], v13 offset:512
    buffer_load_dwordx4 v4, s[20:23], s82 offen  lds
    ds_read_b64_tr_b16 v[220:221], v13 offset:4096
    ds_read_b64_tr_b16 v[222:223], v13 offset:4608
    ds_read_b64_tr_b16 v[180:181], v10 offset:8192
    s_add_u32 m0, s81, 28672
    ds_read_b64_tr_b16 v[182:183], v10 offset:8704
    buffer_load_dwordx4 v5, s[20:23], s82 offen  lds
    ds_read_b64_tr_b16 v[224:225], v10 offset:12288
    ds_read_b64_tr_b16 v[226:227], v10 offset:12800
    ds_read_b64_tr_b16 v[184:185], v11 offset:8192
    ds_read_b64_tr_b16 v[186:187], v11 offset:8704
    ds_read_b64_tr_b16 v[228:229], v11 offset:12288
    ds_read_b64_tr_b16 v[230:231], v11 offset:12800
    s_add_u32 s45, s45, 128
    s_and_b32 s45, s45, 0x7ff
    s_add_u32 s82, s45, 0x40000
    s_add_u32 s81, s81, 32768
    s_cmp_ge_u32 s81, 98304
    s_cselect_b32 s81, s48, s81
    s_waitcnt lgkmcnt(0)
    s_cmp_lg_u32 s86, 0
    s_cbranch_scc1 L_cs_4009
    s_cmp_lg_u32 s43, 0
    s_cbranch_scc1 L_cs_4010
    v_mfma_f32_16x16x32_bf16 v[20:23], v[16:19], v[160:163], v[20:23]
    v_mfma_f32_16x16x32_bf16 v[20:23], v[16:19], v[204:207], v[20:23]
    v_mfma_f32_16x16x32_bf16 v[24:27], v[16:19], v[176:179], v[24:27]
    v_mfma_f32_16x16x32_bf16 v[24:27], v[16:19], v[220:223], v[24:27]
    s_branch L_cs_4009
L_cs_4010:
    s_cmp_lg_u32 s43, 1
    s_cbranch_scc1 L_cs_4011
    v_mfma_f32_16x16x32_bf16 v[20:23], v[16:19], v[164:167], v[20:23]
    v_mfma_f32_16x16x32_bf16 v[20:23], v[16:19], v[208:211], v[20:23]
    v_mfma_f32_16x16x32_bf16 v[24:27], v[16:19], v[180:183], v[24:27]
    v_mfma_f32_16x16x32_bf16 v[24:27], v[16:19], v[224:227], v[24:27]
    s_branch L_cs_4009
L_cs_4011:
    s_cmp_lg_u32 s43, 2
    s_cbranch_scc1 L_cs_4012
    v_mfma_f32_16x16x32_bf16 v[20:23], v[16:19], v[168:171], v[20:23]
    v_mfma_f32_16x16x32_bf16 v[20:23], v[16:19], v[212:215], v[20:23]
    v_mfma_f32_16x16x32_bf16 v[24:27], v[16:19], v[184:187], v[24:27]
    v_mfma_f32_16x16x32_bf16 v[24:27], v[16:19], v[228:231], v[24:27]
    s_branch L_cs_4009
L_cs_4012:
    v_mfma_f32_16x16x32_bf16 v[20:23], v[16:19], v[172:175], v[20:23]
    v_mfma_f32_16x16x32_bf16 v[20:23], v[16:19], v[216:219], v[20:23]
L_cs_4009:
    s_waitcnt vmcnt(8)
    s_call_b64 s[100:101], L_sub_c1_1
    v_add_u32 v8, s80, v6
    v_xor_b32 v9, 64, v8
    s_add_u32 s80, s80, 32768
    s_cmp_ge_u32 s80, 98304
    s_cselect_b32 s80, 0, s80
    ds_read_b64_tr_b16 v[160:161], v14 offset:32768
    s_add_u32 m0, s81, 0
    ds_read_b64_tr_b16 v[162:163], v14 offset:33280
    buffer_load_dwordx4 v2, s[20:23], s45 offen  lds
    ds_read_b64_tr_b16 v[204:205], v14 offset:36864
    ds_read_b64_tr_b16 v[206:207], v14 offset:37376
    ds_read_b128 v[144:147], v8 offset:0
    s_add_u32 m0, s81, 4096
    ds_read_b128 v[148:151], v8 offset:2048
    buffer_load_dwordx4 v3, s[20:23], s45 offen  lds
    ds_read_b128 v[152:155], v8 offset:4096
    ds_read_b128 v[156:159], v8 offset:6144
    ds_read_b128 v[188:191], v9 offset:0
    s_add_u32 m0, s81, 8192
    ds_read_b128 v[192:195], v9 offset:2048
    buffer_load_dwordx4 v4, s[20:23], s45 offen  lds
    ds_read_b128 v[196:199], v9 offset:4096
    ds_read_b128 v[200:203], v9 offset:6144
    ds_read_b64_tr_b16 v[164:165], v10 offset:32768
    s_add_u32 m0, s81, 12288
    ds_read_b64_tr_b16 v[166:167], v10 offset:33280
    buffer_load_dwordx4 v5, s[20:23], s45 offen  lds
    ds_read_b64_tr_b16 v[208:209], v10 offset:36864
    ds_read_b64_tr_b16 v[210:211], v10 offset:37376
    ds_read_b64_tr_b16 v[168:169], v11 offset:32768
    s_add_u32 m0, s81, 16384
    ds_read_b64_tr_b16 v[170:171], v11 offset:33280
    buffer_load_dwordx4 v2, s[20:23], s82 offen  lds
    ds_read_b64_tr_b16 v[212:213], v11 offset:36864
    ds_read_b64_tr_b16 v[214:215], v11 offset:37376
    ds_read_b64_tr_b16 v[172:173], v12 offset:32768
    s_add_u32 m0, s81, 20480
    ds_read_b64_tr_b16 v[174:175], v12 offset:33280
    buffer_load_dwordx4 v3, s[20:23], s82 offen  lds
    ds_read_b64_tr_b16 v[216:217], v12 offset:36864
    ds_read_b64_tr_b16 v[218:219], v12 offset:37376
    ds_read_b64_tr_b16 v[176:177], v13 offset:32768
    s_add_u32 m0, s81, 24576
    ds_read_b64_tr_b16 v[178:179], v13 offset:33280
    buffer_load_dwordx4 v4, s[20:23], s82 offen  lds
    ds_read_b64_tr_b16 v[220:221], v13 offset:36864
    ds_read_b64_tr_b16 v[222:223], v13 offset:37376
    ds_read_b64_tr_b16 v[180:181], v10 offset:40960
    s_add_u32 m0, s81, 28672
    ds_read_b64_tr_b16 v[182:183], v10 offset:41472
    buffer_load_dwordx4 v5, s[20:23], s82 offen  lds
    ds_read_b64_tr_b16 v[224:225], v10 offset:45056
    ds_read_b64_tr_b16 v[226:227], v10 offset:45568
    ds_read_b64_tr_b16 v[184:185], v11 offset:40960
    ds_read_b64_tr_b16 v[186:187], v11 offset:41472
    ds_read_b64_tr_b16 v[228:229], v11 offset:45056
    ds_read_b64_tr_b16 v[230:231], v11 offset:45568
    s_add_u32 s45, s45, 128
    s_and_b32 s45, s45, 0x7ff
    s_add_u32 s82, s45, 0x40000
    s_add_u32 s81, s81, 32768
    s_cmp_ge_u32 s81, 98304
    s_cselect_b32 s81, s48, s81
    s_bfe_u32 s50, s2, 131075
    s_lshl_b32 s50, s50, 2
    s_add_u32 s50, s50, s43
    s_cmp_lg_u32 s50, 0
    s_cbranch_scc1 L_sig_4013
    s_mov_b64 exec, 1
    v_mov_b32 v15, 1
    buffer_store_byte v15, off, s[32:35], s2 sc1
    s_mov_b64 exec, -1
L_sig_4013:
    s_waitcnt lgkmcnt(0)
    s_cmp_lg_u32 s86, 0
    s_cbranch_scc1 L_cs_4014
    s_cmp_lg_u32 s43, 0
    s_cbranch_scc1 L_cs_4015
    v_mfma_f32_16x16x32_bf16 v[20:23], v[16:19], v[160:163], v[20:23]
    v_mfma_f32_16x16x32_bf16 v[20:23], v[16:19], v[204:207], v[20:23]
    v_mfma_f32_16x16x32_bf16 v[24:27], v[16:19], v[176:179], v[24:27]
    v_mfma_f32_16x16x32_bf16 v[24:27], v[16:19], v[220:223], v[24:27]
    s_branch L_cs_4014
L_cs_4015:
    s_cmp_lg_u32 s43, 1
    s_cbranch_scc1 L_cs_4016
    v_mfma_f32_16x16x32_bf16 v[20:23], v[16:19], v[164:167], v[20:23]
    v_mfma_f32_16x16x32_bf16 v[20:23], v[16:19], v[208:211], v[20:23]
    v_mfma_f32_16x16x32_bf16 v[24:27], v[16:19], v[180:183], v[24:27]
    v_mfma_f32_16x16x32_bf16 v[24:27], v[16:19], v[224:227], v[24:27]
    s_branch L_cs_4014
L_cs_4016:
    s_cmp_lg_u32 s43, 2
    s_cbranch_scc1 L_cs_4017
    v_mfma_f32_16x16x32_bf16 v[20:23], v[16:19], v[168:171], v[20:23]
    v_mfma_f32_16x16x32_bf16 v[20:23], v[16:19], v[212:215], v[20:23]
    v_mfma_f32_16x16x32_bf16 v[24:27], v[16:19], v[184:187], v[24:27]
    v_mfma_f32_16x16x32_bf16 v[24:27], v[16:19], v[228:231], v[24:27]
    s_branch L_cs_4014
L_cs_4017:
    v_mfma_f32_16x16x32_bf16 v[20:23], v[16:19], v[172:175], v[20:23]
    v_mfma_f32_16x16x32_bf16 v[20:23], v[16:19], v[216:219], v[20:23]
L_cs_4014:
    s_sub_u32 s86, s86, 1
    s_call_b64 s[100:101], L_sub_c1_2
    v_add_u32 v8, s80, v6
    v_xor_b32 v9, 64, v8
    s_add_u32 s80, s80, 32768
    s_cmp_ge_u32 s80, 98304
    s_cselect_b32 s80, 0, s80
    ds_read_b64_tr_b16 v[160:161], v14 offset:0
    s_add_u32 m0, s81, 0
    ds_read_b64_tr_b16 v[162:163], v14 offset:512
    buffer_load_dwordx4 v2, s[20:23], s45 offen  lds
    ds_read_b64_tr_b16 v[204:205], v14 offset:4096
    ds_read_b64_tr_b16 v[206:207], v14 offset:4608
    ds_read_b128 v[144:147], v8 offset:0
    s_add_u32 m0, s81, 4096
    ds_read_b128 v[148:151], v8 offset:2048
    buffer_load_dwordx4 v3, s[20:23], s45 offen  lds
    ds_read_b128 v[152:155], v8 offset:4096
    ds_read_b128 v[156:159], v8 offset:6144
    ds_read_b128 v[188:191], v9 offset:0
    s_add_u32 m0, s81, 8192
    ds_read_b128 v[192:195], v9 offset:2048
    buffer_load_dwordx4 v4, s[20:23], s45 offen  lds
    ds_read_b128 v[196:199], v9 offset:4096
    ds_read_b128 v[200:203], v9 offset:6144
    ds_read_b64_tr_b16 v[164:165], v10 offset:0
    s_add_u32 m0, s81, 12288
    ds_read_b64_tr_b16 v[166:167], v10 offset:512
    buffer_load_dwordx4 v5, s[20:23], s45 offen  lds
    ds_read_b64_tr_b16 v[208:209], v10 offset:4096
    ds_read_b64_tr_b16 v[210:211], v10 offset:4608
    ds_read_b64_tr_b16 v[168:169], v11 offset:0
    s_add_u32 m0, s81, 16384
    ds_read_b64_tr_b16 v[170:171], v11 offset:512
    buffer_load_dwordx4 v2, s[20:23], s82 offen  lds
    ds_read_b64_tr_b16 v[212:213], v11 offset:4096
    ds_read_b64_tr_b16 v[214:215], v11 offset:4608
    ds_read_b64_tr_b16 v[172:173], v12 offset:0
    s_add_u32 m0, s81, 20480
    ds_read_b64_tr_b16 v[174:175], v12 offset:512
    buffer_load_dwordx4 v3, s[20:23], s82 offen  lds
    ds_read_b64_tr_b16 v[216:217], v12 offset:4096
    ds_read_b64_tr_b16 v[218:219], v12 offset:4608
    ds_read_b64_tr_b16 v[176:177], v13 offset:0
    s_add_u32 m0, s81, 24576
    ds_read_b64_tr_b16 v[178:179], v13 offset:512
    buffer_load_dwordx4 v4, s[20:23], s82 offen  lds
    ds_read_b64_tr_b16 v[220:221], v13 offset:4096
    ds_read_b64_tr_b16 v[222:223], v13 offset:4608
    ds_read_b64_tr_b16 v[180:181], v10 offset:8192
    s_add_u32 m0, s81, 28672
    ds_read_b64_tr_b16 v[182:183], v10 offset:8704
    buffer_load_dwordx4 v5, s[20:23], s82 offen  lds
    ds_read_b64_tr_b16 v[224:225], v10 offset:12288
    ds_read_b64_tr_b16 v[226:227], v10 offset:12800
    ds_read_b64_tr_b16 v[184:185], v11 offset:8192
    ds_read_b64_tr_b16 v[186:187], v11 offset:8704
    ds_read_b64_tr_b16 v[228:229], v11 offset:12288
    ds_read_b64_tr_b16 v[230:231], v11 offset:12800
    s_add_u32 s45, s45, 128
    s_and_b32 s45, s45, 0x7ff
    s_add_u32 s82, s45, 0x40000
    s_add_u32 s81, s81, 32768
    s_cmp_ge_u32 s81, 98304
    s_cselect_b32 s81, s48, s81
    s_bfe_u32 s50, s2, 131075
    s_lshl_b32 s50, s50, 2
    s_add_u32 s50, s50, s43
    s_cmp_lg_u32 s50, 4
    s_cbranch_scc1 L_sig_4018
    s_mov_b64 exec, 1
    v_mov_b32 v15, 1
    buffer_store_byte v15, off, s[32:35], s2 sc1
    s_mov_b64 exec, -1
L_sig_4018:
    s_waitcnt lgkmcnt(0)
    s_cmp_lg_u32 s86, 0
    s_cbranch_scc1 L_cs_4019
    s_cmp_lg_u32 s43, 0
    s_cbranch_scc1 L_cs_4020
    v_mfma_f32_16x16x32_bf16 v[20:23], v[16:19], v[160:163], v[20:23]
    v_mfma_f32_16x16x32_bf16 v[20:23], v[16:19], v[204:207], v[20:23]
    v_mfma_f32_16x16x32_bf16 v[24:27], v[16:19], v[176:179], v[24:27]
    v_mfma_f32_16x16x32_bf16 v[24:27], v[16:19], v[220:223], v[24:27]
    s_branch L_cs_4019
L_cs_4020:
    s_cmp_lg_u32 s43, 1
    s_cbranch_scc1 L_cs_4021
    v_mfma_f32_16x16x32_bf16 v[20:23], v[16:19], v[164:167], v[20:23]
    v_mfma_f32_16x16x32_bf16 v[20:23], v[16:19], v[208:211], v[20:23]
    v_mfma_f32_16x16x32_bf16 v[24:27], v[16:19], v[180:183], v[24:27]
    v_mfma_f32_16x16x32_bf16 v[24:27], v[16:19], v[224:227], v[24:27]
    s_branch L_cs_4019
L_cs_4021:
    s_cmp_lg_u32 s43, 2
    s_cbranch_scc1 L_cs_4022
    v_mfma_f32_16x16x32_bf16 v[20:23], v[16:19], v[168:171], v[20:23]
    v_mfma_f32_16x16x32_bf16 v[20:23], v[16:19], v[212:215], v[20:23]
    v_mfma_f32_16x16x32_bf16 v[24:27], v[16:19], v[184:187], v[24:27]
    v_mfma_f32_16x16x32_bf16 v[24:27], v[16:19], v[228:231], v[24:27]
    s_branch L_cs_4019
L_cs_4022:
    v_mfma_f32_16x16x32_bf16 v[20:23], v[16:19], v[172:175], v[20:23]
    v_mfma_f32_16x16x32_bf16 v[20:23], v[16:19], v[216:219], v[20:23]
L_cs_4019:
    s_waitcnt vmcnt(8)
    s_call_b64 s[100:101], L_sub_c1_2
    v_add_u32 v8, s80, v6
    v_xor_b32 v9, 64, v8
    s_add_u32 s80, s80, 32768
    s_cmp_ge_u32 s80, 98304
    s_cselect_b32 s80, 0, s80
    ds_read_b64_tr_b16 v[160:161], v14 offset:32768
    s_add_u32 m0, s81, 0
    ds_read_b64_tr_b16 v[162:163], v14 offset:33280
    buffer_load_dwordx4 v2, s[20:23], s45 offen  lds
    ds_read_b64_tr_b16 v[204:205], v14 offset:36864
    ds_read_b64_tr_b16 v[206:207], v14 offset:37376
    ds_read_b128 v[144:147], v8 offset:0
    s_add_u32 m0, s81, 4096
    ds_read_b128 v[148:151], v8 offset:2048
    buffer_load_dwordx4 v3, s[20:23], s45 offen  lds
    ds_read_b128 v[152:155], v8 offset:4096
    ds_read_b128 v[156:159], v8 offset:6144
    ds_read_b128 v[188:191], v9 offset:0
    s_add_u32 m0, s81, 8192
    ds_read_b128 v[192:195], v9 offset:2048
    buffer_load_dwordx4 v4, s[20:23], s45 offen  lds
    ds_read_b128 v[196:199], v9 offset:4096
    ds_read_b128 v[200:203], v9 offset:6144
    ds_read_b64_tr_b16 v[164:165], v10 offset:32768
    s_add_u32 m0, s81, 12288
    ds_read_b64_tr_b16 v[166:167], v10 offset:33280
    buffer_load_dwordx4 v5, s[20:23], s45 offen  lds
    ds_read_b64_tr_b16 v[208:209], v10 offset:36864
    ds_read_b64_tr_b16 v[210:211], v10 offset:37376
    ds_read_b64_tr_b16 v[168:169], v11 offset:32768
    s_add_u32 m0, s81, 16384
    ds_read_b64_tr_b16 v[170:171], v11 offset:33280
    buffer_load_dwordx4 v2, s[20:23], s82 offen  lds
    ds_read_b64_tr_b16 v[212:213], v11 offset:36864
    ds_read_b64_tr_b16 v[214:215], v11 offset:37376
    ds_read_b64_tr_b16 v[172:173], v12 offset:32768
    s_add_u32 m0, s81, 20480
    ds_read_b64_tr_b16 v[174:175], v12 offset:33280
    buffer_load_dwordx4 v3, s[20:23], s82 offen  lds
    ds_read_b64_tr_b16 v[216:217], v12 offset:36864
    ds_read_b64_tr_b16 v[218:219], v12 offset:37376
    ds_read_b64_tr_b16 v[176:177], v13 offset:32768
    s_add_u32 m0, s81, 24576
    ds_read_b64_tr_b16 v[178:179], v13 offset:33280
    buffer_load_dwordx4 v4, s[20:23], s82 offen  lds
    ds_read_b64_tr_b16 v[220:221], v13 offset:36864
    ds_read_b64_tr_b16 v[222:223], v13 offset:37376
    ds_read_b64_tr_b16 v[180:181], v10 offset:40960
    s_add_u32 m0, s81, 28672
    ds_read_b64_tr_b16 v[182:183], v10 offset:41472
    buffer_load_dwordx4 v5, s[20:23], s82 offen  lds
    ds_read_b64_tr_b16 v[224:225], v10 offset:45056
    ds_read_b64_tr_b16 v[226:227], v10 offset:45568
    ds_read_b64_tr_b16 v[184:185], v11 offset:40960
    ds_read_b64_tr_b16 v[186:187], v11 offset:41472
    ds_read_b64_tr_b16 v[228:229], v11 offset:45056
    ds_read_b64_tr_b16 v[230:231], v11 offset:45568
    s_add_u32 s45, s45, 128
    s_and_b32 s45, s45, 0x7ff
    s_add_u32 s82, s45, 0x40000
    s_add_u32 s81, s81, 32768
    s_cmp_ge_u32 s81, 98304
    s_cselect_b32 s81, s48, s81
    s_bfe_u32 s50, s2, 131075
    s_lshl_b32 s50, s50, 2
    s_add_u32 s50, s50, s43
    s_cmp_lg_u32 s50, 8
    s_cbranch_scc1 L_sig_4023
    s_mov_b64 exec, 1
    v_mov_b32 v15, 1
    buffer_store_byte v15, off, s[32:35], s2 sc1
    s_mov_b64 exec, -1
L_sig_4023:
    s_waitcnt lgkmcnt(0)
    s_cmp_lg_u32 s86, 0
    s_cbranch_scc1 L_cs_4024
    s_cmp_lg_u32 s43, 0
    s_cbranch_scc1 L_cs_4025
    v_mfma_f32_16x16x32_bf16 v[20:23], v[16:19], v[160:163], v[20:23]
    v_mfma_f32_16x16x32_bf16 v[20:23], v[16:19], v[204:207], v[20:23]
    v_mfma_f32_16x16x32_bf16 v[24:27], v[16:19], v[176:179], v[24:27]
    v_mfma_f32_16x16x32_bf16 v[24:27], v[16:19], v[220:223], v[24:27]
    s_branch L_cs_4024
L_cs_4025:
    s_cmp_lg_u32 s43, 1
    s_cbranch_scc1 L_cs_4026
    v_mfma_f32_16x16x32_bf16 v[20:23], v[16:19], v[164:167], v[20:23]
    v_mfma_f32_16x16x32_bf16 v[20:23], v[16:19], v[208:211], v[20:23]
    v_mfma_f32_16x16x32_bf16 v[24:27], v[16:19], v[180:183], v[24:27]
    v_mfma_f32_16x16x32_bf16 v[24:27], v[16:19], v[224:227], v[24:27]
    s_branch L_cs_4024
L_cs_4026:
    s_cmp_lg_u32 s43, 2
    s_cbranch_scc1 L_cs_4027
    v_mfma_f32_16x16x32_bf16 v[20:23], v[16:19], v[168:171], v[20:23]
    v_mfma_f32_16x16x32_bf16 v[20:23], v[16:19], v[212:215], v[20:23]
    v_mfma_f32_16x16x32_bf16 v[24:27], v[16:19], v[184:187], v[24:27]
    v_mfma_f32_16x16x32_bf16 v[24:27], v[16:19], v[228:231], v[24:27]
    s_branch L_cs_4024
L_cs_4027:
    v_mfma_f32_16x16x32_bf16 v[20:23], v[16:19], v[172:175], v[20:23]
    v_mfma_f32_16x16x32_bf16 v[20:23], v[16:19], v[216:219], v[20:23]
L_cs_4024:
    s_sub_u32 s86, s86, 1
    s_waitcnt vmcnt(8)
    s_call_b64 s[100:101], L_sub_c1_2
    v_add_u32 v8, s80, v6
    v_xor_b32 v9, 64, v8
    s_add_u32 s80, s80, 32768
    s_cmp_ge_u32 s80, 98304
    s_cselect_b32 s80, 0, s80
    ds_read_b64_tr_b16 v[160:161], v14 offset:0
    s_add_u32 m0, s81, 0
    ds_read_b64_tr_b16 v[162:163], v14 offset:512
    buffer_load_dwordx4 v2, s[20:23], s45 offen  lds
    ds_read_b64_tr_b16 v[204:205], v14 offset:4096
    ds_read_b64_tr_b16 v[206:207], v14 offset:4608
    ds_read_b128 v[144:147], v8 offset:0
    s_add_u32 m0, s81, 4096
    ds_read_b128 v[148:151], v8 offset:2048
    buffer_load_dwordx4 v3, s[20:23], s45 offen  lds
    ds_read_b128 v[152:155], v8 offset:4096
    ds_read_b128 v[156:159], v8 offset:6144
    ds_read_b128 v[188:191], v9 offset:0
    s_add_u32 m0, s81, 8192
    ds_read_b128 v[192:195], v9 offset:2048
    buffer_load_dwordx4 v4, s[20:23], s45 offen  lds
    ds_read_b128 v[196:199], v9 offset:4096
    ds_read_b128 v[200:203], v9 offset:6144
    ds_read_b64_tr_b16 v[164:165], v10 offset:0
    s_add_u32 m0, s81, 12288
    ds_read_b64_tr_b16 v[166:167], v10 offset:512
    buffer_load_dwordx4 v5, s[20:23], s45 offen  lds
    ds_read_b64_tr_b16 v[208:209], v10 offset:4096
    ds_read_b64_tr_b16 v[210:211], v10 offset:4608
    ds_read_b64_tr_b16 v[168:169], v11 offset:0
    s_add_u32 m0, s81, 16384
    ds_read_b64_tr_b16 v[170:171], v11 offset:512
    buffer_load_dwordx4 v2, s[20:23], s82 offen  lds
    ds_read_b64_tr_b16 v[212:213], v11 offset:4096
    ds_read_b64_tr_b16 v[214:215], v11 offset:4608
    ds_read_b64_tr_b16 v[172:173], v12 offset:0
    s_add_u32 m0, s81, 20480
    ds_read_b64_tr_b16 v[174:175], v12 offset:512
    buffer_load_dwordx4 v3, s[20:23], s82 offen  lds
    ds_read_b64_tr_b16 v[216:217], v12 offset:4096
    ds_read_b64_tr_b16 v[218:219], v12 offset:4608
    ds_read_b64_tr_b16 v[176:177], v13 offset:0
    s_add_u32 m0, s81, 24576
    ds_read_b64_tr_b16 v[178:179], v13 offset:512
    buffer_load_dwordx4 v4, s[20:23], s82 offen  lds
    ds_read_b64_tr_b16 v[220:221], v13 offset:4096
    ds_read_b64_tr_b16 v[222:223], v13 offset:4608
    ds_read_b64_tr_b16 v[180:181], v10 offset:8192
    s_add_u32 m0, s81, 28672
    ds_read_b64_tr_b16 v[182:183], v10 offset:8704
    buffer_load_dwordx4 v5, s[20:23], s82 offen  lds
    ds_read_b64_tr_b16 v[224:225], v10 offset:12288
    ds_read_b64_tr_b16 v[226:227], v10 offset:12800
    ds_read_b64_tr_b16 v[184:185], v11 offset:8192
    ds_read_b64_tr_b16 v[186:187], v11 offset:8704
    ds_read_b64_tr_b16 v[228:229], v11 offset:12288
    ds_read_b64_tr_b16 v[230:231], v11 offset:12800
    s_add_u32 s45, s45, 128
    s_and_b32 s45, s45, 0x7ff
    s_add_u32 s82, s45, 0x40000
    s_add_u32 s81, s81, 32768
    s_cmp_ge_u32 s81, 98304
    s_cselect_b32 s81, s48, s81
    s_bfe_u32 s50, s2, 131075
    s_lshl_b32 s50, s50, 2
    s_add_u32 s50, s50, s43
    s_cmp_lg_u32 s50, 12
    s_cbranch_scc1 L_sig_4028
    s_mov_b64 exec, 1
    v_mov_b32 v15, 1
    buffer_store_byte v15, off, s[32:35], s2 sc1
    s_mov_b64 exec, -1
L_sig_4028:
    s_waitcnt lgkmcnt(0)
    s_load_dword s90, s[88:89], 0
    s_load_dword s90, s[88:89], 64
    s_load_dword s90, s[88:89], 128
    s_load_dword s90, s[88:89], 192
    s_load_dword s90, s[88:89], 256
    s_load_dword s90, s[88:89], 320
    s_load_dword s90, s[88:89], 384
    s_load_dword s90, s[88:89], 448
    s_cmp_lg_u32 s86, 0
    s_cbranch_scc1 L_cs_4029
    s_cmp_lg_u32 s43, 0
    s_cbranch_scc1 L_cs_4030
    v_mfma_f32_16x16x32_bf16 v[20:23], v[16:19], v[160:163], v[20:23]
    v_mfma_f32_16x16x32_bf16 v[20:23], v[16:19], v[204:207], v[20:23]
    v_mfma_f32_16x16x32_bf16 v[24:27], v[16:19], v[176:179], v[24:27]
    v_mfma_f32_16x16x32_bf16 v[24:27], v[16:19], v[220:223], v[24:27]
    s_branch L_cs_4029
L_cs_4030:
    s_cmp_lg_u32 s43, 1
    s_cbranch_scc1 L_cs_4031
    v_mfma_f32_16x16x32_bf16 v[20:23], v[16:19], v[164:167], v[20:23]
    v_mfma_f32_16x16x32_bf16 v[20:23], v[16:19], v[208:211], v[20:23]
    v_mfma_f32_16x16x32_bf16 v[24:27], v[16:19], v[180:183], v[24:27]
    v_mfma_f32_16x16x32_bf16 v[24:27], v[16:19], v[224:227], v[24:27]
    s_branch L_cs_4029
L_cs_4031:
    s_cmp_lg_u32 s43, 2
    s_cbranch_scc1 L_cs_4032
    v_mfma_f32_16x16x32_bf16 v[20:23], v[16:19], v[168:171], v[20:23]
    v_mfma_f32_16x16x32_bf16 v[20:23], v[16:19], v[212:215], v[20:23]
    v_mfma_f32_16x16x32_bf16 v[24:27], v[16:19], v[184:187], v[24:27]
    v_mfma_f32_16x16x32_bf16 v[24:27], v[16:19], v[228:231], v[24:27]
    s_branch L_cs_4029
L_cs_4032:
    v_mfma_f32_16x16x32_bf16 v[20:23], v[16:19], v[172:175], v[20:23]
    v_mfma_f32_16x16x32_bf16 v[20:23], v[16:19], v[216:219], v[20:23]
L_cs_4029:
    s_waitcnt vmcnt(8)
    s_call_b64 s[100:101], L_sub_c1_2
    v_add_u32 v8, s80, v6
    v_xor_b32 v9, 64, v8
    s_add_u32 s80, s80, 32768
    s_cmp_ge_u32 s80, 98304
    s_cselect_b32 s80, 0, s80
    ds_read_b64_tr_b16 v[160:161], v14 offset:32768
    s_add_u32 m0, s81, 0
    ds_read_b64_tr_b16 v[162:163], v14 offset:33280
    buffer_load_dwordx4 v2, s[20:23], s45 offen  lds
    ds_read_b64_tr_b16 v[204:205], v14 offset:36864
    ds_read_b64_tr_b16 v[206:207], v14 offset:37376
    ds_read_b128 v[144:147], v8 offset:0
    s_add_u32 m0, s81, 4096
    ds_read_b128 v[148:151], v8 offset:2048
    buffer_load_dwordx4 v3, s[20:23], s45 offen  lds
    ds_read_b128 v[152:155], v8 offset:4096
    ds_read_b128 v[156:159], v8 offset:6144
    ds_read_b128 v[188:191], v9 offset:0
    s_add_u32 m0, s81, 8192
    ds_read_b128 v[192:195], v9 offset:2048
    buffer_load_dwordx4 v4, s[20:23], s45 offen  lds
    ds_read_b128 v[196:199], v9 offset:4096
    ds_read_b128 v[200:203], v9 offset:6144
    ds_read_b64_tr_b16 v[164:165], v10 offset:32768
    s_add_u32 m0, s81, 12288
    ds_read_b64_tr_b16 v[166:167], v10 offset:33280
    buffer_load_dwordx4 v5, s[20:23], s45 offen  lds
    ds_read_b64_tr_b16 v[208:209], v10 offset:36864
    ds_read_b64_tr_b16 v[210:211], v10 offset:37376
    ds_read_b64_tr_b16 v[168:169], v11 offset:32768
    s_add_u32 m0, s81, 16384
    ds_read_b64_tr_b16 v[170:171], v11 offset:33280
    buffer_load_dwordx4 v2, s[20:23], s82 offen  lds
    ds_read_b64_tr_b16 v[212:213], v11 offset:36864
    ds_read_b64_tr_b16 v[214:215], v11 offset:37376
    ds_read_b64_tr_b16 v[172:173], v12 offset:32768
    s_add_u32 m0, s81, 20480
    ds_read_b64_tr_b16 v[174:175], v12 offset:33280
    buffer_load_dwordx4 v3, s[20:23], s82 offen  lds
    ds_read_b64_tr_b16 v[216:217], v12 offset:36864
    ds_read_b64_tr_b16 v[218:219], v12 offset:37376
    ds_read_b64_tr_b16 v[176:177], v13 offset:32768
    s_add_u32 m0, s81, 24576
    ds_read_b64_tr_b16 v[178:179], v13 offset:33280
    buffer_load_dwordx4 v4, s[20:23], s82 offen  lds
    ds_read_b64_tr_b16 v[220:221], v13 offset:36864
    ds_read_b64_tr_b16 v[222:223], v13 offset:37376
    ds_read_b64_tr_b16 v[180:181], v10 offset:40960
    s_add_u32 m0, s81, 28672
    ds_read_b64_tr_b16 v[182:183], v10 offset:41472
    buffer_load_dwordx4 v5, s[20:23], s82 offen  lds
    ds_read_b64_tr_b16 v[224:225], v10 offset:45056
    ds_read_b64_tr_b16 v[226:227], v10 offset:45568
    ds_read_b64_tr_b16 v[184:185], v11 offset:40960
    ds_read_b64_tr_b16 v[186:187], v11 offset:41472
    ds_read_b64_tr_b16 v[228:229], v11 offset:45056
    ds_read_b64_tr_b16 v[230:231], v11 offset:45568
    s_add_u32 s45, s45, 128
    s_and_b32 s45, s45, 0x7ff
    s_add_u32 s82, s45, 0x40000
    s_add_u32 s81, s81, 32768
    s_cmp_ge_u32 s81, 98304
    s_cselect_b32 s81, s48, s81
    s_add_u32 s88, s88, 512
    s_addc_u32 s89, s89, 0
    s_waitcnt lgkmcnt(0)
    s_load_dword s90, s[88:89], 0
    s_load_dword s90, s[88:89], 64
    s_load_dword s90, s[88:89], 128
    s_load_dword s90, s[88:89], 192
    s_load_dword s90, s[88:89], 256
    s_load_dword s90, s[88:89], 320
    s_load_dword s90, s[88:89], 384
    s_load_dword s90, s[88:89], 448
    s_cmp_lg_u32 s86, 0
    s_cbranch_scc1 L_cs_4033
    s_cmp_lg_u32 s43, 0
    s_cbranch_scc1 L_cs_4034
    v_mfma_f32_16x16x32_bf16 v[20:23], v[16:19], v[160:163], v[20:23]
    v_mfma_f32_16x16x32_bf16 v[20:23], v[16:19], v[204:207], v[20:23]
    v_mfma_f32_16x16x32_bf16 v[24:27], v[16:19], v[176:179], v[24:27]
    v_mfma_f32_16x16x32_bf16 v[24:27], v[16:19], v[220:223], v[24:27]
    s_branch L_cs_4033
L_cs_4034:
    s_cmp_lg_u32 s43, 1
    s_cbranch_scc1 L_cs_4035
    v_mfma_f32_16x16x32_bf16 v[20:23], v[16:19], v[164:167], v[20:23]
    v_mfma_f32_16x16x32_bf16 v[20:23], v[16:19], v[208:211], v[20:23]
    v_mfma_f32_16x16x32_bf16 v[24:27], v[16:19], v[180:183], v[24:27]
    v_mfma_f32_16x16x32_bf16 v[24:27], v[16:19], v[224:227], v[24:27]
    s_branch L_cs_4033
L_cs_4035:
    s_cmp_lg_u32 s43, 2
    s_cbranch_scc1 L_cs_4036
    v_mfma_f32_16x16x32_bf16 v[20:23], v[16:19], v[168:171], v[20:23]
    v_mfma_f32_16x16x32_bf16 v[20:23], v[16:19], v[212:215], v[20:23]
    v_mfma_f32_16x16x32_bf16 v[24:27], v[16:19], v[184:187], v[24:27]
    v_mfma_f32_16x16x32_bf16 v[24:27], v[16:19], v[228:231], v[24:27]
    s_branch L_cs_4033
L_cs_4036:
    v_mfma_f32_16x16x32_bf16 v[20:23], v[16:19], v[172:175], v[20:23]
    v_mfma_f32_16x16x32_bf16 v[20:23], v[16:19], v[216:219], v[20:23]
L_cs_4033:
    s_sub_u32 s86, s86, 1
    s_waitcnt vmcnt(8)
    s_call_b64 s[100:101], L_sub_c1_2
    s_lshl_b32 s50, s41, 1
    s_add_u32 s50, s50, s44
    s_lshl_b32 s50, s50, 3
    s_add_u32 s50, s50, s40
    s_lshl_b32 s50, s50, 9
    s_lshl_b32 s51, s43, 2
    s_add_u32 s50, s50, s51
    s_add_u32 s50, s50, 19070976
    v_lshlrev_b32 v15, 5, v1
    s_mov_b64 exec, 0xffff
    buffer_store_dword v20, v15, s[28:31], s50 offen sc1
    buffer_store_dword v24, v15, s[28:31], s50 offen offset:16 sc1
    s_mov_b64 exec, -1
    v_add_u32 v8, s80, v6
    v_xor_b32 v9, 64, v8
    s_add_u32 s80, s80, 32768
    s_cmp_ge_u32 s80, 98304
    s_cselect_b32 s80, 0, s80
    ds_read_b64_tr_b16 v[160:161], v14 offset:0
    s_add_u32 m0, s81, 0
    ds_read_b64_tr_b16 v[162:163], v14 offset:512
    buffer_load_dwordx4 v2, s[20:23], s45 offen  lds
    ds_read_b64_tr_b16 v[204:205], v14 offset:4096
    ds_read_b64_tr_b16 v[206:207], v14 offset:4608
    ds_read_b128 v[144:147], v8 offset:0
    s_add_u32 m0, s81, 4096
    ds_read_b128 v[148:151], v8 offset:2048
    buffer_load_dwordx4 v3, s[20:23], s45 offen  lds
    ds_read_b128 v[152:155], v8 offset:4096
    ds_read_b128 v[156:159], v8 offset:6144
    ds_read_b128 v[188:191], v9 offset:0
    s_add_u32 m0, s81, 8192
    ds_read_b128 v[192:195], v9 offset:2048
    buffer_load_dwordx4 v4, s[20:23], s45 offen  lds
    ds_read_b128 v[196:199], v9 offset:4096
    ds_read_b128 v[200:203], v9 offset:6144
    ds_read_b64_tr_b16 v[164:165], v10 offset:0
    s_add_u32 m0, s81, 12288
    ds_read_b64_tr_b16 v[166:167], v10 offset:512
    buffer_load_dwordx4 v5, s[20:23], s45 offen  lds
    ds_read_b64_tr_b16 v[208:209], v10 offset:4096
    ds_read_b64_tr_b16 v[210:211], v10 offset:4608
    ds_read_b64_tr_b16 v[168:169], v11 offset:0
    s_add_u32 m0, s81, 16384
    ds_read_b64_tr_b16 v[170:171], v11 offset:512
    buffer_load_dwordx4 v2, s[20:23], s82 offen  lds
    ds_read_b64_tr_b16 v[212:213], v11 offset:4096
    ds_read_b64_tr_b16 v[214:215], v11 offset:4608
    ds_read_b64_tr_b16 v[172:173], v12 offset:0
    s_add_u32 m0, s81, 20480
    ds_read_b64_tr_b16 v[174:175], v12 offset:512
    buffer_load_dwordx4 v3, s[20:23], s82 offen  lds
    ds_read_b64_tr_b16 v[216:217], v12 offset:4096
    ds_read_b64_tr_b16 v[218:219], v12 offset:4608
    ds_read_b64_tr_b16 v[176:177], v13 offset:0
    s_add_u32 m0, s81, 24576
    ds_read_b64_tr_b16 v[178:179], v13 offset:512
    buffer_load_dwordx4 v4, s[20:23], s82 offen  lds
    ds_read_b64_tr_b16 v[220:221], v13 offset:4096
    ds_read_b64_tr_b16 v[222:223], v13 offset:4608
    ds_read_b64_tr_b16 v[180:181], v10 offset:8192
    s_add_u32 m0, s81, 28672
    ds_read_b64_tr_b16 v[182:183], v10 offset:8704
    buffer_load_dwordx4 v5, s[20:23], s82 offen  lds
    ds_read_b64_tr_b16 v[224:225], v10 offset:12288
    ds_read_b64_tr_b16 v[226:227], v10 offset:12800
    ds_read_b64_tr_b16 v[184:185], v11 offset:8192
    ds_read_b64_tr_b16 v[186:187], v11 offset:8704
    ds_read_b64_tr_b16 v[228:229], v11 offset:12288
    ds_read_b64_tr_b16 v[230:231], v11 offset:12800
    s_add_u32 s45, s45, 128
    s_and_b32 s45, s45, 0x7ff
    s_add_u32 s82, s45, 0x40000
    s_add_u32 s81, s81, 32768
    s_cmp_ge_u32 s81, 98304
    s_cselect_b32 s81, s48, s81
    s_add_u32 s88, s88, 512
    s_addc_u32 s89, s89, 0
    s_waitcnt lgkmcnt(0)
    s_load_dword s90, s[88:89], 0
    s_load_dword s90, s[88:89], 64
    s_load_dword s90, s[88:89], 128
    s_load_dword s90, s[88:89], 192
    s_load_dword s90, s[88:89], 256
    s_load_dword s90, s[88:89], 320
    s_load_dword s90, s[88:89], 384
    s_load_dword s90, s[88:89], 448
    s_waitcnt vmcnt(10)
    s_call_b64 s[100:101], L_sub_c1_2
    v_add_u32 v8, s80, v6
    v_xor_b32 v9, 64, v8
    s_add_u32 s80, s80, 32768
    s_cmp_ge_u32 s80, 98304
    s_cselect_b32 s80, 0, s80
    ds_read_b64_tr_b16 v[160:161], v14 offset:32768
    s_add_u32 m0, s81, 0
    ds_read_b64_tr_b16 v[162:163], v14 offset:33280
    buffer_load_dwordx4 v2, s[20:23], s45 offen  lds
    ds_read_b64_tr_b16 v[204:205], v14 offset:36864
    ds_read_b64_tr_b16 v[206:207], v14 offset:37376
    ds_read_b128 v[144:147], v8 offset:0
    s_add_u32 m0, s81, 4096
    ds_read_b128 v[148:151], v8 offset:2048
    buffer_load_dwordx4 v3, s[20:23], s45 offen  lds
    ds_read_b128 v[152:155], v8 offset:4096
    ds_read_b128 v[156:159], v8 offset:6144
    ds_read_b128 v[188:191], v9 offset:0
    s_add_u32 m0, s81, 8192
    ds_read_b128 v[192:195], v9 offset:2048
    buffer_load_dwordx4 v4, s[20:23], s45 offen  lds
    ds_read_b128 v[196:199], v9 offset:4096
    ds_read_b128 v[200:203], v9 offset:6144
    ds_read_b64_tr_b16 v[164:165], v10 offset:32768
    s_add_u32 m0, s81, 12288
    ds_read_b64_tr_b16 v[166:167], v10 offset:33280
    buffer_load_dwordx4 v5, s[20:23], s45 offen  lds
    ds_read_b64_tr_b16 v[208:209], v10 offset:36864
    ds_read_b64_tr_b16 v[210:211], v10 offset:37376
    ds_read_b64_tr_b16 v[168:169], v11 offset:32768
    s_add_u32 m0, s81, 16384
    ds_read_b64_tr_b16 v[170:171], v11 offset:33280
    buffer_load_dwordx4 v2, s[20:23], s82 offen  lds
    ds_read_b64_tr_b16 v[212:213], v11 offset:36864
    ds_read_b64_tr_b16 v[214:215], v11 offset:37376
    ds_read_b64_tr_b16 v[172:173], v12 offset:32768
    s_add_u32 m0, s81, 20480
    ds_read_b64_tr_b16 v[174:175], v12 offset:33280
    buffer_load_dwordx4 v3, s[20:23], s82 offen  lds
    ds_read_b64_tr_b16 v[216:217], v12 offset:36864
    ds_read_b64_tr_b16 v[218:219], v12 offset:37376
    ds_read_b64_tr_b16 v[176:177], v13 offset:32768
    s_add_u32 m0, s81, 24576
    ds_read_b64_tr_b16 v[178:179], v13 offset:33280
    buffer_load_dwordx4 v4, s[20:23], s82 offen  lds
    ds_read_b64_tr_b16 v[220:221], v13 offset:36864
    ds_read_b64_tr_b16 v[222:223], v13 offset:37376
    ds_read_b64_tr_b16 v[180:181], v10 offset:40960
    s_add_u32 m0, s81, 28672
    ds_read_b64_tr_b16 v[182:183], v10 offset:41472
    buffer_load_dwordx4 v5, s[20:23], s82 offen  lds
    ds_read_b64_tr_b16 v[224:225], v10 offset:45056
    ds_read_b64_tr_b16 v[226:227], v10 offset:45568
    ds_read_b64_tr_b16 v[184:185], v11 offset:40960
    ds_read_b64_tr_b16 v[186:187], v11 offset:41472
    ds_read_b64_tr_b16 v[228:229], v11 offset:45056
    ds_read_b64_tr_b16 v[230:231], v11 offset:45568
    s_add_u32 s45, s45, 128
    s_and_b32 s45, s45, 0x7ff
    s_add_u32 s82, s45, 0x40000
    s_add_u32 s81, s81, 32768
    s_cmp_ge_u32 s81, 98304
    s_cselect_b32 s81, s48, s81
    s_add_u32 s88, s88, 512
    s_addc_u32 s89, s89, 0
    s_waitcnt lgkmcnt(0)
    s_load_dword s90, s[88:89], 0
    s_load_dword s90, s[88:89], 64
    s_load_dword s90, s[88:89], 128
    s_load_dword s90, s[88:89], 192
    s_load_dword s90, s[88:89], 256
    s_load_dword s90, s[88:89], 320
    s_load_dword s90, s[88:89], 384
    s_load_dword s90, s[88:89], 448
    s_waitcnt vmcnt(8)
    s_call_b64 s[100:101], L_sub_c1_2
    v_add_u32 v8, s80, v6
    v_xor_b32 v9, 64, v8
    s_add_u32 s80, s80, 32768
    s_cmp_ge_u32 s80, 98304
    s_cselect_b32 s80, 0, s80
    ds_read_b64_tr_b16 v[160:161], v14 offset:0
    s_add_u32 m0, s81, 0
    ds_read_b64_tr_b16 v[162:163], v14 offset:512
    buffer_load_dwordx4 v2, s[20:23], s45 offen  lds
    ds_read_b64_tr_b16 v[204:205], v14 offset:4096
    ds_read_b64_tr_b16 v[206:207], v14 offset:4608
    ds_read_b128 v[144:147], v8 offset:0
    s_add_u32 m0, s81, 4096
    ds_read_b128 v[148:151], v8 offset:2048
    buffer_load_dwordx4 v3, s[20:23], s45 offen  lds
    ds_read_b128 v[152:155], v8 offset:4096
    ds_read_b128 v[156:159], v8 offset:6144
    ds_read_b128 v[188:191], v9 offset:0
    s_add_u32 m0, s81, 8192
    ds_read_b128 v[192:195], v9 offset:2048
    buffer_load_dwordx4 v4, s[20:23], s45 offen  lds
    ds_read_b128 v[196:199], v9 offset:4096
    ds_read_b128 v[200:203], v9 offset:6144
    ds_read_b64_tr_b16 v[164:165], v10 offset:0
    s_add_u32 m0, s81, 12288
    ds_read_b64_tr_b16 v[166:167], v10 offset:512
    buffer_load_dwordx4 v5, s[20:23], s45 offen  lds
    ds_read_b64_tr_b16 v[208:209], v10 offset:4096
    ds_read_b64_tr_b16 v[210:211], v10 offset:4608
    ds_read_b64_tr_b16 v[168:169], v11 offset:0
    s_add_u32 m0, s81, 16384
    ds_read_b64_tr_b16 v[170:171], v11 offset:512
    buffer_load_dwordx4 v2, s[20:23], s82 offen  lds
    ds_read_b64_tr_b16 v[212:213], v11 offset:4096
    ds_read_b64_tr_b16 v[214:215], v11 offset:4608
    ds_read_b64_tr_b16 v[172:173], v12 offset:0
    s_add_u32 m0, s81, 20480
    ds_read_b64_tr_b16 v[174:175], v12 offset:512
    buffer_load_dwordx4 v3, s[20:23], s82 offen  lds
    ds_read_b64_tr_b16 v[216:217], v12 offset:4096
    ds_read_b64_tr_b16 v[218:219], v12 offset:4608
    ds_read_b64_tr_b16 v[176:177], v13 offset:0
    s_add_u32 m0, s81, 24576
    ds_read_b64_tr_b16 v[178:179], v13 offset:512
    buffer_load_dwordx4 v4, s[20:23], s82 offen  lds
    ds_read_b64_tr_b16 v[220:221], v13 offset:4096
    ds_read_b64_tr_b16 v[222:223], v13 offset:4608
    ds_read_b64_tr_b16 v[180:181], v10 offset:8192
    s_add_u32 m0, s81, 28672
    ds_read_b64_tr_b16 v[182:183], v10 offset:8704
    buffer_load_dwordx4 v5, s[20:23], s82 offen  lds
    ds_read_b64_tr_b16 v[224:225], v10 offset:12288
    ds_read_b64_tr_b16 v[226:227], v10 offset:12800
    ds_read_b64_tr_b16 v[184:185], v11 offset:8192
    ds_read_b64_tr_b16 v[186:187], v11 offset:8704
    ds_read_b64_tr_b16 v[228:229], v11 offset:12288
    ds_read_b64_tr_b16 v[230:231], v11 offset:12800
    s_add_u32 s45, s45, 128
    s_and_b32 s45, s45, 0x7ff
    s_add_u32 s82, s45, 0x40000
    s_add_u32 s81, s81, 32768
    s_cmp_ge_u32 s81, 98304
    s_cselect_b32 s81, s48, s81
    s_add_u32 s88, s88, 512
    s_addc_u32 s89, s89, 0
    v_lshrrev_b32 v15, 4, v1
    v_cmp_eq_u32 vcc, 0, v15
    v_add_u32 v15, 7, v15
    v_and_b32 v7, 15, v1
    v_lshlrev_b32 v7, 1, v7
    v_lshl_add_u32 v0, v15, 5, v7
    v_add_u32 v7, 224, v7
    s_mul_i32 s51, s41, 448
    v_cndmask_b32 v7, v0, v7, vcc
    v_add_u32 v0, 128, v0
    buffer_load_ushort v30, v7, s[36:39], s51 offen
    buffer_load_ushort v31, v0, s[36:39], s51 offen
    s_waitcnt lgkmcnt(0)
    s_load_dword s90, s[88:89], 0
    s_load_dword s90, s[88:89], 64
    s_load_dword s90, s[88:89], 128
    s_load_dword s90, s[88:89], 192
    s_load_dword s90, s[88:89], 256
    s_load_dword s90, s[88:89], 320
    s_load_dword s90, s[88:89], 384
    s_load_dword s90, s[88:89], 448
    s_waitcnt vmcnt(10)
    s_call_b64 s[100:101], L_sub_c1_2
    v_add_u32 v8, s80, v6
    v_xor_b32 v9, 64, v8
    s_add_u32 s80, s80, 32768
    s_cmp_ge_u32 s80, 98304
    s_cselect_b32 s80, 0, s80
    ds_read_b64_tr_b16 v[160:161], v14 offset:32768
    s_add_u32 m0, s81, 0
    ds_read_b64_tr_b16 v[162:163], v14 offset:33280
    buffer_load_dwordx4 v2, s[20:23], s45 offen  lds
    ds_read_b64_tr_b16 v[204:205], v14 offset:36864
    ds_read_b64_tr_b16 v[206:207], v14 offset:37376
    ds_read_b128 v[144:147], v8 offset:0
    s_add_u32 m0, s81, 4096
    ds_read_b128 v[148:151], v8 offset:2048
    buffer_load_dwordx4 v3, s[20:23], s45 offen  lds
    ds_read_b128 v[152:155], v8 offset:4096
    ds_read_b128 v[156:159], v8 offset:6144
    ds_read_b128 v[188:191], v9 offset:0
    s_add_u32 m0, s81, 8192
    ds_read_b128 v[192:195], v9 offset:2048
    buffer_load_dwordx4 v4, s[20:23], s45 offen  lds
    ds_read_b128 v[196:199], v9 offset:4096
    ds_read_b128 v[200:203], v9 offset:6144
    ds_read_b64_tr_b16 v[164:165], v10 offset:32768
    s_add_u32 m0, s81, 12288
    ds_read_b64_tr_b16 v[166:167], v10 offset:33280
    buffer_load_dwordx4 v5, s[20:23], s45 offen  lds
    ds_read_b64_tr_b16 v[208:209], v10 offset:36864
    ds_read_b64_tr_b16 v[210:211], v10 offset:37376
    ds_read_b64_tr_b16 v[168:169], v11 offset:32768
    s_add_u32 m0, s81, 16384
    ds_read_b64_tr_b16 v[170:171], v11 offset:33280
    buffer_load_dwordx4 v2, s[20:23], s82 offen  lds
    ds_read_b64_tr_b16 v[212:213], v11 offset:36864
    ds_read_b64_tr_b16 v[214:215], v11 offset:37376
    ds_read_b64_tr_b16 v[172:173], v12 offset:32768
    s_add_u32 m0, s81, 20480
    ds_read_b64_tr_b16 v[174:175], v12 offset:33280
    buffer_load_dwordx4 v3, s[20:23], s82 offen  lds
    ds_read_b64_tr_b16 v[216:217], v12 offset:36864
    ds_read_b64_tr_b16 v[218:219], v12 offset:37376
    ds_read_b64_tr_b16 v[176:177], v13 offset:32768
    s_add_u32 m0, s81, 24576
    ds_read_b64_tr_b16 v[178:179], v13 offset:33280
    buffer_load_dwordx4 v4, s[20:23], s82 offen  lds
    ds_read_b64_tr_b16 v[220:221], v13 offset:36864
    ds_read_b64_tr_b16 v[222:223], v13 offset:37376
    ds_read_b64_tr_b16 v[180:181], v10 offset:40960
    s_add_u32 m0, s81, 28672
    ds_read_b64_tr_b16 v[182:183], v10 offset:41472
    buffer_load_dwordx4 v5, s[20:23], s82 offen  lds
    ds_read_b64_tr_b16 v[224:225], v10 offset:45056
    ds_read_b64_tr_b16 v[226:227], v10 offset:45568
    ds_read_b64_tr_b16 v[184:185], v11 offset:40960
    ds_read_b64_tr_b16 v[186:187], v11 offset:41472
    ds_read_b64_tr_b16 v[228:229], v11 offset:45056
    ds_read_b64_tr_b16 v[230:231], v11 offset:45568
    s_add_u32 s45, s45, 128
    s_and_b32 s45, s45, 0x7ff
    s_add_u32 s82, s45, 0x40000
    s_add_u32 s81, s81, 32768
    s_cmp_ge_u32 s81, 98304
    s_cselect_b32 s81, s48, s81
    s_add_u32 s88, s88, 512
    s_addc_u32 s89, s89, 0
    s_waitcnt lgkmcnt(0)
    s_load_dword s90, s[88:89], 0
    s_load_dword s90, s[88:89], 64
    s_load_dword s90, s[88:89], 128
    s_load_dword s90, s[88:89], 192
    s_load_dword s90, s[88:89], 256
    s_load_dword s90, s[88:89], 320
    s_load_dword s90, s[88:89], 384
    s_load_dword s90, s[88:89], 448
    s_waitcnt vmcnt(10)
    s_call_b64 s[100:101], L_sub_c1_2
    v_add_u32 v8, s80, v6
    v_xor_b32 v9, 64, v8
    s_add_u32 s80, s80, 32768
    s_cmp_ge_u32 s80, 98304
    s_cselect_b32 s80, 0, s80
    ds_read_b64_tr_b16 v[160:161], v14 offset:0
    s_add_u32 m0, s81, 0
    ds_read_b64_tr_b16 v[162:163], v14 offset:512
    buffer_load_dwordx4 v2, s[20:23], s45 offen  lds
    ds_read_b64_tr_b16 v[204:205], v14 offset:4096
    ds_read_b64_tr_b16 v[206:207], v14 offset:4608
    ds_read_b128 v[144:147], v8 offset:0
    s_add_u32 m0, s81, 4096
    ds_read_b128 v[148:151], v8 offset:2048
    buffer_load_dwordx4 v3, s[20:23], s45 offen  lds
    ds_read_b128 v[152:155], v8 offset:4096
    ds_read_b128 v[156:159], v8 offset:6144
    ds_read_b128 v[188:191], v9 offset:0
    s_add_u32 m0, s81, 8192
    ds_read_b128 v[192:195], v9 offset:2048
    buffer_load_dwordx4 v4, s[20:23], s45 offen  lds
    ds_read_b128 v[196:199], v9 offset:4096
    ds_read_b128 v[200:203], v9 offset:6144
    ds_read_b64_tr_b16 v[164:165], v10 offset:0
    s_add_u32 m0, s81, 12288
    ds_read_b64_tr_b16 v[166:167], v10 offset:512
    buffer_load_dwordx4 v5, s[20:23], s45 offen  lds
    ds_read_b64_tr_b16 v[208:209], v10 offset:4096
    ds_read_b64_tr_b16 v[210:211], v10 offset:4608
    ds_read_b64_tr_b16 v[168:169], v11 offset:0
    s_add_u32 m0, s81, 16384
    ds_read_b64_tr_b16 v[170:171], v11 offset:512
    buffer_load_dwordx4 v2, s[20:23], s82 offen  lds
    ds_read_b64_tr_b16 v[212:213], v11 offset:4096
    ds_read_b64_tr_b16 v[214:215], v11 offset:4608
    ds_read_b64_tr_b16 v[172:173], v12 offset:0
    s_add_u32 m0, s81, 20480
    ds_read_b64_tr_b16 v[174:175], v12 offset:512
    buffer_load_dwordx4 v3, s[20:23], s82 offen  lds
    ds_read_b64_tr_b16 v[216:217], v12 offset:4096
    ds_read_b64_tr_b16 v[218:219], v12 offset:4608
    ds_read_b64_tr_b16 v[176:177], v13 offset:0
    s_add_u32 m0, s81, 24576
    ds_read_b64_tr_b16 v[178:179], v13 offset:512
    buffer_load_dwordx4 v4, s[20:23], s82 offen  lds
    ds_read_b64_tr_b16 v[220:221], v13 offset:4096
    ds_read_b64_tr_b16 v[222:223], v13 offset:4608
    ds_read_b64_tr_b16 v[180:181], v10 offset:8192
    s_add_u32 m0, s81, 28672
    ds_read_b64_tr_b16 v[182:183], v10 offset:8704
    buffer_load_dwordx4 v5, s[20:23], s82 offen  lds
    ds_read_b64_tr_b16 v[224:225], v10 offset:12288
    ds_read_b64_tr_b16 v[226:227], v10 offset:12800
    ds_read_b64_tr_b16 v[184:185], v11 offset:8192
    ds_read_b64_tr_b16 v[186:187], v11 offset:8704
    ds_read_b64_tr_b16 v[228:229], v11 offset:12288
    ds_read_b64_tr_b16 v[230:231], v11 offset:12800
    s_add_u32 s45, s45, 128
    s_and_b32 s45, s45, 0x7ff
    s_add_u32 s82, s45, 0x40000
    s_add_u32 s81, s81, 32768
    s_cmp_ge_u32 s81, 98304
    s_cselect_b32 s81, s48, s81
    s_add_u32 s88, s88, 512
    s_addc_u32 s89, s89, 0
    s_waitcnt lgkmcnt(0)
    s_load_dword s90, s[88:89], 0
    s_load_dword s90, s[88:89], 64
    s_load_dword s90, s[88:89], 128
    s_load_dword s90, s[88:89], 192
    s_load_dword s90, s[88:89], 256
    s_load_dword s90, s[88:89], 320
    s_load_dword s90, s[88:89], 384
    s_load_dword s90, s[88:89], 448
    s_waitcnt vmcnt(8)
    s_call_b64 s[100:101], L_sub_c1_2
    v_add_u32 v8, s80, v6
    v_xor_b32 v9, 64, v8
    s_add_u32 s80, s80, 32768
    s_cmp_ge_u32 s80, 98304
    s_cselect_b32 s80, 0, s80
    ds_read_b64_tr_b16 v[160:161], v14 offset:32768
    s_add_u32 m0, s81, 0
    ds_read_b64_tr_b16 v[162:163], v14 offset:33280
    buffer_load_dwordx4 v2, s[20:23], s45 offen  lds
    ds_read_b64_tr_b16 v[204:205], v14 offset:36864
    ds_read_b64_tr_b16 v[206:207], v14 offset:37376
    ds_read_b128 v[144:147], v8 offset:0
    s_add_u32 m0, s81, 4096
    ds_read_b128 v[148:151], v8 offset:2048
    buffer_load_dwordx4 v3, s[20:23], s45 offen  lds
    ds_read_b128 v[152:155], v8 offset:4096
    ds_read_b128 v[156:159], v8 offset:6144
    ds_read_b128 v[188:191], v9 offset:0
    s_add_u32 m0, s81, 8192
    ds_read_b128 v[192:195], v9 offset:2048
    buffer_load_dwordx4 v4, s[20:23], s45 offen  lds
    ds_read_b128 v[196:199], v9 offset:4096
    ds_read_b128 v[200:203], v9 offset:6144
    ds_read_b64_tr_b16 v[164:165], v10 offset:32768
    s_add_u32 m0, s81, 12288
    ds_read_b64_tr_b16 v[166:167], v10 offset:33280
    buffer_load_dwordx4 v5, s[20:23], s45 offen  lds
    ds_read_b64_tr_b16 v[208:209], v10 offset:36864
    ds_read_b64_tr_b16 v[210:211], v10 offset:37376
    ds_read_b64_tr_b16 v[168:169], v11 offset:32768
    s_add_u32 m0, s81, 16384
    ds_read_b64_tr_b16 v[170:171], v11 offset:33280
    buffer_load_dwordx4 v2, s[20:23], s82 offen  lds
    ds_read_b64_tr_b16 v[212:213], v11 offset:36864
    ds_read_b64_tr_b16 v[214:215], v11 offset:37376
    ds_read_b64_tr_b16 v[172:173], v12 offset:32768
    s_add_u32 m0, s81, 20480
    ds_read_b64_tr_b16 v[174:175], v12 offset:33280
    buffer_load_dwordx4 v3, s[20:23], s82 offen  lds
    ds_read_b64_tr_b16 v[216:217], v12 offset:36864
    ds_read_b64_tr_b16 v[218:219], v12 offset:37376
    ds_read_b64_tr_b16 v[176:177], v13 offset:32768
    s_add_u32 m0, s81, 24576
    ds_read_b64_tr_b16 v[178:179], v13 offset:33280
    buffer_load_dwordx4 v4, s[20:23], s82 offen  lds
    ds_read_b64_tr_b16 v[220:221], v13 offset:36864
    ds_read_b64_tr_b16 v[222:223], v13 offset:37376
    ds_read_b64_tr_b16 v[180:181], v10 offset:40960
    s_add_u32 m0, s81, 28672
    ds_read_b64_tr_b16 v[182:183], v10 offset:41472
    buffer_load_dwordx4 v5, s[20:23], s82 offen  lds
    ds_read_b64_tr_b16 v[224:225], v10 offset:45056
    ds_read_b64_tr_b16 v[226:227], v10 offset:45568
    ds_read_b64_tr_b16 v[184:185], v11 offset:40960
    ds_read_b64_tr_b16 v[186:187], v11 offset:41472
    ds_read_b64_tr_b16 v[228:229], v11 offset:45056
    ds_read_b64_tr_b16 v[230:231], v11 offset:45568
    s_add_u32 s45, s45, 128
    s_and_b32 s45, s45, 0x7ff
    s_add_u32 s82, s45, 0x40000
    s_add_u32 s81, s81, 32768
    s_cmp_ge_u32 s81, 98304
    s_cselect_b32 s81, s48, s81
    s_mov_b64 s[88:89], s[92:93]
    v_and_b32 v7, 15, v1
    v_lshrrev_b32 v0, 4, v1
    v_lshlrev_b32 v0, 10, v0
    v_lshl_add_u32 v0, v7, 5, v0
    v_lshlrev_b32 v7, 4, v7
    s_lshl_b32 s50, s40, 2
    s_add_u32 s50, s50, s43
    s_lshl_b32 s50, s50, 10
    s_add_u32 s94, s50, 18874368
    s_lshl_b32 s95, s41, 13
    s_add_u32 s95, s95, 19075072
    buffer_load_dwordx4 v[232:235], v7, s[28:31], s94 offen offset:0 sc1
    buffer_load_dwordx4 v[236:239], v7, s[28:31], s94 offen offset:256 sc1
    buffer_load_dwordx4 v[240:243], v7, s[28:31], s94 offen offset:512 sc1
    buffer_load_dwordx4 v[244:247], v7, s[28:31], s94 offen offset:768 sc1
    s_waitcnt lgkmcnt(0)
    s_load_dword s90, s[88:89], 0
    s_load_dword s90, s[88:89], 64
    s_load_dword s90, s[88:89], 128
    s_load_dword s90, s[88:89], 192
    s_load_dword s90, s[88:89], 256
    s_load_dword s90, s[88:89], 320
    s_load_dword s90, s[88:89], 384
    s_load_dword s90, s[88:89], 448
    s_waitcnt vmcnt(12)
    s_call_b64 s[100:101], L_sub_c1_2
    v_add_u32 v8, s80, v6
    v_xor_b32 v9, 64, v8
    s_add_u32 s80, s80, 32768
    s_cmp_ge_u32 s80, 98304
    s_cselect_b32 s80, 0, s80
    ds_read_b64_tr_b16 v[160:161], v14 offset:0
    ds_read_b64_tr_b16 v[162:163], v14 offset:512
    ds_read_b64_tr_b16 v[204:205], v14 offset:4096
    ds_read_b64_tr_b16 v[206:207], v14 offset:4608
    ds_read_b128 v[144:147], v8 offset:0
    ds_read_b128 v[148:151], v8 offset:2048
    ds_read_b128 v[152:155], v8 offset:4096
    ds_read_b128 v[156:159], v8 offset:6144
    ds_read_b128 v[188:191], v9 offset:0
    ds_read_b128 v[192:195], v9 offset:2048
    ds_read_b128 v[196:199], v9 offset:4096
    ds_read_b128 v[200:203], v9 offset:6144
    ds_read_b64_tr_b16 v[164:165], v10 offset:0
    ds_read_b64_tr_b16 v[166:167], v10 offset:512
    ds_read_b64_tr_b16 v[208:209], v10 offset:4096
    ds_read_b64_tr_b16 v[210:211], v10 offset:4608
    ds_read_b64_tr_b16 v[168:169], v11 offset:0
    ds_read_b64_tr_b16 v[170:171], v11 offset:512
    ds_read_b64_tr_b16 v[212:213], v11 offset:4096
    ds_read_b64_tr_b16 v[214:215], v11 offset:4608
    ds_read_b64_tr_b16 v[172:173], v12 offset:0
    ds_read_b64_tr_b16 v[174:175], v12 offset:512
    ds_read_b64_tr_b16 v[216:217], v12 offset:4096
    ds_read_b64_tr_b16 v[218:219], v12 offset:4608
    ds_read_b64_tr_b16 v[176:177], v13 offset:0
    ds_read_b64_tr_b16 v[178:179], v13 offset:512
    ds_read_b64_tr_b16 v[220:221], v13 offset:4096
    ds_read_b64_tr_b16 v[222:223], v13 offset:4608
    ds_read_b64_tr_b16 v[180:181], v10 offset:8192
    ds_read_b64_tr_b16 v[182:183], v10 offset:8704
    ds_read_b64_tr_b16 v[224:225], v10 offset:12288
    ds_read_b64_tr_b16 v[226:227], v10 offset:12800
    ds_read_b64_tr_b16 v[184:185], v11 offset:8192
    ds_read_b64_tr_b16 v[186:187], v11 offset:8704
    ds_read_b64_tr_b16 v[228:229], v11 offset:12288
    ds_read_b64_tr_b16 v[230:231], v11 offset:12800
    s_add_u32 s88, s88, 512
    s_addc_u32 s89, s89, 0
    buffer_load_dwordx4 v[20:23], v0, s[28:31], s95 offen offset:0 sc1
    buffer_load_dwordx4 v[24:27], v0, s[28:31], s95 offen offset:16 sc1
    buffer_load_dwordx4 v[248:251], v0, s[28:31], s95 offen offset:512 sc1
    buffer_load_dwordx4 v[252:255], v0, s[28:31], s95 offen offset:528 sc1
    s_waitcnt lgkmcnt(0)
    s_load_dword s90, s[88:89], 0
    s_load_dword s90, s[88:89], 64
    s_load_dword s90, s[88:89], 128
    s_load_dword s90, s[88:89], 192
    s_load_dword s90, s[88:89], 256
    s_load_dword s90, s[88:89], 320
    s_load_dword s90, s[88:89], 384
    s_load_dword s90, s[88:89], 448
    s_waitcnt vmcnt(8)
    s_call_b64 s[100:101], L_sub_c1_2
    v_add_u32 v8, s80, v6
    v_xor_b32 v9, 64, v8
    s_add_u32 s80, s80, 32768
    s_cmp_ge_u32 s80, 98304
    s_cselect_b32 s80, 0, s80
    ds_read_b64_tr_b16 v[160:161], v14 offset:32768
    ds_read_b64_tr_b16 v[162:163], v14 offset:33280
    ds_read_b64_tr_b16 v[204:205], v14 offset:36864
    ds_read_b64_tr_b16 v[206:207], v14 offset:37376
    ds_read_b128 v[144:147], v8 offset:0
    ds_read_b128 v[148:151], v8 offset:2048
    ds_read_b128 v[152:155], v8 offset:4096
    ds_read_b128 v[156:159], v8 offset:6144
    ds_read_b128 v[188:191], v9 offset:0
    ds_read_b128 v[192:195], v9 offset:2048
    ds_read_b128 v[196:199], v9 offset:4096
    ds_read_b128 v[200:203], v9 offset:6144
    ds_read_b64_tr_b16 v[164:165], v10 offset:32768
    ds_read_b64_tr_b16 v[166:167], v10 offset:33280
    ds_read_b64_tr_b16 v[208:209], v10 offset:36864
    ds_read_b64_tr_b16 v[210:211], v10 offset:37376
    ds_read_b64_tr_b16 v[168:169], v11 offset:32768
    ds_read_b64_tr_b16 v[170:171], v11 offset:33280
    ds_read_b64_tr_b16 v[212:213], v11 offset:36864
    ds_read_b64_tr_b16 v[214:215], v11 offset:37376
    ds_read_b64_tr_b16 v[172:173], v12 offset:32768
    ds_read_b64_tr_b16 v[174:175], v12 offset:33280
    ds_read_b64_tr_b16 v[216:217], v12 offset:36864
    ds_read_b64_tr_b16 v[218:219], v12 offset:37376
    ds_read_b64_tr_b16 v[176:177], v13 offset:32768
    ds_read_b64_tr_b16 v[178:179], v13 offset:33280
    ds_read_b64_tr_b16 v[220:221], v13 offset:36864
    ds_read_b64_tr_b16 v[222:223], v13 offset:37376
    ds_read_b64_tr_b16 v[180:181], v10 offset:40960
    ds_read_b64_tr_b16 v[182:183], v10 offset:41472
    ds_read_b64_tr_b16 v[224:225], v10 offset:45056
    ds_read_b64_tr_b16 v[226:227], v10 offset:45568
    ds_read_b64_tr_b16 v[184:185], v11 offset:40960
    ds_read_b64_tr_b16 v[186:187], v11 offset:41472
    ds_read_b64_tr_b16 v[228:229], v11 offset:45056
    ds_read_b64_tr_b16 v[230:231], v11 offset:45568
    s_waitcnt lgkmcnt(0)
    s_call_b64 s[100:101], L_sub_c1_3
    s_mov_b32 s57, 0x3fb8aa3b
    s_mov_b32 s63, 0x20000
L_poll_4037:
    s_waitcnt vmcnt(1)
    v_pk_add_f32 v[144:145], v[20:21], v[248:249]
    v_pk_add_f32 v[146:147], v[22:23], v[250:251]
    s_waitcnt vmcnt(0)
    v_pk_add_f32 v[148:149], v[24:25], v[252:253]
    v_pk_add_f32 v[150:151], v[26:27], v[254:255]
    v_pk_add_f32 v[152:153], v[144:145], v[146:147]
    v_add_f32 v154, v235, v239
    v_add_f32 v155, v243, v247
    v_pk_add_f32 v[152:153], v[152:153], v[148:149]
    v_add_f32 v154, v154, v150
    v_pk_add_f32 v[152:153], v[152:153], v[154:155]
    v_cmp_u_f32 vcc, v152, v153
    s_nop 0
    s_cmp_eq_u64 vcc, 0
    s_cbranch_scc1 L_go_4038
    s_sleep 4
    buffer_load_dwordx4 v[20:23], v0, s[28:31], s95 offen offset:0 sc1
    buffer_load_dwordx4 v[24:27], v0, s[28:31], s95 offen offset:16 sc1
    buffer_load_dwordx4 v[248:251], v0, s[28:31], s95 offen offset:512 sc1
    buffer_load_dwordx4 v[252:255], v0, s[28:31], s95 offen offset:528 sc1
    buffer_load_dwordx4 v[232:235], v7, s[28:31], s94 offen offset:0 sc1
    buffer_load_dwordx4 v[236:239], v7, s[28:31], s94 offen offset:256 sc1
    buffer_load_dwordx4 v[240:243], v7, s[28:31], s94 offen offset:512 sc1
    buffer_load_dwordx4 v[244:247], v7, s[28:31], s94 offen offset:768 sc1
    s_waitcnt vmcnt(0)
    s_sub_u32 s63, s63, 1
    s_cmp_lg_u32 s63, 0
    s_cbranch_scc1 L_poll_4037
L_go_4038:
    v_mul_f32 v216, s57, v235
    v_mov_b32 v235, 0
    v_mul_f32 v218, s57, v239
    v_mov_b32 v239, 0
    v_mul_f32 v220, s57, v243
    v_mov_b32 v243, 0
    v_mul_f32 v222, s57, v247
    v_mov_b32 v247, 0
    s_mov_b32 vcc_lo, 0xffff
    s_mov_b32 vcc_hi, 0x0
    v_cvt_pk_bf16_f32 v160, v144, v144
    v_and_b32 v156, 0xffff0000, v160
    v_sub_f32 v144, v144, v156
    v_cndmask_b32 v162, 0, v30, vcc
    v_lshlrev_b32 v156, 16, v162
    v_cvt_pk_bf16_f32 v161, v144, v156
    v_mov_b32 v163, 0
    s_mov_b32 vcc_lo, 0xffff0000
    s_mov_b32 vcc_hi, 0x0
    v_cvt_pk_bf16_f32 v164, v145, v145
    v_and_b32 v157, 0xffff0000, v164
    v_sub_f32 v145, v145, v157
    v_cndmask_b32 v166, 0, v30, vcc
    v_lshlrev_b32 v157, 16, v166
    v_cvt_pk_bf16_f32 v165, v145, v157
    v_mov_b32 v167, 0
    s_mov_b32 vcc_lo, 0x0
    s_mov_b32 vcc_hi, 0xffff
    v_cvt_pk_bf16_f32 v168, v146, v146
    v_and_b32 v156, 0xffff0000, v168
    v_sub_f32 v146, v146, v156
    v_cndmask_b32 v170, 0, v30, vcc
    v_lshlrev_b32 v156, 16, v170
    v_cvt_pk_bf16_f32 v169, v146, v156
    v_mov_b32 v171, 0
    s_mov_b32 vcc_lo, 0x0
    s_mov_b32 vcc_hi, 0xffff0000
    v_cvt_pk_bf16_f32 v172, v147, v147
    v_and_b32 v157, 0xffff0000, v172
    v_sub_f32 v147, v147, v157
    v_cndmask_b32 v174, 0, v30, vcc
    v_lshlrev_b32 v157, 16, v174
    v_cvt_pk_bf16_f32 v173, v147, v157
    v_mov_b32 v175, 0
    s_mov_b32 vcc_lo, 0xffff
    s_mov_b32 vcc_hi, 0x0
    v_cvt_pk_bf16_f32 v176, v148, v148
    v_and_b32 v156, 0xffff0000, v176
    v_sub_f32 v148, v148, v156
    v_cndmask_b32 v178, 0, v31, vcc
    v_lshlrev_b32 v156, 16, v178
    v_cvt_pk_bf16_f32 v177, v148, v156
    v_mov_b32 v179, 0
    s_mov_b32 vcc_lo, 0xffff0000
    s_mov_b32 vcc_hi, 0x0
    v_cvt_pk_bf16_f32 v180, v149, v149
    v_and_b32 v157, 0xffff0000, v180
    v_sub_f32 v149, v149, v157
    v_cndmask_b32 v182, 0, v31, vcc
    v_lshlrev_b32 v157, 16, v182
    v_cvt_pk_bf16_f32 v181, v149, v157
    v_mov_b32 v183, 0
    s_mov_b32 vcc_lo, 0x0
    s_mov_b32 vcc_hi, 0xffff
    v_cvt_pk_bf16_f32 v184, v150, v150
    v_and_b32 v156, 0xffff0000, v184
    v_sub_f32 v150, v150, v156
    v_cndmask_b32 v186, 0, v31, vcc
    v_lshlrev_b32 v156, 16, v186
    v_cvt_pk_bf16_f32 v185, v150, v156
    v_mov_b32 v187, 0
    v_mfma_f32_16x16x32_bf16 v[32:35], v[160:163], v[232:235], v[32:35]
    v_mfma_f32_16x16x32_bf16 v[36:39], v[160:163], v[236:239], v[36:39]
    v_mfma_f32_16x16x32_bf16 v[40:43], v[160:163], v[240:243], v[40:43]
    v_mfma_f32_16x16x32_bf16 v[44:47], v[160:163], v[244:247], v[44:47]
    v_mfma_f32_16x16x32_bf16 v[48:51], v[164:167], v[232:235], v[48:51]
    v_mfma_f32_16x16x32_bf16 v[52:55], v[164:167], v[236:239], v[52:55]
    v_mfma_f32_16x16x32_bf16 v[56:59], v[164:167], v[240:243], v[56:59]
    v_mfma_f32_16x16x32_bf16 v[60:63], v[164:167], v[244:247], v[60:63]
    v_mfma_f32_16x16x32_bf16 v[64:67], v[168:171], v[232:235], v[64:67]
    v_mfma_f32_16x16x32_bf16 v[68:71], v[168:171], v[236:239], v[68:71]
    v_mfma_f32_16x16x32_bf16 v[72:75], v[168:171], v[240:243], v[72:75]
    v_mfma_f32_16x16x32_bf16 v[76:79], v[168:171], v[244:247], v[76:79]
    v_mfma_f32_16x16x32_bf16 v[80:83], v[172:175], v[232:235], v[80:83]
    v_mfma_f32_16x16x32_bf16 v[84:87], v[172:175], v[236:239], v[84:87]
    v_mfma_f32_16x16x32_bf16 v[88:91], v[172:175], v[240:243], v[88:91]
    v_mfma_f32_16x16x32_bf16 v[92:95], v[172:175], v[244:247], v[92:95]
    v_mfma_f32_16x16x32_bf16 v[96:99], v[176:179], v[232:235], v[96:99]
    v_mfma_f32_16x16x32_bf16 v[100:103], v[176:179], v[236:239], v[100:103]
    v_mfma_f32_16x16x32_bf16 v[104:107], v[176:179], v[240:243], v[104:107]
    v_mfma_f32_16x16x32_bf16 v[108:111], v[176:179], v[244:247], v[108:111]
    v_mfma_f32_16x16x32_bf16 v[112:115], v[180:183], v[232:235], v[112:115]
    v_mfma_f32_16x16x32_bf16 v[116:119], v[180:183], v[236:239], v[116:119]
    v_mfma_f32_16x16x32_bf16 v[120:123], v[180:183], v[240:243], v[120:123]
    v_mfma_f32_16x16x32_bf16 v[124:127], v[180:183], v[244:247], v[124:127]
    v_mfma_f32_16x16x32_bf16 v[128:131], v[184:187], v[232:235], v[128:131]
    v_mfma_f32_16x16x32_bf16 v[132:135], v[184:187], v[236:239], v[132:135]
    v_mfma_f32_16x16x32_bf16 v[136:139], v[184:187], v[240:243], v[136:139]
    v_mfma_f32_16x16x32_bf16 v[140:143], v[184:187], v[244:247], v[140:143]
    s_lshl_b32 s50, s40, 1
    s_lshr_b32 s51, s43, 1
    s_add_u32 s50, s50, s51
    s_mul_i32 s50, s50, 112
    s_mul_i32 s51, s41, 7
    s_add_u32 s50, s50, s51
    s_lshl_b32 s50, s50, 13
    s_and_b32 s51, s43, 1
    s_lshl_b32 s51, s51, 12
    s_add_u32 s50, s50, s51
    s_add_u32 s50, s50, 0
    s_lshl_b32 s52, s44, 3
    s_add_u32 s51, s50, s52
    s_add_u32 s51, s51, 24576
    s_lshl_b32 s52, s44, 15
    s_add_u32 s50, s50, s52
    v_lshlrev_b32 v15, 4, v1
    v_pk_mul_f32 v[144:145], v[32:33], v[216:217] op_sel_hi:[1,0]
    v_pk_mul_f32 v[146:147], v[34:35], v[216:217] op_sel_hi:[1,0]
    v_exp_f32 v144, v144
    v_exp_f32 v145, v145
    v_exp_f32 v146, v146
    v_exp_f32 v147, v147
    v_pk_fma_f32 v[152:153], v[144:145], -0.5, -1.0 op_sel_hi:[1,0,0]
    v_pk_fma_f32 v[154:155], v[146:147], -0.5, -1.0 op_sel_hi:[1,0,0]
    v_pk_fma_f32 v[144:145], v[144:145], v[152:153], -1.0 op_sel_hi:[1,1,0]
    v_pk_fma_f32 v[146:147], v[146:147], v[154:155], -1.0 op_sel_hi:[1,1,0]
    v_rcp_f32 v144, v144
    v_rcp_f32 v145, v145
    v_rcp_f32 v146, v146
    v_rcp_f32 v147, v147
    v_pk_fma_f32 v[144:145], v[144:145], v[32:33], v[32:33]
    v_pk_fma_f32 v[146:147], v[146:147], v[34:35], v[34:35]
    v_cvt_pk_bf16_f32 v176, v144, v145
    v_cvt_pk_bf16_f32 v177, v146, v147
    buffer_store_dwordx2 v[176:177], v15, s[28:31], s51 offen offset:0 sc1
    v_pk_mul_f32 v[160:161], v[36:37], v[218:219] op_sel_hi:[1,0]
    v_pk_mul_f32 v[162:163], v[38:39], v[218:219] op_sel_hi:[1,0]
    v_exp_f32 v160, v160
    v_exp_f32 v161, v161
    v_exp_f32 v162, v162
    v_exp_f32 v163, v163
    v_pk_fma_f32 v[168:169], v[160:161], -0.5, -1.0 op_sel_hi:[1,0,0]
    v_pk_fma_f32 v[170:171], v[162:163], -0.5, -1.0 op_sel_hi:[1,0,0]
    v_pk_fma_f32 v[160:161], v[160:161], v[168:169], -1.0 op_sel_hi:[1,1,0]
    v_pk_fma_f32 v[162:163], v[162:163], v[170:171], -1.0 op_sel_hi:[1,1,0]
    v_rcp_f32 v160, v160
    v_rcp_f32 v161, v161
    v_rcp_f32 v162, v162
    v_rcp_f32 v163, v163
    v_pk_fma_f32 v[160:161], v[160:161], v[36:37], v[36:37]
    v_pk_fma_f32 v[162:163], v[162:163], v[38:39], v[38:39]
    v_cvt_pk_bf16_f32 v180, v160, v161
    v_cvt_pk_bf16_f32 v181, v162, v163
    buffer_store_dwordx2 v[180:181], v15, s[28:31], s51 offen offset:1024 sc1
    v_pk_mul_f32 v[144:145], v[40:41], v[220:221] op_sel_hi:[1,0]
    v_pk_mul_f32 v[146:147], v[42:43], v[220:221] op_sel_hi:[1,0]
    v_exp_f32 v144, v144
    v_exp_f32 v145, v145
    v_exp_f32 v146, v146
    v_exp_f32 v147, v147
    v_pk_fma_f32 v[152:153], v[144:145], -0.5, -1.0 op_sel_hi:[1,0,0]
    v_pk_fma_f32 v[154:155], v[146:147], -0.5, -1.0 op_sel_hi:[1,0,0]
    v_pk_fma_f32 v[144:145], v[144:145], v[152:153], -1.0 op_sel_hi:[1,1,0]
    v_pk_fma_f32 v[146:147], v[146:147], v[154:155], -1.0 op_sel_hi:[1,1,0]
    v_rcp_f32 v144, v144
    v_rcp_f32 v145, v145
    v_rcp_f32 v146, v146
    v_rcp_f32 v147, v147
    v_pk_fma_f32 v[144:145], v[144:145], v[40:41], v[40:41]
    v_pk_fma_f32 v[146:147], v[146:147], v[42:43], v[42:43]
    v_cvt_pk_bf16_f32 v184, v144, v145
    v_cvt_pk_bf16_f32 v185, v146, v147
    buffer_store_dwordx2 v[184:185], v15, s[28:31], s51 offen offset:2048 sc1
    v_pk_mul_f32 v[160:161], v[44:45], v[222:223] op_sel_hi:[1,0]
    v_pk_mul_f32 v[162:163], v[46:47], v[222:223] op_sel_hi:[1,0]
    v_exp_f32 v160, v160
    v_exp_f32 v161, v161
    v_exp_f32 v162, v162
    v_exp_f32 v163, v163
    v_pk_fma_f32 v[168:169], v[160:161], -0.5, -1.0 op_sel_hi:[1,0,0]
    v_pk_fma_f32 v[170:171], v[162:163], -0.5, -1.0 op_sel_hi:[1,0,0]
    v_pk_fma_f32 v[160:161], v[160:161], v[168:169], -1.0 op_sel_hi:[1,1,0]
    v_pk_fma_f32 v[162:163], v[162:163], v[170:171], -1.0 op_sel_hi:[1,1,0]
    v_rcp_f32 v160, v160
    v_rcp_f32 v161, v161
    v_rcp_f32 v162, v162
    v_rcp_f32 v163, v163
    v_pk_fma_f32 v[160:161], v[160:161], v[44:45], v[44:45]
    v_pk_fma_f32 v[162:163], v[162:163], v[46:47], v[46:47]
    v_cvt_pk_bf16_f32 v188, v160, v161
    v_cvt_pk_bf16_f32 v189, v162, v163
    buffer_store_dwordx2 v[188:189], v15, s[28:31], s51 offen offset:3072 sc1
    v_pk_mul_f32 v[144:145], v[48:49], v[216:217] op_sel_hi:[1,0]
    v_pk_mul_f32 v[146:147], v[50:51], v[216:217] op_sel_hi:[1,0]
    v_pk_mul_f32 v[148:149], v[64:65], v[216:217] op_sel_hi:[1,0]
    v_pk_mul_f32 v[150:151], v[66:67], v[216:217] op_sel_hi:[1,0]
    v_exp_f32 v144, v144
    v_exp_f32 v145, v145
    v_exp_f32 v146, v146
    v_exp_f32 v147, v147
    v_exp_f32 v148, v148
    v_exp_f32 v149, v149
    v_exp_f32 v150, v150
    v_exp_f32 v151, v151
    v_pk_fma_f32 v[152:153], v[144:145], -0.5, -1.0 op_sel_hi:[1,0,0]
    v_pk_fma_f32 v[154:155], v[146:147], -0.5, -1.0 op_sel_hi:[1,0,0]
    v_pk_fma_f32 v[156:157], v[148:149], -0.5, -1.0 op_sel_hi:[1,0,0]
    v_pk_fma_f32 v[158:159], v[150:151], -0.5, -1.0 op_sel_hi:[1,0,0]
    v_pk_fma_f32 v[144:145], v[144:145], v[152:153], -1.0 op_sel_hi:[1,1,0]
    v_pk_fma_f32 v[146:147], v[146:147], v[154:155], -1.0 op_sel_hi:[1,1,0]
    v_pk_fma_f32 v[148:149], v[148:149], v[156:157], -1.0 op_sel_hi:[1,1,0]
    v_pk_fma_f32 v[150:151], v[150:151], v[158:159], -1.0 op_sel_hi:[1,1,0]
    v_rcp_f32 v144, v144
    v_rcp_f32 v145, v145
    v_rcp_f32 v146, v146
    v_rcp_f32 v147, v147
    v_rcp_f32 v148, v148
    v_rcp_f32 v149, v149
    v_rcp_f32 v150, v150
    v_rcp_f32 v151, v151
    v_pk_fma_f32 v[144:145], v[144:145], v[48:49], v[48:49]
    v_pk_fma_f32 v[146:147], v[146:147], v[50:51], v[50:51]
    v_pk_fma_f32 v[148:149], v[148:149], v[64:65], v[64:65]
    v_pk_fma_f32 v[150:151], v[150:151], v[66:67], v[66:67]
    v_cvt_pk_bf16_f32 v176, v144, v145
    v_cvt_pk_bf16_f32 v177, v146, v147
    v_cvt_pk_bf16_f32 v178, v148, v149
    v_cvt_pk_bf16_f32 v179, v150, v151
    buffer_store_dwordx4 v[176:179], v15, s[28:31], s50 offen offset:0 sc1
    v_pk_mul_f32 v[160:161], v[52:53], v[218:219] op_sel_hi:[1,0]
    v_pk_mul_f32 v[162:163], v[54:55], v[218:219] op_sel_hi:[1,0]
    v_pk_mul_f32 v[164:165], v[68:69], v[218:219] op_sel_hi:[1,0]
    v_pk_mul_f32 v[166:167], v[70:71], v[218:219] op_sel_hi:[1,0]
    v_exp_f32 v160, v160
    v_exp_f32 v161, v161
    v_exp_f32 v162, v162
    v_exp_f32 v163, v163
    v_exp_f32 v164, v164
    v_exp_f32 v165, v165
    v_exp_f32 v166, v166
    v_exp_f32 v167, v167
    v_pk_fma_f32 v[168:169], v[160:161], -0.5, -1.0 op_sel_hi:[1,0,0]
    v_pk_fma_f32 v[170:171], v[162:163], -0.5, -1.0 op_sel_hi:[1,0,0]
    v_pk_fma_f32 v[172:173], v[164:165], -0.5, -1.0 op_sel_hi:[1,0,0]
    v_pk_fma_f32 v[174:175], v[166:167], -0.5, -1.0 op_sel_hi:[1,0,0]
    v_pk_fma_f32 v[160:161], v[160:161], v[168:169], -1.0 op_sel_hi:[1,1,0]
    v_pk_fma_f32 v[162:163], v[162:163], v[170:171], -1.0 op_sel_hi:[1,1,0]
    v_pk_fma_f32 v[164:165], v[164:165], v[172:173], -1.0 op_sel_hi:[1,1,0]
    v_pk_fma_f32 v[166:167], v[166:167], v[174:175], -1.0 op_sel_hi:[1,1,0]
    v_rcp_f32 v160, v160
    v_rcp_f32 v161, v161
    v_rcp_f32 v162, v162
    v_rcp_f32 v163, v163
    v_rcp_f32 v164, v164
    v_rcp_f32 v165, v165
    v_rcp_f32 v166, v166
    v_rcp_f32 v167, v167
    v_pk_fma_f32 v[160:161], v[160:161], v[52:53], v[52:53]
    v_pk_fma_f32 v[162:163], v[162:163], v[54:55], v[54:55]
    v_pk_fma_f32 v[164:165], v[164:165], v[68:69], v[68:69]
    v_pk_fma_f32 v[166:167], v[166:167], v[70:71], v[70:71]
    v_cvt_pk_bf16_f32 v180, v160, v161
    v_cvt_pk_bf16_f32 v181, v162, v163
    v_cvt_pk_bf16_f32 v182, v164, v165
    v_cvt_pk_bf16_f32 v183, v166, v167
    buffer_store_dwordx4 v[180:183], v15, s[28:31], s50 offen offset:1024 sc1
    v_pk_mul_f32 v[144:145], v[56:57], v[220:221] op_sel_hi:[1,0]
    v_pk_mul_f32 v[146:147], v[58:59], v[220:221] op_sel_hi:[1,0]
    v_pk_mul_f32 v[148:149], v[72:73], v[220:221] op_sel_hi:[1,0]
    v_pk_mul_f32 v[150:151], v[74:75], v[220:221] op_sel_hi:[1,0]
    v_exp_f32 v144, v144
    v_exp_f32 v145, v145
    v_exp_f32 v146, v146
    v_exp_f32 v147, v147
    v_exp_f32 v148, v148
    v_exp_f32 v149, v149
    v_exp_f32 v150, v150
    v_exp_f32 v151, v151
    v_pk_fma_f32 v[152:153], v[144:145], -0.5, -1.0 op_sel_hi:[1,0,0]
    v_pk_fma_f32 v[154:155], v[146:147], -0.5, -1.0 op_sel_hi:[1,0,0]
    v_pk_fma_f32 v[156:157], v[148:149], -0.5, -1.0 op_sel_hi:[1,0,0]
    v_pk_fma_f32 v[158:159], v[150:151], -0.5, -1.0 op_sel_hi:[1,0,0]
    v_pk_fma_f32 v[144:145], v[144:145], v[152:153], -1.0 op_sel_hi:[1,1,0]
    v_pk_fma_f32 v[146:147], v[146:147], v[154:155], -1.0 op_sel_hi:[1,1,0]
    v_pk_fma_f32 v[148:149], v[148:149], v[156:157], -1.0 op_sel_hi:[1,1,0]
    v_pk_fma_f32 v[150:151], v[150:151], v[158:159], -1.0 op_sel_hi:[1,1,0]
    v_rcp_f32 v144, v144
    v_rcp_f32 v145, v145
    v_rcp_f32 v146, v146
    v_rcp_f32 v147, v147
    v_rcp_f32 v148, v148
    v_rcp_f32 v149, v149
    v_rcp_f32 v150, v150
    v_rcp_f32 v151, v151
    v_pk_fma_f32 v[144:145], v[144:145], v[56:57], v[56:57]
    v_pk_fma_f32 v[146:147], v[146:147], v[58:59], v[58:59]
    v_pk_fma_f32 v[148:149], v[148:149], v[72:73], v[72:73]
    v_pk_fma_f32 v[150:151], v[150:151], v[74:75], v[74:75]
    v_cvt_pk_bf16_f32 v184, v144, v145
    v_cvt_pk_bf16_f32 v185, v146, v147
    v_cvt_pk_bf16_f32 v186, v148, v149
    v_cvt_pk_bf16_f32 v187, v150, v151
    buffer_store_dwordx4 v[184:187], v15, s[28:31], s50 offen offset:2048 sc1
    v_pk_mul_f32 v[160:161], v[60:61], v[222:223] op_sel_hi:[1,0]
    v_pk_mul_f32 v[162:163], v[62:63], v[222:223] op_sel_hi:[1,0]
    v_pk_mul_f32 v[164:165], v[76:77], v[222:223] op_sel_hi:[1,0]
    v_pk_mul_f32 v[166:167], v[78:79], v[222:223] op_sel_hi:[1,0]
    v_exp_f32 v160, v160
    v_exp_f32 v161, v161
    v_exp_f32 v162, v162
    v_exp_f32 v163, v163
    v_exp_f32 v164, v164
    v_exp_f32 v165, v165
    v_exp_f32 v166, v166
    v_exp_f32 v167, v167
    v_pk_fma_f32 v[168:169], v[160:161], -0.5, -1.0 op_sel_hi:[1,0,0]
    v_pk_fma_f32 v[170:171], v[162:163], -0.5, -1.0 op_sel_hi:[1,0,0]
    v_pk_fma_f32 v[172:173], v[164:165], -0.5, -1.0 op_sel_hi:[1,0,0]
    v_pk_fma_f32 v[174:175], v[166:167], -0.5, -1.0 op_sel_hi:[1,0,0]
    v_pk_fma_f32 v[160:161], v[160:161], v[168:169], -1.0 op_sel_hi:[1,1,0]
    v_pk_fma_f32 v[162:163], v[162:163], v[170:171], -1.0 op_sel_hi:[1,1,0]
    v_pk_fma_f32 v[164:165], v[164:165], v[172:173], -1.0 op_sel_hi:[1,1,0]
    v_pk_fma_f32 v[166:167], v[166:167], v[174:175], -1.0 op_sel_hi:[1,1,0]
    v_rcp_f32 v160, v160
    v_rcp_f32 v161, v161
    v_rcp_f32 v162, v162
    v_rcp_f32 v163, v163
    v_rcp_f32 v164, v164
    v_rcp_f32 v165, v165
    v_rcp_f32 v166, v166
    v_rcp_f32 v167, v167
    v_pk_fma_f32 v[160:161], v[160:161], v[60:61], v[60:61]
    v_pk_fma_f32 v[162:163], v[162:163], v[62:63], v[62:63]
    v_pk_fma_f32 v[164:165], v[164:165], v[76:77], v[76:77]
    v_pk_fma_f32 v[166:167], v[166:167], v[78:79], v[78:79]
    v_cvt_pk_bf16_f32 v188, v160, v161
    v_cvt_pk_bf16_f32 v189, v162, v163
    v_cvt_pk_bf16_f32 v190, v164, v165
    v_cvt_pk_bf16_f32 v191, v166, v167
    buffer_store_dwordx4 v[188:191], v15, s[28:31], s50 offen offset:3072 sc1
    s_add_u32 s50, s50, 8192
    v_pk_mul_f32 v[144:145], v[80:81], v[216:217] op_sel_hi:[1,0]
    v_pk_mul_f32 v[146:147], v[82:83], v[216:217] op_sel_hi:[1,0]
    v_pk_mul_f32 v[148:149], v[96:97], v[216:217] op_sel_hi:[1,0]
    v_pk_mul_f32 v[150:151], v[98:99], v[216:217] op_sel_hi:[1,0]
    v_exp_f32 v144, v144
    v_exp_f32 v145, v145
    v_exp_f32 v146, v146
    v_exp_f32 v147, v147
    v_exp_f32 v148, v148
    v_exp_f32 v149, v149
    v_exp_f32 v150, v150
    v_exp_f32 v151, v151
    v_pk_fma_f32 v[152:153], v[144:145], -0.5, -1.0 op_sel_hi:[1,0,0]
    v_pk_fma_f32 v[154:155], v[146:147], -0.5, -1.0 op_sel_hi:[1,0,0]
    v_pk_fma_f32 v[156:157], v[148:149], -0.5, -1.0 op_sel_hi:[1,0,0]
    v_pk_fma_f32 v[158:159], v[150:151], -0.5, -1.0 op_sel_hi:[1,0,0]
    v_pk_fma_f32 v[144:145], v[144:145], v[152:153], -1.0 op_sel_hi:[1,1,0]
    v_pk_fma_f32 v[146:147], v[146:147], v[154:155], -1.0 op_sel_hi:[1,1,0]
    v_pk_fma_f32 v[148:149], v[148:149], v[156:157], -1.0 op_sel_hi:[1,1,0]
    v_pk_fma_f32 v[150:151], v[150:151], v[158:159], -1.0 op_sel_hi:[1,1,0]
    v_rcp_f32 v144, v144
    v_rcp_f32 v145, v145
    v_rcp_f32 v146, v146
    v_rcp_f32 v147, v147
    v_rcp_f32 v148, v148
    v_rcp_f32 v149, v149
    v_rcp_f32 v150, v150
    v_rcp_f32 v151, v151
    v_pk_fma_f32 v[144:145], v[144:145], v[80:81], v[80:81]
    v_pk_fma_f32 v[146:147], v[146:147], v[82:83], v[82:83]
    v_pk_fma_f32 v[148:149], v[148:149], v[96:97], v[96:97]
    v_pk_fma_f32 v[150:151], v[150:151], v[98:99], v[98:99]
    v_cvt_pk_bf16_f32 v176, v144, v145
    v_cvt_pk_bf16_f32 v177, v146, v147
    v_cvt_pk_bf16_f32 v178, v148, v149
    v_cvt_pk_bf16_f32 v179, v150, v151
    buffer_store_dwordx4 v[176:179], v15, s[28:31], s50 offen offset:0 sc1
    v_pk_mul_f32 v[160:161], v[84:85], v[218:219] op_sel_hi:[1,0]
    v_pk_mul_f32 v[162:163], v[86:87], v[218:219] op_sel_hi:[1,0]
    v_pk_mul_f32 v[164:165], v[100:101], v[218:219] op_sel_hi:[1,0]
    v_pk_mul_f32 v[166:167], v[102:103], v[218:219] op_sel_hi:[1,0]
    v_exp_f32 v160, v160
    v_exp_f32 v161, v161
    v_exp_f32 v162, v162
    v_exp_f32 v163, v163
    v_exp_f32 v164, v164
    v_exp_f32 v165, v165
    v_exp_f32 v166, v166
    v_exp_f32 v167, v167
    v_pk_fma_f32 v[168:169], v[160:161], -0.5, -1.0 op_sel_hi:[1,0,0]
    v_pk_fma_f32 v[170:171], v[162:163], -0.5, -1.0 op_sel_hi:[1,0,0]
    v_pk_fma_f32 v[172:173], v[164:165], -0.5, -1.0 op_sel_hi:[1,0,0]
    v_pk_fma_f32 v[174:175], v[166:167], -0.5, -1.0 op_sel_hi:[1,0,0]
    v_pk_fma_f32 v[160:161], v[160:161], v[168:169], -1.0 op_sel_hi:[1,1,0]
    v_pk_fma_f32 v[162:163], v[162:163], v[170:171], -1.0 op_sel_hi:[1,1,0]
    v_pk_fma_f32 v[164:165], v[164:165], v[172:173], -1.0 op_sel_hi:[1,1,0]
    v_pk_fma_f32 v[166:167], v[166:167], v[174:175], -1.0 op_sel_hi:[1,1,0]
    v_rcp_f32 v160, v160
    v_rcp_f32 v161, v161
    v_rcp_f32 v162, v162
    v_rcp_f32 v163, v163
    v_rcp_f32 v164, v164
    v_rcp_f32 v165, v165
    v_rcp_f32 v166, v166
    v_rcp_f32 v167, v167
    v_pk_fma_f32 v[160:161], v[160:161], v[84:85], v[84:85]
    v_pk_fma_f32 v[162:163], v[162:163], v[86:87], v[86:87]
    v_pk_fma_f32 v[164:165], v[164:165], v[100:101], v[100:101]
    v_pk_fma_f32 v[166:167], v[166:167], v[102:103], v[102:103]
    v_cvt_pk_bf16_f32 v180, v160, v161
    v_cvt_pk_bf16_f32 v181, v162, v163
    v_cvt_pk_bf16_f32 v182, v164, v165
    v_cvt_pk_bf16_f32 v183, v166, v167
    buffer_store_dwordx4 v[180:183], v15, s[28:31], s50 offen offset:1024 sc1
    v_pk_mul_f32 v[144:145], v[88:89], v[220:221] op_sel_hi:[1,0]
    v_pk_mul_f32 v[146:147], v[90:91], v[220:221] op_sel_hi:[1,0]
    v_pk_mul_f32 v[148:149], v[104:105], v[220:221] op_sel_hi:[1,0]
    v_pk_mul_f32 v[150:151], v[106:107], v[220:221] op_sel_hi:[1,0]
    v_exp_f32 v144, v144
    v_exp_f32 v145, v145
    v_exp_f32 v146, v146
    v_exp_f32 v147, v147
    v_exp_f32 v148, v148
    v_exp_f32 v149, v149
    v_exp_f32 v150, v150
    v_exp_f32 v151, v151
    v_pk_fma_f32 v[152:153], v[144:145], -0.5, -1.0 op_sel_hi:[1,0,0]
    v_pk_fma_f32 v[154:155], v[146:147], -0.5, -1.0 op_sel_hi:[1,0,0]
    v_pk_fma_f32 v[156:157], v[148:149], -0.5, -1.0 op_sel_hi:[1,0,0]
    v_pk_fma_f32 v[158:159], v[150:151], -0.5, -1.0 op_sel_hi:[1,0,0]
    v_pk_fma_f32 v[144:145], v[144:145], v[152:153], -1.0 op_sel_hi:[1,1,0]
    v_pk_fma_f32 v[146:147], v[146:147], v[154:155], -1.0 op_sel_hi:[1,1,0]
    v_pk_fma_f32 v[148:149], v[148:149], v[156:157], -1.0 op_sel_hi:[1,1,0]
    v_pk_fma_f32 v[150:151], v[150:151], v[158:159], -1.0 op_sel_hi:[1,1,0]
    v_rcp_f32 v144, v144
    v_rcp_f32 v145, v145
    v_rcp_f32 v146, v146
    v_rcp_f32 v147, v147
    v_rcp_f32 v148, v148
    v_rcp_f32 v149, v149
    v_rcp_f32 v150, v150
    v_rcp_f32 v151, v151
    v_pk_fma_f32 v[144:145], v[144:145], v[88:89], v[88:89]
    v_pk_fma_f32 v[146:147], v[146:147], v[90:91], v[90:91]
    v_pk_fma_f32 v[148:149], v[148:149], v[104:105], v[104:105]
    v_pk_fma_f32 v[150:151], v[150:151], v[106:107], v[106:107]
    v_cvt_pk_bf16_f32 v184, v144, v145
    v_cvt_pk_bf16_f32 v185, v146, v147
    v_cvt_pk_bf16_f32 v186, v148, v149
    v_cvt_pk_bf16_f32 v187, v150, v151
    buffer_store_dwordx4 v[184:187], v15, s[28:31], s50 offen offset:2048 sc1
    v_pk_mul_f32 v[160:161], v[92:93], v[222:223] op_sel_hi:[1,0]
    v_pk_mul_f32 v[162:163], v[94:95], v[222:223] op_sel_hi:[1,0]
    v_pk_mul_f32 v[164:165], v[108:109], v[222:223] op_sel_hi:[1,0]
    v_pk_mul_f32 v[166:167], v[110:111], v[222:223] op_sel_hi:[1,0]
    v_exp_f32 v160, v160
    v_exp_f32 v161, v161
    v_exp_f32 v162, v162
    v_exp_f32 v163, v163
    v_exp_f32 v164, v164
    v_exp_f32 v165, v165
    v_exp_f32 v166, v166
    v_exp_f32 v167, v167
    v_pk_fma_f32 v[168:169], v[160:161], -0.5, -1.0 op_sel_hi:[1,0,0]
    v_pk_fma_f32 v[170:171], v[162:163], -0.5, -1.0 op_sel_hi:[1,0,0]
    v_pk_fma_f32 v[172:173], v[164:165], -0.5, -1.0 op_sel_hi:[1,0,0]
    v_pk_fma_f32 v[174:175], v[166:167], -0.5, -1.0 op_sel_hi:[1,0,0]
    v_pk_fma_f32 v[160:161], v[160:161], v[168:169], -1.0 op_sel_hi:[1,1,0]
    v_pk_fma_f32 v[162:163], v[162:163], v[170:171], -1.0 op_sel_hi:[1,1,0]
    v_pk_fma_f32 v[164:165], v[164:165], v[172:173], -1.0 op_sel_hi:[1,1,0]
    v_pk_fma_f32 v[166:167], v[166:167], v[174:175], -1.0 op_sel_hi:[1,1,0]
    v_rcp_f32 v160, v160
    v_rcp_f32 v161, v161
    v_rcp_f32 v162, v162
    v_rcp_f32 v163, v163
    v_rcp_f32 v164, v164
    v_rcp_f32 v165, v165
    v_rcp_f32 v166, v166
    v_rcp_f32 v167, v167
    v_pk_fma_f32 v[160:161], v[160:161], v[92:93], v[92:93]
    v_pk_fma_f32 v[162:163], v[162:163], v[94:95], v[94:95]
    v_pk_fma_f32 v[164:165], v[164:165], v[108:109], v[108:109]
    v_pk_fma_f32 v[166:167], v[166:167], v[110:111], v[110:111]
    v_cvt_pk_bf16_f32 v188, v160, v161
    v_cvt_pk_bf16_f32 v189, v162, v163
    v_cvt_pk_bf16_f32 v190, v164, v165
    v_cvt_pk_bf16_f32 v191, v166, v167
    buffer_store_dwordx4 v[188:191], v15, s[28:31], s50 offen offset:3072 sc1
    s_add_u32 s50, s50, 8192
    v_pk_mul_f32 v[144:145], v[112:113], v[216:217] op_sel_hi:[1,0]
    v_pk_mul_f32 v[146:147], v[114:115], v[216:217] op_sel_hi:[1,0]
    v_pk_mul_f32 v[148:149], v[128:129], v[216:217] op_sel_hi:[1,0]
    v_pk_mul_f32 v[150:151], v[130:131], v[216:217] op_sel_hi:[1,0]
    v_exp_f32 v144, v144
    v_exp_f32 v145, v145
    v_exp_f32 v146, v146
    v_exp_f32 v147, v147
    v_exp_f32 v148, v148
    v_exp_f32 v149, v149
    v_exp_f32 v150, v150
    v_exp_f32 v151, v151
    v_pk_fma_f32 v[152:153], v[144:145], -0.5, -1.0 op_sel_hi:[1,0,0]
    v_pk_fma_f32 v[154:155], v[146:147], -0.5, -1.0 op_sel_hi:[1,0,0]
    v_pk_fma_f32 v[156:157], v[148:149], -0.5, -1.0 op_sel_hi:[1,0,0]
    v_pk_fma_f32 v[158:159], v[150:151], -0.5, -1.0 op_sel_hi:[1,0,0]
    v_pk_fma_f32 v[144:145], v[144:145], v[152:153], -1.0 op_sel_hi:[1,1,0]
    v_pk_fma_f32 v[146:147], v[146:147], v[154:155], -1.0 op_sel_hi:[1,1,0]
    v_pk_fma_f32 v[148:149], v[148:149], v[156:157], -1.0 op_sel_hi:[1,1,0]
    v_pk_fma_f32 v[150:151], v[150:151], v[158:159], -1.0 op_sel_hi:[1,1,0]
    v_rcp_f32 v144, v144
    v_rcp_f32 v145, v145
    v_rcp_f32 v146, v146
    v_rcp_f32 v147, v147
    v_rcp_f32 v148, v148
    v_rcp_f32 v149, v149
    v_rcp_f32 v150, v150
    v_rcp_f32 v151, v151
    v_pk_fma_f32 v[144:145], v[144:145], v[112:113], v[112:113]
    v_pk_fma_f32 v[146:147], v[146:147], v[114:115], v[114:115]
    v_pk_fma_f32 v[148:149], v[148:149], v[128:129], v[128:129]
    v_pk_fma_f32 v[150:151], v[150:151], v[130:131], v[130:131]
    v_cvt_pk_bf16_f32 v176, v144, v145
    v_cvt_pk_bf16_f32 v177, v146, v147
    v_cvt_pk_bf16_f32 v178, v148, v149
    v_cvt_pk_bf16_f32 v179, v150, v151
    buffer_store_dwordx4 v[176:179], v15, s[28:31], s50 offen offset:0 sc1
    v_pk_mul_f32 v[160:161], v[116:117], v[218:219] op_sel_hi:[1,0]
    v_pk_mul_f32 v[162:163], v[118:119], v[218:219] op_sel_hi:[1,0]
    v_pk_mul_f32 v[164:165], v[132:133], v[218:219] op_sel_hi:[1,0]
    v_pk_mul_f32 v[166:167], v[134:135], v[218:219] op_sel_hi:[1,0]
    v_exp_f32 v160, v160
    v_exp_f32 v161, v161
    v_exp_f32 v162, v162
    v_exp_f32 v163, v163
    v_exp_f32 v164, v164
    v_exp_f32 v165, v165
    v_exp_f32 v166, v166
    v_exp_f32 v167, v167
    v_pk_fma_f32 v[168:169], v[160:161], -0.5, -1.0 op_sel_hi:[1,0,0]
    v_pk_fma_f32 v[170:171], v[162:163], -0.5, -1.0 op_sel_hi:[1,0,0]
    v_pk_fma_f32 v[172:173], v[164:165], -0.5, -1.0 op_sel_hi:[1,0,0]
    v_pk_fma_f32 v[174:175], v[166:167], -0.5, -1.0 op_sel_hi:[1,0,0]
    v_pk_fma_f32 v[160:161], v[160:161], v[168:169], -1.0 op_sel_hi:[1,1,0]
    v_pk_fma_f32 v[162:163], v[162:163], v[170:171], -1.0 op_sel_hi:[1,1,0]
    v_pk_fma_f32 v[164:165], v[164:165], v[172:173], -1.0 op_sel_hi:[1,1,0]
    v_pk_fma_f32 v[166:167], v[166:167], v[174:175], -1.0 op_sel_hi:[1,1,0]
    v_rcp_f32 v160, v160
    v_rcp_f32 v161, v161
    v_rcp_f32 v162, v162
    v_rcp_f32 v163, v163
    v_rcp_f32 v164, v164
    v_rcp_f32 v165, v165
    v_rcp_f32 v166, v166
    v_rcp_f32 v167, v167
    v_pk_fma_f32 v[160:161], v[160:161], v[116:117], v[116:117]
    v_pk_fma_f32 v[162:163], v[162:163], v[118:119], v[118:119]
    v_pk_fma_f32 v[164:165], v[164:165], v[132:133], v[132:133]
    v_pk_fma_f32 v[166:167], v[166:167], v[134:135], v[134:135]
    v_cvt_pk_bf16_f32 v180, v160, v161
    v_cvt_pk_bf16_f32 v181, v162, v163
    v_cvt_pk_bf16_f32 v182, v164, v165
    v_cvt_pk_bf16_f32 v183, v166, v167
    buffer_store_dwordx4 v[180:183], v15, s[28:31], s50 offen offset:1024 sc1
    v_pk_mul_f32 v[144:145], v[120:121], v[220:221] op_sel_hi:[1,0]
    v_pk_mul_f32 v[146:147], v[122:123], v[220:221] op_sel_hi:[1,0]
    v_pk_mul_f32 v[148:149], v[136:137], v[220:221] op_sel_hi:[1,0]
    v_pk_mul_f32 v[150:151], v[138:139], v[220:221] op_sel_hi:[1,0]
    v_exp_f32 v144, v144
    v_exp_f32 v145, v145
    v_exp_f32 v146, v146
    v_exp_f32 v147, v147
    v_exp_f32 v148, v148
    v_exp_f32 v149, v149
    v_exp_f32 v150, v150
    v_exp_f32 v151, v151
    v_pk_fma_f32 v[152:153], v[144:145], -0.5, -1.0 op_sel_hi:[1,0,0]
    v_pk_fma_f32 v[154:155], v[146:147], -0.5, -1.0 op_sel_hi:[1,0,0]
    v_pk_fma_f32 v[156:157], v[148:149], -0.5, -1.0 op_sel_hi:[1,0,0]
    v_pk_fma_f32 v[158:159], v[150:151], -0.5, -1.0 op_sel_hi:[1,0,0]
    v_pk_fma_f32 v[144:145], v[144:145], v[152:153], -1.0 op_sel_hi:[1,1,0]
    v_pk_fma_f32 v[146:147], v[146:147], v[154:155], -1.0 op_sel_hi:[1,1,0]
    v_pk_fma_f32 v[148:149], v[148:149], v[156:157], -1.0 op_sel_hi:[1,1,0]
    v_pk_fma_f32 v[150:151], v[150:151], v[158:159], -1.0 op_sel_hi:[1,1,0]
    v_rcp_f32 v144, v144
    v_rcp_f32 v145, v145
    v_rcp_f32 v146, v146
    v_rcp_f32 v147, v147
    v_rcp_f32 v148, v148
    v_rcp_f32 v149, v149
    v_rcp_f32 v150, v150
    v_rcp_f32 v151, v151
    v_pk_fma_f32 v[144:145], v[144:145], v[120:121], v[120:121]
    v_pk_fma_f32 v[146:147], v[146:147], v[122:123], v[122:123]
    v_pk_fma_f32 v[148:149], v[148:149], v[136:137], v[136:137]
    v_pk_fma_f32 v[150:151], v[150:151], v[138:139], v[138:139]
    v_cvt_pk_bf16_f32 v184, v144, v145
    v_cvt_pk_bf16_f32 v185, v146, v147
    v_cvt_pk_bf16_f32 v186, v148, v149
    v_cvt_pk_bf16_f32 v187, v150, v151
    buffer_store_dwordx4 v[184:187], v15, s[28:31], s50 offen offset:2048 sc1
    v_pk_mul_f32 v[160:161], v[124:125], v[222:223] op_sel_hi:[1,0]
    v_pk_mul_f32 v[162:163], v[126:127], v[222:223] op_sel_hi:[1,0]
    v_pk_mul_f32 v[164:165], v[140:141], v[222:223] op_sel_hi:[1,0]
    v_pk_mul_f32 v[166:167], v[142:143], v[222:223] op_sel_hi:[1,0]
    v_exp_f32 v160, v160
    v_exp_f32 v161, v161
    v_exp_f32 v162, v162
    v_exp_f32 v163, v163
    v_exp_f32 v164, v164
    v_exp_f32 v165, v165
    v_exp_f32 v166, v166
    v_exp_f32 v167, v167
    v_pk_fma_f32 v[168:169], v[160:161], -0.5, -1.0 op_sel_hi:[1,0,0]
    v_pk_fma_f32 v[170:171], v[162:163], -0.5, -1.0 op_sel_hi:[1,0,0]
    v_pk_fma_f32 v[172:173], v[164:165], -0.5, -1.0 op_sel_hi:[1,0,0]
    v_pk_fma_f32 v[174:175], v[166:167], -0.5, -1.0 op_sel_hi:[1,0,0]
    v_pk_fma_f32 v[160:161], v[160:161], v[168:169], -1.0 op_sel_hi:[1,1,0]
    v_pk_fma_f32 v[162:163], v[162:163], v[170:171], -1.0 op_sel_hi:[1,1,0]
    v_pk_fma_f32 v[164:165], v[164:165], v[172:173], -1.0 op_sel_hi:[1,1,0]
    v_pk_fma_f32 v[166:167], v[166:167], v[174:175], -1.0 op_sel_hi:[1,1,0]
    v_rcp_f32 v160, v160
    v_rcp_f32 v161, v161
    v_rcp_f32 v162, v162
    v_rcp_f32 v163, v163
    v_rcp_f32 v164, v164
    v_rcp_f32 v165, v165
    v_rcp_f32 v166, v166
    v_rcp_f32 v167, v167
    v_pk_fma_f32 v[160:161], v[160:161], v[124:125], v[124:125]
    v_pk_fma_f32 v[162:163], v[162:163], v[126:127], v[126:127]
    v_pk_fma_f32 v[164:165], v[164:165], v[140:141], v[140:141]
    v_pk_fma_f32 v[166:167], v[166:167], v[142:143], v[142:143]
    v_cvt_pk_bf16_f32 v188, v160, v161
    v_cvt_pk_bf16_f32 v189, v162, v163
    v_cvt_pk_bf16_f32 v190, v164, v165
    v_cvt_pk_bf16_f32 v191, v166, v167
    buffer_store_dwordx4 v[188:191], v15, s[28:31], s50 offen offset:3072 sc1
    s_lshr_b32 s47, s41, 1
    s_lshl_b32 s47, s47, 5
    s_and_b32 s48, s41, 1
    s_add_u32 s47, s47, s48
    s_lshl_b32 s48, s40, 9
    s_add_u32 s47, s47, s48
    s_lshl_b32 s47, s47, 2
    s_add_u32 s47, s47, 21430272
    s_branch L_p2
L_p2:
    s_load_dwordx2 s[50:51], s[0:1], 56
    s_load_dwordx2 s[96:97], s[0:1], 24
    s_load_dwordx2 s[98:99], s[0:1], 64
    s_and_b32 s54, s2, 1
    s_lshl_b32 s54, s54, 3
    s_bfe_u32 s80, s2, 0x30003
    s_add_u32 s80, s80, s54
    s_bfe_u32 s82, s2, 0x10002
    s_lshr_b32 s93, s80, 1
    s_lshl_b32 s93, s93, 11
    s_add_u32 s93, s93, 21430272
    s_add_u32 s94, s18, s93
    s_addc_u32 s95, s19, 0
    s_lshl_b32 s62, s82, 9
    s_cmp_lg_u32 s42, 0
    s_cbranch_scc1 L_sk_9001
    s_load_dwordx2 s[8:9], s[94:95], s62 glc
L_sk_9001:
    s_bfe_u32 s54, s2, 0x10001
    s_lshl_b32 s54, s54, 2
    s_lshr_b32 s81, s2, 6
    s_add_u32 s81, s81, s54
    s_lshl_b32 s86, s42, 12
    s_and_b32 s84, s42, 1
    s_lshr_b32 s85, s42, 1
    s_mul_i32 s46, s82, 3670016
    v_lshrrev_b32 v12, 3, v1
    s_lshl_b32 s54, s42, 3
    v_add_u32 v12, s54, v12
    v_lshlrev_b32 v3, 11, v12
    v_lshrrev_b32 v12, 4, v1
    v_lshlrev_b32 v12, 1, v12
    v_and_b32 v13, 7, v1
    v_xor_b32 v12, v12, v13
    v_lshl_add_u32 v3, v12, 4, v3
    s_lshl_b32 s54, s81, 8
    s_add_u32 s54, s54, 2048
    v_add_u32 v3, s54, v3
    v_subrev_u32 v9, 896, v3
    v_lshlrev_b32 v4, 4, v1
    s_lshl_b32 s54, s42, 11
    v_add_u32 v2, s54, v4
    s_mul_i32 s45, s80, 112
    s_mul_i32 s54, s82, 56
    s_add_u32 s45, s45, s54
    s_lshl_b32 s45, s45, 13
    s_add_u32 s45, s45, 0
    s_lshr_b32 s54, s42, 2
    s_lshl_b32 s54, s54, 3
    s_and_b32 s55, s42, 2
    s_lshl_b32 s55, s55, 1
    s_add_u32 s54, s54, s55
    s_add_u32 s54, s54, s84
    s_lshl_b32 s55, s82, 1
    s_add_u32 s54, s54, s55
    s_lshl_b32 s54, s54, 10
    v_add_u32 v5, s54, v4
    s_lshl_b32 s54, s84, 13
    v_add_u32 v6, s54, v4
    v_bfe_u32 v144, v1, 2, 3
    v_lshlrev_b32 v144, 7, v144
    v_lshrrev_b32 v145, 5, v1
    v_lshl_add_u32 v144, v145, 12, v144
    v_and_b32 v145, 3, v1
    v_lshl_add_u32 v144, v145, 3, v144
    s_lshr_b32 s54, s85, 1
    s_lshl_b32 s54, s54, 10
    s_add_u32 s54, s54, 2048
    v_add_u32 v144, s54, v144
    v_bfe_u32 v145, v1, 3, 2
    s_and_b32 s54, s85, 1
    s_lshl_b32 s54, s54, 1
    v_xor_b32 v145, s54, v145
    v_lshl_add_u32 v16, v145, 5, v144
    v_xor_b32 v17, 32, v16
    v_add_u32 v7, 65536, v6
    v_add_u32 v18, 65536, v16
    v_add_u32 v19, 65536, v17
    v_add_u32 v8, 131072, v6
    v_add_u32 v20, 131072, v16
    v_add_u32 v21, 131072, v17
    s_lshl_b32 s48, s80, 2
    s_add_u32 s48, s48, s82
    s_lshl_b32 s48, s48, 16
    s_lshl_b32 s54, s81, 8
    s_add_u32 s48, s48, s54
    s_lshl_b32 s88, s84, 17
    s_add_u32 s88, s88, s48
    s_lshl_b32 s54, s85, 6
    s_add_u32 s88, s88, s54
    s_add_u32 s89, s88, 32768
    v_and_b32 v144, 15, v1
    v_lshlrev_b32 v0, 11, v144
    v_bfe_u32 v145, v1, 4, 1
    v_lshlrev_b32 v145, 1, v145
    v_lshrrev_b32 v146, 5, v1
    v_add_u32 v145, v145, v146
    v_lshl_add_u32 v0, v145, 4, v0
    s_lshl_b32 s54, s85, 2
    v_add_u32 v145, s54, v145
    v_xor_b32 v145, v145, v144
    v_lshlrev_b32 v25, 4, v145
    v_and_b32 v145, 3, v1
    v_lshl_add_u32 v25, v145, 8, v25
    v_bfe_u32 v145, v1, 2, 1
    v_lshl_add_u32 v25, v145, 15, v25
    v_bfe_u32 v145, v1, 3, 1
    v_lshl_add_u32 v25, v145, 12, v25
    s_lshl_b32 s54, s84, 14
    s_add_u32 s54, s54, 1024
    v_add_u32 v25, s54, v25
    v_lshrrev_b32 v145, 4, v1
    s_lshl_b32 s54, s42, 3
    v_add_u32 v145, s54, v145
    v_and_b32 v146, 31, v145
    v_lshrrev_b32 v22, 5, v145
    v_lshl_add_u32 v22, v22, 6, v146
    v_lshlrev_b32 v22, 11, v22
    v_xor_b32 v145, v145, v1
    v_and_b32 v145, 15, v145
    v_lshl_add_u32 v22, v145, 4, v22
    v_xor_b32 v23, 64, v22
    v_add_u32 v23, 8192, v23
    s_xor_b32 s90, s2, 4
    s_lshl_b32 s90, s90, 3
    s_add_u32 s90, s90, s42
    s_lshl_b32 s90, s90, 11
    s_add_u32 s90, s90, 33554432
    s_xor_b32 s91, s90, 65536
    v_min_u32 v27, 11, v1
    v_lshlrev_b32 v27, 7, v27
    v_lshlrev_b32 v165, 4, v144
    s_lshr_b32 s87, s88, 16
    s_lshl_b32 s87, s87, 9
    s_add_u32 s87, s87, 18874368
    buffer_load_dword v164, v165, s[28:31], s87 offen offset:12 sc1
    buffer_load_dword v166, v165, s[28:31], s87 offen offset:268 sc1
    s_waitcnt lgkmcnt(0)
    s_sub_u32 s24, s50, 4096
    s_subb_u32 s25, s51, 0
    s_and_b32 s25, s25, 0xffff
    s_mov_b32 s26, 0x701000
    s_mov_b32 s27, 0x00020000
    s_sub_u32 s36, s96, 4096
    s_subb_u32 s37, s97, 0
    s_and_b32 s37, s37, 0xffff
    s_mov_b32 s38, 0x201000
    s_mov_b32 s39, 0x00020000
    s_mov_b32 s32, s98
    s_and_b32 s33, s99, 0xffff
    s_mov_b32 s34, 0x400000
    s_mov_b32 s35, 0x00020000
    s_waitcnt vmcnt(0)
    s_cmp_lg_u32 s42, 0
    s_cbranch_scc1 L_sk_9002
    s_and_b32 s8, s8, s9
    v_mov_b32 v144, s8
    v_mov_b32 v145, 0
    ds_write_b32 v145, v144
    s_waitcnt lgkmcnt(0)
L_sk_9002:
    s_barrier
    v_mov_b32 v145, 0
    ds_read_b32 v144, v145
    s_cmp_lg_u32 s42, 0
    s_cbranch_scc1 L_sk_9005
    s_mov_b64 exec, 1
    v_mov_b32 v14, 1
    buffer_store_dword v14, off, s[28:31], s47 sc1
    s_mov_b64 exec, -1
L_sk_9005:
    s_add_u32 m0, s86, 0
    s_waitcnt lgkmcnt(0)
    v_readfirstlane_b32 s61, v144
    s_nop 0
    s_cmp_eq_u32 s61, 1
    s_cbranch_scc0 L_slow_9003
    buffer_load_dwordx4 v3, s[24:27], s46 offen offset:2048 lds
    buffer_load_dwordx4 v9, s[24:27], s46 offen offset:3072 lds
    s_add_u32 s46, s46, 131072
    s_barrier
    buffer_load_dwordx4 v2, s[28:31], s45 offen sc1 lds
    buffer_load_dwordx4 v2, s[28:31], s45 offen offset:1024 sc1 lds
    s_add_u32 s45, s45, 16384
    s_add_u32 m0, s86, 32768
    s_nop 0
    buffer_load_dwordx4 v3, s[24:27], s46 offen offset:2048 lds
    buffer_load_dwordx4 v9, s[24:27], s46 offen offset:3072 lds
    s_add_u32 s46, s46, 131072
L_join_9004:
    buffer_load_dwordx4 v2, s[28:31], s45 offen sc1 lds
    buffer_load_dwordx4 v2, s[28:31], s45 offen offset:1024 sc1 lds
    s_add_u32 s45, s45, 16384
    s_waitcnt vmcnt(2)
    s_mov_b32 s52, 0xbfb8aa3b
    s_mov_b32 s53, 0xbfb8aa3b
    s_barrier
    ds_read_b128 v[80:83], v6 offset:0
    ds_read_b128 v[96:99], v6 offset:16384
    ds_read_b64_tr_b16 v[112:113], v16 offset:0
    ds_read_b64_tr_b16 v[114:115], v16 offset:8192
    ds_read_b64_tr_b16 v[116:117], v16 offset:16384
    ds_read_b64_tr_b16 v[118:119], v16 offset:24576
    ds_read_b128 v[84:87], v6 offset:1024
    ds_read_b128 v[100:103], v6 offset:17408
    ds_read_b128 v[88:91], v6 offset:4096
    ds_read_b128 v[104:107], v6 offset:20480
    ds_read_b128 v[92:95], v6 offset:5120
    ds_read_b128 v[108:111], v6 offset:21504
    s_waitcnt lgkmcnt(8)
    v_mfma_f32_16x16x32_bf16 v[32:35], v[112:115], v[80:83], 0
    ds_read_b64_tr_b16 v[120:121], v17 offset:0
    s_add_u32 m0, s86, 65536
    s_cmp_eq_u32 s61, 1
    s_cbranch_scc0 L_sk_9006
    buffer_load_dwordx4 v3, s[24:27], s46 offen offset:2048 lds
    buffer_load_dwordx4 v9, s[24:27], s46 offen offset:3072 lds
    s_add_u32 s46, s46, 131072
L_sk_9006:
    s_waitcnt lgkmcnt(7)
    v_mfma_f32_16x16x32_bf16 v[32:35], v[116:119], v[96:99], v[32:35]
    ds_read_b64_tr_b16 v[122:123], v17 offset:8192
    buffer_load_dwordx4 v2, s[28:31], s45 offen sc1 lds
    s_waitcnt lgkmcnt(6)
    v_mfma_f32_16x16x32_bf16 v[36:39], v[116:119], v[100:103], 0
    ds_read_b64_tr_b16 v[124:125], v17 offset:16384
    buffer_load_dwordx4 v2, s[28:31], s45 offen offset:1024 sc1 lds
    s_add_u32 s45, s45, 16384
    v_mfma_f32_16x16x32_bf16 v[36:39], v[112:115], v[84:87], v[36:39]
    ds_read_b64_tr_b16 v[126:127], v17 offset:24576
    s_waitcnt lgkmcnt(7)
    v_mfma_f32_16x16x32_bf16 v[40:43], v[112:115], v[88:91], 0
    s_add_u32 m0, s86, 98304
    s_cmp_eq_u32 s61, 1
    s_cbranch_scc0 L_sk_9007
    buffer_load_dwordx4 v3, s[24:27], s46 offen offset:2048 lds
    buffer_load_dwordx4 v9, s[24:27], s46 offen offset:3072 lds
    s_add_u32 s46, s46, 131072
L_sk_9007:
    s_waitcnt lgkmcnt(6)
    v_mfma_f32_16x16x32_bf16 v[40:43], v[116:119], v[104:107], v[40:43]
    buffer_load_dwordx4 v2, s[28:31], s45 offen sc1 lds
    s_waitcnt lgkmcnt(4)
    v_mfma_f32_16x16x32_bf16 v[44:47], v[116:119], v[108:111], 0
    buffer_load_dwordx4 v2, s[28:31], s45 offen offset:1024 sc1 lds
    s_add_u32 s45, s45, 16384
    v_mfma_f32_16x16x32_bf16 v[44:47], v[112:115], v[92:95], v[44:47]
    s_waitcnt vmcnt(4) lgkmcnt(0)
    s_barrier
    v_mfma_f32_16x16x32_bf16 v[48:51], v[120:123], v[80:83], 0
    ds_read_b128 v[192:195], v6 offset:32768
    ds_read_b128 v[208:211], v6 offset:49152
    v_mfma_f32_16x16x32_bf16 v[48:51], v[124:127], v[96:99], v[48:51]
    ds_read_b64_tr_b16 v[112:113], v16 offset:32768
    s_add_u32 m0, s86, 131072
    s_cmp_eq_u32 s61, 1
    s_cbranch_scc0 L_sk_9008
    buffer_load_dwordx4 v3, s[24:27], s46 offen offset:2048 lds
    buffer_load_dwordx4 v9, s[24:27], s46 offen offset:3072 lds
    s_add_u32 s46, s46, 131072
L_sk_9008:
    v_mfma_f32_16x16x32_bf16 v[52:55], v[124:127], v[100:103], 0
    ds_read_b64_tr_b16 v[114:115], v16 offset:40960
    ds_read_b64_tr_b16 v[116:117], v16 offset:49152
    buffer_load_dwordx4 v2, s[28:31], s45 offen sc1 lds
    v_mfma_f32_16x16x32_bf16 v[52:55], v[120:123], v[84:87], v[52:55]
    ds_read_b64_tr_b16 v[118:119], v16 offset:57344
    v_mfma_f32_16x16x32_bf16 v[56:59], v[120:123], v[88:91], 0
    ds_read_b128 v[196:199], v6 offset:33792
    ds_read_b128 v[212:215], v6 offset:50176
    buffer_load_dwordx4 v2, s[28:31], s45 offen offset:1024 sc1 lds
    s_add_u32 s45, s45, 16384
    s_add_u32 m0, s86, 0
    v_mfma_f32_16x16x32_bf16 v[56:59], v[124:127], v[104:107], v[56:59]
    ds_read_b128 v[200:203], v6 offset:36864
    buffer_load_dwordx4 v2, s[28:31], s45 offen sc1 lds
    v_mfma_f32_16x16x32_bf16 v[60:63], v[124:127], v[108:111], 0
    ds_read_b128 v[216:219], v6 offset:53248
    ds_read_b128 v[204:207], v6 offset:37888
    v_mfma_f32_16x16x32_bf16 v[60:63], v[120:123], v[92:95], v[60:63]
    ds_read_b128 v[220:223], v6 offset:54272
    buffer_load_dwordx4 v2, s[28:31], s45 offen offset:1024 sc1 lds
    s_add_u32 s45, s45, 16384
    s_waitcnt lgkmcnt(8)
    v_mfma_f32_16x16x32_bf16 v[32:35], v[112:115], v[192:195], v[32:35]
    ds_read_b64_tr_b16 v[120:121], v17 offset:32768
    buffer_load_dwordx4 v3, s[24:27], s46 offen offset:2048 lds
    s_waitcnt lgkmcnt(7)
    v_mfma_f32_16x16x32_bf16 v[32:35], v[116:119], v[208:211], v[32:35]
    ds_read_b64_tr_b16 v[122:123], v17 offset:40960
    s_waitcnt lgkmcnt(6)
    v_mfma_f32_16x16x32_bf16 v[36:39], v[116:119], v[212:215], v[36:39]
    ds_read_b64_tr_b16 v[124:125], v17 offset:49152
    v_mfma_f32_16x16x32_bf16 v[36:39], v[112:115], v[196:199], v[36:39]
    ds_read_b64_tr_b16 v[126:127], v17 offset:57344
    s_waitcnt lgkmcnt(7)
    v_mfma_f32_16x16x32_bf16 v[40:43], v[112:115], v[200:203], v[40:43]
    buffer_load_dwordx4 v9, s[24:27], s46 offen offset:3072 lds
    s_add_u32 s46, s46, 131072
    s_waitcnt lgkmcnt(6)
    v_mfma_f32_16x16x32_bf16 v[40:43], v[116:119], v[216:219], v[40:43]
    s_waitcnt lgkmcnt(4)
    v_mfma_f32_16x16x32_bf16 v[44:47], v[116:119], v[220:223], v[44:47]
    v_mfma_f32_16x16x32_bf16 v[44:47], v[112:115], v[204:207], v[44:47]
    s_waitcnt vmcnt(8) lgkmcnt(0)
    s_barrier
    s_cmp_lg_u32 s42, 0
    s_cbranch_scc1 L_sk_9009
    s_add_u32 s62, s62, 128
    s_load_dwordx2 s[8:9], s[94:95], s62 glc
L_sk_9009:
    v_mfma_f32_16x16x32_bf16 v[48:51], v[120:123], v[192:195], v[48:51]
    ds_read_b128 v[80:83], v7 offset:0
    ds_read_b128 v[96:99], v7 offset:16384
    s_add_u32 m0, s86, 32768
    v_mfma_f32_16x16x32_bf16 v[48:51], v[124:127], v[208:211], v[48:51]
    ds_read_b64_tr_b16 v[112:113], v18 offset:0
    buffer_load_dwordx4 v2, s[28:31], s45 offen sc1 lds
    v_mfma_f32_16x16x32_bf16 v[52:55], v[124:127], v[212:215], v[52:55]
    ds_read_b64_tr_b16 v[114:115], v18 offset:8192
    ds_read_b64_tr_b16 v[116:117], v18 offset:16384
    v_mfma_f32_16x16x32_bf16 v[52:55], v[120:123], v[196:199], v[52:55]
    ds_read_b64_tr_b16 v[118:119], v18 offset:24576
    v_mfma_f32_16x16x32_bf16 v[56:59], v[120:123], v[200:203], v[56:59]
    ds_read_b128 v[84:87], v7 offset:1024
    ds_read_b128 v[100:103], v7 offset:17408
    v_mfma_f32_16x16x32_bf16 v[56:59], v[124:127], v[216:219], v[56:59]
    ds_read_b128 v[88:91], v7 offset:4096
    buffer_load_dwordx4 v2, s[28:31], s45 offen offset:1024 sc1 lds
    s_add_u32 s45, s45, 16384
    v_mfma_f32_16x16x32_bf16 v[60:63], v[124:127], v[220:223], v[60:63]
    ds_read_b128 v[104:107], v7 offset:20480
    ds_read_b128 v[92:95], v7 offset:5120
    v_mfma_f32_16x16x32_bf16 v[60:63], v[120:123], v[204:207], v[60:63]
    ds_read_b128 v[108:111], v7 offset:21504
    s_waitcnt lgkmcnt(8)
    v_mfma_f32_16x16x32_bf16 v[32:35], v[112:115], v[80:83], v[32:35]
    ds_read_b64_tr_b16 v[120:121], v19 offset:0
    buffer_load_dwordx4 v3, s[24:27], s46 offen offset:2048 lds
    s_waitcnt lgkmcnt(7)
    v_mfma_f32_16x16x32_bf16 v[32:35], v[116:119], v[96:99], v[32:35]
    ds_read_b64_tr_b16 v[122:123], v19 offset:8192
    s_waitcnt lgkmcnt(6)
    v_mfma_f32_16x16x32_bf16 v[36:39], v[116:119], v[100:103], v[36:39]
    ds_read_b64_tr_b16 v[124:125], v19 offset:16384
    v_mfma_f32_16x16x32_bf16 v[36:39], v[112:115], v[84:87], v[36:39]
    ds_read_b64_tr_b16 v[126:127], v19 offset:24576
    s_waitcnt lgkmcnt(7)
    v_mfma_f32_16x16x32_bf16 v[40:43], v[112:115], v[88:91], v[40:43]
    buffer_load_dwordx4 v9, s[24:27], s46 offen offset:3072 lds
    s_add_u32 s46, s46, 131072
    s_waitcnt lgkmcnt(6)
    v_mfma_f32_16x16x32_bf16 v[40:43], v[116:119], v[104:107], v[40:43]
    s_waitcnt lgkmcnt(4)
    v_mfma_f32_16x16x32_bf16 v[44:47], v[116:119], v[108:111], v[44:47]
    v_mfma_f32_16x16x32_bf16 v[44:47], v[112:115], v[92:95], v[44:47]
    s_waitcnt vmcnt(10) lgkmcnt(0)
    s_cmp_lg_u32 s42, 0
    s_cbranch_scc1 L_sk_9010
    s_mov_b32 s63, 0x40000
L_poll_9011:
    s_waitcnt lgkmcnt(0)
    s_and_b32 s8, s8, s9
    s_cmp_eq_u32 s8, 1
    s_cbranch_scc1 L_go_9012
    s_sleep 4
    s_load_dwordx2 s[8:9], s[94:95], s62 glc
    s_sub_u32 s63, s63, 1
    s_cmp_lg_u32 s63, 0
    s_cbranch_scc1 L_poll_9011
    s_waitcnt lgkmcnt(0)
L_go_9012:
L_sk_9010:
    s_barrier
    v_mfma_f32_16x16x32_bf16 v[48:51], v[120:123], v[80:83], v[48:51]
    ds_read_b128 v[192:195], v7 offset:32768
    ds_read_b128 v[208:211], v7 offset:49152
    s_add_u32 m0, s86, 65536
    v_mfma_f32_16x16x32_bf16 v[48:51], v[124:127], v[96:99], v[48:51]
    ds_read_b64_tr_b16 v[112:113], v18 offset:32768
    buffer_load_dwordx4 v2, s[28:31], s45 offen sc1 lds
    v_mfma_f32_16x16x32_bf16 v[52:55], v[124:127], v[100:103], v[52:55]
    ds_read_b64_tr_b16 v[114:115], v18 offset:40960
    ds_read_b64_tr_b16 v[116:117], v18 offset:49152
    v_mfma_f32_16x16x32_bf16 v[52:55], v[120:123], v[84:87], v[52:55]
    ds_read_b64_tr_b16 v[118:119], v18 offset:57344
    v_mfma_f32_16x16x32_bf16 v[56:59], v[120:123], v[88:91], v[56:59]
    ds_read_b128 v[196:199], v7 offset:33792
    ds_read_b128 v[212:215], v7 offset:50176
    v_mfma_f32_16x16x32_bf16 v[56:59], v[124:127], v[104:107], v[56:59]
    ds_read_b128 v[200:203], v7 offset:36864
    buffer_load_dwordx4 v2, s[28:31], s45 offen offset:1024 sc1 lds
    s_add_u32 s45, s45, 16384
    v_mfma_f32_16x16x32_bf16 v[60:63], v[124:127], v[108:111], v[60:63]
    ds_read_b128 v[216:219], v7 offset:53248
    ds_read_b128 v[204:207], v7 offset:37888
    v_mfma_f32_16x16x32_bf16 v[60:63], v[120:123], v[92:95], v[60:63]
    ds_read_b128 v[220:223], v7 offset:54272
    s_waitcnt lgkmcnt(8)
    v_mfma_f32_16x16x32_bf16 v[32:35], v[112:115], v[192:195], v[32:35]
    ds_read_b64_tr_b16 v[120:121], v19 offset:32768
    buffer_load_dwordx4 v3, s[24:27], s46 offen offset:2048 lds
    s_waitcnt lgkmcnt(7)
    v_mfma_f32_16x16x32_bf16 v[32:35], v[116:119], v[208:211], v[32:35]
    ds_read_b64_tr_b16 v[122:123], v19 offset:40960
    s_waitcnt lgkmcnt(6)
    v_mfma_f32_16x16x32_bf16 v[36:39], v[116:119], v[212:215], v[36:39]
    ds_read_b64_tr_b16 v[124:125], v19 offset:49152
    v_mfma_f32_16x16x32_bf16 v[36:39], v[112:115], v[196:199], v[36:39]
    ds_read_b64_tr_b16 v[126:127], v19 offset:57344
    s_waitcnt lgkmcnt(7)
    v_mfma_f32_16x16x32_bf16 v[40:43], v[112:115], v[200:203], v[40:43]
    buffer_load_dwordx4 v9, s[24:27], s46 offen offset:3072 lds
    s_add_u32 s46, s46, 131072
    s_waitcnt lgkmcnt(6)
    v_mfma_f32_16x16x32_bf16 v[40:43], v[116:119], v[216:219], v[40:43]
    s_waitcnt lgkmcnt(4)
    v_mfma_f32_16x16x32_bf16 v[44:47], v[116:119], v[220:223], v[44:47]
    v_mfma_f32_16x16x32_bf16 v[44:47], v[112:115], v[204:207], v[44:47]
    s_waitcnt vmcnt(12) lgkmcnt(0)
    s_barrier
    s_cmp_lg_u32 s42, 0
    s_cbranch_scc1 L_sk_9013
    buffer_load_dwordx4 v[28:31], v27, s[28:31], s93 offen sc1
L_sk_9013:
    v_mfma_f32_16x16x32_bf16 v[48:51], v[120:123], v[192:195], v[48:51]
    ds_read_b128 v[80:83], v8 offset:0
    ds_read_b128 v[96:99], v8 offset:16384
    s_add_u32 m0, s86, 98304
    v_mfma_f32_16x16x32_bf16 v[48:51], v[124:127], v[208:211], v[48:51]
    ds_read_b64_tr_b16 v[112:113], v20 offset:0
    buffer_load_dwordx4 v2, s[28:31], s45 offen sc1 lds
    v_mfma_f32_16x16x32_bf16 v[52:55], v[124:127], v[212:215], v[52:55]
    ds_read_b64_tr_b16 v[114:115], v20 offset:8192
    ds_read_b64_tr_b16 v[116:117], v20 offset:16384
    v_mfma_f32_16x16x32_bf16 v[52:55], v[120:123], v[196:199], v[52:55]
    ds_read_b64_tr_b16 v[118:119], v20 offset:24576
    v_mfma_f32_16x16x32_bf16 v[56:59], v[120:123], v[200:203], v[56:59]
    ds_read_b128 v[84:87], v8 offset:1024
    ds_read_b128 v[100:103], v8 offset:17408
    v_mfma_f32_16x16x32_bf16 v[56:59], v[124:127], v[216:219], v[56:59]
    ds_read_b128 v[88:91], v8 offset:4096
    buffer_load_dwordx4 v2, s[28:31], s45 offen offset:1024 sc1 lds
    s_add_u32 s45, s45, 16384
    v_mfma_f32_16x16x32_bf16 v[60:63], v[124:127], v[220:223], v[60:63]
    ds_read_b128 v[104:107], v8 offset:20480
    ds_read_b128 v[92:95], v8 offset:5120
    v_mfma_f32_16x16x32_bf16 v[60:63], v[120:123], v[204:207], v[60:63]
    ds_read_b128 v[108:111], v8 offset:21504
    s_waitcnt lgkmcnt(8)
    v_mfma_f32_16x16x32_bf16 v[32:35], v[112:115], v[80:83], v[32:35]
    ds_read_b64_tr_b16 v[120:121], v21 offset:0
    buffer_load_dwordx4 v3, s[24:27], s46 offen offset:2048 lds
    s_waitcnt lgkmcnt(7)
    v_mfma_f32_16x16x32_bf16 v[32:35], v[116:119], v[96:99], v[32:35]
    ds_read_b64_tr_b16 v[122:123], v21 offset:8192
    s_waitcnt lgkmcnt(6)
    v_mfma_f32_16x16x32_bf16 v[36:39], v[116:119], v[100:103], v[36:39]
    ds_read_b64_tr_b16 v[124:125], v21 offset:16384
    v_mfma_f32_16x16x32_bf16 v[36:39], v[112:115], v[84:87], v[36:39]
    ds_read_b64_tr_b16 v[126:127], v21 offset:24576
    s_waitcnt lgkmcnt(7)
    v_mfma_f32_16x16x32_bf16 v[40:43], v[112:115], v[88:91], v[40:43]
    buffer_load_dwordx4 v9, s[24:27], s46 offen offset:3072 lds
    s_add_u32 s46, s46, 131072
    s_waitcnt lgkmcnt(6)
    v_mfma_f32_16x16x32_bf16 v[40:43], v[116:119], v[104:107], v[40:43]
    s_waitcnt lgkmcnt(4)
    v_mfma_f32_16x16x32_bf16 v[44:47], v[116:119], v[108:111], v[44:47]
    v_mfma_f32_16x16x32_bf16 v[44:47], v[112:115], v[92:95], v[44:47]
    s_waitcnt vmcnt(12) lgkmcnt(0)
    s_barrier
    v_mfma_f32_16x16x32_bf16 v[48:51], v[120:123], v[80:83], v[48:51]
    ds_read_b128 v[192:195], v6 offset:0
    ds_read_b128 v[208:211], v6 offset:16384
    s_add_u32 m0, s86, 131072
    v_mfma_f32_16x16x32_bf16 v[48:51], v[124:127], v[96:99], v[48:51]
    ds_read_b64_tr_b16 v[112:113], v16 offset:0
    buffer_load_dwordx4 v2, s[28:31], s45 offen sc1 lds
    v_mfma_f32_16x16x32_bf16 v[52:55], v[124:127], v[100:103], v[52:55]
    ds_read_b64_tr_b16 v[114:115], v16 offset:8192
    ds_read_b64_tr_b16 v[116:117], v16 offset:16384
    v_mfma_f32_16x16x32_bf16 v[52:55], v[120:123], v[84:87], v[52:55]
    ds_read_b64_tr_b16 v[118:119], v16 offset:24576
    v_mfma_f32_16x16x32_bf16 v[56:59], v[120:123], v[88:91], v[56:59]
    ds_read_b128 v[196:199], v6 offset:1024
    ds_read_b128 v[212:215], v6 offset:17408
    v_mfma_f32_16x16x32_bf16 v[56:59], v[124:127], v[104:107], v[56:59]
    ds_read_b128 v[200:203], v6 offset:4096
    buffer_load_dwordx4 v2, s[28:31], s45 offen offset:1024 sc1 lds
    s_add_u32 s45, s45, 16384
    v_mfma_f32_16x16x32_bf16 v[60:63], v[124:127], v[108:111], v[60:63]
    ds_read_b128 v[216:219], v6 offset:20480
    ds_read_b128 v[204:207], v6 offset:5120
    v_mfma_f32_16x16x32_bf16 v[60:63], v[120:123], v[92:95], v[60:63]
    ds_read_b128 v[220:223], v6 offset:21504
    s_waitcnt lgkmcnt(8)
    v_mfma_f32_16x16x32_bf16 v[32:35], v[112:115], v[192:195], v[32:35]
    ds_read_b64_tr_b16 v[120:121], v17 offset:0
    buffer_load_dwordx4 v3, s[24:27], s46 offen offset:2048 lds
    s_waitcnt lgkmcnt(7)
    v_mfma_f32_16x16x32_bf16 v[32:35], v[116:119], v[208:211], v[32:35]
    ds_read_b64_tr_b16 v[122:123], v17 offset:8192
    s_waitcnt lgkmcnt(6)
    v_mfma_f32_16x16x32_bf16 v[36:39], v[116:119], v[212:215], v[36:39]
    ds_read_b64_tr_b16 v[124:125], v17 offset:16384
    v_mfma_f32_16x16x32_bf16 v[36:39], v[112:115], v[196:199], v[36:39]
    ds_read_b64_tr_b16 v[126:127], v17 offset:24576
    s_waitcnt lgkmcnt(7)
    v_mfma_f32_16x16x32_bf16 v[40:43], v[112:115], v[200:203], v[40:43]
    buffer_load_dwordx4 v9, s[24:27], s46 offen offset:3072 lds
    s_add_u32 s46, s46, 131072
    s_waitcnt lgkmcnt(6)
    v_mfma_f32_16x16x32_bf16 v[40:43], v[116:119], v[216:219], v[40:43]
    s_waitcnt lgkmcnt(4)
    v_mfma_f32_16x16x32_bf16 v[44:47], v[116:119], v[220:223], v[44:47]
    v_mfma_f32_16x16x32_bf16 v[44:47], v[112:115], v[204:207], v[44:47]
    s_waitcnt vmcnt(12) lgkmcnt(0)
    s_barrier
    v_mfma_f32_16x16x32_bf16 v[48:51], v[120:123], v[192:195], v[48:51]
    ds_read_b128 v[80:83], v6 offset:32768
    ds_read_b128 v[96:99], v6 offset:49152
    s_add_u32 m0, s86, 0
    v_mfma_f32_16x16x32_bf16 v[48:51], v[124:127], v[208:211], v[48:51]
    ds_read_b64_tr_b16 v[112:113], v16 offset:32768
    buffer_load_dwordx4 v2, s[28:31], s45 offen sc1 lds
    v_mfma_f32_16x16x32_bf16 v[52:55], v[124:127], v[212:215], v[52:55]
    ds_read_b64_tr_b16 v[114:115], v16 offset:40960
    ds_read_b64_tr_b16 v[116:117], v16 offset:49152
    v_mfma_f32_16x16x32_bf16 v[52:55], v[120:123], v[196:199], v[52:55]
    ds_read_b64_tr_b16 v[118:119], v16 offset:57344
    v_mfma_f32_16x16x32_bf16 v[56:59], v[120:123], v[200:203], v[56:59]
    ds_read_b128 v[84:87], v6 offset:33792
    ds_read_b128 v[100:103], v6 offset:50176
    v_mfma_f32_16x16x32_bf16 v[56:59], v[124:127], v[216:219], v[56:59]
    ds_read_b128 v[88:91], v6 offset:36864
    buffer_load_dwordx4 v2, s[28:31], s45 offen offset:1024 sc1 lds
    s_add_u32 s45, s45, 16384
    v_mfma_f32_16x16x32_bf16 v[60:63], v[124:127], v[220:223], v[60:63]
    ds_read_b128 v[104:107], v6 offset:53248
    ds_read_b128 v[92:95], v6 offset:37888
    v_mfma_f32_16x16x32_bf16 v[60:63], v[120:123], v[204:207], v[60:63]
    ds_read_b128 v[108:111], v6 offset:54272
    s_waitcnt lgkmcnt(8)
    v_mfma_f32_16x16x32_bf16 v[32:35], v[112:115], v[80:83], v[32:35]
    ds_read_b64_tr_b16 v[120:121], v17 offset:32768
    buffer_load_dwordx4 v3, s[24:27], s46 offen offset:2048 lds
    s_waitcnt lgkmcnt(7)
    v_mfma_f32_16x16x32_bf16 v[32:35], v[116:119], v[96:99], v[32:35]
    ds_read_b64_tr_b16 v[122:123], v17 offset:40960
    s_waitcnt lgkmcnt(6)
    v_mfma_f32_16x16x32_bf16 v[36:39], v[116:119], v[100:103], v[36:39]
    ds_read_b64_tr_b16 v[124:125], v17 offset:49152
    v_mfma_f32_16x16x32_bf16 v[36:39], v[112:115], v[84:87], v[36:39]
    ds_read_b64_tr_b16 v[126:127], v17 offset:57344
    s_waitcnt lgkmcnt(7)
    v_mfma_f32_16x16x32_bf16 v[40:43], v[112:115], v[88:91], v[40:43]
    buffer_load_dwordx4 v9, s[24:27], s46 offen offset:3072 lds
    s_add_u32 s46, s46, 131072
    s_waitcnt lgkmcnt(6)
    v_mfma_f32_16x16x32_bf16 v[40:43], v[116:119], v[104:107], v[40:43]
    s_waitcnt lgkmcnt(4)
    v_mfma_f32_16x16x32_bf16 v[44:47], v[116:119], v[108:111], v[44:47]
    v_mfma_f32_16x16x32_bf16 v[44:47], v[112:115], v[92:95], v[44:47]
    s_waitcnt vmcnt(12) lgkmcnt(0)
    s_barrier
    v_mfma_f32_16x16x32_bf16 v[48:51], v[120:123], v[80:83], v[48:51]
    ds_read_b128 v[192:195], v7 offset:0
    ds_read_b128 v[208:211], v7 offset:16384
    s_add_u32 m0, s86, 32768
    v_mfma_f32_16x16x32_bf16 v[48:51], v[124:127], v[96:99], v[48:51]
    ds_read_b64_tr_b16 v[112:113], v18 offset:0
    buffer_load_dwordx4 v2, s[28:31], s45 offen sc1 lds
    v_mfma_f32_16x16x32_bf16 v[52:55], v[124:127], v[100:103], v[52:55]
    ds_read_b64_tr_b16 v[114:115], v18 offset:8192
    ds_read_b64_tr_b16 v[116:117], v18 offset:16384
    v_mfma_f32_16x16x32_bf16 v[52:55], v[120:123], v[84:87], v[52:55]
    ds_read_b64_tr_b16 v[118:119], v18 offset:24576
    v_mfma_f32_16x16x32_bf16 v[56:59], v[120:123], v[88:91], v[56:59]
    ds_read_b128 v[196:199], v7 offset:1024
    ds_read_b128 v[212:215], v7 offset:17408
    v_mfma_f32_16x16x32_bf16 v[56:59], v[124:127], v[104:107], v[56:59]
    ds_read_b128 v[200:203], v7 offset:4096
    buffer_load_dwordx4 v2, s[28:31], s45 offen offset:1024 sc1 lds
    s_add_u32 s45, s45, 16384
    v_mfma_f32_16x16x32_bf16 v[60:63], v[124:127], v[108:111], v[60:63]
    ds_read_b128 v[216:219], v7 offset:20480
    ds_read_b128 v[204:207], v7 offset:5120
    v_mfma_f32_16x16x32_bf16 v[60:63], v[120:123], v[92:95], v[60:63]
    ds_read_b128 v[220:223], v7 offset:21504
    s_waitcnt lgkmcnt(8)
    v_mfma_f32_16x16x32_bf16 v[32:35], v[112:115], v[192:195], v[32:35]
    ds_read_b64_tr_b16 v[120:121], v19 offset:0
    buffer_load_dwordx4 v3, s[24:27], s46 offen offset:2048 lds
    s_waitcnt lgkmcnt(7)
    v_mfma_f32_16x16x32_bf16 v[32:35], v[116:119], v[208:211], v[32:35]
    ds_read_b64_tr_b16 v[122:123], v19 offset:8192
    s_waitcnt lgkmcnt(6)
    v_mfma_f32_16x16x32_bf16 v[36:39], v[116:119], v[212:215], v[36:39]
    ds_read_b64_tr_b16 v[124:125], v19 offset:16384
    v_mfma_f32_16x16x32_bf16 v[36:39], v[112:115], v[196:199], v[36:39]
    ds_read_b64_tr_b16 v[126:127], v19 offset:24576
    s_waitcnt lgkmcnt(7)
    v_mfma_f32_16x16x32_bf16 v[40:43], v[112:115], v[200:203], v[40:43]
    buffer_load_dwordx4 v9, s[24:27], s46 offen offset:3072 lds
    s_add_u32 s46, s46, 131072
    s_waitcnt lgkmcnt(6)
    v_mfma_f32_16x16x32_bf16 v[40:43], v[116:119], v[216:219], v[40:43]
    s_waitcnt lgkmcnt(4)
    v_mfma_f32_16x16x32_bf16 v[44:47], v[116:119], v[220:223], v[44:47]
    v_mfma_f32_16x16x32_bf16 v[44:47], v[112:115], v[204:207], v[44:47]
    s_waitcnt vmcnt(12) lgkmcnt(0)
    s_barrier
    v_mfma_f32_16x16x32_bf16 v[48:51], v[120:123], v[192:195], v[48:51]
    ds_read_b128 v[80:83], v7 offset:32768
    ds_read_b128 v[96:99], v7 offset:49152
    s_add_u32 m0, s86, 65536
    v_mfma_f32_16x16x32_bf16 v[48:51], v[124:127], v[208:211], v[48:51]
    ds_read_b64_tr_b16 v[112:113], v18 offset:32768
    buffer_load_dwordx4 v2, s[28:31], s45 offen sc1 lds
    v_mfma_f32_16x16x32_bf16 v[52:55], v[124:127], v[212:215], v[52:55]
    ds_read_b64_tr_b16 v[114:115], v18 offset:40960
    ds_read_b64_tr_b16 v[116:117], v18 offset:49152
    v_mfma_f32_16x16x32_bf16 v[52:55], v[120:123], v[196:199], v[52:55]
    ds_read_b64_tr_b16 v[118:119], v18 offset:57344
    v_mfma_f32_16x16x32_bf16 v[56:59], v[120:123], v[200:203], v[56:59]
    ds_read_b128 v[84:87], v7 offset:33792
    ds_read_b128 v[100:103], v7 offset:50176
    v_mfma_f32_16x16x32_bf16 v[56:59], v[124:127], v[216:219], v[56:59]
    ds_read_b128 v[88:91], v7 offset:36864
    buffer_load_dwordx4 v2, s[28:31], s45 offen offset:1024 sc1 lds
    s_add_u32 s45, s45, 16384
    v_mfma_f32_16x16x32_bf16 v[60:63], v[124:127], v[220:223], v[60:63]
    ds_read_b128 v[104:107], v7 offset:53248
    ds_read_b128 v[92:95], v7 offset:37888
    v_mfma_f32_16x16x32_bf16 v[60:63], v[120:123], v[204:207], v[60:63]
    ds_read_b128 v[108:111], v7 offset:54272
    s_waitcnt lgkmcnt(8)
    v_mfma_f32_16x16x32_bf16 v[32:35], v[112:115], v[80:83], v[32:35]
    ds_read_b64_tr_b16 v[120:121], v19 offset:32768
    buffer_load_dwordx4 v3, s[24:27], s46 offen offset:2048 lds
    s_waitcnt lgkmcnt(7)
    v_mfma_f32_16x16x32_bf16 v[32:35], v[116:119], v[96:99], v[32:35]
    ds_read_b64_tr_b16 v[122:123], v19 offset:40960
    s_waitcnt lgkmcnt(6)
    v_mfma_f32_16x16x32_bf16 v[36:39], v[116:119], v[100:103], v[36:39]
    ds_read_b64_tr_b16 v[124:125], v19 offset:49152
    v_mfma_f32_16x16x32_bf16 v[36:39], v[112:115], v[84:87], v[36:39]
    ds_read_b64_tr_b16 v[126:127], v19 offset:57344
    s_waitcnt lgkmcnt(7)
    v_mfma_f32_16x16x32_bf16 v[40:43], v[112:115], v[88:91], v[40:43]
    buffer_load_dwordx4 v9, s[24:27], s46 offen offset:3072 lds
    s_add_u32 s46, s46, 131072
    s_waitcnt lgkmcnt(6)
    v_mfma_f32_16x16x32_bf16 v[40:43], v[116:119], v[104:107], v[40:43]
    s_waitcnt lgkmcnt(4)
    v_mfma_f32_16x16x32_bf16 v[44:47], v[116:119], v[108:111], v[44:47]
    v_mfma_f32_16x16x32_bf16 v[44:47], v[112:115], v[92:95], v[44:47]
    s_waitcnt vmcnt(12) lgkmcnt(0)
    s_barrier
    v_mfma_f32_16x16x32_bf16 v[48:51], v[120:123], v[80:83], v[48:51]
    ds_read_b128 v[192:195], v8 offset:0
    ds_read_b128 v[208:211], v8 offset:16384
    s_add_u32 m0, s86, 98304
    v_mfma_f32_16x16x32_bf16 v[48:51], v[124:127], v[96:99], v[48:51]
    ds_read_b64_tr_b16 v[112:113], v20 offset:0
    buffer_load_dwordx4 v2, s[28:31], s45 offen sc1 lds
    v_mfma_f32_16x16x32_bf16 v[52:55], v[124:127], v[100:103], v[52:55]
    ds_read_b64_tr_b16 v[114:115], v20 offset:8192
    ds_read_b64_tr_b16 v[116:117], v20 offset:16384
    v_mfma_f32_16x16x32_bf16 v[52:55], v[120:123], v[84:87], v[52:55]
    ds_read_b64_tr_b16 v[118:119], v20 offset:24576
    v_mfma_f32_16x16x32_bf16 v[56:59], v[120:123], v[88:91], v[56:59]
    ds_read_b128 v[196:199], v8 offset:1024
    ds_read_b128 v[212:215], v8 offset:17408
    v_mfma_f32_16x16x32_bf16 v[56:59], v[124:127], v[104:107], v[56:59]
    ds_read_b128 v[200:203], v8 offset:4096
    buffer_load_dwordx4 v2, s[28:31], s45 offen offset:1024 sc1 lds
    s_add_u32 s45, s45, 16384
    v_mfma_f32_16x16x32_bf16 v[60:63], v[124:127], v[108:111], v[60:63]
    ds_read_b128 v[216:219], v8 offset:20480
    ds_read_b128 v[204:207], v8 offset:5120
    v_mfma_f32_16x16x32_bf16 v[60:63], v[120:123], v[92:95], v[60:63]
    ds_read_b128 v[220:223], v8 offset:21504
    s_waitcnt lgkmcnt(8)
    v_mfma_f32_16x16x32_bf16 v[32:35], v[112:115], v[192:195], v[32:35]
    ds_read_b64_tr_b16 v[120:121], v21 offset:0
    buffer_load_dwordx4 v3, s[24:27], s46 offen offset:2048 lds
    s_waitcnt lgkmcnt(7)
    v_mfma_f32_16x16x32_bf16 v[32:35], v[116:119], v[208:211], v[32:35]
    ds_read_b64_tr_b16 v[122:123], v21 offset:8192
    s_waitcnt lgkmcnt(6)
    v_mfma_f32_16x16x32_bf16 v[36:39], v[116:119], v[212:215], v[36:39]
    ds_read_b64_tr_b16 v[124:125], v21 offset:16384
    v_mfma_f32_16x16x32_bf16 v[36:39], v[112:115], v[196:199], v[36:39]
    ds_read_b64_tr_b16 v[126:127], v21 offset:24576
    s_waitcnt lgkmcnt(7)
    v_mfma_f32_16x16x32_bf16 v[40:43], v[112:115], v[200:203], v[40:43]
    buffer_load_dwordx4 v9, s[24:27], s46 offen offset:3072 lds
    s_add_u32 s46, s46, 131072
    s_waitcnt lgkmcnt(6)
    v_mfma_f32_16x16x32_bf16 v[40:43], v[116:119], v[216:219], v[40:43]
    s_waitcnt lgkmcnt(4)
    v_mfma_f32_16x16x32_bf16 v[44:47], v[116:119], v[220:223], v[44:47]
    v_mfma_f32_16x16x32_bf16 v[44:47], v[112:115], v[204:207], v[44:47]
    s_waitcnt vmcnt(12) lgkmcnt(0)
    s_cmp_lg_u32 s42, 0
    s_cbranch_scc1 L_sk_9014
    s_add_u32 s62, s62, 128
    v_and_b32 v14, v28, v29
    v_cmp_eq_u32 vcc, 1, v14
    s_lshr_b32 s54, s62, 7
    s_bitcmp1_b32 vcc_lo, s54
    s_cbranch_scc1 L_sk_9014
    s_mov_b32 s63, 0x40000
    s_load_dwordx2 s[8:9], s[94:95], s62 glc
L_poll_9015:
    s_waitcnt lgkmcnt(0)
    s_and_b32 s8, s8, s9
    s_cmp_eq_u32 s8, 1
    s_cbranch_scc1 L_go_9016
    s_sleep 4
    s_load_dwordx2 s[8:9], s[94:95], s62 glc
    s_sub_u32 s63, s63, 1
    s_cmp_lg_u32 s63, 0
    s_cbranch_scc1 L_poll_9015
    s_waitcnt lgkmcnt(0)
L_go_9016:
L_sk_9014:
    s_barrier
    v_mfma_f32_16x16x32_bf16 v[48:51], v[120:123], v[192:195], v[48:51]
    ds_read_b128 v[80:83], v6 offset:0
    ds_read_b128 v[96:99], v6 offset:16384
    s_add_u32 m0, s86, 131072
    v_mfma_f32_16x16x32_bf16 v[48:51], v[124:127], v[208:211], v[48:51]
    ds_read_b64_tr_b16 v[112:113], v16 offset:0
    buffer_load_dwordx4 v2, s[28:31], s45 offen sc1 lds
    v_mfma_f32_16x16x32_bf16 v[52:55], v[124:127], v[212:215], v[52:55]
    ds_read_b64_tr_b16 v[114:115], v16 offset:8192
    ds_read_b64_tr_b16 v[116:117], v16 offset:16384
    v_mfma_f32_16x16x32_bf16 v[52:55], v[120:123], v[196:199], v[52:55]
    ds_read_b64_tr_b16 v[118:119], v16 offset:24576
    v_mfma_f32_16x16x32_bf16 v[56:59], v[120:123], v[200:203], v[56:59]
    ds_read_b128 v[84:87], v6 offset:1024
    ds_read_b128 v[100:103], v6 offset:17408
    v_mfma_f32_16x16x32_bf16 v[56:59], v[124:127], v[216:219], v[56:59]
    ds_read_b128 v[88:91], v6 offset:4096
    buffer_load_dwordx4 v2, s[28:31], s45 offen offset:1024 sc1 lds
    s_add_u32 s45, s45, 16384
    v_mfma_f32_16x16x32_bf16 v[60:63], v[124:127], v[220:223], v[60:63]
    ds_read_b128 v[104:107], v6 offset:20480
    ds_read_b128 v[92:95], v6 offset:5120
    v_mfma_f32_16x16x32_bf16 v[60:63], v[120:123], v[204:207], v[60:63]
    ds_read_b128 v[108:111], v6 offset:21504
    s_waitcnt lgkmcnt(8)
    v_mfma_f32_16x16x32_bf16 v[32:35], v[112:115], v[80:83], v[32:35]
    ds_read_b64_tr_b16 v[120:121], v17 offset:0
    buffer_load_dwordx4 v3, s[24:27], s46 offen offset:2048 lds
    s_waitcnt lgkmcnt(7)
    v_mfma_f32_16x16x32_bf16 v[32:35], v[116:119], v[96:99], v[32:35]
    ds_read_b64_tr_b16 v[122:123], v17 offset:8192
    s_waitcnt lgkmcnt(6)
    v_mfma_f32_16x16x32_bf16 v[36:39], v[116:119], v[100:103], v[36:39]
    ds_read_b64_tr_b16 v[124:125], v17 offset:16384
    v_mfma_f32_16x16x32_bf16 v[36:39], v[112:115], v[84:87], v[36:39]
    ds_read_b64_tr_b16 v[126:127], v17 offset:24576
    s_waitcnt lgkmcnt(7)
    v_mfma_f32_16x16x32_bf16 v[40:43], v[112:115], v[88:91], v[40:43]
    buffer_load_dwordx4 v9, s[24:27], s46 offen offset:3072 lds
    s_add_u32 s46, s46, 131072
    s_waitcnt lgkmcnt(6)
    v_mfma_f32_16x16x32_bf16 v[40:43], v[116:119], v[104:107], v[40:43]
    s_waitcnt lgkmcnt(4)
    v_mfma_f32_16x16x32_bf16 v[44:47], v[116:119], v[108:111], v[44:47]
    v_mfma_f32_16x16x32_bf16 v[44:47], v[112:115], v[92:95], v[44:47]
    s_waitcnt vmcnt(12) lgkmcnt(0)
    s_barrier
    s_cmp_lg_u32 s42, 0
    s_cbranch_scc1 L_sk_9017
    buffer_load_dwordx4 v[28:31], v27, s[28:31], s93 offen sc1
L_sk_9017:
    v_mfma_f32_16x16x32_bf16 v[48:51], v[120:123], v[80:83], v[48:51]
    ds_read_b128 v[192:195], v6 offset:32768
    ds_read_b128 v[208:211], v6 offset:49152
    s_add_u32 m0, s86, 0
    v_mfma_f32_16x16x32_bf16 v[48:51], v[124:127], v[96:99], v[48:51]
    ds_read_b64_tr_b16 v[112:113], v16 offset:32768
    buffer_load_dwordx4 v2, s[28:31], s45 offen sc1 lds
    v_mfma_f32_16x16x32_bf16 v[52:55], v[124:127], v[100:103], v[52:55]
    ds_read_b64_tr_b16 v[114:115], v16 offset:40960
    ds_read_b64_tr_b16 v[116:117], v16 offset:49152
    v_mfma_f32_16x16x32_bf16 v[52:55], v[120:123], v[84:87], v[52:55]
    ds_read_b64_tr_b16 v[118:119], v16 offset:57344
    v_mfma_f32_16x16x32_bf16 v[56:59], v[120:123], v[88:91], v[56:59]
    ds_read_b128 v[196:199], v6 offset:33792
    ds_read_b128 v[212:215], v6 offset:50176
    v_mfma_f32_16x16x32_bf16 v[56:59], v[124:127], v[104:107], v[56:59]
    ds_read_b128 v[200:203], v6 offset:36864
    buffer_load_dwordx4 v2, s[28:31], s45 offen offset:1024 sc1 lds
    s_add_u32 s45, s45, 16384
    v_mfma_f32_16x16x32_bf16 v[60:63], v[124:127], v[108:111], v[60:63]
    ds_read_b128 v[216:219], v6 offset:53248
    ds_read_b128 v[204:207], v6 offset:37888
    v_mfma_f32_16x16x32_bf16 v[60:63], v[120:123], v[92:95], v[60:63]
    ds_read_b128 v[220:223], v6 offset:54272
    s_waitcnt lgkmcnt(8)
    v_mfma_f32_16x16x32_bf16 v[32:35], v[112:115], v[192:195], v[32:35]
    ds_read_b64_tr_b16 v[120:121], v17 offset:32768
    buffer_load_dwordx4 v3, s[24:27], s46 offen offset:2048 lds
    s_waitcnt lgkmcnt(7)
    v_mfma_f32_16x16x32_bf16 v[32:35], v[116:119], v[208:211], v[32:35]
    ds_read_b64_tr_b16 v[122:123], v17 offset:40960
    s_waitcnt lgkmcnt(6)
    v_mfma_f32_16x16x32_bf16 v[36:39], v[116:119], v[212:215], v[36:39]
    ds_read_b64_tr_b16 v[124:125], v17 offset:49152
    v_mfma_f32_16x16x32_bf16 v[36:39], v[112:115], v[196:199], v[36:39]
    ds_read_b64_tr_b16 v[126:127], v17 offset:57344
    s_waitcnt lgkmcnt(7)
    v_mfma_f32_16x16x32_bf16 v[40:43], v[112:115], v[200:203], v[40:43]
    buffer_load_dwordx4 v9, s[24:27], s46 offen offset:3072 lds
    s_add_u32 s46, s46, 131072
    s_waitcnt lgkmcnt(6)
    v_mfma_f32_16x16x32_bf16 v[40:43], v[116:119], v[216:219], v[40:43]
    s_waitcnt lgkmcnt(4)
    v_mfma_f32_16x16x32_bf16 v[44:47], v[116:119], v[220:223], v[44:47]
    v_mfma_f32_16x16x32_bf16 v[44:47], v[112:115], v[204:207], v[44:47]
    s_waitcnt vmcnt(12) lgkmcnt(0)
    s_barrier
    v_mfma_f32_16x16x32_bf16 v[48:51], v[120:123], v[192:195], v[48:51]
    ds_read_b128 v[80:83], v7 offset:0
    ds_read_b128 v[96:99], v7 offset:16384
    s_add_u32 m0, s86, 32768
    v_mfma_f32_16x16x32_bf16 v[48:51], v[124:127], v[208:211], v[48:51]
    ds_read_b64_tr_b16 v[112:113], v18 offset:0
    buffer_load_dwordx4 v2, s[28:31], s45 offen sc1 lds
    v_mfma_f32_16x16x32_bf16 v[52:55], v[124:127], v[212:215], v[52:55]
    ds_read_b64_tr_b16 v[114:115], v18 offset:8192
    ds_read_b64_tr_b16 v[116:117], v18 offset:16384
    v_mfma_f32_16x16x32_bf16 v[52:55], v[120:123], v[196:199], v[52:55]
    ds_read_b64_tr_b16 v[118:119], v18 offset:24576
    v_mfma_f32_16x16x32_bf16 v[56:59], v[120:123], v[200:203], v[56:59]
    ds_read_b128 v[84:87], v7 offset:1024
    ds_read_b128 v[100:103], v7 offset:17408
    v_mfma_f32_16x16x32_bf16 v[56:59], v[124:127], v[216:219], v[56:59]
    ds_read_b128 v[88:91], v7 offset:4096
    buffer_load_dwordx4 v2, s[28:31], s45 offen offset:1024 sc1 lds
    s_add_u32 s45, s45, 16384
    v_mfma_f32_16x16x32_bf16 v[60:63], v[124:127], v[220:223], v[60:63]
    ds_read_b128 v[104:107], v7 offset:20480
    ds_read_b128 v[92:95], v7 offset:5120
    v_mfma_f32_16x16x32_bf16 v[60:63], v[120:123], v[204:207], v[60:63]
    ds_read_b128 v[108:111], v7 offset:21504
    s_waitcnt lgkmcnt(8)
    v_mfma_f32_16x16x32_bf16 v[32:35], v[112:115], v[80:83], v[32:35]
    ds_read_b64_tr_b16 v[120:121], v19 offset:0
    buffer_load_dwordx4 v3, s[24:27], s46 offen offset:2048 lds
    s_waitcnt lgkmcnt(7)
    v_mfma_f32_16x16x32_bf16 v[32:35], v[116:119], v[96:99], v[32:35]
    ds_read_b64_tr_b16 v[122:123], v19 offset:8192
    s_waitcnt lgkmcnt(6)
    v_mfma_f32_16x16x32_bf16 v[36:39], v[116:119], v[100:103], v[36:39]
    ds_read_b64_tr_b16 v[124:125], v19 offset:16384
    v_mfma_f32_16x16x32_bf16 v[36:39], v[112:115], v[84:87], v[36:39]
    ds_read_b64_tr_b16 v[126:127], v19 offset:24576
    s_waitcnt lgkmcnt(7)
    v_mfma_f32_16x16x32_bf16 v[40:43], v[112:115], v[88:91], v[40:43]
    buffer_load_dwordx4 v9, s[24:27], s46 offen offset:3072 lds
    s_add_u32 s46, s46, 131072
    s_waitcnt lgkmcnt(6)
    v_mfma_f32_16x16x32_bf16 v[40:43], v[116:119], v[104:107], v[40:43]
    s_waitcnt lgkmcnt(4)
    v_mfma_f32_16x16x32_bf16 v[44:47], v[116:119], v[108:111], v[44:47]
    v_mfma_f32_16x16x32_bf16 v[44:47], v[112:115], v[92:95], v[44:47]
    s_waitcnt vmcnt(12) lgkmcnt(0)
    s_barrier
    v_mfma_f32_16x16x32_bf16 v[48:51], v[120:123], v[80:83], v[48:51]
    ds_read_b128 v[192:195], v7 offset:32768
    ds_read_b128 v[208:211], v7 offset:49152
    s_add_u32 m0, s86, 65536
    v_mfma_f32_16x16x32_bf16 v[48:51], v[124:127], v[96:99], v[48:51]
    ds_read_b64_tr_b16 v[112:113], v18 offset:32768
    buffer_load_dwordx4 v2, s[28:31], s45 offen sc1 lds
    v_mfma_f32_16x16x32_bf16 v[52:55], v[124:127], v[100:103], v[52:55]
    ds_read_b64_tr_b16 v[114:115], v18 offset:40960
    ds_read_b64_tr_b16 v[116:117], v18 offset:49152
    v_mfma_f32_16x16x32_bf16 v[52:55], v[120:123], v[84:87], v[52:55]
    ds_read_b64_tr_b16 v[118:119], v18 offset:57344
    v_mfma_f32_16x16x32_bf16 v[56:59], v[120:123], v[88:91], v[56:59]
    ds_read_b128 v[196:199], v7 offset:33792
    ds_read_b128 v[212:215], v7 offset:50176
    v_mfma_f32_16x16x32_bf16 v[56:59], v[124:127], v[104:107], v[56:59]
    ds_read_b128 v[200:203], v7 offset:36864
    buffer_load_dwordx4 v2, s[28:31], s45 offen offset:1024 sc1 lds
    s_add_u32 s45, s45, 16384
    v_mfma_f32_16x16x32_bf16 v[60:63], v[124:127], v[108:111], v[60:63]
    ds_read_b128 v[216:219], v7 offset:53248
    ds_read_b128 v[204:207], v7 offset:37888
    v_mfma_f32_16x16x32_bf16 v[60:63], v[120:123], v[92:95], v[60:63]
    ds_read_b128 v[220:223], v7 offset:54272
    s_waitcnt lgkmcnt(8)
    v_mfma_f32_16x16x32_bf16 v[32:35], v[112:115], v[192:195], v[32:35]
    ds_read_b64_tr_b16 v[120:121], v19 offset:32768
    buffer_load_dwordx4 v3, s[24:27], s46 offen offset:2048 lds
    s_waitcnt lgkmcnt(7)
    v_mfma_f32_16x16x32_bf16 v[32:35], v[116:119], v[208:211], v[32:35]
    ds_read_b64_tr_b16 v[122:123], v19 offset:40960
    s_waitcnt lgkmcnt(6)
    v_mfma_f32_16x16x32_bf16 v[36:39], v[116:119], v[212:215], v[36:39]
    ds_read_b64_tr_b16 v[124:125], v19 offset:49152
    v_mfma_f32_16x16x32_bf16 v[36:39], v[112:115], v[196:199], v[36:39]
    ds_read_b64_tr_b16 v[126:127], v19 offset:57344
    s_waitcnt lgkmcnt(7)
    v_mfma_f32_16x16x32_bf16 v[40:43], v[112:115], v[200:203], v[40:43]
    buffer_load_dwordx4 v9, s[24:27], s46 offen offset:3072 lds
    s_add_u32 s46, s46, 131072
    s_waitcnt lgkmcnt(6)
    v_mfma_f32_16x16x32_bf16 v[40:43], v[116:119], v[216:219], v[40:43]
    s_waitcnt lgkmcnt(4)
    v_mfma_f32_16x16x32_bf16 v[44:47], v[116:119], v[220:223], v[44:47]
    v_mfma_f32_16x16x32_bf16 v[44:47], v[112:115], v[204:207], v[44:47]
    s_waitcnt vmcnt(12) lgkmcnt(0)
    s_barrier
    v_mfma_f32_16x16x32_bf16 v[48:51], v[120:123], v[192:195], v[48:51]
    ds_read_b128 v[80:83], v8 offset:0
    ds_read_b128 v[96:99], v8 offset:16384
    s_add_u32 m0, s86, 98304
    v_mfma_f32_16x16x32_bf16 v[48:51], v[124:127], v[208:211], v[48:51]
    ds_read_b64_tr_b16 v[112:113], v20 offset:0
    buffer_load_dwordx4 v2, s[28:31], s45 offen sc1 lds
    v_mfma_f32_16x16x32_bf16 v[52:55], v[124:127], v[212:215], v[52:55]
    ds_read_b64_tr_b16 v[114:115], v20 offset:8192
    ds_read_b64_tr_b16 v[116:117], v20 offset:16384
    v_mfma_f32_16x16x32_bf16 v[52:55], v[120:123], v[196:199], v[52:55]
    ds_read_b64_tr_b16 v[118:119], v20 offset:24576
    v_mfma_f32_16x16x32_bf16 v[56:59], v[120:123], v[200:203], v[56:59]
    ds_read_b128 v[84:87], v8 offset:1024
    ds_read_b128 v[100:103], v8 offset:17408
    v_mfma_f32_16x16x32_bf16 v[56:59], v[124:127], v[216:219], v[56:59]
    ds_read_b128 v[88:91], v8 offset:4096
    buffer_load_dwordx4 v2, s[28:31], s45 offen offset:1024 sc1 lds
    s_add_u32 s45, s45, 16384
    v_mfma_f32_16x16x32_bf16 v[60:63], v[124:127], v[220:223], v[60:63]
    ds_read_b128 v[104:107], v8 offset:20480
    ds_read_b128 v[92:95], v8 offset:5120
    v_mfma_f32_16x16x32_bf16 v[60:63], v[120:123], v[204:207], v[60:63]
    ds_read_b128 v[108:111], v8 offset:21504
    s_waitcnt lgkmcnt(8)
    v_mfma_f32_16x16x32_bf16 v[32:35], v[112:115], v[80:83], v[32:35]
    ds_read_b64_tr_b16 v[120:121], v21 offset:0
    buffer_load_dwordx4 v3, s[24:27], s46 offen offset:2048 lds
    s_waitcnt lgkmcnt(7)
    v_mfma_f32_16x16x32_bf16 v[32:35], v[116:119], v[96:99], v[32:35]
    ds_read_b64_tr_b16 v[122:123], v21 offset:8192
    s_waitcnt lgkmcnt(6)
    v_mfma_f32_16x16x32_bf16 v[36:39], v[116:119], v[100:103], v[36:39]
    ds_read_b64_tr_b16 v[124:125], v21 offset:16384
    v_mfma_f32_16x16x32_bf16 v[36:39], v[112:115], v[84:87], v[36:39]
    ds_read_b64_tr_b16 v[126:127], v21 offset:24576
    s_waitcnt lgkmcnt(7)
    v_mfma_f32_16x16x32_bf16 v[40:43], v[112:115], v[88:91], v[40:43]
    buffer_load_dwordx4 v9, s[24:27], s46 offen offset:3072 lds
    s_add_u32 s46, s46, 131072
    s_waitcnt lgkmcnt(6)
    v_mfma_f32_16x16x32_bf16 v[40:43], v[116:119], v[104:107], v[40:43]
    s_waitcnt lgkmcnt(4)
    v_mfma_f32_16x16x32_bf16 v[44:47], v[116:119], v[108:111], v[44:47]
    v_mfma_f32_16x16x32_bf16 v[44:47], v[112:115], v[92:95], v[44:47]
    s_waitcnt vmcnt(12) lgkmcnt(0)
    s_barrier
    v_mfma_f32_16x16x32_bf16 v[48:51], v[120:123], v[80:83], v[48:51]
    ds_read_b128 v[192:195], v6 offset:0
    ds_read_b128 v[208:211], v6 offset:16384
    s_add_u32 m0, s86, 131072
    v_mfma_f32_16x16x32_bf16 v[48:51], v[124:127], v[96:99], v[48:51]
    ds_read_b64_tr_b16 v[112:113], v16 offset:0
    buffer_load_dwordx4 v2, s[28:31], s45 offen sc1 lds
    v_mfma_f32_16x16x32_bf16 v[52:55], v[124:127], v[100:103], v[52:55]
    ds_read_b64_tr_b16 v[114:115], v16 offset:8192
    ds_read_b64_tr_b16 v[116:117], v16 offset:16384
    v_mfma_f32_16x16x32_bf16 v[52:55], v[120:123], v[84:87], v[52:55]
    ds_read_b64_tr_b16 v[118:119], v16 offset:24576
    v_mfma_f32_16x16x32_bf16 v[56:59], v[120:123], v[88:91], v[56:59]
    ds_read_b128 v[196:199], v6 offset:1024
    ds_read_b128 v[212:215], v6 offset:17408
    v_mfma_f32_16x16x32_bf16 v[56:59], v[124:127], v[104:107], v[56:59]
    ds_read_b128 v[200:203], v6 offset:4096
    buffer_load_dwordx4 v2, s[28:31], s45 offen offset:1024 sc1 lds
    s_add_u32 s45, s45, 16384
    v_mfma_f32_16x16x32_bf16 v[60:63], v[124:127], v[108:111], v[60:63]
    ds_read_b128 v[216:219], v6 offset:20480
    ds_read_b128 v[204:207], v6 offset:5120
    v_mfma_f32_16x16x32_bf16 v[60:63], v[120:123], v[92:95], v[60:63]
    ds_read_b128 v[220:223], v6 offset:21504
    s_waitcnt lgkmcnt(8)
    v_mfma_f32_16x16x32_bf16 v[32:35], v[112:115], v[192:195], v[32:35]
    ds_read_b64_tr_b16 v[120:121], v17 offset:0
    buffer_load_dwordx4 v3, s[24:27], s46 offen offset:2048 lds
    s_waitcnt lgkmcnt(7)
    v_mfma_f32_16x16x32_bf16 v[32:35], v[116:119], v[208:211], v[32:35]
    ds_read_b64_tr_b16 v[122:123], v17 offset:8192
    s_waitcnt lgkmcnt(6)
    v_mfma_f32_16x16x32_bf16 v[36:39], v[116:119], v[212:215], v[36:39]
    ds_read_b64_tr_b16 v[124:125], v17 offset:16384
    v_mfma_f32_16x16x32_bf16 v[36:39], v[112:115], v[196:199], v[36:39]
    ds_read_b64_tr_b16 v[126:127], v17 offset:24576
    s_waitcnt lgkmcnt(7)
    v_mfma_f32_16x16x32_bf16 v[40:43], v[112:115], v[200:203], v[40:43]
    buffer_load_dwordx4 v9, s[24:27], s46 offen offset:3072 lds
    s_add_u32 s46, s46, 131072
    s_waitcnt lgkmcnt(6)
    v_mfma_f32_16x16x32_bf16 v[40:43], v[116:119], v[216:219], v[40:43]
    s_waitcnt lgkmcnt(4)
    v_mfma_f32_16x16x32_bf16 v[44:47], v[116:119], v[220:223], v[44:47]
    v_mfma_f32_16x16x32_bf16 v[44:47], v[112:115], v[204:207], v[44:47]
    s_waitcnt vmcnt(12) lgkmcnt(0)
    s_barrier
    v_mfma_f32_16x16x32_bf16 v[48:51], v[120:123], v[192:195], v[48:51]
    ds_read_b128 v[80:83], v6 offset:32768
    ds_read_b128 v[96:99], v6 offset:49152
    s_add_u32 m0, s86, 0
    v_mfma_f32_16x16x32_bf16 v[48:51], v[124:127], v[208:211], v[48:51]
    ds_read_b64_tr_b16 v[112:113], v16 offset:32768
    buffer_load_dwordx4 v2, s[28:31], s45 offen sc1 lds
    v_mfma_f32_16x16x32_bf16 v[52:55], v[124:127], v[212:215], v[52:55]
    ds_read_b64_tr_b16 v[114:115], v16 offset:40960
    ds_read_b64_tr_b16 v[116:117], v16 offset:49152
    v_mfma_f32_16x16x32_bf16 v[52:55], v[120:123], v[196:199], v[52:55]
    ds_read_b64_tr_b16 v[118:119], v16 offset:57344
    v_mfma_f32_16x16x32_bf16 v[56:59], v[120:123], v[200:203], v[56:59]
    ds_read_b128 v[84:87], v6 offset:33792
    ds_read_b128 v[100:103], v6 offset:50176
    v_mfma_f32_16x16x32_bf16 v[56:59], v[124:127], v[216:219], v[56:59]
    ds_read_b128 v[88:91], v6 offset:36864
    buffer_load_dwordx4 v2, s[28:31], s45 offen offset:1024 sc1 lds
    s_add_u32 s45, s45, 16384
    v_mfma_f32_16x16x32_bf16 v[60:63], v[124:127], v[220:223], v[60:63]
    ds_read_b128 v[104:107], v6 offset:53248
    ds_read_b128 v[92:95], v6 offset:37888
    v_mfma_f32_16x16x32_bf16 v[60:63], v[120:123], v[204:207], v[60:63]
    ds_read_b128 v[108:111], v6 offset:54272
    s_waitcnt lgkmcnt(8)
    v_mfma_f32_16x16x32_bf16 v[32:35], v[112:115], v[80:83], v[32:35]
    ds_read_b64_tr_b16 v[120:121], v17 offset:32768
    buffer_load_dwordx4 v3, s[24:27], s46 offen offset:2048 lds
    s_waitcnt lgkmcnt(7)
    v_mfma_f32_16x16x32_bf16 v[32:35], v[116:119], v[96:99], v[32:35]
    ds_read_b64_tr_b16 v[122:123], v17 offset:40960
    s_waitcnt lgkmcnt(6)
    v_mfma_f32_16x16x32_bf16 v[36:39], v[116:119], v[100:103], v[36:39]
    ds_read_b64_tr_b16 v[124:125], v17 offset:49152
    v_mfma_f32_16x16x32_bf16 v[36:39], v[112:115], v[84:87], v[36:39]
    ds_read_b64_tr_b16 v[126:127], v17 offset:57344
    s_waitcnt lgkmcnt(7)
    v_mfma_f32_16x16x32_bf16 v[40:43], v[112:115], v[88:91], v[40:43]
    buffer_load_dwordx4 v9, s[24:27], s46 offen offset:3072 lds
    s_add_u32 s46, s46, 131072
    s_waitcnt lgkmcnt(6)
    v_mfma_f32_16x16x32_bf16 v[40:43], v[116:119], v[104:107], v[40:43]
    s_waitcnt lgkmcnt(4)
    v_mfma_f32_16x16x32_bf16 v[44:47], v[116:119], v[108:111], v[44:47]
    v_mfma_f32_16x16x32_bf16 v[44:47], v[112:115], v[92:95], v[44:47]
    s_waitcnt vmcnt(12) lgkmcnt(0)
    s_cmp_lg_u32 s42, 0
    s_cbranch_scc1 L_sk_9018
    s_add_u32 s62, s62, 128
    v_and_b32 v14, v28, v29
    v_cmp_eq_u32 vcc, 1, v14
    s_lshr_b32 s54, s62, 7
    s_bitcmp1_b32 vcc_lo, s54
    s_cbranch_scc1 L_sk_9018
    s_mov_b32 s63, 0x40000
    s_load_dwordx2 s[8:9], s[94:95], s62 glc
L_poll_9019:
    s_waitcnt lgkmcnt(0)
    s_and_b32 s8, s8, s9
    s_cmp_eq_u32 s8, 1
    s_cbranch_scc1 L_go_9020
    s_sleep 4
    s_load_dwordx2 s[8:9], s[94:95], s62 glc
    s_sub_u32 s63, s63, 1
    s_cmp_lg_u32 s63, 0
    s_cbranch_scc1 L_poll_9019
    s_waitcnt lgkmcnt(0)
L_go_9020:
L_sk_9018:
    s_barrier
    v_mfma_f32_16x16x32_bf16 v[48:51], v[120:123], v[80:83], v[48:51]
    ds_read_b128 v[192:195], v7 offset:0
    ds_read_b128 v[208:211], v7 offset:16384
    s_add_u32 m0, s86, 32768
    v_mfma_f32_16x16x32_bf16 v[48:51], v[124:127], v[96:99], v[48:51]
    ds_read_b64_tr_b16 v[112:113], v18 offset:0
    buffer_load_dwordx4 v2, s[28:31], s45 offen sc1 lds
    v_mfma_f32_16x16x32_bf16 v[52:55], v[124:127], v[100:103], v[52:55]
    ds_read_b64_tr_b16 v[114:115], v18 offset:8192
    ds_read_b64_tr_b16 v[116:117], v18 offset:16384
    v_mfma_f32_16x16x32_bf16 v[52:55], v[120:123], v[84:87], v[52:55]
    ds_read_b64_tr_b16 v[118:119], v18 offset:24576
    v_mfma_f32_16x16x32_bf16 v[56:59], v[120:123], v[88:91], v[56:59]
    ds_read_b128 v[196:199], v7 offset:1024
    ds_read_b128 v[212:215], v7 offset:17408
    v_mfma_f32_16x16x32_bf16 v[56:59], v[124:127], v[104:107], v[56:59]
    ds_read_b128 v[200:203], v7 offset:4096
    buffer_load_dwordx4 v2, s[28:31], s45 offen offset:1024 sc1 lds
    s_add_u32 s45, s45, 16384
    v_mfma_f32_16x16x32_bf16 v[60:63], v[124:127], v[108:111], v[60:63]
    ds_read_b128 v[216:219], v7 offset:20480
    ds_read_b128 v[204:207], v7 offset:5120
    v_mfma_f32_16x16x32_bf16 v[60:63], v[120:123], v[92:95], v[60:63]
    ds_read_b128 v[220:223], v7 offset:21504
    s_waitcnt lgkmcnt(8)
    v_mfma_f32_16x16x32_bf16 v[32:35], v[112:115], v[192:195], v[32:35]
    ds_read_b64_tr_b16 v[120:121], v19 offset:0
    buffer_load_dwordx4 v3, s[24:27], s46 offen offset:2048 lds
    s_waitcnt lgkmcnt(7)
    v_mfma_f32_16x16x32_bf16 v[32:35], v[116:119], v[208:211], v[32:35]
    ds_read_b64_tr_b16 v[122:123], v19 offset:8192
    s_waitcnt lgkmcnt(6)
    v_mfma_f32_16x16x32_bf16 v[36:39], v[116:119], v[212:215], v[36:39]
    ds_read_b64_tr_b16 v[124:125], v19 offset:16384
    v_mfma_f32_16x16x32_bf16 v[36:39], v[112:115], v[196:199], v[36:39]
    ds_read_b64_tr_b16 v[126:127], v19 offset:24576
    s_waitcnt lgkmcnt(7)
    v_mfma_f32_16x16x32_bf16 v[40:43], v[112:115], v[200:203], v[40:43]
    buffer_load_dwordx4 v9, s[24:27], s46 offen offset:3072 lds
    s_add_u32 s46, s46, 131072
    s_waitcnt lgkmcnt(6)
    v_mfma_f32_16x16x32_bf16 v[40:43], v[116:119], v[216:219], v[40:43]
    s_waitcnt lgkmcnt(4)
    v_mfma_f32_16x16x32_bf16 v[44:47], v[116:119], v[220:223], v[44:47]
    v_mfma_f32_16x16x32_bf16 v[44:47], v[112:115], v[204:207], v[44:47]
    s_waitcnt vmcnt(12) lgkmcnt(0)
    s_barrier
    s_cmp_lg_u32 s42, 0
    s_cbranch_scc1 L_sk_9021
    buffer_load_dwordx4 v[28:31], v27, s[28:31], s93 offen sc1
L_sk_9021:
    v_mfma_f32_16x16x32_bf16 v[48:51], v[120:123], v[192:195], v[48:51]
    ds_read_b128 v[80:83], v7 offset:32768
    ds_read_b128 v[96:99], v7 offset:49152
    s_add_u32 m0, s86, 65536
    v_mfma_f32_16x16x32_bf16 v[48:51], v[124:127], v[208:211], v[48:51]
    ds_read_b64_tr_b16 v[112:113], v18 offset:32768
    buffer_load_dwordx4 v2, s[28:31], s45 offen sc1 lds
    v_mfma_f32_16x16x32_bf16 v[52:55], v[124:127], v[212:215], v[52:55]
    ds_read_b64_tr_b16 v[114:115], v18 offset:40960
    ds_read_b64_tr_b16 v[116:117], v18 offset:49152
    v_mfma_f32_16x16x32_bf16 v[52:55], v[120:123], v[196:199], v[52:55]
    ds_read_b64_tr_b16 v[118:119], v18 offset:57344
    v_mfma_f32_16x16x32_bf16 v[56:59], v[120:123], v[200:203], v[56:59]
    ds_read_b128 v[84:87], v7 offset:33792
    ds_read_b128 v[100:103], v7 offset:50176
    v_mfma_f32_16x16x32_bf16 v[56:59], v[124:127], v[216:219], v[56:59]
    ds_read_b128 v[88:91], v7 offset:36864
    buffer_load_dwordx4 v2, s[28:31], s45 offen offset:1024 sc1 lds
    s_add_u32 s45, s45, 16384
    v_mfma_f32_16x16x32_bf16 v[60:63], v[124:127], v[220:223], v[60:63]
    ds_read_b128 v[104:107], v7 offset:53248
    ds_read_b128 v[92:95], v7 offset:37888
    v_mfma_f32_16x16x32_bf16 v[60:63], v[120:123], v[204:207], v[60:63]
    ds_read_b128 v[108:111], v7 offset:54272
    s_waitcnt lgkmcnt(8)
    v_mfma_f32_16x16x32_bf16 v[32:35], v[112:115], v[80:83], v[32:35]
    ds_read_b64_tr_b16 v[120:121], v19 offset:32768
    buffer_load_dwordx4 v3, s[24:27], s46 offen offset:2048 lds
    s_waitcnt lgkmcnt(7)
    v_mfma_f32_16x16x32_bf16 v[32:35], v[116:119], v[96:99], v[32:35]
    ds_read_b64_tr_b16 v[122:123], v19 offset:40960
    s_waitcnt lgkmcnt(6)
    v_mfma_f32_16x16x32_bf16 v[36:39], v[116:119], v[100:103], v[36:39]
    ds_read_b64_tr_b16 v[124:125], v19 offset:49152
    v_mfma_f32_16x16x32_bf16 v[36:39], v[112:115], v[84:87], v[36:39]
    ds_read_b64_tr_b16 v[126:127], v19 offset:57344
    s_waitcnt lgkmcnt(7)
    v_mfma_f32_16x16x32_bf16 v[40:43], v[112:115], v[88:91], v[40:43]
    buffer_load_dwordx4 v9, s[24:27], s46 offen offset:3072 lds
    s_add_u32 s46, s46, 131072
    s_waitcnt lgkmcnt(6)
    v_mfma_f32_16x16x32_bf16 v[40:43], v[116:119], v[104:107], v[40:43]
    s_waitcnt lgkmcnt(4)
    v_mfma_f32_16x16x32_bf16 v[44:47], v[116:119], v[108:111], v[44:47]
    v_mfma_f32_16x16x32_bf16 v[44:47], v[112:115], v[92:95], v[44:47]
    s_waitcnt vmcnt(12) lgkmcnt(0)
    s_barrier
    v_mfma_f32_16x16x32_bf16 v[48:51], v[120:123], v[80:83], v[48:51]
    ds_read_b128 v[192:195], v8 offset:0
    ds_read_b128 v[208:211], v8 offset:16384
    s_add_u32 m0, s86, 98304
    v_mfma_f32_16x16x32_bf16 v[48:51], v[124:127], v[96:99], v[48:51]
    ds_read_b64_tr_b16 v[112:113], v20 offset:0
    buffer_load_dwordx4 v2, s[28:31], s45 offen sc1 lds
    v_mfma_f32_16x16x32_bf16 v[52:55], v[124:127], v[100:103], v[52:55]
    ds_read_b64_tr_b16 v[114:115], v20 offset:8192
    ds_read_b64_tr_b16 v[116:117], v20 offset:16384
    v_mfma_f32_16x16x32_bf16 v[52:55], v[120:123], v[84:87], v[52:55]
    ds_read_b64_tr_b16 v[118:119], v20 offset:24576
    v_mfma_f32_16x16x32_bf16 v[56:59], v[120:123], v[88:91], v[56:59]
    ds_read_b128 v[196:199], v8 offset:1024
    ds_read_b128 v[212:215], v8 offset:17408
    v_mfma_f32_16x16x32_bf16 v[56:59], v[124:127], v[104:107], v[56:59]
    ds_read_b128 v[200:203], v8 offset:4096
    buffer_load_dwordx4 v2, s[28:31], s45 offen offset:1024 sc1 lds
    s_add_u32 s45, s45, 16384
    v_mfma_f32_16x16x32_bf16 v[60:63], v[124:127], v[108:111], v[60:63]
    ds_read_b128 v[216:219], v8 offset:20480
    ds_read_b128 v[204:207], v8 offset:5120
    v_mfma_f32_16x16x32_bf16 v[60:63], v[120:123], v[92:95], v[60:63]
    ds_read_b128 v[220:223], v8 offset:21504
    s_waitcnt lgkmcnt(8)
    v_mfma_f32_16x16x32_bf16 v[32:35], v[112:115], v[192:195], v[32:35]
    ds_read_b64_tr_b16 v[120:121], v21 offset:0
    buffer_load_dwordx4 v3, s[24:27], s46 offen offset:2048 lds
    s_waitcnt lgkmcnt(7)
    v_mfma_f32_16x16x32_bf16 v[32:35], v[116:119], v[208:211], v[32:35]
    ds_read_b64_tr_b16 v[122:123], v21 offset:8192
    s_waitcnt lgkmcnt(6)
    v_mfma_f32_16x16x32_bf16 v[36:39], v[116:119], v[212:215], v[36:39]
    ds_read_b64_tr_b16 v[124:125], v21 offset:16384
    v_mfma_f32_16x16x32_bf16 v[36:39], v[112:115], v[196:199], v[36:39]
    ds_read_b64_tr_b16 v[126:127], v21 offset:24576
    s_waitcnt lgkmcnt(7)
    v_mfma_f32_16x16x32_bf16 v[40:43], v[112:115], v[200:203], v[40:43]
    buffer_load_dwordx4 v9, s[24:27], s46 offen offset:3072 lds
    s_add_u32 s46, s46, 131072
    s_waitcnt lgkmcnt(6)
    v_mfma_f32_16x16x32_bf16 v[40:43], v[116:119], v[216:219], v[40:43]
    s_waitcnt lgkmcnt(4)
    v_mfma_f32_16x16x32_bf16 v[44:47], v[116:119], v[220:223], v[44:47]
    v_mfma_f32_16x16x32_bf16 v[44:47], v[112:115], v[204:207], v[44:47]
    s_waitcnt vmcnt(12) lgkmcnt(0)
    s_barrier
    v_mfma_f32_16x16x32_bf16 v[48:51], v[120:123], v[192:195], v[48:51]
    ds_read_b128 v[80:83], v6 offset:0
    ds_read_b128 v[96:99], v6 offset:16384
    s_add_u32 m0, s86, 131072
    v_mfma_f32_16x16x32_bf16 v[48:51], v[124:127], v[208:211], v[48:51]
    ds_read_b64_tr_b16 v[112:113], v16 offset:0
    buffer_load_dwordx4 v2, s[28:31], s45 offen sc1 lds
    v_mfma_f32_16x16x32_bf16 v[52:55], v[124:127], v[212:215], v[52:55]
    ds_read_b64_tr_b16 v[114:115], v16 offset:8192
    ds_read_b64_tr_b16 v[116:117], v16 offset:16384
    v_mfma_f32_16x16x32_bf16 v[52:55], v[120:123], v[196:199], v[52:55]
    ds_read_b64_tr_b16 v[118:119], v16 offset:24576
    v_mfma_f32_16x16x32_bf16 v[56:59], v[120:123], v[200:203], v[56:59]
    ds_read_b128 v[84:87], v6 offset:1024
    ds_read_b128 v[100:103], v6 offset:17408
    v_mfma_f32_16x16x32_bf16 v[56:59], v[124:127], v[216:219], v[56:59]
    ds_read_b128 v[88:91], v6 offset:4096
    buffer_load_dwordx4 v2, s[28:31], s45 offen offset:1024 sc1 lds
    s_add_u32 s45, s45, 16384
    v_mfma_f32_16x16x32_bf16 v[60:63], v[124:127], v[220:223], v[60:63]
    ds_read_b128 v[104:107], v6 offset:20480
    ds_read_b128 v[92:95], v6 offset:5120
    v_mfma_f32_16x16x32_bf16 v[60:63], v[120:123], v[204:207], v[60:63]
    ds_read_b128 v[108:111], v6 offset:21504
    s_waitcnt lgkmcnt(8)
    v_mfma_f32_16x16x32_bf16 v[32:35], v[112:115], v[80:83], v[32:35]
    ds_read_b64_tr_b16 v[120:121], v17 offset:0
    buffer_load_dwordx4 v3, s[24:27], s46 offen offset:2048 lds
    s_waitcnt lgkmcnt(7)
    v_mfma_f32_16x16x32_bf16 v[32:35], v[116:119], v[96:99], v[32:35]
    ds_read_b64_tr_b16 v[122:123], v17 offset:8192
    s_waitcnt lgkmcnt(6)
    v_mfma_f32_16x16x32_bf16 v[36:39], v[116:119], v[100:103], v[36:39]
    ds_read_b64_tr_b16 v[124:125], v17 offset:16384
    v_mfma_f32_16x16x32_bf16 v[36:39], v[112:115], v[84:87], v[36:39]
    ds_read_b64_tr_b16 v[126:127], v17 offset:24576
    s_waitcnt lgkmcnt(7)
    v_mfma_f32_16x16x32_bf16 v[40:43], v[112:115], v[88:91], v[40:43]
    buffer_load_dwordx4 v9, s[24:27], s46 offen offset:3072 lds
    s_add_u32 s46, s46, 131072
    s_waitcnt lgkmcnt(6)
    v_mfma_f32_16x16x32_bf16 v[40:43], v[116:119], v[104:107], v[40:43]
    s_waitcnt lgkmcnt(4)
    v_mfma_f32_16x16x32_bf16 v[44:47], v[116:119], v[108:111], v[44:47]
    v_mfma_f32_16x16x32_bf16 v[44:47], v[112:115], v[92:95], v[44:47]
    s_waitcnt vmcnt(12) lgkmcnt(0)
    s_barrier
    v_mfma_f32_16x16x32_bf16 v[48:51], v[120:123], v[80:83], v[48:51]
    ds_read_b128 v[192:195], v6 offset:32768
    ds_read_b128 v[208:211], v6 offset:49152
    s_add_u32 m0, s86, 0
    v_mfma_f32_16x16x32_bf16 v[48:51], v[124:127], v[96:99], v[48:51]
    ds_read_b64_tr_b16 v[112:113], v16 offset:32768
    buffer_load_dwordx4 v2, s[28:31], s45 offen sc1 lds
    v_mfma_f32_16x16x32_bf16 v[52:55], v[124:127], v[100:103], v[52:55]
    ds_read_b64_tr_b16 v[114:115], v16 offset:40960
    ds_read_b64_tr_b16 v[116:117], v16 offset:49152
    v_mfma_f32_16x16x32_bf16 v[52:55], v[120:123], v[84:87], v[52:55]
    ds_read_b64_tr_b16 v[118:119], v16 offset:57344
    v_mfma_f32_16x16x32_bf16 v[56:59], v[120:123], v[88:91], v[56:59]
    ds_read_b128 v[196:199], v6 offset:33792
    ds_read_b128 v[212:215], v6 offset:50176
    v_mfma_f32_16x16x32_bf16 v[56:59], v[124:127], v[104:107], v[56:59]
    ds_read_b128 v[200:203], v6 offset:36864
    buffer_load_dwordx4 v2, s[28:31], s45 offen offset:1024 sc1 lds
    s_add_u32 s45, s45, 16384
    v_mfma_f32_16x16x32_bf16 v[60:63], v[124:127], v[108:111], v[60:63]
    ds_read_b128 v[216:219], v6 offset:53248
    ds_read_b128 v[204:207], v6 offset:37888
    v_mfma_f32_16x16x32_bf16 v[60:63], v[120:123], v[92:95], v[60:63]
    ds_read_b128 v[220:223], v6 offset:54272
    s_waitcnt lgkmcnt(8)
    v_mfma_f32_16x16x32_bf16 v[32:35], v[112:115], v[192:195], v[32:35]
    ds_read_b64_tr_b16 v[120:121], v17 offset:32768
    buffer_load_dwordx4 v3, s[24:27], s46 offen offset:2048 lds
    s_waitcnt lgkmcnt(7)
    v_mfma_f32_16x16x32_bf16 v[32:35], v[116:119], v[208:211], v[32:35]
    ds_read_b64_tr_b16 v[122:123], v17 offset:40960
    s_waitcnt lgkmcnt(6)
    v_mfma_f32_16x16x32_bf16 v[36:39], v[116:119], v[212:215], v[36:39]
    ds_read_b64_tr_b16 v[124:125], v17 offset:49152
    v_mfma_f32_16x16x32_bf16 v[36:39], v[112:115], v[196:199], v[36:39]
    ds_read_b64_tr_b16 v[126:127], v17 offset:57344
    s_waitcnt lgkmcnt(7)
    v_mfma_f32_16x16x32_bf16 v[40:43], v[112:115], v[200:203], v[40:43]
    buffer_load_dwordx4 v9, s[24:27], s46 offen offset:3072 lds
    s_add_u32 s46, s46, 131072
    s_waitcnt lgkmcnt(6)
    v_mfma_f32_16x16x32_bf16 v[40:43], v[116:119], v[216:219], v[40:43]
    s_waitcnt lgkmcnt(4)
    v_mfma_f32_16x16x32_bf16 v[44:47], v[116:119], v[220:223], v[44:47]
    v_mfma_f32_16x16x32_bf16 v[44:47], v[112:115], v[204:207], v[44:47]
    s_waitcnt vmcnt(12) lgkmcnt(0)
    s_barrier
    v_mfma_f32_16x16x32_bf16 v[48:51], v[120:123], v[192:195], v[48:51]
    ds_read_b128 v[80:83], v7 offset:0
    ds_read_b128 v[96:99], v7 offset:16384
    s_add_u32 m0, s86, 32768
    v_mfma_f32_16x16x32_bf16 v[48:51], v[124:127], v[208:211], v[48:51]
    ds_read_b64_tr_b16 v[112:113], v18 offset:0
    buffer_load_dwordx4 v2, s[28:31], s45 offen sc1 lds
    v_mfma_f32_16x16x32_bf16 v[52:55], v[124:127], v[212:215], v[52:55]
    ds_read_b64_tr_b16 v[114:115], v18 offset:8192
    ds_read_b64_tr_b16 v[116:117], v18 offset:16384
    v_mfma_f32_16x16x32_bf16 v[52:55], v[120:123], v[196:199], v[52:55]
    ds_read_b64_tr_b16 v[118:119], v18 offset:24576
    v_mfma_f32_16x16x32_bf16 v[56:59], v[120:123], v[200:203], v[56:59]
    ds_read_b128 v[84:87], v7 offset:1024
    ds_read_b128 v[100:103], v7 offset:17408
    v_mfma_f32_16x16x32_bf16 v[56:59], v[124:127], v[216:219], v[56:59]
    ds_read_b128 v[88:91], v7 offset:4096
    buffer_load_dwordx4 v2, s[28:31], s45 offen offset:1024 sc1 lds
    s_add_u32 s45, s45, 16384
    v_mfma_f32_16x16x32_bf16 v[60:63], v[124:127], v[220:223], v[60:63]
    ds_read_b128 v[104:107], v7 offset:20480
    ds_read_b128 v[92:95], v7 offset:5120
    v_mfma_f32_16x16x32_bf16 v[60:63], v[120:123], v[204:207], v[60:63]
    ds_read_b128 v[108:111], v7 offset:21504
    s_waitcnt lgkmcnt(8)
    v_mfma_f32_16x16x32_bf16 v[32:35], v[112:115], v[80:83], v[32:35]
    ds_read_b64_tr_b16 v[120:121], v19 offset:0
    buffer_load_dwordx4 v3, s[24:27], s46 offen offset:2048 lds
    s_waitcnt lgkmcnt(7)
    v_mfma_f32_16x16x32_bf16 v[32:35], v[116:119], v[96:99], v[32:35]
    ds_read_b64_tr_b16 v[122:123], v19 offset:8192
    s_waitcnt lgkmcnt(6)
    v_mfma_f32_16x16x32_bf16 v[36:39], v[116:119], v[100:103], v[36:39]
    ds_read_b64_tr_b16 v[124:125], v19 offset:16384
    v_mfma_f32_16x16x32_bf16 v[36:39], v[112:115], v[84:87], v[36:39]
    ds_read_b64_tr_b16 v[126:127], v19 offset:24576
    s_waitcnt lgkmcnt(7)
    v_mfma_f32_16x16x32_bf16 v[40:43], v[112:115], v[88:91], v[40:43]
    buffer_load_dwordx4 v9, s[24:27], s46 offen offset:3072 lds
    s_add_u32 s46, s46, 131072
    s_waitcnt lgkmcnt(6)
    v_mfma_f32_16x16x32_bf16 v[40:43], v[116:119], v[104:107], v[40:43]
    s_waitcnt lgkmcnt(4)
    v_mfma_f32_16x16x32_bf16 v[44:47], v[116:119], v[108:111], v[44:47]
    v_mfma_f32_16x16x32_bf16 v[44:47], v[112:115], v[92:95], v[44:47]
    s_waitcnt vmcnt(12) lgkmcnt(0)
    s_barrier
    v_mfma_f32_16x16x32_bf16 v[48:51], v[120:123], v[80:83], v[48:51]
    ds_read_b128 v[192:195], v7 offset:32768
    ds_read_b128 v[208:211], v7 offset:49152
    s_add_u32 m0, s86, 65536
    v_mfma_f32_16x16x32_bf16 v[48:51], v[124:127], v[96:99], v[48:51]
    ds_read_b64_tr_b16 v[112:113], v18 offset:32768
    buffer_load_dwordx4 v2, s[28:31], s45 offen sc1 lds
    v_mfma_f32_16x16x32_bf16 v[52:55], v[124:127], v[100:103], v[52:55]
    ds_read_b64_tr_b16 v[114:115], v18 offset:40960
    ds_read_b64_tr_b16 v[116:117], v18 offset:49152
    v_mfma_f32_16x16x32_bf16 v[52:55], v[120:123], v[84:87], v[52:55]
    ds_read_b64_tr_b16 v[118:119], v18 offset:57344
    v_mfma_f32_16x16x32_bf16 v[56:59], v[120:123], v[88:91], v[56:59]
    ds_read_b128 v[196:199], v7 offset:33792
    ds_read_b128 v[212:215], v7 offset:50176
    v_mfma_f32_16x16x32_bf16 v[56:59], v[124:127], v[104:107], v[56:59]
    ds_read_b128 v[200:203], v7 offset:36864
    buffer_load_dwordx4 v2, s[28:31], s45 offen offset:1024 sc1 lds
    s_lshl_b32 s45, s80, 18
    s_add_u32 s45, s45, 14680064
    v_mfma_f32_16x16x32_bf16 v[60:63], v[124:127], v[108:111], v[60:63]
    ds_read_b128 v[216:219], v7 offset:53248
    ds_read_b128 v[204:207], v7 offset:37888
    v_mfma_f32_16x16x32_bf16 v[60:63], v[120:123], v[92:95], v[60:63]
    ds_read_b128 v[220:223], v7 offset:54272
    s_waitcnt lgkmcnt(8)
    v_mfma_f32_16x16x32_bf16 v[32:35], v[112:115], v[192:195], v[32:35]
    ds_read_b64_tr_b16 v[120:121], v19 offset:32768
    buffer_load_dwordx4 v3, s[24:27], s46 offen offset:2048 lds
    s_waitcnt lgkmcnt(7)
    v_mfma_f32_16x16x32_bf16 v[32:35], v[116:119], v[208:211], v[32:35]
    ds_read_b64_tr_b16 v[122:123], v19 offset:40960
    s_waitcnt lgkmcnt(6)
    v_mfma_f32_16x16x32_bf16 v[36:39], v[116:119], v[212:215], v[36:39]
    ds_read_b64_tr_b16 v[124:125], v19 offset:49152
    v_mfma_f32_16x16x32_bf16 v[36:39], v[112:115], v[196:199], v[36:39]
    ds_read_b64_tr_b16 v[126:127], v19 offset:57344
    s_waitcnt lgkmcnt(7)
    v_mfma_f32_16x16x32_bf16 v[40:43], v[112:115], v[200:203], v[40:43]
    buffer_load_dwordx4 v9, s[24:27], s46 offen offset:3072 lds
    s_mov_b32 s46, 0
    s_waitcnt lgkmcnt(6)
    v_mfma_f32_16x16x32_bf16 v[40:43], v[116:119], v[216:219], v[40:43]
    s_waitcnt lgkmcnt(4)
    v_mfma_f32_16x16x32_bf16 v[44:47], v[116:119], v[220:223], v[44:47]
    v_mfma_f32_16x16x32_bf16 v[44:47], v[112:115], v[204:207], v[44:47]
    s_waitcnt vmcnt(12) lgkmcnt(0)
    s_cmp_lg_u32 s42, 0
    s_cbranch_scc1 L_sk_9022
    v_and_b32 v14, v28, v29
    v_and_b32 v12, v30, v31
    v_and_b32 v14, v14, v12
    v_cmp_eq_u32 vcc, 1, v14
    s_and_b32 s54, vcc_lo, 0xf00
    s_cmp_eq_u32 s54, 0xf00
    s_cbranch_scc1 L_sk_9022
    s_mov_b32 s63, 0x40000
    s_load_dwordx4 s[4:7], s[94:95], 1024 glc
    s_load_dwordx4 s[8:11], s[94:95], 1152 glc
    s_load_dwordx4 s[12:15], s[94:95], 1280 glc
    s_load_dwordx4 s[16:19], s[94:95], 1408 glc
L_poll_9023:
    s_waitcnt lgkmcnt(0)
    s_and_b64 s[4:5], s[4:5], s[12:13]
    s_and_b64 s[6:7], s[6:7], s[14:15]
    s_and_b64 s[8:9], s[8:9], s[16:17]
    s_and_b64 s[10:11], s[10:11], s[18:19]
    s_and_b64 s[4:5], s[4:5], s[8:9]
    s_and_b64 s[6:7], s[6:7], s[10:11]
    s_and_b64 s[4:5], s[4:5], s[6:7]
    s_and_b32 s4, s4, s5
    s_cmp_eq_u32 s4, 1
    s_cbranch_scc1 L_go_9024
    s_sleep 4
    s_load_dwordx4 s[4:7], s[94:95], 1024 glc
    s_load_dwordx4 s[8:11], s[94:95], 1152 glc
    s_load_dwordx4 s[12:15], s[94:95], 1280 glc
    s_load_dwordx4 s[16:19], s[94:95], 1408 glc
    s_sub_u32 s63, s63, 1
    s_cmp_lg_u32 s63, 0
    s_cbranch_scc1 L_poll_9023
    s_waitcnt lgkmcnt(0)
L_go_9024:
L_sk_9022:
    s_barrier
    v_mfma_f32_16x16x32_bf16 v[48:51], v[120:123], v[192:195], v[48:51]
    ds_read_b128 v[80:83], v8 offset:0
    ds_read_b128 v[96:99], v8 offset:16384
    s_add_u32 m0, s86, 98304
    v_mfma_f32_16x16x32_bf16 v[48:51], v[124:127], v[208:211], v[48:51]
    ds_read_b64_tr_b16 v[112:113], v20 offset:0
    buffer_load_dwordx4 v5, s[28:31], s45 offen sc1 lds
    s_add_u32 s45, s45, 16384
    v_mfma_f32_16x16x32_bf16 v[52:55], v[124:127], v[212:215], v[52:55]
    ds_read_b64_tr_b16 v[114:115], v20 offset:8192
    ds_read_b64_tr_b16 v[116:117], v20 offset:16384
    v_mfma_f32_16x16x32_bf16 v[52:55], v[120:123], v[196:199], v[52:55]
    ds_read_b64_tr_b16 v[118:119], v20 offset:24576
    v_mfma_f32_16x16x32_bf16 v[56:59], v[120:123], v[200:203], v[56:59]
    ds_read_b128 v[84:87], v8 offset:1024
    ds_read_b128 v[100:103], v8 offset:17408
    v_mfma_f32_16x16x32_bf16 v[56:59], v[124:127], v[216:219], v[56:59]
    ds_read_b128 v[88:91], v8 offset:4096
    v_mfma_f32_16x16x32_bf16 v[60:63], v[124:127], v[220:223], v[60:63]
    ds_read_b128 v[104:107], v8 offset:20480
    ds_read_b128 v[92:95], v8 offset:5120
    v_mfma_f32_16x16x32_bf16 v[60:63], v[120:123], v[204:207], v[60:63]
    ds_read_b128 v[108:111], v8 offset:21504
    s_waitcnt lgkmcnt(8)
    v_mfma_f32_16x16x32_bf16 v[32:35], v[112:115], v[80:83], v[32:35]
    ds_read_b64_tr_b16 v[120:121], v21 offset:0
    buffer_load_dwordx4 v3, s[36:39], s46 offen offset:2048 lds
    s_waitcnt lgkmcnt(7)
    v_mfma_f32_16x16x32_bf16 v[32:35], v[116:119], v[96:99], v[32:35]
    ds_read_b64_tr_b16 v[122:123], v21 offset:8192
    s_waitcnt lgkmcnt(6)
    v_mfma_f32_16x16x32_bf16 v[36:39], v[116:119], v[100:103], v[36:39]
    ds_read_b64_tr_b16 v[124:125], v21 offset:16384
    v_mfma_f32_16x16x32_bf16 v[36:39], v[112:115], v[84:87], v[36:39]
    ds_read_b64_tr_b16 v[126:127], v21 offset:24576
    s_waitcnt lgkmcnt(7)
    v_mfma_f32_16x16x32_bf16 v[40:43], v[112:115], v[88:91], v[40:43]
    buffer_load_dwordx4 v9, s[36:39], s46 offen offset:3072 lds
    s_add_u32 s46, s46, 131072
    s_waitcnt lgkmcnt(6)
    v_mfma_f32_16x16x32_bf16 v[40:43], v[116:119], v[104:107], v[40:43]
    s_waitcnt lgkmcnt(4)
    v_mfma_f32_16x16x32_bf16 v[44:47], v[116:119], v[108:111], v[44:47]
    v_mfma_f32_16x16x32_bf16 v[44:47], v[112:115], v[92:95], v[44:47]
    s_waitcnt vmcnt(11) lgkmcnt(0)
    s_barrier
    v_mfma_f32_16x16x32_bf16 v[48:51], v[120:123], v[80:83], v[48:51]
    ds_read_b128 v[192:195], v6 offset:0
    ds_read_b128 v[208:211], v6 offset:16384
    s_add_u32 m0, s86, 131072
    v_mfma_f32_16x16x32_bf16 v[48:51], v[124:127], v[96:99], v[48:51]
    ds_read_b64_tr_b16 v[112:113], v16 offset:0
    buffer_load_dwordx4 v5, s[28:31], s45 offen sc1 lds
    s_add_u32 s45, s45, 16384
    v_mfma_f32_16x16x32_bf16 v[52:55], v[124:127], v[100:103], v[52:55]
    ds_read_b64_tr_b16 v[114:115], v16 offset:8192
    ds_read_b64_tr_b16 v[116:117], v16 offset:16384
    v_mfma_f32_16x16x32_bf16 v[52:55], v[120:123], v[84:87], v[52:55]
    ds_read_b64_tr_b16 v[118:119], v16 offset:24576
    v_mfma_f32_16x16x32_bf16 v[56:59], v[120:123], v[88:91], v[56:59]
    ds_read_b128 v[196:199], v6 offset:1024
    ds_read_b128 v[212:215], v6 offset:17408
    v_mfma_f32_16x16x32_bf16 v[56:59], v[124:127], v[104:107], v[56:59]
    ds_read_b128 v[200:203], v6 offset:4096
    v_mfma_f32_16x16x32_bf16 v[60:63], v[124:127], v[108:111], v[60:63]
    ds_read_b128 v[216:219], v6 offset:20480
    ds_read_b128 v[204:207], v6 offset:5120
    v_mfma_f32_16x16x32_bf16 v[60:63], v[120:123], v[92:95], v[60:63]
    ds_read_b128 v[220:223], v6 offset:21504
    s_waitcnt lgkmcnt(8)
    v_mfma_f32_16x16x32_bf16 v[32:35], v[112:115], v[192:195], v[32:35]
    ds_read_b64_tr_b16 v[120:121], v17 offset:0
    buffer_load_dwordx4 v3, s[36:39], s46 offen offset:2048 lds
    s_waitcnt lgkmcnt(7)
    v_mfma_f32_16x16x32_bf16 v[32:35], v[116:119], v[208:211], v[32:35]
    ds_read_b64_tr_b16 v[122:123], v17 offset:8192
    s_waitcnt lgkmcnt(6)
    v_mfma_f32_16x16x32_bf16 v[36:39], v[116:119], v[212:215], v[36:39]
    ds_read_b64_tr_b16 v[124:125], v17 offset:16384
    v_mfma_f32_16x16x32_bf16 v[36:39], v[112:115], v[196:199], v[36:39]
    ds_read_b64_tr_b16 v[126:127], v17 offset:24576
    s_waitcnt lgkmcnt(7)
    v_mfma_f32_16x16x32_bf16 v[40:43], v[112:115], v[200:203], v[40:43]
    buffer_load_dwordx4 v9, s[36:39], s46 offen offset:3072 lds
    s_add_u32 s46, s46, 131072
    s_waitcnt lgkmcnt(6)
    v_mfma_f32_16x16x32_bf16 v[40:43], v[116:119], v[216:219], v[40:43]
    s_waitcnt lgkmcnt(4)
    v_mfma_f32_16x16x32_bf16 v[44:47], v[116:119], v[220:223], v[44:47]
    v_mfma_f32_16x16x32_bf16 v[44:47], v[112:115], v[204:207], v[44:47]
    s_waitcnt vmcnt(10) lgkmcnt(0)
    s_barrier
    v_mfma_f32_16x16x32_bf16 v[48:51], v[120:123], v[192:195], v[48:51]
    ds_read_b128 v[80:83], v6 offset:32768
    ds_read_b128 v[96:99], v6 offset:49152
    s_add_u32 m0, s86, 0
    v_mfma_f32_16x16x32_bf16 v[48:51], v[124:127], v[208:211], v[48:51]
    ds_read_b64_tr_b16 v[112:113], v16 offset:32768
    buffer_load_dwordx4 v5, s[28:31], s45 offen sc1 lds
    s_add_u32 s45, s45, 16384
    v_mfma_f32_16x16x32_bf16 v[52:55], v[124:127], v[212:215], v[52:55]
    ds_read_b64_tr_b16 v[114:115], v16 offset:40960
    ds_read_b64_tr_b16 v[116:117], v16 offset:49152
    v_mfma_f32_16x16x32_bf16 v[52:55], v[120:123], v[196:199], v[52:55]
    ds_read_b64_tr_b16 v[118:119], v16 offset:57344
    v_mfma_f32_16x16x32_bf16 v[56:59], v[120:123], v[200:203], v[56:59]
    ds_read_b128 v[84:87], v6 offset:33792
    ds_read_b128 v[100:103], v6 offset:50176
    v_mfma_f32_16x16x32_bf16 v[56:59], v[124:127], v[216:219], v[56:59]
    ds_read_b128 v[88:91], v6 offset:36864
    v_mfma_f32_16x16x32_bf16 v[60:63], v[124:127], v[220:223], v[60:63]
    ds_read_b128 v[104:107], v6 offset:53248
    ds_read_b128 v[92:95], v6 offset:37888
    v_mfma_f32_16x16x32_bf16 v[60:63], v[120:123], v[204:207], v[60:63]
    ds_read_b128 v[108:111], v6 offset:54272
    s_waitcnt lgkmcnt(8)
    v_mfma_f32_16x16x32_bf16 v[32:35], v[112:115], v[80:83], v[32:35]
    ds_read_b64_tr_b16 v[120:121], v17 offset:32768
    buffer_load_dwordx4 v3, s[36:39], s46 offen offset:2048 lds
    s_waitcnt lgkmcnt(7)
    v_mfma_f32_16x16x32_bf16 v[32:35], v[116:119], v[96:99], v[32:35]
    ds_read_b64_tr_b16 v[122:123], v17 offset:40960
    s_waitcnt lgkmcnt(6)
    v_mfma_f32_16x16x32_bf16 v[36:39], v[116:119], v[100:103], v[36:39]
    ds_read_b64_tr_b16 v[124:125], v17 offset:49152
    v_mfma_f32_16x16x32_bf16 v[36:39], v[112:115], v[84:87], v[36:39]
    ds_read_b64_tr_b16 v[126:127], v17 offset:57344
    s_waitcnt lgkmcnt(7)
    v_mfma_f32_16x16x32_bf16 v[40:43], v[112:115], v[88:91], v[40:43]
    buffer_load_dwordx4 v9, s[36:39], s46 offen offset:3072 lds
    s_add_u32 s46, s46, 131072
    s_waitcnt lgkmcnt(6)
    v_mfma_f32_16x16x32_bf16 v[40:43], v[116:119], v[104:107], v[40:43]
    s_waitcnt lgkmcnt(4)
    v_mfma_f32_16x16x32_bf16 v[44:47], v[116:119], v[108:111], v[44:47]
    v_mfma_f32_16x16x32_bf16 v[44:47], v[112:115], v[92:95], v[44:47]
    s_waitcnt vmcnt(9) lgkmcnt(0)
    s_barrier
    v_mfma_f32_16x16x32_bf16 v[48:51], v[120:123], v[80:83], v[48:51]
    ds_read_b128 v[192:195], v7 offset:0
    ds_read_b128 v[208:211], v7 offset:16384
    s_add_u32 m0, s86, 32768
    v_mfma_f32_16x16x32_bf16 v[48:51], v[124:127], v[96:99], v[48:51]
    ds_read_b64_tr_b16 v[112:113], v18 offset:0
    buffer_load_dwordx4 v5, s[28:31], s45 offen sc1 lds
    s_add_u32 s45, s45, 16384
    v_mfma_f32_16x16x32_bf16 v[52:55], v[124:127], v[100:103], v[52:55]
    ds_read_b64_tr_b16 v[114:115], v18 offset:8192
    ds_read_b64_tr_b16 v[116:117], v18 offset:16384
    v_mfma_f32_16x16x32_bf16 v[52:55], v[120:123], v[84:87], v[52:55]
    ds_read_b64_tr_b16 v[118:119], v18 offset:24576
    v_mfma_f32_16x16x32_bf16 v[56:59], v[120:123], v[88:91], v[56:59]
    ds_read_b128 v[196:199], v7 offset:1024
    ds_read_b128 v[212:215], v7 offset:17408
    v_mfma_f32_16x16x32_bf16 v[56:59], v[124:127], v[104:107], v[56:59]
    ds_read_b128 v[200:203], v7 offset:4096
    v_mfma_f32_16x16x32_bf16 v[60:63], v[124:127], v[108:111], v[60:63]
    ds_read_b128 v[216:219], v7 offset:20480
    ds_read_b128 v[204:207], v7 offset:5120
    v_mfma_f32_16x16x32_bf16 v[60:63], v[120:123], v[92:95], v[60:63]
    ds_read_b128 v[220:223], v7 offset:21504
    s_waitcnt lgkmcnt(8)
    v_mfma_f32_16x16x32_bf16 v[32:35], v[112:115], v[192:195], v[32:35]
    ds_read_b64_tr_b16 v[120:121], v19 offset:0
    buffer_load_dwordx4 v3, s[36:39], s46 offen offset:2048 lds
    s_waitcnt lgkmcnt(7)
    v_mfma_f32_16x16x32_bf16 v[32:35], v[116:119], v[208:211], v[32:35]
    ds_read_b64_tr_b16 v[122:123], v19 offset:8192
    s_waitcnt lgkmcnt(6)
    v_mfma_f32_16x16x32_bf16 v[36:39], v[116:119], v[212:215], v[36:39]
    ds_read_b64_tr_b16 v[124:125], v19 offset:16384
    v_mfma_f32_16x16x32_bf16 v[36:39], v[112:115], v[196:199], v[36:39]
    ds_read_b64_tr_b16 v[126:127], v19 offset:24576
    s_waitcnt lgkmcnt(7)
    v_mfma_f32_16x16x32_bf16 v[40:43], v[112:115], v[200:203], v[40:43]
    buffer_load_dwordx4 v9, s[36:39], s46 offen offset:3072 lds
    s_add_u32 s46, s46, 131072
    s_waitcnt lgkmcnt(6)
    v_mfma_f32_16x16x32_bf16 v[40:43], v[116:119], v[216:219], v[40:43]
    s_waitcnt lgkmcnt(4)
    v_mfma_f32_16x16x32_bf16 v[44:47], v[116:119], v[220:223], v[44:47]
    v_mfma_f32_16x16x32_bf16 v[44:47], v[112:115], v[204:207], v[44:47]
    s_waitcnt vmcnt(9) lgkmcnt(0)
    s_barrier
    v_mfma_f32_16x16x32_bf16 v[48:51], v[120:123], v[192:195], v[48:51]
    ds_read_b128 v[80:83], v7 offset:32768
    s_add_u32 m0, s86, 65536
    v_mfma_f32_16x16x32_bf16 v[48:51], v[124:127], v[208:211], v[48:51]
    ds_read_b128 v[96:99], v7 offset:49152
    buffer_load_dwordx4 v5, s[28:31], s45 offen sc1 lds
    s_add_u32 s45, s45, 16384
    v_mfma_f32_16x16x32_bf16 v[52:55], v[124:127], v[212:215], v[52:55]
    ds_read_b64_tr_b16 v[112:113], v18 offset:32768
    v_mfma_f32_16x16x32_bf16 v[52:55], v[120:123], v[196:199], v[52:55]
    ds_read_b64_tr_b16 v[114:115], v18 offset:40960
    v_mfma_f32_16x16x32_bf16 v[56:59], v[120:123], v[200:203], v[56:59]
    ds_read_b64_tr_b16 v[116:117], v18 offset:49152
    v_mfma_f32_16x16x32_bf16 v[56:59], v[124:127], v[216:219], v[56:59]
    ds_read_b64_tr_b16 v[118:119], v18 offset:57344
    v_mfma_f32_16x16x32_bf16 v[60:63], v[124:127], v[220:223], v[60:63]
    ds_read_b128 v[84:87], v7 offset:36864
    v_mfma_f32_16x16x32_bf16 v[60:63], v[120:123], v[204:207], v[60:63]
    ds_read_b128 v[100:103], v7 offset:53248
    s_waitcnt lgkmcnt(4)
    v_mfma_f32_16x16x32_bf16 v[64:67], v[112:115], v[80:83], 0
    ds_read_b64_tr_b16 v[120:121], v19 offset:32768
    ds_read_b64_tr_b16 v[122:123], v19 offset:40960
    s_waitcnt lgkmcnt(4)
    v_mfma_f32_16x16x32_bf16 v[64:67], v[116:119], v[96:99], v[64:67]
    ds_read_b64_tr_b16 v[124:125], v19 offset:49152
    ds_read_b64_tr_b16 v[126:127], v19 offset:57344
    buffer_load_dwordx4 v3, s[36:39], s46 offen offset:2048 lds
    s_waitcnt lgkmcnt(4)
    v_mfma_f32_16x16x32_bf16 v[68:71], v[116:119], v[100:103], 0
    v_mfma_f32_16x16x32_bf16 v[68:71], v[112:115], v[84:87], v[68:71]
    buffer_load_dwordx4 v9, s[36:39], s46 offen offset:3072 lds
    s_add_u32 s46, s46, 131072
    s_cmp_eq_u32 s82, 0
    s_cbranch_scc1 L_snd_9025
    v_swap_b32 v32, v40
    v_swap_b32 v33, v41
    v_swap_b32 v34, v42
    v_swap_b32 v35, v43
    v_swap_b32 v36, v44
    v_swap_b32 v37, v45
    v_swap_b32 v38, v46
    v_swap_b32 v39, v47
    v_swap_b32 v48, v56
    v_swap_b32 v49, v57
    v_swap_b32 v50, v58
    v_swap_b32 v51, v59
    v_swap_b32 v52, v60
    v_swap_b32 v53, v61
    v_swap_b32 v54, v62
    v_swap_b32 v55, v63
L_snd_9025:
    v_cvt_pk_bf16_f32 v144, v40, v41
    v_cvt_pk_bf16_f32 v145, v42, v43
    v_cvt_pk_bf16_f32 v146, v56, v57
    v_cvt_pk_bf16_f32 v147, v58, v59
    buffer_store_dwordx4 v[144:147], v4, s[28:31], s90 offen offset:0 sc1
    v_cvt_pk_bf16_f32 v148, v44, v45
    v_cvt_pk_bf16_f32 v149, v46, v47
    v_cvt_pk_bf16_f32 v150, v60, v61
    v_cvt_pk_bf16_f32 v151, v62, v63
    buffer_store_dwordx4 v[148:151], v4, s[28:31], s90 offen offset:1024 sc1
    s_waitcnt vmcnt(11) lgkmcnt(0)
    s_barrier
    v_mfma_f32_16x16x32_bf16 v[72:75], v[120:123], v[80:83], 0
    ds_read_b128 v[192:195], v8 offset:0
    ds_read_b128 v[208:211], v8 offset:16384
    s_add_u32 m0, s86, 98304
    s_nop 0
    buffer_load_dwordx4 v5, s[28:31], s45 offen sc1 lds
    s_add_u32 s45, s45, 16384
    v_mfma_f32_16x16x32_bf16 v[72:75], v[124:127], v[96:99], v[72:75]
    ds_read_b64_tr_b16 v[112:113], v20 offset:0
    ds_read_b64_tr_b16 v[114:115], v20 offset:8192
    v_mfma_f32_16x16x32_bf16 v[76:79], v[124:127], v[100:103], 0
    ds_read_b64_tr_b16 v[116:117], v20 offset:16384
    ds_read_b64_tr_b16 v[118:119], v20 offset:24576
    v_mfma_f32_16x16x32_bf16 v[76:79], v[120:123], v[84:87], v[76:79]
    ds_read_b128 v[196:199], v8 offset:4096
    ds_read_b128 v[212:215], v8 offset:20480
    s_waitcnt lgkmcnt(4)
    v_mfma_f32_16x16x32_bf16 v[64:67], v[112:115], v[192:195], v[64:67]
    ds_read_b64_tr_b16 v[120:121], v21 offset:0
    ds_read_b64_tr_b16 v[122:123], v21 offset:8192
    s_waitcnt lgkmcnt(4)
    v_mfma_f32_16x16x32_bf16 v[64:67], v[116:119], v[208:211], v[64:67]
    ds_read_b64_tr_b16 v[124:125], v21 offset:16384
    ds_read_b64_tr_b16 v[126:127], v21 offset:24576
    buffer_load_dwordx4 v3, s[36:39], s46 offen offset:2048 lds
    s_waitcnt lgkmcnt(4)
    v_mfma_f32_16x16x32_bf16 v[68:71], v[116:119], v[212:215], v[68:71]
    v_mfma_f32_16x16x32_bf16 v[68:71], v[112:115], v[196:199], v[68:71]
    buffer_load_dwordx4 v9, s[36:39], s46 offen offset:3072 lds
    s_add_u32 s46, s46, 131072
    s_waitcnt vmcnt(11) lgkmcnt(0)
    s_barrier
    v_mfma_f32_16x16x32_bf16 v[72:75], v[120:123], v[192:195], v[72:75]
    ds_read_b128 v[80:83], v6 offset:0
    ds_read_b128 v[96:99], v6 offset:16384
    s_add_u32 m0, s86, 131072
    s_nop 0
    buffer_load_dwordx4 v5, s[28:31], s45 offen sc1 lds
    s_add_u32 s45, s45, 16384
    v_mfma_f32_16x16x32_bf16 v[72:75], v[124:127], v[208:211], v[72:75]
    ds_read_b64_tr_b16 v[112:113], v16 offset:0
    ds_read_b64_tr_b16 v[114:115], v16 offset:8192
    v_mfma_f32_16x16x32_bf16 v[76:79], v[124:127], v[212:215], v[76:79]
    ds_read_b64_tr_b16 v[116:117], v16 offset:16384
    ds_read_b64_tr_b16 v[118:119], v16 offset:24576
    v_mfma_f32_16x16x32_bf16 v[76:79], v[120:123], v[196:199], v[76:79]
    ds_read_b128 v[84:87], v6 offset:4096
    ds_read_b128 v[100:103], v6 offset:20480
    s_waitcnt lgkmcnt(4)
    v_mfma_f32_16x16x32_bf16 v[64:67], v[112:115], v[80:83], v[64:67]
    ds_read_b64_tr_b16 v[120:121], v17 offset:0
    ds_read_b64_tr_b16 v[122:123], v17 offset:8192
    s_waitcnt lgkmcnt(4)
    v_mfma_f32_16x16x32_bf16 v[64:67], v[116:119], v[96:99], v[64:67]
    ds_read_b64_tr_b16 v[124:125], v17 offset:16384
    ds_read_b64_tr_b16 v[126:127], v17 offset:24576
    buffer_load_dwordx4 v3, s[36:39], s46 offen offset:2048 lds
    s_waitcnt lgkmcnt(4)
    v_mfma_f32_16x16x32_bf16 v[68:71], v[116:119], v[100:103], v[68:71]
    v_mfma_f32_16x16x32_bf16 v[68:71], v[112:115], v[84:87], v[68:71]
    buffer_load_dwordx4 v9, s[36:39], s46 offen offset:3072 lds
    s_add_u32 s46, s46, 131072
    s_waitcnt vmcnt(11) lgkmcnt(0)
    s_barrier
    v_mfma_f32_16x16x32_bf16 v[72:75], v[120:123], v[80:83], v[72:75]
    ds_read_b128 v[192:195], v6 offset:32768
    ds_read_b128 v[208:211], v6 offset:49152
    s_add_u32 m0, s86, 0
    s_nop 0
    buffer_load_dwordx4 v5, s[28:31], s45 offen sc1 lds
    s_add_u32 s45, s45, 16384
    v_mfma_f32_16x16x32_bf16 v[72:75], v[124:127], v[96:99], v[72:75]
    ds_read_b64_tr_b16 v[112:113], v16 offset:32768
    ds_read_b64_tr_b16 v[114:115], v16 offset:40960
    v_mfma_f32_16x16x32_bf16 v[76:79], v[124:127], v[100:103], v[76:79]
    ds_read_b64_tr_b16 v[116:117], v16 offset:49152
    ds_read_b64_tr_b16 v[118:119], v16 offset:57344
    v_mfma_f32_16x16x32_bf16 v[76:79], v[120:123], v[84:87], v[76:79]
    ds_read_b128 v[196:199], v6 offset:36864
    ds_read_b128 v[212:215], v6 offset:53248
    s_waitcnt lgkmcnt(4)
    v_mfma_f32_16x16x32_bf16 v[64:67], v[112:115], v[192:195], v[64:67]
    ds_read_b64_tr_b16 v[120:121], v17 offset:32768
    ds_read_b64_tr_b16 v[122:123], v17 offset:40960
    s_waitcnt lgkmcnt(4)
    v_mfma_f32_16x16x32_bf16 v[64:67], v[116:119], v[208:211], v[64:67]
    ds_read_b64_tr_b16 v[124:125], v17 offset:49152
    ds_read_b64_tr_b16 v[126:127], v17 offset:57344
    buffer_load_dwordx4 v3, s[36:39], s46 offen offset:2048 lds
    s_waitcnt lgkmcnt(4)
    v_mfma_f32_16x16x32_bf16 v[68:71], v[116:119], v[212:215], v[68:71]
    v_mfma_f32_16x16x32_bf16 v[68:71], v[112:115], v[196:199], v[68:71]
    buffer_load_dwordx4 v9, s[36:39], s46 offen offset:3072 lds
    s_add_u32 s46, s46, 131072
    s_waitcnt vmcnt(11) lgkmcnt(0)
    s_barrier
    v_mfma_f32_16x16x32_bf16 v[72:75], v[120:123], v[192:195], v[72:75]
    ds_read_b128 v[80:83], v7 offset:0
    ds_read_b128 v[96:99], v7 offset:16384
    s_add_u32 m0, s86, 32768
    s_nop 0
    buffer_load_dwordx4 v5, s[28:31], s45 offen sc1 lds
    s_add_u32 s45, s45, 16384
    v_mfma_f32_16x16x32_bf16 v[72:75], v[124:127], v[208:211], v[72:75]
    ds_read_b64_tr_b16 v[112:113], v18 offset:0
    ds_read_b64_tr_b16 v[114:115], v18 offset:8192
    v_mfma_f32_16x16x32_bf16 v[76:79], v[124:127], v[212:215], v[76:79]
    ds_read_b64_tr_b16 v[116:117], v18 offset:16384
    ds_read_b64_tr_b16 v[118:119], v18 offset:24576
    v_mfma_f32_16x16x32_bf16 v[76:79], v[120:123], v[196:199], v[76:79]
    ds_read_b128 v[84:87], v7 offset:4096
    ds_read_b128 v[100:103], v7 offset:20480
    s_waitcnt lgkmcnt(4)
    v_mfma_f32_16x16x32_bf16 v[64:67], v[112:115], v[80:83], v[64:67]
    ds_read_b64_tr_b16 v[120:121], v19 offset:0
    ds_read_b64_tr_b16 v[122:123], v19 offset:8192
    s_waitcnt lgkmcnt(4)
    v_mfma_f32_16x16x32_bf16 v[64:67], v[116:119], v[96:99], v[64:67]
    ds_read_b64_tr_b16 v[124:125], v19 offset:16384
    ds_read_b64_tr_b16 v[126:127], v19 offset:24576
    buffer_load_dwordx4 v3, s[36:39], s46 offen offset:2048 lds
    s_waitcnt lgkmcnt(4)
    v_mfma_f32_16x16x32_bf16 v[68:71], v[116:119], v[100:103], v[68:71]
    v_mfma_f32_16x16x32_bf16 v[68:71], v[112:115], v[84:87], v[68:71]
    buffer_load_dwordx4 v9, s[36:39], s46 offen offset:3072 lds
    s_add_u32 s46, s46, 131072
    s_add_u32 m0, s86, 1024
    s_nop 0
    buffer_load_dwordx4 v22, s[20:23], s48 offen lds
    s_add_u32 m0, s86, 33792
    s_nop 0
    buffer_load_dwordx4 v23, s[20:23], s48 offen lds
    s_waitcnt vmcnt(11) lgkmcnt(0)
    s_barrier
    v_mfma_f32_16x16x32_bf16 v[72:75], v[120:123], v[80:83], v[72:75]
    ds_read_b128 v[192:195], v7 offset:32768
    ds_read_b128 v[208:211], v7 offset:49152
    s_add_u32 m0, s86, 65536
    s_nop 0
    buffer_load_dwordx4 v5, s[28:31], s45 offen sc1 lds
    s_add_u32 s45, s45, 16384
    v_mfma_f32_16x16x32_bf16 v[72:75], v[124:127], v[96:99], v[72:75]
    ds_read_b64_tr_b16 v[112:113], v18 offset:32768
    ds_read_b64_tr_b16 v[114:115], v18 offset:40960
    v_mfma_f32_16x16x32_bf16 v[76:79], v[124:127], v[100:103], v[76:79]
    ds_read_b64_tr_b16 v[116:117], v18 offset:49152
    ds_read_b64_tr_b16 v[118:119], v18 offset:57344
    v_mfma_f32_16x16x32_bf16 v[76:79], v[120:123], v[84:87], v[76:79]
    ds_read_b128 v[196:199], v7 offset:36864
    ds_read_b128 v[212:215], v7 offset:53248
    s_waitcnt lgkmcnt(4)
    v_mfma_f32_16x16x32_bf16 v[64:67], v[112:115], v[192:195], v[64:67]
    ds_read_b64_tr_b16 v[120:121], v19 offset:32768
    ds_read_b64_tr_b16 v[122:123], v19 offset:40960
    s_waitcnt lgkmcnt(4)
    v_mfma_f32_16x16x32_bf16 v[64:67], v[116:119], v[208:211], v[64:67]
    ds_read_b64_tr_b16 v[124:125], v19 offset:49152
    ds_read_b64_tr_b16 v[126:127], v19 offset:57344
    buffer_load_dwordx4 v3, s[36:39], s46 offen offset:2048 lds
    s_waitcnt lgkmcnt(4)
    v_mfma_f32_16x16x32_bf16 v[68:71], v[116:119], v[212:215], v[68:71]
    v_mfma_f32_16x16x32_bf16 v[68:71], v[112:115], v[196:199], v[68:71]
    buffer_load_dwordx4 v9, s[36:39], s46 offen offset:3072 lds
    s_add_u32 s46, s46, 131072
    s_waitcnt vmcnt(11) lgkmcnt(0)
    s_barrier
    v_mfma_f32_16x16x32_bf16 v[72:75], v[120:123], v[192:195], v[72:75]
    ds_read_b128 v[80:83], v8 offset:0
    ds_read_b128 v[96:99], v8 offset:16384
    s_add_u32 m0, s86, 98304
    s_nop 0
    buffer_load_dwordx4 v5, s[28:31], s45 offen sc1 lds
    s_add_u32 s45, s45, 16384
    v_mfma_f32_16x16x32_bf16 v[72:75], v[124:127], v[208:211], v[72:75]
    ds_read_b64_tr_b16 v[112:113], v20 offset:0
    ds_read_b64_tr_b16 v[114:115], v20 offset:8192
    v_mfma_f32_16x16x32_bf16 v[76:79], v[124:127], v[212:215], v[76:79]
    ds_read_b64_tr_b16 v[116:117], v20 offset:16384
    ds_read_b64_tr_b16 v[118:119], v20 offset:24576
    v_mfma_f32_16x16x32_bf16 v[76:79], v[120:123], v[196:199], v[76:79]
    ds_read_b128 v[84:87], v8 offset:4096
    ds_read_b128 v[100:103], v8 offset:20480
    s_waitcnt lgkmcnt(4)
    v_mfma_f32_16x16x32_bf16 v[64:67], v[112:115], v[80:83], v[64:67]
    ds_read_b64_tr_b16 v[120:121], v21 offset:0
    ds_read_b64_tr_b16 v[122:123], v21 offset:8192
    s_waitcnt lgkmcnt(4)
    v_mfma_f32_16x16x32_bf16 v[64:67], v[116:119], v[96:99], v[64:67]
    ds_read_b64_tr_b16 v[124:125], v21 offset:16384
    ds_read_b64_tr_b16 v[126:127], v21 offset:24576
    buffer_load_dwordx4 v3, s[36:39], s46 offen offset:2048 lds
    s_waitcnt lgkmcnt(4)
    v_mfma_f32_16x16x32_bf16 v[68:71], v[116:119], v[100:103], v[68:71]
    v_mfma_f32_16x16x32_bf16 v[68:71], v[112:115], v[84:87], v[68:71]
    buffer_load_dwordx4 v9, s[36:39], s46 offen offset:3072 lds
    s_add_u32 s46, s46, 131072
    s_waitcnt vmcnt(11) lgkmcnt(0)
    s_barrier
    v_mfma_f32_16x16x32_bf16 v[72:75], v[120:123], v[80:83], v[72:75]
    ds_read_b128 v[192:195], v6 offset:0
    ds_read_b128 v[208:211], v6 offset:16384
    s_add_u32 m0, s86, 131072
    s_nop 0
    buffer_load_dwordx4 v5, s[28:31], s45 offen sc1 lds
    s_add_u32 s45, s45, 16384
    v_mfma_f32_16x16x32_bf16 v[72:75], v[124:127], v[96:99], v[72:75]
    ds_read_b64_tr_b16 v[112:113], v16 offset:0
    ds_read_b64_tr_b16 v[114:115], v16 offset:8192
    v_mfma_f32_16x16x32_bf16 v[76:79], v[124:127], v[100:103], v[76:79]
    ds_read_b64_tr_b16 v[116:117], v16 offset:16384
    ds_read_b64_tr_b16 v[118:119], v16 offset:24576
    v_mfma_f32_16x16x32_bf16 v[76:79], v[120:123], v[84:87], v[76:79]
    ds_read_b128 v[196:199], v6 offset:4096
    ds_read_b128 v[212:215], v6 offset:20480
    s_waitcnt lgkmcnt(4)
    v_mfma_f32_16x16x32_bf16 v[64:67], v[112:115], v[192:195], v[64:67]
    ds_read_b64_tr_b16 v[120:121], v17 offset:0
    ds_read_b64_tr_b16 v[122:123], v17 offset:8192
    s_waitcnt lgkmcnt(4)
    v_mfma_f32_16x16x32_bf16 v[64:67], v[116:119], v[208:211], v[64:67]
    ds_read_b64_tr_b16 v[124:125], v17 offset:16384
    ds_read_b64_tr_b16 v[126:127], v17 offset:24576
    buffer_load_dwordx4 v3, s[36:39], s46 offen offset:2048 lds
    s_waitcnt lgkmcnt(4)
    v_mfma_f32_16x16x32_bf16 v[68:71], v[116:119], v[212:215], v[68:71]
    v_mfma_f32_16x16x32_bf16 v[68:71], v[112:115], v[196:199], v[68:71]
    buffer_load_dwordx4 v9, s[36:39], s46 offen offset:3072 lds
    s_add_u32 s46, s46, 131072
    s_waitcnt vmcnt(11) lgkmcnt(0)
    s_barrier
    v_mfma_f32_16x16x32_bf16 v[72:75], v[120:123], v[192:195], v[72:75]
    ds_read_b128 v[80:83], v6 offset:32768
    ds_read_b128 v[96:99], v6 offset:49152
    s_add_u32 m0, s86, 0
    s_nop 0
    buffer_load_dwordx4 v5, s[28:31], s45 offen sc1 lds
    s_add_u32 s45, s45, 16384
    v_mfma_f32_16x16x32_bf16 v[72:75], v[124:127], v[208:211], v[72:75]
    ds_read_b64_tr_b16 v[112:113], v16 offset:32768
    ds_read_b64_tr_b16 v[114:115], v16 offset:40960
    v_mfma_f32_16x16x32_bf16 v[76:79], v[124:127], v[212:215], v[76:79]
    ds_read_b64_tr_b16 v[116:117], v16 offset:49152
    ds_read_b64_tr_b16 v[118:119], v16 offset:57344
    v_mfma_f32_16x16x32_bf16 v[76:79], v[120:123], v[196:199], v[76:79]
    ds_read_b128 v[84:87], v6 offset:36864
    ds_read_b128 v[100:103], v6 offset:53248
    s_waitcnt lgkmcnt(4)
    v_mfma_f32_16x16x32_bf16 v[64:67], v[112:115], v[80:83], v[64:67]
    ds_read_b64_tr_b16 v[120:121], v17 offset:32768
    ds_read_b64_tr_b16 v[122:123], v17 offset:40960
    s_waitcnt lgkmcnt(4)
    v_mfma_f32_16x16x32_bf16 v[64:67], v[116:119], v[96:99], v[64:67]
    ds_read_b64_tr_b16 v[124:125], v17 offset:49152
    ds_read_b64_tr_b16 v[126:127], v17 offset:57344
    buffer_load_dwordx4 v3, s[36:39], s46 offen offset:2048 lds
    s_waitcnt lgkmcnt(4)
    v_mfma_f32_16x16x32_bf16 v[68:71], v[116:119], v[100:103], v[68:71]
    v_mfma_f32_16x16x32_bf16 v[68:71], v[112:115], v[84:87], v[68:71]
    buffer_load_dwordx4 v9, s[36:39], s46 offen offset:3072 lds
    s_add_u32 s46, s46, 131072
    s_waitcnt vmcnt(9) lgkmcnt(0)
    s_barrier
    v_mfma_f32_16x16x32_bf16 v[72:75], v[120:123], v[80:83], v[72:75]
    ds_read_b128 v[192:195], v7 offset:0
    ds_read_b128 v[208:211], v7 offset:16384
    s_add_u32 m0, s86, 32768
    s_nop 0
    buffer_load_dwordx4 v5, s[28:31], s45 offen sc1 lds
    s_add_u32 s45, s45, 16384
    v_mfma_f32_16x16x32_bf16 v[72:75], v[124:127], v[96:99], v[72:75]
    ds_read_b64_tr_b16 v[112:113], v18 offset:0
    ds_read_b64_tr_b16 v[114:115], v18 offset:8192
    v_mfma_f32_16x16x32_bf16 v[76:79], v[124:127], v[100:103], v[76:79]
    ds_read_b64_tr_b16 v[116:117], v18 offset:16384
    ds_read_b64_tr_b16 v[118:119], v18 offset:24576
    v_mfma_f32_16x16x32_bf16 v[76:79], v[120:123], v[84:87], v[76:79]
    ds_read_b128 v[196:199], v7 offset:4096
    ds_read_b128 v[212:215], v7 offset:20480
    s_waitcnt lgkmcnt(4)
    v_mfma_f32_16x16x32_bf16 v[64:67], v[112:115], v[192:195], v[64:67]
    ds_read_b64_tr_b16 v[120:121], v19 offset:0
    ds_read_b64_tr_b16 v[122:123], v19 offset:8192
    s_waitcnt lgkmcnt(4)
    v_mfma_f32_16x16x32_bf16 v[64:67], v[116:119], v[208:211], v[64:67]
    ds_read_b64_tr_b16 v[124:125], v19 offset:16384
    ds_read_b64_tr_b16 v[126:127], v19 offset:24576
    buffer_load_dwordx4 v3, s[36:39], s46 offen offset:2048 lds
    s_waitcnt lgkmcnt(4)
    v_mfma_f32_16x16x32_bf16 v[68:71], v[116:119], v[212:215], v[68:71]
    v_mfma_f32_16x16x32_bf16 v[68:71], v[112:115], v[196:199], v[68:71]
    buffer_load_dwordx4 v9, s[36:39], s46 offen offset:3072 lds
    s_add_u32 s46, s46, 131072
    s_waitcnt vmcnt(9) lgkmcnt(0)
    s_barrier
    v_mfma_f32_16x16x32_bf16 v[72:75], v[120:123], v[192:195], v[72:75]
    ds_read_b128 v[80:83], v7 offset:32768
    ds_read_b128 v[96:99], v7 offset:49152
    s_add_u32 m0, s86, 65536
    s_nop 0
    buffer_load_dwordx4 v5, s[28:31], s45 offen sc1 lds
    s_add_u32 s45, s45, 16384
    v_mfma_f32_16x16x32_bf16 v[72:75], v[124:127], v[208:211], v[72:75]
    ds_read_b64_tr_b16 v[112:113], v18 offset:32768
    ds_read_b64_tr_b16 v[114:115], v18 offset:40960
    v_mfma_f32_16x16x32_bf16 v[76:79], v[124:127], v[212:215], v[76:79]
    ds_read_b64_tr_b16 v[116:117], v18 offset:49152
    ds_read_b64_tr_b16 v[118:119], v18 offset:57344
    v_mfma_f32_16x16x32_bf16 v[76:79], v[120:123], v[196:199], v[76:79]
    ds_read_b128 v[84:87], v7 offset:36864
    ds_read_b128 v[100:103], v7 offset:53248
    s_waitcnt lgkmcnt(4)
    v_mfma_f32_16x16x32_bf16 v[64:67], v[112:115], v[80:83], v[64:67]
    ds_read_b64_tr_b16 v[120:121], v19 offset:32768
    ds_read_b64_tr_b16 v[122:123], v19 offset:40960
    s_waitcnt lgkmcnt(4)
    v_mfma_f32_16x16x32_bf16 v[64:67], v[116:119], v[96:99], v[64:67]
    ds_read_b64_tr_b16 v[124:125], v19 offset:49152
    ds_read_b64_tr_b16 v[126:127], v19 offset:57344
    buffer_load_dwordx4 v3, s[36:39], s46 offen offset:2048 lds
    s_waitcnt lgkmcnt(4)
    v_mfma_f32_16x16x32_bf16 v[68:71], v[116:119], v[100:103], v[68:71]
    v_mfma_f32_16x16x32_bf16 v[68:71], v[112:115], v[84:87], v[68:71]
    buffer_load_dwordx4 v9, s[36:39], s46 offen offset:3072 lds
    s_add_u32 s46, s46, 131072
    s_waitcnt vmcnt(9) lgkmcnt(0)
    s_barrier
    v_mfma_f32_16x16x32_bf16 v[72:75], v[120:123], v[80:83], v[72:75]
    ds_read_b128 v[192:195], v8 offset:0
    ds_read_b128 v[208:211], v8 offset:16384
    s_add_u32 m0, s86, 98304
    s_nop 0
    buffer_load_dwordx4 v5, s[28:31], s45 offen sc1 lds
    s_add_u32 s45, s45, 16384
    v_mfma_f32_16x16x32_bf16 v[72:75], v[124:127], v[96:99], v[72:75]
    ds_read_b64_tr_b16 v[112:113], v20 offset:0
    ds_read_b64_tr_b16 v[114:115], v20 offset:8192
    v_mfma_f32_16x16x32_bf16 v[76:79], v[124:127], v[100:103], v[76:79]
    ds_read_b64_tr_b16 v[116:117], v20 offset:16384
    ds_read_b64_tr_b16 v[118:119], v20 offset:24576
    v_mfma_f32_16x16x32_bf16 v[76:79], v[120:123], v[84:87], v[76:79]
    ds_read_b128 v[196:199], v8 offset:4096
    ds_read_b128 v[212:215], v8 offset:20480
    s_waitcnt lgkmcnt(4)
    v_mfma_f32_16x16x32_bf16 v[64:67], v[112:115], v[192:195], v[64:67]
    ds_read_b64_tr_b16 v[120:121], v21 offset:0
    ds_read_b64_tr_b16 v[122:123], v21 offset:8192
    s_waitcnt lgkmcnt(4)
    v_mfma_f32_16x16x32_bf16 v[64:67], v[116:119], v[208:211], v[64:67]
    ds_read_b64_tr_b16 v[124:125], v21 offset:16384
    ds_read_b64_tr_b16 v[126:127], v21 offset:24576
    buffer_load_dwordx4 v3, s[36:39], s46 offen offset:2048 lds
    s_waitcnt lgkmcnt(4)
    v_mfma_f32_16x16x32_bf16 v[68:71], v[116:119], v[212:215], v[68:71]
    v_mfma_f32_16x16x32_bf16 v[68:71], v[112:115], v[196:199], v[68:71]
    buffer_load_dwordx4 v9, s[36:39], s46 offen offset:3072 lds
    s_add_u32 s46, s46, 131072
    s_waitcnt vmcnt(9) lgkmcnt(0)
    s_barrier
    v_mfma_f32_16x16x32_bf16 v[72:75], v[120:123], v[192:195], v[72:75]
    ds_read_b128 v[80:83], v6 offset:0
    ds_read_b128 v[96:99], v6 offset:16384
    v_mfma_f32_16x16x32_bf16 v[72:75], v[124:127], v[208:211], v[72:75]
    ds_read_b64_tr_b16 v[112:113], v16 offset:0
    ds_read_b64_tr_b16 v[114:115], v16 offset:8192
    v_mfma_f32_16x16x32_bf16 v[76:79], v[124:127], v[212:215], v[76:79]
    ds_read_b64_tr_b16 v[116:117], v16 offset:16384
    ds_read_b64_tr_b16 v[118:119], v16 offset:24576
    v_mfma_f32_16x16x32_bf16 v[76:79], v[120:123], v[196:199], v[76:79]
    ds_read_b128 v[84:87], v6 offset:4096
    ds_read_b128 v[100:103], v6 offset:20480
    s_waitcnt lgkmcnt(4)
    v_mfma_f32_16x16x32_bf16 v[64:67], v[112:115], v[80:83], v[64:67]
    ds_read_b64_tr_b16 v[120:121], v17 offset:0
    ds_read_b64_tr_b16 v[122:123], v17 offset:8192
    s_waitcnt lgkmcnt(4)
    v_mfma_f32_16x16x32_bf16 v[64:67], v[116:119], v[96:99], v[64:67]
    ds_read_b64_tr_b16 v[124:125], v17 offset:16384
    ds_read_b64_tr_b16 v[126:127], v17 offset:24576
    s_waitcnt lgkmcnt(4)
    v_mfma_f32_16x16x32_bf16 v[68:71], v[116:119], v[100:103], v[68:71]
    v_mfma_f32_16x16x32_bf16 v[68:71], v[112:115], v[84:87], v[68:71]
    s_waitcnt vmcnt(6) lgkmcnt(0)
    s_barrier
    v_mfma_f32_16x16x32_bf16 v[72:75], v[120:123], v[80:83], v[72:75]
    ds_read_b128 v[192:195], v6 offset:32768
    ds_read_b128 v[208:211], v6 offset:49152
    v_mfma_f32_16x16x32_bf16 v[72:75], v[124:127], v[96:99], v[72:75]
    ds_read_b64_tr_b16 v[112:113], v16 offset:32768
    ds_read_b64_tr_b16 v[114:115], v16 offset:40960
    v_mfma_f32_16x16x32_bf16 v[76:79], v[124:127], v[100:103], v[76:79]
    ds_read_b64_tr_b16 v[116:117], v16 offset:49152
    ds_read_b64_tr_b16 v[118:119], v16 offset:57344
    buffer_load_dwordx4 v[128:131], v4, s[28:31], s91 offen offset:0 sc1
    v_mfma_f32_16x16x32_bf16 v[76:79], v[120:123], v[84:87], v[76:79]
    ds_read_b128 v[196:199], v6 offset:36864
    ds_read_b128 v[212:215], v6 offset:53248
    buffer_load_dwordx4 v[132:135], v4, s[28:31], s91 offen offset:1024 sc1
    s_waitcnt lgkmcnt(4)
    v_mfma_f32_16x16x32_bf16 v[64:67], v[112:115], v[192:195], v[64:67]
    ds_read_b64_tr_b16 v[120:121], v17 offset:32768
    ds_read_b64_tr_b16 v[122:123], v17 offset:40960
    s_waitcnt lgkmcnt(4)
    v_mfma_f32_16x16x32_bf16 v[64:67], v[116:119], v[208:211], v[64:67]
    ds_read_b64_tr_b16 v[124:125], v17 offset:49152
    ds_read_b64_tr_b16 v[126:127], v17 offset:57344
    s_waitcnt lgkmcnt(4)
    v_mfma_f32_16x16x32_bf16 v[68:71], v[116:119], v[212:215], v[68:71]
    v_mfma_f32_16x16x32_bf16 v[68:71], v[112:115], v[196:199], v[68:71]
    s_waitcnt vmcnt(5) lgkmcnt(0)
    s_barrier
    v_mfma_f32_16x16x32_bf16 v[72:75], v[120:123], v[192:195], v[72:75]
    ds_read_b128 v[80:83], v7 offset:0
    ds_read_b128 v[96:99], v7 offset:16384
    v_mfma_f32_16x16x32_bf16 v[72:75], v[124:127], v[208:211], v[72:75]
    ds_read_b64_tr_b16 v[112:113], v18 offset:0
    ds_read_b64_tr_b16 v[114:115], v18 offset:8192
    v_mfma_f32_16x16x32_bf16 v[76:79], v[124:127], v[212:215], v[76:79]
    ds_read_b64_tr_b16 v[116:117], v18 offset:16384
    ds_read_b64_tr_b16 v[118:119], v18 offset:24576
    v_mfma_f32_16x16x32_bf16 v[76:79], v[120:123], v[196:199], v[76:79]
    ds_read_b128 v[84:87], v7 offset:4096
    ds_read_b128 v[100:103], v7 offset:20480
    s_waitcnt lgkmcnt(4)
    v_mfma_f32_16x16x32_bf16 v[64:67], v[112:115], v[80:83], v[64:67]
    ds_read_b64_tr_b16 v[120:121], v19 offset:0
    ds_read_b64_tr_b16 v[122:123], v19 offset:8192
    s_waitcnt lgkmcnt(4)
    v_mfma_f32_16x16x32_bf16 v[64:67], v[116:119], v[96:99], v[64:67]
    ds_read_b64_tr_b16 v[124:125], v19 offset:16384
    ds_read_b64_tr_b16 v[126:127], v19 offset:24576
    s_waitcnt lgkmcnt(4)
    v_mfma_f32_16x16x32_bf16 v[68:71], v[116:119], v[100:103], v[68:71]
    v_mfma_f32_16x16x32_bf16 v[68:71], v[112:115], v[84:87], v[68:71]
    s_waitcnt vmcnt(2) lgkmcnt(0)
    s_barrier
    v_mfma_f32_16x16x32_bf16 v[72:75], v[120:123], v[80:83], v[72:75]
    ds_read_b128 v[192:195], v7 offset:32768
    ds_read_b128 v[208:211], v7 offset:49152
    v_mfma_f32_16x16x32_bf16 v[72:75], v[124:127], v[96:99], v[72:75]
    ds_read_b64_tr_b16 v[112:113], v18 offset:32768
    ds_read_b64_tr_b16 v[114:115], v18 offset:40960
    v_mfma_f32_16x16x32_bf16 v[76:79], v[124:127], v[100:103], v[76:79]
    ds_read_b64_tr_b16 v[116:117], v18 offset:49152
    ds_read_b64_tr_b16 v[118:119], v18 offset:57344
    v_mfma_f32_16x16x32_bf16 v[76:79], v[120:123], v[84:87], v[76:79]
    ds_read_b128 v[196:199], v7 offset:36864
    ds_read_b128 v[212:215], v7 offset:53248
    s_waitcnt lgkmcnt(4)
    v_mfma_f32_16x16x32_bf16 v[64:67], v[112:115], v[192:195], v[64:67]
    ds_read_b64_tr_b16 v[120:121], v19 offset:32768
    ds_read_b64_tr_b16 v[122:123], v19 offset:40960
    s_waitcnt lgkmcnt(4)
    v_mfma_f32_16x16x32_bf16 v[64:67], v[116:119], v[208:211], v[64:67]
    ds_read_b64_tr_b16 v[124:125], v19 offset:49152
    ds_read_b64_tr_b16 v[126:127], v19 offset:57344
    s_waitcnt lgkmcnt(4)
    v_mfma_f32_16x16x32_bf16 v[68:71], v[116:119], v[212:215], v[68:71]
    v_mfma_f32_16x16x32_bf16 v[68:71], v[112:115], v[196:199], v[68:71]
    s_waitcnt lgkmcnt(0)
    v_mfma_f32_16x16x32_bf16 v[72:75], v[120:123], v[192:195], v[72:75]
    ds_read_b128 v[136:139], v25 offset:0
    v_mfma_f32_16x16x32_bf16 v[72:75], v[124:127], v[208:211], v[72:75]
    ds_read_b128 v[140:143], v25 offset:8192
    v_mfma_f32_16x16x32_bf16 v[76:79], v[124:127], v[212:215], v[76:79]
    v_mfma_f32_16x16x32_bf16 v[76:79], v[120:123], v[196:199], v[76:79]
    s_waitcnt vmcnt(0)
    s_mov_b32 s63, 0x20000
L_poll_9026:
    v_cmp_eq_u32 vcc, -1, v128
    v_cmp_eq_u32 s[56:57], -1, v132
    s_nop 0
    s_or_b64 vcc, vcc, s[56:57]
    s_cbranch_scc0 L_go_9027
    s_sleep 2
    buffer_load_dwordx4 v[128:131], v4, s[28:31], s91 offen offset:0 sc1
    buffer_load_dwordx4 v[132:135], v4, s[28:31], s91 offen offset:1024 sc1
    s_waitcnt vmcnt(0)
    s_sub_u32 s63, s63, 1
    s_cmp_lg_u32 s63, 0
    s_cbranch_scc1 L_poll_9026
L_go_9027:
    v_lshlrev_b32 v144, 16, v128
    v_and_b32 v145, 0xffff0000, v128
    v_lshlrev_b32 v146, 16, v129
    v_and_b32 v147, 0xffff0000, v129
    v_lshlrev_b32 v148, 16, v130
    v_and_b32 v149, 0xffff0000, v130
    v_lshlrev_b32 v150, 16, v131
    v_and_b32 v151, 0xffff0000, v131
    v_lshlrev_b32 v152, 16, v132
    v_and_b32 v153, 0xffff0000, v132
    v_lshlrev_b32 v154, 16, v133
    v_and_b32 v155, 0xffff0000, v133
    v_lshlrev_b32 v156, 16, v134
    v_and_b32 v157, 0xffff0000, v134
    v_lshlrev_b32 v158, 16, v135
    v_and_b32 v159, 0xffff0000, v135
    v_pk_add_f32 v[32:33], v[32:33], v[144:145]
    v_pk_add_f32 v[34:35], v[34:35], v[146:147]
    v_pk_add_f32 v[48:49], v[48:49], v[148:149]
    v_pk_add_f32 v[50:51], v[50:51], v[150:151]
    v_pk_add_f32 v[36:37], v[36:37], v[152:153]
    v_pk_add_f32 v[38:39], v[38:39], v[154:155]
    v_pk_add_f32 v[52:53], v[52:53], v[156:157]
    v_pk_add_f32 v[54:55], v[54:55], v[158:159]
    v_pk_mul_f32 v[32:33], v[32:33], v[164:165] op_sel_hi:[1,0]
    v_pk_mul_f32 v[34:35], v[34:35], v[164:165] op_sel_hi:[1,0]
    v_pk_mul_f32 v[48:49], v[48:49], v[164:165] op_sel_hi:[1,0]
    v_pk_mul_f32 v[50:51], v[50:51], v[164:165] op_sel_hi:[1,0]
    v_pk_mul_f32 v[36:37], v[36:37], v[166:167] op_sel_hi:[1,0]
    v_pk_mul_f32 v[38:39], v[38:39], v[166:167] op_sel_hi:[1,0]
    v_pk_mul_f32 v[52:53], v[52:53], v[166:167] op_sel_hi:[1,0]
    v_pk_mul_f32 v[54:55], v[54:55], v[166:167] op_sel_hi:[1,0]
    v_pk_mul_f32 v[144:145], v[32:33], s[52:53]
    v_pk_mul_f32 v[146:147], v[34:35], s[52:53]
    v_pk_mul_f32 v[148:149], v[48:49], s[52:53]
    v_pk_mul_f32 v[150:151], v[50:51], s[52:53]
    v_pk_mul_f32 v[152:153], v[36:37], s[52:53]
    v_pk_mul_f32 v[154:155], v[38:39], s[52:53]
    v_pk_mul_f32 v[156:157], v[52:53], s[52:53]
    v_pk_mul_f32 v[158:159], v[54:55], s[52:53]
    v_exp_f32 v144, v144
    v_exp_f32 v145, v145
    v_exp_f32 v146, v146
    v_exp_f32 v147, v147
    v_exp_f32 v148, v148
    v_exp_f32 v149, v149
    v_exp_f32 v150, v150
    v_exp_f32 v151, v151
    v_exp_f32 v152, v152
    v_exp_f32 v153, v153
    v_exp_f32 v154, v154
    v_exp_f32 v155, v155
    v_exp_f32 v156, v156
    v_exp_f32 v157, v157
    v_exp_f32 v158, v158
    v_exp_f32 v159, v159
    v_pk_add_f32 v[144:145], v[144:145], 1.0 op_sel_hi:[1,0]
    v_pk_add_f32 v[146:147], v[146:147], 1.0 op_sel_hi:[1,0]
    v_pk_add_f32 v[148:149], v[148:149], 1.0 op_sel_hi:[1,0]
    v_pk_add_f32 v[150:151], v[150:151], 1.0 op_sel_hi:[1,0]
    v_pk_add_f32 v[152:153], v[152:153], 1.0 op_sel_hi:[1,0]
    v_pk_add_f32 v[154:155], v[154:155], 1.0 op_sel_hi:[1,0]
    v_pk_add_f32 v[156:157], v[156:157], 1.0 op_sel_hi:[1,0]
    v_pk_add_f32 v[158:159], v[158:159], 1.0 op_sel_hi:[1,0]
    v_rcp_f32 v144, v144
    v_rcp_f32 v145, v145
    v_rcp_f32 v146, v146
    v_rcp_f32 v147, v147
    v_rcp_f32 v148, v148
    v_rcp_f32 v149, v149
    v_rcp_f32 v150, v150
    v_rcp_f32 v151, v151
    v_rcp_f32 v152, v152
    v_rcp_f32 v153, v153
    v_rcp_f32 v154, v154
    v_rcp_f32 v155, v155
    v_rcp_f32 v156, v156
    v_rcp_f32 v157, v157
    v_rcp_f32 v158, v158
    v_rcp_f32 v159, v159
    v_pk_mul_f32 v[144:145], v[144:145], v[32:33]
    v_pk_mul_f32 v[146:147], v[146:147], v[34:35]
    v_pk_mul_f32 v[148:149], v[148:149], v[48:49]
    v_pk_mul_f32 v[150:151], v[150:151], v[50:51]
    v_pk_mul_f32 v[152:153], v[152:153], v[36:37]
    v_pk_mul_f32 v[154:155], v[154:155], v[38:39]
    v_pk_mul_f32 v[156:157], v[156:157], v[52:53]
    v_pk_mul_f32 v[158:159], v[158:159], v[54:55]
    s_waitcnt lgkmcnt(1)
    v_lshlrev_b32 v172, 16, v136
    v_and_b32 v173, 0xffff0000, v136
    v_lshlrev_b32 v174, 16, v137
    v_and_b32 v175, 0xffff0000, v137
    v_lshlrev_b32 v176, 16, v138
    v_and_b32 v177, 0xffff0000, v138
    v_lshlrev_b32 v178, 16, v139
    v_and_b32 v179, 0xffff0000, v139
    s_waitcnt lgkmcnt(0)
    v_lshlrev_b32 v180, 16, v140
    v_and_b32 v181, 0xffff0000, v140
    v_lshlrev_b32 v182, 16, v141
    v_and_b32 v183, 0xffff0000, v141
    v_lshlrev_b32 v184, 16, v142
    v_and_b32 v185, 0xffff0000, v142
    v_lshlrev_b32 v186, 16, v143
    v_and_b32 v187, 0xffff0000, v143
    v_pk_mul_f32 v[144:145], v[144:145], v[64:65]
    v_pk_mul_f32 v[146:147], v[146:147], v[66:67]
    v_pk_mul_f32 v[148:149], v[148:149], v[72:73]
    v_pk_mul_f32 v[150:151], v[150:151], v[74:75]
    s_nop 0
    v_permlane16_swap_b32 v144, v148
    v_permlane16_swap_b32 v145, v149
    v_permlane16_swap_b32 v146, v150
    v_permlane16_swap_b32 v147, v151
    v_pk_add_f32 v[144:145], v[144:145], v[172:173]
    v_pk_add_f32 v[146:147], v[146:147], v[174:175]
    v_pk_add_f32 v[148:149], v[148:149], v[176:177]
    v_pk_add_f32 v[150:151], v[150:151], v[178:179]
    v_cvt_pk_bf16_f32 v172, v144, v145
    v_cvt_pk_bf16_f32 v173, v146, v147
    v_cvt_pk_bf16_f32 v174, v148, v149
    v_cvt_pk_bf16_f32 v175, v150, v151
    buffer_store_dwordx4 v[172:175], v0, s[32:35], s88 offen sc1
    v_pk_mul_f32 v[152:153], v[152:153], v[68:69]
    v_pk_mul_f32 v[154:155], v[154:155], v[70:71]
    v_pk_mul_f32 v[156:157], v[156:157], v[76:77]
    v_pk_mul_f32 v[158:159], v[158:159], v[78:79]
    s_nop 0
    v_permlane16_swap_b32 v152, v156
    v_permlane16_swap_b32 v153, v157
    v_permlane16_swap_b32 v154, v158
    v_permlane16_swap_b32 v155, v159
    v_pk_add_f32 v[152:153], v[152:153], v[180:181]
    v_pk_add_f32 v[154:155], v[154:155], v[182:183]
    v_pk_add_f32 v[156:157], v[156:157], v[184:185]
    v_pk_add_f32 v[158:159], v[158:159], v[186:187]
    v_cvt_pk_bf16_f32 v180, v152, v153
    v_cvt_pk_bf16_f32 v181, v154, v155
    v_cvt_pk_bf16_f32 v182, v156, v157
    v_cvt_pk_bf16_f32 v183, v158, v159
    buffer_store_dwordx4 v[180:183], v0, s[32:35], s89 offen sc1
    s_endpgm
L_slow_9003:
    s_add_u32 m0, s86, 0
    s_nop 0
    buffer_load_dwordx4 v3, s[24:27], s46 offen offset:2048 lds
    buffer_load_dwordx4 v9, s[24:27], s46 offen offset:3072 lds
    s_add_u32 s46, s46, 131072
    s_add_u32 m0, s86, 32768
    s_nop 0
    buffer_load_dwordx4 v3, s[24:27], s46 offen offset:2048 lds
    buffer_load_dwordx4 v9, s[24:27], s46 offen offset:3072 lds
    s_add_u32 s46, s46, 131072
    s_add_u32 m0, s86, 65536
    s_nop 0
    buffer_load_dwordx4 v3, s[24:27], s46 offen offset:2048 lds
    buffer_load_dwordx4 v9, s[24:27], s46 offen offset:3072 lds
    s_add_u32 s46, s46, 131072
    s_add_u32 m0, s86, 98304
    s_nop 0
    buffer_load_dwordx4 v3, s[24:27], s46 offen offset:2048 lds
    buffer_load_dwordx4 v9, s[24:27], s46 offen offset:3072 lds
    s_add_u32 s46, s46, 131072
    s_add_u32 m0, s86, 131072
    s_nop 0
    buffer_load_dwordx4 v3, s[24:27], s46 offen offset:2048 lds
    buffer_load_dwordx4 v9, s[24:27], s46 offen offset:3072 lds
    s_add_u32 s46, s46, 131072
    s_cmp_lg_u32 s42, 0
    s_cbranch_scc1 L_sk_9501
    s_mov_b32 s63, 0x40000
    s_load_dwordx2 s[8:9], s[94:95], s62 glc
L_poll_9502:
    s_waitcnt lgkmcnt(0)
    s_and_b32 s8, s8, s9
    s_cmp_eq_u32 s8, 1
    s_cbranch_scc1 L_go_9503
    s_sleep 4
    s_load_dwordx2 s[8:9], s[94:95], s62 glc
    s_sub_u32 s63, s63, 1
    s_cmp_lg_u32 s63, 0
    s_cbranch_scc1 L_poll_9502
    s_waitcnt lgkmcnt(0)
L_go_9503:
L_sk_9501:
    s_add_u32 m0, s86, 0
    s_barrier
    buffer_load_dwordx4 v2, s[28:31], s45 offen sc1 lds
    buffer_load_dwordx4 v2, s[28:31], s45 offen offset:1024 sc1 lds
    s_add_u32 s45, s45, 16384
    s_add_u32 m0, s86, 32768
    s_branch L_join_9004
L_k1_exit:
    s_endpgm
    .p2align 6
L_sub_c0_0:
    s_setprio 1
    s_barrier
    v_mfma_f32_16x16x32_bf16 v[32:35], v[160:163], v[144:147], v[32:35]
    v_mfma_f32_16x16x32_bf16 v[32:35], v[204:207], v[188:191], v[32:35]
    v_mfma_f32_16x16x32_bf16 v[36:39], v[204:207], v[192:195], v[36:39]
    v_mfma_f32_16x16x32_bf16 v[36:39], v[160:163], v[148:151], v[36:39]
    v_mfma_f32_16x16x32_bf16 v[40:43], v[160:163], v[152:155], v[40:43]
    v_mfma_f32_16x16x32_bf16 v[40:43], v[204:207], v[196:199], v[40:43]
    v_mfma_f32_16x16x32_bf16 v[44:47], v[204:207], v[200:203], v[44:47]
    v_mfma_f32_16x16x32_bf16 v[44:47], v[160:163], v[156:159], v[44:47]
    v_mfma_f32_16x16x32_bf16 v[60:63], v[164:167], v[156:159], v[60:63]
    v_mfma_f32_16x16x32_bf16 v[60:63], v[208:211], v[200:203], v[60:63]
    v_mfma_f32_16x16x32_bf16 v[56:59], v[208:211], v[196:199], v[56:59]
    v_mfma_f32_16x16x32_bf16 v[56:59], v[164:167], v[152:155], v[56:59]
    v_mfma_f32_16x16x32_bf16 v[52:55], v[164:167], v[148:151], v[52:55]
    v_mfma_f32_16x16x32_bf16 v[52:55], v[208:211], v[192:195], v[52:55]
    v_mfma_f32_16x16x32_bf16 v[48:51], v[208:211], v[188:191], v[48:51]
    v_mfma_f32_16x16x32_bf16 v[48:51], v[164:167], v[144:147], v[48:51]
    v_mfma_f32_16x16x32_bf16 v[64:67], v[168:171], v[144:147], v[64:67]
    v_mfma_f32_16x16x32_bf16 v[64:67], v[212:215], v[188:191], v[64:67]
    v_mfma_f32_16x16x32_bf16 v[68:71], v[212:215], v[192:195], v[68:71]
    v_mfma_f32_16x16x32_bf16 v[68:71], v[168:171], v[148:151], v[68:71]
    v_mfma_f32_16x16x32_bf16 v[72:75], v[168:171], v[152:155], v[72:75]
    v_mfma_f32_16x16x32_bf16 v[72:75], v[212:215], v[196:199], v[72:75]
    v_mfma_f32_16x16x32_bf16 v[76:79], v[212:215], v[200:203], v[76:79]
    v_mfma_f32_16x16x32_bf16 v[76:79], v[168:171], v[156:159], v[76:79]
    v_mfma_f32_16x16x32_bf16 v[92:95], v[172:175], v[156:159], v[92:95]
    v_mfma_f32_16x16x32_bf16 v[92:95], v[216:219], v[200:203], v[92:95]
    v_mfma_f32_16x16x32_bf16 v[88:91], v[216:219], v[196:199], v[88:91]
    v_mfma_f32_16x16x32_bf16 v[88:91], v[172:175], v[152:155], v[88:91]
    v_mfma_f32_16x16x32_bf16 v[84:87], v[172:175], v[148:151], v[84:87]
    v_mfma_f32_16x16x32_bf16 v[84:87], v[216:219], v[192:195], v[84:87]
    v_mfma_f32_16x16x32_bf16 v[80:83], v[216:219], v[188:191], v[80:83]
    v_mfma_f32_16x16x32_bf16 v[80:83], v[172:175], v[144:147], v[80:83]
    v_mfma_f32_16x16x32_bf16 v[96:99], v[144:147], v[176:179], v[96:99]
    v_mfma_f32_16x16x32_bf16 v[96:99], v[188:191], v[220:223], v[96:99]
    v_mfma_f32_16x16x32_bf16 v[100:103], v[192:195], v[220:223], v[100:103]
    v_mfma_f32_16x16x32_bf16 v[100:103], v[148:151], v[176:179], v[100:103]
    v_mfma_f32_16x16x32_bf16 v[104:107], v[152:155], v[176:179], v[104:107]
    v_mfma_f32_16x16x32_bf16 v[104:107], v[196:199], v[220:223], v[104:107]
    v_mfma_f32_16x16x32_bf16 v[108:111], v[200:203], v[220:223], v[108:111]
    v_mfma_f32_16x16x32_bf16 v[108:111], v[156:159], v[176:179], v[108:111]
    v_mfma_f32_16x16x32_bf16 v[124:127], v[156:159], v[180:183], v[124:127]
    v_mfma_f32_16x16x32_bf16 v[124:127], v[200:203], v[224:227], v[124:127]
    v_mfma_f32_16x16x32_bf16 v[120:123], v[196:199], v[224:227], v[120:123]
    v_mfma_f32_16x16x32_bf16 v[120:123], v[152:155], v[180:183], v[120:123]
    v_mfma_f32_16x16x32_bf16 v[116:119], v[148:151], v[180:183], v[116:119]
    v_mfma_f32_16x16x32_bf16 v[116:119], v[192:195], v[224:227], v[116:119]
    v_mfma_f32_16x16x32_bf16 v[112:115], v[188:191], v[224:227], v[112:115]
    v_mfma_f32_16x16x32_bf16 v[112:115], v[144:147], v[180:183], v[112:115]
    s_waitcnt vmcnt(7)
    s_barrier
    s_setprio 0
    s_setpc_b64 s[100:101]
    .p2align 6
L_sub_c0_1:
    s_setprio 1
    s_barrier
    v_mfma_f32_16x16x32_bf16 v[32:35], v[160:163], v[144:147], v[32:35]
    v_mfma_f32_16x16x32_bf16 v[32:35], v[204:207], v[188:191], v[32:35]
    v_mfma_f32_16x16x32_bf16 v[36:39], v[204:207], v[192:195], v[36:39]
    v_mfma_f32_16x16x32_bf16 v[36:39], v[160:163], v[148:151], v[36:39]
    v_mfma_f32_16x16x32_bf16 v[40:43], v[160:163], v[152:155], v[40:43]
    v_mfma_f32_16x16x32_bf16 v[40:43], v[204:207], v[196:199], v[40:43]
    v_mfma_f32_16x16x32_bf16 v[44:47], v[204:207], v[200:203], v[44:47]
    v_mfma_f32_16x16x32_bf16 v[44:47], v[160:163], v[156:159], v[44:47]
    v_mfma_f32_16x16x32_bf16 v[60:63], v[164:167], v[156:159], v[60:63]
    v_mfma_f32_16x16x32_bf16 v[60:63], v[208:211], v[200:203], v[60:63]
    v_mfma_f32_16x16x32_bf16 v[56:59], v[208:211], v[196:199], v[56:59]
    v_mfma_f32_16x16x32_bf16 v[56:59], v[164:167], v[152:155], v[56:59]
    v_mfma_f32_16x16x32_bf16 v[52:55], v[164:167], v[148:151], v[52:55]
    v_mfma_f32_16x16x32_bf16 v[52:55], v[208:211], v[192:195], v[52:55]
    v_mfma_f32_16x16x32_bf16 v[48:51], v[208:211], v[188:191], v[48:51]
    v_mfma_f32_16x16x32_bf16 v[48:51], v[164:167], v[144:147], v[48:51]
    v_mfma_f32_16x16x32_bf16 v[64:67], v[168:171], v[144:147], v[64:67]
    v_mfma_f32_16x16x32_bf16 v[64:67], v[212:215], v[188:191], v[64:67]
    v_mfma_f32_16x16x32_bf16 v[68:71], v[212:215], v[192:195], v[68:71]
    v_mfma_f32_16x16x32_bf16 v[68:71], v[168:171], v[148:151], v[68:71]
    v_mfma_f32_16x16x32_bf16 v[72:75], v[168:171], v[152:155], v[72:75]
    v_mfma_f32_16x16x32_bf16 v[72:75], v[212:215], v[196:199], v[72:75]
    v_mfma_f32_16x16x32_bf16 v[76:79], v[212:215], v[200:203], v[76:79]
    v_mfma_f32_16x16x32_bf16 v[76:79], v[168:171], v[156:159], v[76:79]
    v_mfma_f32_16x16x32_bf16 v[92:95], v[172:175], v[156:159], v[92:95]
    v_mfma_f32_16x16x32_bf16 v[92:95], v[216:219], v[200:203], v[92:95]
    v_mfma_f32_16x16x32_bf16 v[88:91], v[216:219], v[196:199], v[88:91]
    v_mfma_f32_16x16x32_bf16 v[88:91], v[172:175], v[152:155], v[88:91]
    v_mfma_f32_16x16x32_bf16 v[84:87], v[172:175], v[148:151], v[84:87]
    v_mfma_f32_16x16x32_bf16 v[84:87], v[216:219], v[192:195], v[84:87]
    v_mfma_f32_16x16x32_bf16 v[80:83], v[216:219], v[188:191], v[80:83]
    v_mfma_f32_16x16x32_bf16 v[80:83], v[172:175], v[144:147], v[80:83]
    v_mfma_f32_16x16x32_bf16 v[96:99], v[144:147], v[176:179], v[96:99]
    v_mfma_f32_16x16x32_bf16 v[96:99], v[188:191], v[220:223], v[96:99]
    v_mfma_f32_16x16x32_bf16 v[100:103], v[192:195], v[220:223], v[100:103]
    v_mfma_f32_16x16x32_bf16 v[100:103], v[148:151], v[176:179], v[100:103]
    v_mfma_f32_16x16x32_bf16 v[104:107], v[152:155], v[176:179], v[104:107]
    v_mfma_f32_16x16x32_bf16 v[104:107], v[196:199], v[220:223], v[104:107]
    v_mfma_f32_16x16x32_bf16 v[108:111], v[200:203], v[220:223], v[108:111]
    v_mfma_f32_16x16x32_bf16 v[108:111], v[156:159], v[176:179], v[108:111]
    v_mfma_f32_16x16x32_bf16 v[124:127], v[156:159], v[180:183], v[124:127]
    v_mfma_f32_16x16x32_bf16 v[124:127], v[200:203], v[224:227], v[124:127]
    v_mfma_f32_16x16x32_bf16 v[120:123], v[196:199], v[224:227], v[120:123]
    v_mfma_f32_16x16x32_bf16 v[120:123], v[152:155], v[180:183], v[120:123]
    v_mfma_f32_16x16x32_bf16 v[116:119], v[148:151], v[180:183], v[116:119]
    v_mfma_f32_16x16x32_bf16 v[116:119], v[192:195], v[224:227], v[116:119]
    v_mfma_f32_16x16x32_bf16 v[112:115], v[188:191], v[224:227], v[112:115]
    v_mfma_f32_16x16x32_bf16 v[112:115], v[144:147], v[180:183], v[112:115]
    s_waitcnt vmcnt(0)
    s_barrier
    s_setprio 0
    s_setpc_b64 s[100:101]
    .p2align 6
L_sub_c0_2:
    s_setprio 1
    s_barrier
    v_mfma_f32_16x16x32_bf16 v[32:35], v[160:163], v[144:147], v[32:35]
    v_mfma_f32_16x16x32_bf16 v[32:35], v[204:207], v[188:191], v[32:35]
    v_mfma_f32_16x16x32_bf16 v[36:39], v[204:207], v[192:195], v[36:39]
    v_mfma_f32_16x16x32_bf16 v[36:39], v[160:163], v[148:151], v[36:39]
    v_mfma_f32_16x16x32_bf16 v[40:43], v[160:163], v[152:155], v[40:43]
    v_mfma_f32_16x16x32_bf16 v[40:43], v[204:207], v[196:199], v[40:43]
    v_mfma_f32_16x16x32_bf16 v[44:47], v[204:207], v[200:203], v[44:47]
    v_mfma_f32_16x16x32_bf16 v[44:47], v[160:163], v[156:159], v[44:47]
    v_mfma_f32_16x16x32_bf16 v[60:63], v[164:167], v[156:159], v[60:63]
    v_mfma_f32_16x16x32_bf16 v[60:63], v[208:211], v[200:203], v[60:63]
    v_mfma_f32_16x16x32_bf16 v[56:59], v[208:211], v[196:199], v[56:59]
    v_mfma_f32_16x16x32_bf16 v[56:59], v[164:167], v[152:155], v[56:59]
    v_mfma_f32_16x16x32_bf16 v[52:55], v[164:167], v[148:151], v[52:55]
    v_mfma_f32_16x16x32_bf16 v[52:55], v[208:211], v[192:195], v[52:55]
    v_mfma_f32_16x16x32_bf16 v[48:51], v[208:211], v[188:191], v[48:51]
    v_mfma_f32_16x16x32_bf16 v[48:51], v[164:167], v[144:147], v[48:51]
    v_mfma_f32_16x16x32_bf16 v[64:67], v[168:171], v[144:147], v[64:67]
    v_mfma_f32_16x16x32_bf16 v[64:67], v[212:215], v[188:191], v[64:67]
    v_mfma_f32_16x16x32_bf16 v[68:71], v[212:215], v[192:195], v[68:71]
    v_mfma_f32_16x16x32_bf16 v[68:71], v[168:171], v[148:151], v[68:71]
    v_mfma_f32_16x16x32_bf16 v[72:75], v[168:171], v[152:155], v[72:75]
    v_mfma_f32_16x16x32_bf16 v[72:75], v[212:215], v[196:199], v[72:75]
    v_mfma_f32_16x16x32_bf16 v[76:79], v[212:215], v[200:203], v[76:79]
    v_mfma_f32_16x16x32_bf16 v[76:79], v[168:171], v[156:159], v[76:79]
    v_mfma_f32_16x16x32_bf16 v[92:95], v[172:175], v[156:159], v[92:95]
    v_mfma_f32_16x16x32_bf16 v[92:95], v[216:219], v[200:203], v[92:95]
    v_mfma_f32_16x16x32_bf16 v[88:91], v[216:219], v[196:199], v[88:91]
    v_mfma_f32_16x16x32_bf16 v[88:91], v[172:175], v[152:155], v[88:91]
    v_mfma_f32_16x16x32_bf16 v[84:87], v[172:175], v[148:151], v[84:87]
    v_mfma_f32_16x16x32_bf16 v[84:87], v[216:219], v[192:195], v[84:87]
    v_mfma_f32_16x16x32_bf16 v[80:83], v[216:219], v[188:191], v[80:83]
    v_mfma_f32_16x16x32_bf16 v[80:83], v[172:175], v[144:147], v[80:83]
    v_mfma_f32_16x16x32_bf16 v[96:99], v[144:147], v[176:179], v[96:99]
    v_mfma_f32_16x16x32_bf16 v[96:99], v[188:191], v[220:223], v[96:99]
    v_mfma_f32_16x16x32_bf16 v[100:103], v[192:195], v[220:223], v[100:103]
    v_mfma_f32_16x16x32_bf16 v[100:103], v[148:151], v[176:179], v[100:103]
    v_mfma_f32_16x16x32_bf16 v[104:107], v[152:155], v[176:179], v[104:107]
    v_mfma_f32_16x16x32_bf16 v[104:107], v[196:199], v[220:223], v[104:107]
    v_mfma_f32_16x16x32_bf16 v[108:111], v[200:203], v[220:223], v[108:111]
    v_mfma_f32_16x16x32_bf16 v[108:111], v[156:159], v[176:179], v[108:111]
    v_mfma_f32_16x16x32_bf16 v[124:127], v[156:159], v[180:183], v[124:127]
    v_mfma_f32_16x16x32_bf16 v[124:127], v[200:203], v[224:227], v[124:127]
    v_mfma_f32_16x16x32_bf16 v[120:123], v[196:199], v[224:227], v[120:123]
    v_mfma_f32_16x16x32_bf16 v[120:123], v[152:155], v[180:183], v[120:123]
    v_mfma_f32_16x16x32_bf16 v[116:119], v[148:151], v[180:183], v[116:119]
    v_mfma_f32_16x16x32_bf16 v[116:119], v[192:195], v[224:227], v[116:119]
    v_mfma_f32_16x16x32_bf16 v[112:115], v[188:191], v[224:227], v[112:115]
    v_mfma_f32_16x16x32_bf16 v[112:115], v[144:147], v[180:183], v[112:115]
    s_barrier
    s_setprio 0
    s_setpc_b64 s[100:101]
    .p2align 6
L_sub_c0_3:
    s_setprio 1
    s_barrier
    v_mfma_f32_16x16x32_bf16 v[32:35], v[160:163], v[144:147], v[32:35]
    v_mfma_f32_16x16x32_bf16 v[32:35], v[204:207], v[188:191], v[32:35]
    v_mfma_f32_16x16x32_bf16 v[36:39], v[204:207], v[192:195], v[36:39]
    v_mfma_f32_16x16x32_bf16 v[36:39], v[160:163], v[148:151], v[36:39]
    v_mfma_f32_16x16x32_bf16 v[40:43], v[160:163], v[152:155], v[40:43]
    v_mfma_f32_16x16x32_bf16 v[40:43], v[204:207], v[196:199], v[40:43]
    v_mfma_f32_16x16x32_bf16 v[44:47], v[204:207], v[200:203], v[44:47]
    v_mfma_f32_16x16x32_bf16 v[44:47], v[160:163], v[156:159], v[44:47]
    v_mfma_f32_16x16x32_bf16 v[60:63], v[164:167], v[156:159], v[60:63]
    v_mfma_f32_16x16x32_bf16 v[60:63], v[208:211], v[200:203], v[60:63]
    v_mfma_f32_16x16x32_bf16 v[56:59], v[208:211], v[196:199], v[56:59]
    v_mfma_f32_16x16x32_bf16 v[56:59], v[164:167], v[152:155], v[56:59]
    v_mfma_f32_16x16x32_bf16 v[52:55], v[164:167], v[148:151], v[52:55]
    v_mfma_f32_16x16x32_bf16 v[52:55], v[208:211], v[192:195], v[52:55]
    v_mfma_f32_16x16x32_bf16 v[48:51], v[208:211], v[188:191], v[48:51]
    v_mfma_f32_16x16x32_bf16 v[48:51], v[164:167], v[144:147], v[48:51]
    v_mfma_f32_16x16x32_bf16 v[64:67], v[168:171], v[144:147], v[64:67]
    v_mfma_f32_16x16x32_bf16 v[64:67], v[212:215], v[188:191], v[64:67]
    v_mfma_f32_16x16x32_bf16 v[68:71], v[212:215], v[192:195], v[68:71]
    v_mfma_f32_16x16x32_bf16 v[68:71], v[168:171], v[148:151], v[68:71]
    v_mfma_f32_16x16x32_bf16 v[72:75], v[168:171], v[152:155], v[72:75]
    v_mfma_f32_16x16x32_bf16 v[72:75], v[212:215], v[196:199], v[72:75]
    v_mfma_f32_16x16x32_bf16 v[76:79], v[212:215], v[200:203], v[76:79]
    v_mfma_f32_16x16x32_bf16 v[76:79], v[168:171], v[156:159], v[76:79]
    v_mfma_f32_16x16x32_bf16 v[92:95], v[172:175], v[156:159], v[92:95]
    v_mfma_f32_16x16x32_bf16 v[92:95], v[216:219], v[200:203], v[92:95]
    v_mfma_f32_16x16x32_bf16 v[88:91], v[216:219], v[196:199], v[88:91]
    v_mfma_f32_16x16x32_bf16 v[88:91], v[172:175], v[152:155], v[88:91]
    v_mfma_f32_16x16x32_bf16 v[84:87], v[172:175], v[148:151], v[84:87]
    v_mfma_f32_16x16x32_bf16 v[84:87], v[216:219], v[192:195], v[84:87]
    v_mfma_f32_16x16x32_bf16 v[80:83], v[216:219], v[188:191], v[80:83]
    v_mfma_f32_16x16x32_bf16 v[80:83], v[172:175], v[144:147], v[80:83]
    v_mfma_f32_16x16x32_bf16 v[96:99], v[144:147], v[176:179], v[96:99]
    v_mfma_f32_16x16x32_bf16 v[96:99], v[188:191], v[220:223], v[96:99]
    v_mfma_f32_16x16x32_bf16 v[100:103], v[192:195], v[220:223], v[100:103]
    v_mfma_f32_16x16x32_bf16 v[100:103], v[148:151], v[176:179], v[100:103]
    v_mfma_f32_16x16x32_bf16 v[104:107], v[152:155], v[176:179], v[104:107]
    v_mfma_f32_16x16x32_bf16 v[104:107], v[196:199], v[220:223], v[104:107]
    v_mfma_f32_16x16x32_bf16 v[108:111], v[200:203], v[220:223], v[108:111]
    v_mfma_f32_16x16x32_bf16 v[108:111], v[156:159], v[176:179], v[108:111]
    v_mfma_f32_16x16x32_bf16 v[124:127], v[156:159], v[180:183], v[124:127]
    v_mfma_f32_16x16x32_bf16 v[124:127], v[200:203], v[224:227], v[124:127]
    v_mfma_f32_16x16x32_bf16 v[120:123], v[196:199], v[224:227], v[120:123]
    v_mfma_f32_16x16x32_bf16 v[120:123], v[152:155], v[180:183], v[120:123]
    v_mfma_f32_16x16x32_bf16 v[116:119], v[148:151], v[180:183], v[116:119]
    v_mfma_f32_16x16x32_bf16 v[116:119], v[192:195], v[224:227], v[116:119]
    v_mfma_f32_16x16x32_bf16 v[112:115], v[188:191], v[224:227], v[112:115]
    v_mfma_f32_16x16x32_bf16 v[112:115], v[144:147], v[180:183], v[112:115]
    s_setprio 0
    s_setpc_b64 s[100:101]
    .p2align 6
L_sub_c1_0:
    s_setprio 1
    s_barrier
    v_mfma_f32_16x16x32_bf16 v[32:35], v[160:163], v[144:147], v[32:35]
    v_mfma_f32_16x16x32_bf16 v[32:35], v[204:207], v[188:191], v[32:35]
    v_mfma_f32_16x16x32_bf16 v[36:39], v[204:207], v[192:195], v[36:39]
    v_mfma_f32_16x16x32_bf16 v[36:39], v[160:163], v[148:151], v[36:39]
    v_mfma_f32_16x16x32_bf16 v[40:43], v[160:163], v[152:155], v[40:43]
    v_mfma_f32_16x16x32_bf16 v[40:43], v[204:207], v[196:199], v[40:43]
    v_mfma_f32_16x16x32_bf16 v[44:47], v[204:207], v[200:203], v[44:47]
    v_mfma_f32_16x16x32_bf16 v[44:47], v[160:163], v[156:159], v[44:47]
    v_mfma_f32_16x16x32_bf16 v[60:63], v[164:167], v[156:159], v[60:63]
    v_mfma_f32_16x16x32_bf16 v[60:63], v[208:211], v[200:203], v[60:63]
    v_mfma_f32_16x16x32_bf16 v[56:59], v[208:211], v[196:199], v[56:59]
    v_mfma_f32_16x16x32_bf16 v[56:59], v[164:167], v[152:155], v[56:59]
    v_mfma_f32_16x16x32_bf16 v[52:55], v[164:167], v[148:151], v[52:55]
    v_mfma_f32_16x16x32_bf16 v[52:55], v[208:211], v[192:195], v[52:55]
    v_mfma_f32_16x16x32_bf16 v[48:51], v[208:211], v[188:191], v[48:51]
    v_mfma_f32_16x16x32_bf16 v[48:51], v[164:167], v[144:147], v[48:51]
    v_mfma_f32_16x16x32_bf16 v[64:67], v[168:171], v[144:147], v[64:67]
    v_mfma_f32_16x16x32_bf16 v[64:67], v[212:215], v[188:191], v[64:67]
    v_mfma_f32_16x16x32_bf16 v[68:71], v[212:215], v[192:195], v[68:71]
    v_mfma_f32_16x16x32_bf16 v[68:71], v[168:171], v[148:151], v[68:71]
    v_mfma_f32_16x16x32_bf16 v[72:75], v[168:171], v[152:155], v[72:75]
    v_mfma_f32_16x16x32_bf16 v[72:75], v[212:215], v[196:199], v[72:75]
    v_mfma_f32_16x16x32_bf16 v[76:79], v[212:215], v[200:203], v[76:79]
    v_mfma_f32_16x16x32_bf16 v[76:79], v[168:171], v[156:159], v[76:79]
    v_mfma_f32_16x16x32_bf16 v[92:95], v[172:175], v[156:159], v[92:95]
    v_mfma_f32_16x16x32_bf16 v[92:95], v[216:219], v[200:203], v[92:95]
    v_mfma_f32_16x16x32_bf16 v[88:91], v[216:219], v[196:199], v[88:91]
    v_mfma_f32_16x16x32_bf16 v[88:91], v[172:175], v[152:155], v[88:91]
    v_mfma_f32_16x16x32_bf16 v[84:87], v[172:175], v[148:151], v[84:87]
    v_mfma_f32_16x16x32_bf16 v[84:87], v[216:219], v[192:195], v[84:87]
    v_mfma_f32_16x16x32_bf16 v[80:83], v[216:219], v[188:191], v[80:83]
    v_mfma_f32_16x16x32_bf16 v[80:83], v[172:175], v[144:147], v[80:83]
    v_mfma_f32_16x16x32_bf16 v[96:99], v[176:179], v[144:147], v[96:99]
    v_mfma_f32_16x16x32_bf16 v[96:99], v[220:223], v[188:191], v[96:99]
    v_mfma_f32_16x16x32_bf16 v[100:103], v[220:223], v[192:195], v[100:103]
    v_mfma_f32_16x16x32_bf16 v[100:103], v[176:179], v[148:151], v[100:103]
    v_mfma_f32_16x16x32_bf16 v[104:107], v[176:179], v[152:155], v[104:107]
    v_mfma_f32_16x16x32_bf16 v[104:107], v[220:223], v[196:199], v[104:107]
    v_mfma_f32_16x16x32_bf16 v[108:111], v[220:223], v[200:203], v[108:111]
    v_mfma_f32_16x16x32_bf16 v[108:111], v[176:179], v[156:159], v[108:111]
    v_mfma_f32_16x16x32_bf16 v[124:127], v[180:183], v[156:159], v[124:127]
    v_mfma_f32_16x16x32_bf16 v[124:127], v[224:227], v[200:203], v[124:127]
    v_mfma_f32_16x16x32_bf16 v[120:123], v[224:227], v[196:199], v[120:123]
    v_mfma_f32_16x16x32_bf16 v[120:123], v[180:183], v[152:155], v[120:123]
    v_mfma_f32_16x16x32_bf16 v[116:119], v[180:183], v[148:151], v[116:119]
    v_mfma_f32_16x16x32_bf16 v[116:119], v[224:227], v[192:195], v[116:119]
    v_mfma_f32_16x16x32_bf16 v[112:115], v[224:227], v[188:191], v[112:115]
    v_mfma_f32_16x16x32_bf16 v[112:115], v[180:183], v[144:147], v[112:115]
    v_mfma_f32_16x16x32_bf16 v[128:131], v[184:187], v[144:147], v[128:131]
    v_mfma_f32_16x16x32_bf16 v[128:131], v[228:231], v[188:191], v[128:131]
    v_mfma_f32_16x16x32_bf16 v[132:135], v[228:231], v[192:195], v[132:135]
    v_mfma_f32_16x16x32_bf16 v[132:135], v[184:187], v[148:151], v[132:135]
    v_mfma_f32_16x16x32_bf16 v[136:139], v[184:187], v[152:155], v[136:139]
    v_mfma_f32_16x16x32_bf16 v[136:139], v[228:231], v[196:199], v[136:139]
    v_mfma_f32_16x16x32_bf16 v[140:143], v[228:231], v[200:203], v[140:143]
    v_mfma_f32_16x16x32_bf16 v[140:143], v[184:187], v[156:159], v[140:143]
    s_waitcnt vmcnt(4)
    s_barrier
    s_setprio 0
    s_setpc_b64 s[100:101]
    .p2align 6
L_sub_c1_1:
    s_setprio 1
    s_barrier
    v_mfma_f32_16x16x32_bf16 v[32:35], v[160:163], v[144:147], v[32:35]
    v_mfma_f32_16x16x32_bf16 v[32:35], v[204:207], v[188:191], v[32:35]
    v_mfma_f32_16x16x32_bf16 v[36:39], v[204:207], v[192:195], v[36:39]
    v_mfma_f32_16x16x32_bf16 v[36:39], v[160:163], v[148:151], v[36:39]
    v_mfma_f32_16x16x32_bf16 v[40:43], v[160:163], v[152:155], v[40:43]
    v_mfma_f32_16x16x32_bf16 v[40:43], v[204:207], v[196:199], v[40:43]
    v_mfma_f32_16x16x32_bf16 v[44:47], v[204:207], v[200:203], v[44:47]
    v_mfma_f32_16x16x32_bf16 v[44:47], v[160:163], v[156:159], v[44:47]
    v_mfma_f32_16x16x32_bf16 v[60:63], v[164:167], v[156:159], v[60:63]
    v_mfma_f32_16x16x32_bf16 v[60:63], v[208:211], v[200:203], v[60:63]
    v_mfma_f32_16x16x32_bf16 v[56:59], v[208:211], v[196:199], v[56:59]
    v_mfma_f32_16x16x32_bf16 v[56:59], v[164:167], v[152:155], v[56:59]
    v_mfma_f32_16x16x32_bf16 v[52:55], v[164:167], v[148:151], v[52:55]
    v_mfma_f32_16x16x32_bf16 v[52:55], v[208:211], v[192:195], v[52:55]
    v_mfma_f32_16x16x32_bf16 v[48:51], v[208:211], v[188:191], v[48:51]
    v_mfma_f32_16x16x32_bf16 v[48:51], v[164:167], v[144:147], v[48:51]
    v_mfma_f32_16x16x32_bf16 v[64:67], v[168:171], v[144:147], v[64:67]
    v_mfma_f32_16x16x32_bf16 v[64:67], v[212:215], v[188:191], v[64:67]
    v_mfma_f32_16x16x32_bf16 v[68:71], v[212:215], v[192:195], v[68:71]
    v_mfma_f32_16x16x32_bf16 v[68:71], v[168:171], v[148:151], v[68:71]
    v_mfma_f32_16x16x32_bf16 v[72:75], v[168:171], v[152:155], v[72:75]
    v_mfma_f32_16x16x32_bf16 v[72:75], v[212:215], v[196:199], v[72:75]
    v_mfma_f32_16x16x32_bf16 v[76:79], v[212:215], v[200:203], v[76:79]
    v_mfma_f32_16x16x32_bf16 v[76:79], v[168:171], v[156:159], v[76:79]
    v_mfma_f32_16x16x32_bf16 v[92:95], v[172:175], v[156:159], v[92:95]
    v_mfma_f32_16x16x32_bf16 v[92:95], v[216:219], v[200:203], v[92:95]
    v_mfma_f32_16x16x32_bf16 v[88:91], v[216:219], v[196:199], v[88:91]
    v_mfma_f32_16x16x32_bf16 v[88:91], v[172:175], v[152:155], v[88:91]
    v_mfma_f32_16x16x32_bf16 v[84:87], v[172:175], v[148:151], v[84:87]
    v_mfma_f32_16x16x32_bf16 v[84:87], v[216:219], v[192:195], v[84:87]
    v_mfma_f32_16x16x32_bf16 v[80:83], v[216:219], v[188:191], v[80:83]
    v_mfma_f32_16x16x32_bf16 v[80:83], v[172:175], v[144:147], v[80:83]
    v_mfma_f32_16x16x32_bf16 v[96:99], v[176:179], v[144:147], v[96:99]
    v_mfma_f32_16x16x32_bf16 v[96:99], v[220:223], v[188:191], v[96:99]
    v_mfma_f32_16x16x32_bf16 v[100:103], v[220:223], v[192:195], v[100:103]
    v_mfma_f32_16x16x32_bf16 v[100:103], v[176:179], v[148:151], v[100:103]
    v_mfma_f32_16x16x32_bf16 v[104:107], v[176:179], v[152:155], v[104:107]
    v_mfma_f32_16x16x32_bf16 v[104:107], v[220:223], v[196:199], v[104:107]
    v_mfma_f32_16x16x32_bf16 v[108:111], v[220:223], v[200:203], v[108:111]
    v_mfma_f32_16x16x32_bf16 v[108:111], v[176:179], v[156:159], v[108:111]
    v_mfma_f32_16x16x32_bf16 v[124:127], v[180:183], v[156:159], v[124:127]
    v_mfma_f32_16x16x32_bf16 v[124:127], v[224:227], v[200:203], v[124:127]
    v_mfma_f32_16x16x32_bf16 v[120:123], v[224:227], v[196:199], v[120:123]
    v_mfma_f32_16x16x32_bf16 v[120:123], v[180:183], v[152:155], v[120:123]
    v_mfma_f32_16x16x32_bf16 v[116:119], v[180:183], v[148:151], v[116:119]
    v_mfma_f32_16x16x32_bf16 v[116:119], v[224:227], v[192:195], v[116:119]
    v_mfma_f32_16x16x32_bf16 v[112:115], v[224:227], v[188:191], v[112:115]
    v_mfma_f32_16x16x32_bf16 v[112:115], v[180:183], v[144:147], v[112:115]
    v_mfma_f32_16x16x32_bf16 v[128:131], v[184:187], v[144:147], v[128:131]
    v_mfma_f32_16x16x32_bf16 v[128:131], v[228:231], v[188:191], v[128:131]
    v_mfma_f32_16x16x32_bf16 v[132:135], v[228:231], v[192:195], v[132:135]
    v_mfma_f32_16x16x32_bf16 v[132:135], v[184:187], v[148:151], v[132:135]
    v_mfma_f32_16x16x32_bf16 v[136:139], v[184:187], v[152:155], v[136:139]
    v_mfma_f32_16x16x32_bf16 v[136:139], v[228:231], v[196:199], v[136:139]
    v_mfma_f32_16x16x32_bf16 v[140:143], v[228:231], v[200:203], v[140:143]
    v_mfma_f32_16x16x32_bf16 v[140:143], v[184:187], v[156:159], v[140:143]
    s_waitcnt vmcnt(0)
    s_barrier
    s_setprio 0
    s_setpc_b64 s[100:101]
    .p2align 6
L_sub_c1_2:
    s_setprio 1
    s_barrier
    v_mfma_f32_16x16x32_bf16 v[32:35], v[160:163], v[144:147], v[32:35]
    v_mfma_f32_16x16x32_bf16 v[32:35], v[204:207], v[188:191], v[32:35]
    v_mfma_f32_16x16x32_bf16 v[36:39], v[204:207], v[192:195], v[36:39]
    v_mfma_f32_16x16x32_bf16 v[36:39], v[160:163], v[148:151], v[36:39]
    v_mfma_f32_16x16x32_bf16 v[40:43], v[160:163], v[152:155], v[40:43]
    v_mfma_f32_16x16x32_bf16 v[40:43], v[204:207], v[196:199], v[40:43]
    v_mfma_f32_16x16x32_bf16 v[44:47], v[204:207], v[200:203], v[44:47]
    v_mfma_f32_16x16x32_bf16 v[44:47], v[160:163], v[156:159], v[44:47]
    v_mfma_f32_16x16x32_bf16 v[60:63], v[164:167], v[156:159], v[60:63]
    v_mfma_f32_16x16x32_bf16 v[60:63], v[208:211], v[200:203], v[60:63]
    v_mfma_f32_16x16x32_bf16 v[56:59], v[208:211], v[196:199], v[56:59]
    v_mfma_f32_16x16x32_bf16 v[56:59], v[164:167], v[152:155], v[56:59]
    v_mfma_f32_16x16x32_bf16 v[52:55], v[164:167], v[148:151], v[52:55]
    v_mfma_f32_16x16x32_bf16 v[52:55], v[208:211], v[192:195], v[52:55]
    v_mfma_f32_16x16x32_bf16 v[48:51], v[208:211], v[188:191], v[48:51]
    v_mfma_f32_16x16x32_bf16 v[48:51], v[164:167], v[144:147], v[48:51]
    v_mfma_f32_16x16x32_bf16 v[64:67], v[168:171], v[144:147], v[64:67]
    v_mfma_f32_16x16x32_bf16 v[64:67], v[212:215], v[188:191], v[64:67]
    v_mfma_f32_16x16x32_bf16 v[68:71], v[212:215], v[192:195], v[68:71]
    v_mfma_f32_16x16x32_bf16 v[68:71], v[168:171], v[148:151], v[68:71]
    v_mfma_f32_16x16x32_bf16 v[72:75], v[168:171], v[152:155], v[72:75]
    v_mfma_f32_16x16x32_bf16 v[72:75], v[212:215], v[196:199], v[72:75]
    v_mfma_f32_16x16x32_bf16 v[76:79], v[212:215], v[200:203], v[76:79]
    v_mfma_f32_16x16x32_bf16 v[76:79], v[168:171], v[156:159], v[76:79]
    v_mfma_f32_16x16x32_bf16 v[92:95], v[172:175], v[156:159], v[92:95]
    v_mfma_f32_16x16x32_bf16 v[92:95], v[216:219], v[200:203], v[92:95]
    v_mfma_f32_16x16x32_bf16 v[88:91], v[216:219], v[196:199], v[88:91]
    v_mfma_f32_16x16x32_bf16 v[88:91], v[172:175], v[152:155], v[88:91]
    v_mfma_f32_16x16x32_bf16 v[84:87], v[172:175], v[148:151], v[84:87]
    v_mfma_f32_16x16x32_bf16 v[84:87], v[216:219], v[192:195], v[84:87]
    v_mfma_f32_16x16x32_bf16 v[80:83], v[216:219], v[188:191], v[80:83]
    v_mfma_f32_16x16x32_bf16 v[80:83], v[172:175], v[144:147], v[80:83]
    v_mfma_f32_16x16x32_bf16 v[96:99], v[176:179], v[144:147], v[96:99]
    v_mfma_f32_16x16x32_bf16 v[96:99], v[220:223], v[188:191], v[96:99]
    v_mfma_f32_16x16x32_bf16 v[100:103], v[220:223], v[192:195], v[100:103]
    v_mfma_f32_16x16x32_bf16 v[100:103], v[176:179], v[148:151], v[100:103]
    v_mfma_f32_16x16x32_bf16 v[104:107], v[176:179], v[152:155], v[104:107]
    v_mfma_f32_16x16x32_bf16 v[104:107], v[220:223], v[196:199], v[104:107]
    v_mfma_f32_16x16x32_bf16 v[108:111], v[220:223], v[200:203], v[108:111]
    v_mfma_f32_16x16x32_bf16 v[108:111], v[176:179], v[156:159], v[108:111]
    v_mfma_f32_16x16x32_bf16 v[124:127], v[180:183], v[156:159], v[124:127]
    v_mfma_f32_16x16x32_bf16 v[124:127], v[224:227], v[200:203], v[124:127]
    v_mfma_f32_16x16x32_bf16 v[120:123], v[224:227], v[196:199], v[120:123]
    v_mfma_f32_16x16x32_bf16 v[120:123], v[180:183], v[152:155], v[120:123]
    v_mfma_f32_16x16x32_bf16 v[116:119], v[180:183], v[148:151], v[116:119]
    v_mfma_f32_16x16x32_bf16 v[116:119], v[224:227], v[192:195], v[116:119]
    v_mfma_f32_16x16x32_bf16 v[112:115], v[224:227], v[188:191], v[112:115]
    v_mfma_f32_16x16x32_bf16 v[112:115], v[180:183], v[144:147], v[112:115]
    v_mfma_f32_16x16x32_bf16 v[128:131], v[184:187], v[144:147], v[128:131]
    v_mfma_f32_16x16x32_bf16 v[128:131], v[228:231], v[188:191], v[128:131]
    v_mfma_f32_16x16x32_bf16 v[132:135], v[228:231], v[192:195], v[132:135]
    v_mfma_f32_16x16x32_bf16 v[132:135], v[184:187], v[148:151], v[132:135]
    v_mfma_f32_16x16x32_bf16 v[136:139], v[184:187], v[152:155], v[136:139]
    v_mfma_f32_16x16x32_bf16 v[136:139], v[228:231], v[196:199], v[136:139]
    v_mfma_f32_16x16x32_bf16 v[140:143], v[228:231], v[200:203], v[140:143]
    v_mfma_f32_16x16x32_bf16 v[140:143], v[184:187], v[156:159], v[140:143]
    s_barrier
    s_setprio 0
    s_setpc_b64 s[100:101]
    .p2align 6
L_sub_c1_3:
    s_setprio 1
    s_barrier
    v_mfma_f32_16x16x32_bf16 v[32:35], v[160:163], v[144:147], v[32:35]
    v_mfma_f32_16x16x32_bf16 v[32:35], v[204:207], v[188:191], v[32:35]
    v_mfma_f32_16x16x32_bf16 v[36:39], v[204:207], v[192:195], v[36:39]
    v_mfma_f32_16x16x32_bf16 v[36:39], v[160:163], v[148:151], v[36:39]
    v_mfma_f32_16x16x32_bf16 v[40:43], v[160:163], v[152:155], v[40:43]
    v_mfma_f32_16x16x32_bf16 v[40:43], v[204:207], v[196:199], v[40:43]
    v_mfma_f32_16x16x32_bf16 v[44:47], v[204:207], v[200:203], v[44:47]
    v_mfma_f32_16x16x32_bf16 v[44:47], v[160:163], v[156:159], v[44:47]
    v_mfma_f32_16x16x32_bf16 v[60:63], v[164:167], v[156:159], v[60:63]
    v_mfma_f32_16x16x32_bf16 v[60:63], v[208:211], v[200:203], v[60:63]
    v_mfma_f32_16x16x32_bf16 v[56:59], v[208:211], v[196:199], v[56:59]
    v_mfma_f32_16x16x32_bf16 v[56:59], v[164:167], v[152:155], v[56:59]
    v_mfma_f32_16x16x32_bf16 v[52:55], v[164:167], v[148:151], v[52:55]
    v_mfma_f32_16x16x32_bf16 v[52:55], v[208:211], v[192:195], v[52:55]
    v_mfma_f32_16x16x32_bf16 v[48:51], v[208:211], v[188:191], v[48:51]
    v_mfma_f32_16x16x32_bf16 v[48:51], v[164:167], v[144:147], v[48:51]
    v_mfma_f32_16x16x32_bf16 v[64:67], v[168:171], v[144:147], v[64:67]
    v_mfma_f32_16x16x32_bf16 v[64:67], v[212:215], v[188:191], v[64:67]
    v_mfma_f32_16x16x32_bf16 v[68:71], v[212:215], v[192:195], v[68:71]
    v_mfma_f32_16x16x32_bf16 v[68:71], v[168:171], v[148:151], v[68:71]
    v_mfma_f32_16x16x32_bf16 v[72:75], v[168:171], v[152:155], v[72:75]
    v_mfma_f32_16x16x32_bf16 v[72:75], v[212:215], v[196:199], v[72:75]
    v_mfma_f32_16x16x32_bf16 v[76:79], v[212:215], v[200:203], v[76:79]
    v_mfma_f32_16x16x32_bf16 v[76:79], v[168:171], v[156:159], v[76:79]
    v_mfma_f32_16x16x32_bf16 v[92:95], v[172:175], v[156:159], v[92:95]
    v_mfma_f32_16x16x32_bf16 v[92:95], v[216:219], v[200:203], v[92:95]
    v_mfma_f32_16x16x32_bf16 v[88:91], v[216:219], v[196:199], v[88:91]
    v_mfma_f32_16x16x32_bf16 v[88:91], v[172:175], v[152:155], v[88:91]
    v_mfma_f32_16x16x32_bf16 v[84:87], v[172:175], v[148:151], v[84:87]
    v_mfma_f32_16x16x32_bf16 v[84:87], v[216:219], v[192:195], v[84:87]
    v_mfma_f32_16x16x32_bf16 v[80:83], v[216:219], v[188:191], v[80:83]
    v_mfma_f32_16x16x32_bf16 v[80:83], v[172:175], v[144:147], v[80:83]
    v_mfma_f32_16x16x32_bf16 v[96:99], v[176:179], v[144:147], v[96:99]
    v_mfma_f32_16x16x32_bf16 v[96:99], v[220:223], v[188:191], v[96:99]
    v_mfma_f32_16x16x32_bf16 v[100:103], v[220:223], v[192:195], v[100:103]
    v_mfma_f32_16x16x32_bf16 v[100:103], v[176:179], v[148:151], v[100:103]
    v_mfma_f32_16x16x32_bf16 v[104:107], v[176:179], v[152:155], v[104:107]
    v_mfma_f32_16x16x32_bf16 v[104:107], v[220:223], v[196:199], v[104:107]
    v_mfma_f32_16x16x32_bf16 v[108:111], v[220:223], v[200:203], v[108:111]
    v_mfma_f32_16x16x32_bf16 v[108:111], v[176:179], v[156:159], v[108:111]
    v_mfma_f32_16x16x32_bf16 v[124:127], v[180:183], v[156:159], v[124:127]
    v_mfma_f32_16x16x32_bf16 v[124:127], v[224:227], v[200:203], v[124:127]
    v_mfma_f32_16x16x32_bf16 v[120:123], v[224:227], v[196:199], v[120:123]
    v_mfma_f32_16x16x32_bf16 v[120:123], v[180:183], v[152:155], v[120:123]
    v_mfma_f32_16x16x32_bf16 v[116:119], v[180:183], v[148:151], v[116:119]
    v_mfma_f32_16x16x32_bf16 v[116:119], v[224:227], v[192:195], v[116:119]
    v_mfma_f32_16x16x32_bf16 v[112:115], v[224:227], v[188:191], v[112:115]
    v_mfma_f32_16x16x32_bf16 v[112:115], v[180:183], v[144:147], v[112:115]
    v_mfma_f32_16x16x32_bf16 v[128:131], v[184:187], v[144:147], v[128:131]
    v_mfma_f32_16x16x32_bf16 v[128:131], v[228:231], v[188:191], v[128:131]
    v_mfma_f32_16x16x32_bf16 v[132:135], v[228:231], v[192:195], v[132:135]
    v_mfma_f32_16x16x32_bf16 v[132:135], v[184:187], v[148:151], v[132:135]
    v_mfma_f32_16x16x32_bf16 v[136:139], v[184:187], v[152:155], v[136:139]
    v_mfma_f32_16x16x32_bf16 v[136:139], v[228:231], v[196:199], v[136:139]
    v_mfma_f32_16x16x32_bf16 v[140:143], v[228:231], v[200:203], v[140:143]
    v_mfma_f32_16x16x32_bf16 v[140:143], v[184:187], v[156:159], v[140:143]
    s_setprio 0
    s_setpc_b64 s[100:101]
L_code_end:
.section .rodata,"a"
.p2align 6
.amdhsa_kernel recurrent_scan__linear_kernel_hedgehog__dense_activation_mish__prompt_kernel
  .amdhsa_next_free_vgpr 256
  .amdhsa_next_free_sgpr 102
  .amdhsa_accum_offset 256
  .amdhsa_group_segment_fixed_size 0
  .amdhsa_kernarg_size 88
  .amdhsa_user_sgpr_count 2
  .amdhsa_user_sgpr_kernarg_segment_ptr 1
  .amdhsa_system_sgpr_workgroup_id_x 1
  .amdhsa_float_denorm_mode_32 3
  .amdhsa_float_denorm_mode_16_64 3
.end_amdhsa_kernel
```
